```python
import torch

def _softmax(x, axis=-1):
    return torch.softmax(x, dim=axis)
def _gelu(x):
    return torch.nn.functional.gelu(x, approximate="tanh")
def _silu(x):
    return torch.nn.functional.silu(x)
def _sigmoid(x):
    return torch.sigmoid(x)
def _layernorm(x, axis=-1, eps=1e-5):
    m = x.mean(dim=axis, keepdim=True)
    v = x.var(dim=axis, keepdim=True, unbiased=False)
    return (x - m) / torch.sqrt(v + eps)
def _scatter_add(tgt, idx, src, axis=0):
    return tgt.clone().index_add_(axis, idx, src)
def _segment_sum(src, seg, n):
    out = torch.zeros((n,) + src.shape[1:], dtype=src.dtype)
    return out.index_add_(0, seg, src)
def _pad(x, pw):
    flat = tuple(v for pair in reversed(pw) for v in pair)
    return torch.nn.functional.pad(x, flat)

kernel_name = 'gated_mix__compressed_kv_cla__linear_kernel_hedgehog__prompt'

def setup_inputs():

    _w = (lambda a: (lambda t: t.to(torch.bfloat16) if t.is_floating_point() else t)(torch.as_tensor(a)))
    def _A_setup():
        B, H, Sq, Sk, D, M = 1, 32, 2048, 2048, 128, 576
        Dc = 4 * D
        return {
            "x": _w((lambda *s: torch.randn(*s, dtype=torch.bfloat16) * 0.05)(B, Sq, M)),
            "c_kv": _w((lambda *s: torch.randn(*s, dtype=torch.bfloat16) * 0.4)(B, Sk, Dc)),
            "w_q": _w((lambda *s: torch.randn(*s, dtype=torch.bfloat16) * 6.4)(M, H, D) * (M ** -0.5)),
            "w_uk": _w((lambda *s: torch.randn(*s, dtype=torch.bfloat16) * 6.4)(Dc, H, D) * (Dc ** -0.5)),
            "w_uv": _w((lambda *s: torch.randn(*s, dtype=torch.bfloat16) * 0.4)(Dc, H, D) * (Dc ** -0.5)),
            "w_o": _w((lambda *s: torch.randn(*s, dtype=torch.bfloat16) * 0.4)(H, D, M) * ((H * D) ** -0.5)),
        }
    _A_in = _A_setup()

    def _B_setup():
        B, S, D, H = 1, 2048, 576, 32
        Dh = D // H
        return {
            "x": _w((lambda *s: torch.randn(*s, dtype=torch.bfloat16) * 0.05)(B, S, D)),
            "wqkv": _w((lambda *s: torch.randn(*s, dtype=torch.bfloat16) * 0.8)(D, 3 * D)),
            "w_phi": _w((lambda *s: torch.randn(*s, dtype=torch.bfloat16) * 0.8)(H, Dh, Dh) * (Dh ** -0.5)),
            "wo": _w((lambda *s: torch.randn(*s, dtype=torch.bfloat16) * 0.05)(D, D)),
        }
    _B_in = _B_setup()

    return {
        "A_x": _A_in["x"],
        "A_c_kv": _A_in["c_kv"],
        "A_w_q": _A_in["w_q"],
        "A_w_uk": _A_in["w_uk"],
        "A_w_uv": _A_in["w_uv"],
        "A_w_o": _A_in["w_o"],
        "B_x": _B_in["x"],
        "B_wqkv": _B_in["wqkv"],
        "B_w_phi": _B_in["w_phi"],
        "B_wo": _B_in["wo"],
        "gate_w": _w((lambda *s: torch.randn(*s, dtype=torch.bfloat16) * 0.05)(576) * 16.0),
    }

def reference(A_x, A_c_kv, A_w_q, A_w_uk, A_w_uv, A_w_o, B_x, B_wqkv, B_w_phi, B_wo, gate_w):
    def _A_ref(x, c_kv, w_q, w_uk, w_uv, w_o):
        B, Sq, M = x.shape[0], x.shape[1], x.shape[2]
        Sk = c_kv.shape[1]
        H, D = w_q.shape[1], w_q.shape[2]
        q = torch.einsum("bqm,mhd->bhqd", x, w_q)
        k = torch.einsum("bkc,chd->bhkd", c_kv, w_uk)
        v = torch.einsum("bkc,chd->bhkd", c_kv, w_uv)
        scores = torch.einsum("bhqd,bhkd->bhqk", q, k) * (D ** -0.5)
        off = Sk - Sq
        qi = torch.arange(Sq)[:, None]
        kj = torch.arange(Sk)[None, :]
        cmask = kj <= (qi + off)
        scores = torch.where(cmask[None, None], scores, -1e9)
        p = _softmax(scores, axis=-1)
        ctx = torch.einsum("bhqk,bhkd->bhqd", p, v)
        return torch.einsum("bhqd,hdm->bqm", ctx, w_o)

    def _B_ref(x, wqkv, w_phi, wo):
        B, S, D = x.shape
        H = 32; Dh = D // H
        qkv = (lambda x, *d: x.permute(*d))((x @ wqkv).reshape(B, S, 3, H, Dh), 2, 0, 3, 1, 4)
        q, k, v = qkv[0], qkv[1], qkv[2]
        pq = torch.einsum("bhsd,hdf->bhsf", q, w_phi)
        pk = torch.einsum("bhsd,hdf->bhsf", k, w_phi)
        phi_q = torch.concatenate([_softmax(pq, axis=-1), _softmax(-pq, axis=-1)], axis=-1)
        phi_k = torch.concatenate([_softmax(pk, axis=-1), _softmax(-pk, axis=-1)], axis=-1)
        kv = torch.einsum("bhsf,bhsd->bhfd", phi_k, v)
        z  = torch.einsum("bhsf->bhf", phi_k)
        num = torch.einsum("bhqf,bhfd->bhqd", phi_q, kv)
        den = torch.einsum("bhqf,bhf->bhq", phi_q, z)[..., None] + 1e-6
        o = num / den
        return (lambda x, *d: x.permute(*d))(o, 0, 2, 1, 3).reshape(B, S, D) @ wo

    x = A_x
    g = _sigmoid((x * gate_w).sum(-1, keepdims=True))
    a = _A_ref(x, A_c_kv, A_w_q, A_w_uk, A_w_uv, A_w_o)
    b = _B_ref(x, B_wqkv, B_w_phi, B_wo)
    return g * a + (1 - g) * b
```

```asm
; @launch grid=(256,1,1) block=(512,1,1) lds=163840
.amdgcn_target "amdgcn-amd-amdhsa--gfx950"
.text
.globl gated_mix__compressed_kv_cla__linear_kernel_hedgehog__prompt_kernel
.p2align 8
.type gated_mix__compressed_kv_cla__linear_kernel_hedgehog__prompt_kernel,@function
gated_mix__compressed_kv_cla__linear_kernel_hedgehog__prompt_kernel:
    s_cmp_ge_u32 s2, 256
    s_cbranch_scc1 F_END
    s_load_dwordx16 s[16:31], s[0:1], 0
    s_load_dwordx8 s[32:39], s[0:1], 64
    s_load_dwordx4 s[40:43], s[0:1], 96
    s_and_b32 s3, s2, 7
    s_lshr_b32 s6, s2, 6
    s_lshl_b32 s6, s6, 3
    s_add_u32 s3, s3, s6
    s_lshr_b32 s4, s2, 3
    s_and_b32 s4, s4, 7
    s_and_b32 s3, s2, 7
    s_lshl_b32 s3, s3, 2
    s_lshr_b32 s6, s2, 6
    s_add_u32 s3, s3, s6
    v_lshrrev_b32 v20, 6, v0
    v_and_b32 v1, 63, v0
    v_readfirstlane_b32 s5, v20
    s_lshr_b32 s10, s2, 3
    s_lshl_b32 s10, s10, 13
    s_getpc_b64 s[12:13]
F_PC:
    s_mov_b32 s14, F_COLD-F_PC
    s_mov_b32 s15, 0x00020000
    s_cmp_lg_u32 s5, 7
    s_cselect_b32 s10, s14, s10
    v_lshlrev_b32 v24, 7, v1
    s_cmp_ge_u32 s10, s14
    s_cbranch_scc1 F_NCT
    buffer_load_dword v31, v24, s[12:15], s10 offen
F_NCT:
    s_and_b32 s54, s5, 3
    v_lshrrev_b32 v20, 3, v1
    s_xor_b32 s6, s4, 7
    s_lshl_b32 s6, s6, 8
    s_lshl_b32 s8, s5, 5
    s_add_u32 s6, s6, s8
    v_add_u32 v20, s6, v20
    v_lshrrev_b32 v21, 4, v1
    v_and_b32 v22, 7, v1
    v_xor_b32 v22, v21, v22
    v_lshlrev_b32 v22, 4, v22
    v_lshl_add_u32 v13, v20, 10, v22
    v_xor_b32 v14, 64, v13
    s_lshl_b32 s6, s54, 3
    v_add_u32 v20, s6, v21
    s_and_b32 s6, s54, 1
    s_lshl_b32 s6, s6, 2
    v_add_u32 v22, s6, v21
    v_lshlrev_b32 v22, 1, v22
    v_and_b32 v23, 15, v1
    v_xor_b32 v22, v22, v23
    v_lshlrev_b32 v22, 4, v22
    v_lshl_add_u32 v3, v20, 13, v22
    s_lshl_b32 s6, s3, 8
    v_add_u32 v3, s6, v3
    s_lshl_b32 s80, s5, 12
    s_lshl_b32 s96, s5, 11
    s_waitcnt lgkmcnt(0)
    s_mov_b32 s56, s18
    s_mov_b32 s57, s19
    s_mov_b32 s58, 2097152
    s_mov_b32 s59, 0x00020000
    s_cmp_lt_u32 s5, 4
    s_cselect_b32 s60, s22, s24
    s_cselect_b32 s61, s23, s25
    s_mov_b32 s62, 4194304
    s_mov_b32 s63, 0x00020000
    s_add_u32 m0, s96, 98304
    s_mov_b32 s53, 0
    buffer_load_dwordx4 v3, s[60:63], s53 offen offset:0 lds
    s_mov_b32 s53, 31744
    buffer_load_dwordx4 v3, s[60:63], s53 offen offset:1024 lds
    s_add_u32 m0, s80, 0
    s_mov_b32 s53, 0
    buffer_load_dwordx4 v13, s[56:59], s53 offen offset:0 lds
    s_mov_b32 s53, 7168
    buffer_load_dwordx4 v14, s[56:59], s53 offen offset:1024 lds
    s_mov_b32 s53, 14336
    buffer_load_dwordx4 v13, s[56:59], s53 offen offset:2048 lds
    s_mov_b32 s53, 21504
    buffer_load_dwordx4 v14, s[56:59], s53 offen offset:3072 lds
    s_add_u32 m0, s96, 114688
    s_mov_b32 s53, 262144
    buffer_load_dwordx4 v3, s[60:63], s53 offen offset:0 lds
    s_mov_b32 s53, 293888
    buffer_load_dwordx4 v3, s[60:63], s53 offen offset:1024 lds
    s_barrier
    s_add_u32 m0, s80, 32768
    s_mov_b32 s53, 128
    buffer_load_dwordx4 v13, s[56:59], s53 offen offset:0 lds
    s_mov_b32 s53, 7296
    buffer_load_dwordx4 v14, s[56:59], s53 offen offset:1024 lds
    s_mov_b32 s53, 14464
    buffer_load_dwordx4 v13, s[56:59], s53 offen offset:2048 lds
    s_mov_b32 s53, 21632
    buffer_load_dwordx4 v14, s[56:59], s53 offen offset:3072 lds
    s_add_u32 m0, s96, 131072
    s_mov_b32 s53, 524288
    buffer_load_dwordx4 v3, s[60:63], s53 offen offset:0 lds
    s_mov_b32 s53, 556032
    buffer_load_dwordx4 v3, s[60:63], s53 offen offset:1024 lds
    s_add_u32 m0, s96, 147456
    s_mov_b32 s53, 786432
    buffer_load_dwordx4 v3, s[60:63], s53 offen offset:0 lds
    s_mov_b32 s53, 818176
    buffer_load_dwordx4 v3, s[60:63], s53 offen offset:1024 lds
    s_add_u32 m0, s80, 65536
    s_mov_b32 s53, 256
    buffer_load_dwordx4 v13, s[56:59], s53 offen offset:0 lds
    s_mov_b32 s53, 7424
    buffer_load_dwordx4 v14, s[56:59], s53 offen offset:1024 lds
    s_mov_b32 s53, 14592
    buffer_load_dwordx4 v13, s[56:59], s53 offen offset:2048 lds
    s_mov_b32 s53, 21760
    buffer_load_dwordx4 v14, s[56:59], s53 offen offset:3072 lds
    s_mov_b32 s15, 0x00020000
    s_mov_b32 s64, s16
    s_mov_b32 s65, s17
    s_mov_b32 s66, 2359296
    s_mov_b32 s67, 0x00020000
    s_mov_b32 s68, s30
    s_mov_b32 s69, s31
    s_mov_b32 s70, 1990656
    s_mov_b32 s71, 0x00020000
    s_mov_b32 s72, s36
    s_mov_b32 s73, s37
    s_mov_b32 s74, 1152
    s_mov_b32 s75, 0x00020000
    s_mov_b32 s44, s42
    s_mov_b32 s45, s43
    s_mov_b32 s46, 268435456
    s_mov_b32 s47, 0x00020000
    s_mov_b32 s48, s40
    s_mov_b32 s49, s41
    s_mov_b32 s50, 256
    s_mov_b32 s51, 0x00020000
    s_mov_b32 s92, s20
    s_mov_b32 s93, s21
    s_mov_b32 s94, 4718592
    s_mov_b32 s95, 0x00020000
    s_mov_b32 s52, 0x40000000
    v_lshlrev_b32 v2, 4, v1
    s_lshl_b32 s6, s2, 7
    s_add_u32 s6, s6, 83886080
    s_cmp_ge_u32 s2, 72
    s_cselect_b32 s6, s52, s6
    s_cmp_lg_u32 s5, 7
    s_cbranch_scc1 F_NCL
    v_mov_b32 v22, 0
    v_lshrrev_b32 v20, 2, v2
    s_mov_b32 exec_hi, 0
    buffer_store_dword v22, v20, s[44:47], s6 offen sc1
    s_mov_b64 exec, -1
F_NCL:
    v_and_b32 v20, 15, v1
    v_lshrrev_b32 v22, 1, v20
    v_xor_b32 v22, v22, v21
    s_lshl_b32 s6, s54, 6
    v_add_u32 v20, s6, v20
    v_lshlrev_b32 v20, 7, v20
    v_lshl_add_u32 v15, v22, 4, v20
    v_xor_b32 v16, 64, v15
    v_add_u32 v17, 0x10000, v15
    v_add_u32 v18, 0x10000, v16
    v_bfe_u32 v20, v1, 2, 2
    v_lshl_add_u32 v22, v21, 3, v20
    v_lshlrev_b32 v22, 8, v22
    v_and_b32 v23, 1, v21
    v_lshl_add_u32 v20, v23, 2, v20
    v_lshl_add_u32 v22, v20, 5, v22
    v_and_b32 v20, 3, v1
    v_lshl_add_u32 v22, v20, 3, v22
    s_lshr_b32 s6, s5, 2
    s_lshl_b32 s6, s6, 13
    s_add_u32 s6, s6, 98304
    v_add_u32 v4, s6, v22
    v_xor_b32 v5, 32, v4
    v_xor_b32 v6, 64, v4
    v_xor_b32 v7, 96, v4
    v_xor_b32 v8, 128, v4
    v_xor_b32 v9, 160, v4
    v_xor_b32 v10, 192, v4
    v_xor_b32 v11, 224, v4
    s_lshr_b32 s6, s5, 2
    s_lshl_b32 s6, s6, 24
    s_lshl_b32 s8, s3, 19
    s_add_u32 s6, s6, s8
    s_xor_b32 s8, s4, 7
    s_lshl_b32 s8, s8, 2
    s_add_u32 s8, s8, s54
    s_lshl_b32 s8, s8, 14
    s_add_u32 s82, s6, s8
    s_add_u32 s83, s82, 4096
    s_add_u32 s84, s82, 8192
    s_add_u32 s85, s82, 12288
    s_sub_u32 s6, 15, s4
    s_cmp_lt_u32 s5, 4
    s_cselect_b32 s6, s4, s6
    s_lshl_b32 s6, s6, 7
    s_lshl_b32 s8, s54, 5
    s_add_u32 s7, s6, s8
    s_lshl_b32 s97, s5, 10
    s_mul_i32 s6, s3, 73728
    s_add_u32 s6, s6, s97
    s_add_u32 s98, s6, 79691776
    s_lshr_b32 s6, s7, 4
    s_mul_i32 s6, s6, 18432
    s_add_u32 s99, s6, 75497472
    s_cmp_ge_u32 s5, 4
    s_cbranch_scc1 F_B
    s_mov_b32 s64, s24
    s_mov_b32 s65, s25
    s_mov_b32 s66, 4194304
    s_mov_b32 s67, 0x00020000
    s_waitcnt vmcnt(14)
    s_barrier
    ds_read_b128 v[56:59], v15 offset:0
    ds_read_b128 v[60:63], v15 offset:2048
    ds_read_b128 v[64:67], v15 offset:4096
    ds_read_b128 v[68:71], v15 offset:6144
    ds_read_b64_tr_b16 v[32:33], v4 offset:0
    ds_read_b64_tr_b16 v[34:35], v4 offset:1024
    ds_read_b64_tr_b16 v[36:37], v5 offset:0
    ds_read_b64_tr_b16 v[38:39], v5 offset:1024
    ds_read_b64_tr_b16 v[40:41], v6 offset:0
    ds_read_b64_tr_b16 v[42:43], v6 offset:1024
    ds_read_b64_tr_b16 v[44:45], v7 offset:0
    ds_read_b64_tr_b16 v[46:47], v7 offset:1024
    s_waitcnt lgkmcnt(6)
    v_mfma_f32_16x16x32_bf16 v[128:131], v[32:35], v[56:59], 0
    ds_read_b64_tr_b16 v[48:49], v8 offset:0
    v_mfma_f32_16x16x32_bf16 v[132:135], v[32:35], v[60:63], 0
    ds_read_b64_tr_b16 v[50:51], v8 offset:1024
    v_mfma_f32_16x16x32_bf16 v[136:139], v[32:35], v[64:67], 0
    v_mfma_f32_16x16x32_bf16 v[140:143], v[32:35], v[68:71], 0
    s_waitcnt lgkmcnt(6)
    v_mfma_f32_16x16x32_bf16 v[144:147], v[36:39], v[56:59], 0
    ds_read_b64_tr_b16 v[52:53], v9 offset:0
    v_mfma_f32_16x16x32_bf16 v[148:151], v[36:39], v[60:63], 0
    ds_read_b64_tr_b16 v[54:55], v9 offset:1024
    v_mfma_f32_16x16x32_bf16 v[152:155], v[36:39], v[64:67], 0
    v_mfma_f32_16x16x32_bf16 v[156:159], v[36:39], v[68:71], 0
    s_waitcnt lgkmcnt(6)
    v_mfma_f32_16x16x32_bf16 v[160:163], v[40:43], v[56:59], 0
    ds_read_b64_tr_b16 v[32:33], v10 offset:0
    v_mfma_f32_16x16x32_bf16 v[164:167], v[40:43], v[60:63], 0
    ds_read_b64_tr_b16 v[34:35], v10 offset:1024
    v_mfma_f32_16x16x32_bf16 v[168:171], v[40:43], v[64:67], 0
    v_mfma_f32_16x16x32_bf16 v[172:175], v[40:43], v[68:71], 0
    s_waitcnt lgkmcnt(6)
    v_mfma_f32_16x16x32_bf16 v[176:179], v[44:47], v[56:59], 0
    ds_read_b64_tr_b16 v[36:37], v11 offset:0
    v_mfma_f32_16x16x32_bf16 v[180:183], v[44:47], v[60:63], 0
    ds_read_b64_tr_b16 v[38:39], v11 offset:1024
    v_mfma_f32_16x16x32_bf16 v[184:187], v[44:47], v[64:67], 0
    v_mfma_f32_16x16x32_bf16 v[188:191], v[44:47], v[68:71], 0
    s_waitcnt lgkmcnt(6)
    v_mfma_f32_16x16x32_bf16 v[192:195], v[48:51], v[56:59], 0
    s_waitcnt vmcnt(12)
    s_barrier
    ds_read_b64_tr_b16 v[40:41], v4 offset:16384
    v_mfma_f32_16x16x32_bf16 v[196:199], v[48:51], v[60:63], 0
    ds_read_b64_tr_b16 v[42:43], v4 offset:17408
    v_mfma_f32_16x16x32_bf16 v[200:203], v[48:51], v[64:67], 0
    ds_read_b128 v[72:75], v16 offset:0
    v_mfma_f32_16x16x32_bf16 v[204:207], v[48:51], v[68:71], 0
    s_waitcnt lgkmcnt(7)
    v_mfma_f32_16x16x32_bf16 v[208:211], v[52:55], v[56:59], 0
    ds_read_b64_tr_b16 v[44:45], v5 offset:16384
    v_mfma_f32_16x16x32_bf16 v[212:215], v[52:55], v[60:63], 0
    ds_read_b64_tr_b16 v[46:47], v5 offset:17408
    v_mfma_f32_16x16x32_bf16 v[216:219], v[52:55], v[64:67], 0
    ds_read_b128 v[76:79], v16 offset:2048
    v_mfma_f32_16x16x32_bf16 v[220:223], v[52:55], v[68:71], 0
    s_waitcnt lgkmcnt(8)
    v_mfma_f32_16x16x32_bf16 v[224:227], v[32:35], v[56:59], 0
    ds_read_b64_tr_b16 v[48:49], v6 offset:16384
    v_mfma_f32_16x16x32_bf16 v[228:231], v[32:35], v[60:63], 0
    ds_read_b64_tr_b16 v[50:51], v6 offset:17408
    v_mfma_f32_16x16x32_bf16 v[232:235], v[32:35], v[64:67], 0
    ds_read_b128 v[80:83], v16 offset:4096
    v_mfma_f32_16x16x32_bf16 v[236:239], v[32:35], v[68:71], 0
    s_waitcnt lgkmcnt(9)
    v_mfma_f32_16x16x32_bf16 v[240:243], v[36:39], v[56:59], 0
    ds_read_b64_tr_b16 v[52:53], v7 offset:16384
    v_mfma_f32_16x16x32_bf16 v[244:247], v[36:39], v[60:63], 0
    ds_read_b64_tr_b16 v[54:55], v7 offset:17408
    v_mfma_f32_16x16x32_bf16 v[248:251], v[36:39], v[64:67], 0
    ds_read_b128 v[84:87], v16 offset:6144
    v_mfma_f32_16x16x32_bf16 v[252:255], v[36:39], v[68:71], 0
    s_waitcnt lgkmcnt(9)
    v_mfma_f32_16x16x32_bf16 v[128:131], v[40:43], v[72:75], v[128:131]
    ds_read_b64_tr_b16 v[32:33], v8 offset:16384
    s_waitcnt lgkmcnt(7)
    v_mfma_f32_16x16x32_bf16 v[132:135], v[40:43], v[76:79], v[132:135]
    ds_read_b64_tr_b16 v[34:35], v8 offset:17408
    s_waitcnt lgkmcnt(5)
    v_mfma_f32_16x16x32_bf16 v[136:139], v[40:43], v[80:83], v[136:139]
    s_waitcnt lgkmcnt(2)
    v_mfma_f32_16x16x32_bf16 v[140:143], v[40:43], v[84:87], v[140:143]
    v_mfma_f32_16x16x32_bf16 v[144:147], v[44:47], v[72:75], v[144:147]
    ds_read_b64_tr_b16 v[36:37], v9 offset:16384
    v_mfma_f32_16x16x32_bf16 v[148:151], v[44:47], v[76:79], v[148:151]
    ds_read_b64_tr_b16 v[38:39], v9 offset:17408
    v_mfma_f32_16x16x32_bf16 v[152:155], v[44:47], v[80:83], v[152:155]
    v_mfma_f32_16x16x32_bf16 v[156:159], v[44:47], v[84:87], v[156:159]
    v_mfma_f32_16x16x32_bf16 v[160:163], v[48:51], v[72:75], v[160:163]
    ds_read_b64_tr_b16 v[40:41], v10 offset:16384
    v_mfma_f32_16x16x32_bf16 v[164:167], v[48:51], v[76:79], v[164:167]
    ds_read_b64_tr_b16 v[42:43], v10 offset:17408
    v_mfma_f32_16x16x32_bf16 v[168:171], v[48:51], v[80:83], v[168:171]
    v_mfma_f32_16x16x32_bf16 v[172:175], v[48:51], v[84:87], v[172:175]
    v_mfma_f32_16x16x32_bf16 v[176:179], v[52:55], v[72:75], v[176:179]
    ds_read_b64_tr_b16 v[44:45], v11 offset:16384
    v_mfma_f32_16x16x32_bf16 v[180:183], v[52:55], v[76:79], v[180:183]
    ds_read_b64_tr_b16 v[46:47], v11 offset:17408
    v_mfma_f32_16x16x32_bf16 v[184:187], v[52:55], v[80:83], v[184:187]
    v_mfma_f32_16x16x32_bf16 v[188:191], v[52:55], v[84:87], v[188:191]
    s_waitcnt lgkmcnt(6)
    v_mfma_f32_16x16x32_bf16 v[192:195], v[32:35], v[72:75], v[192:195]
    s_waitcnt vmcnt(6)
    s_barrier
    ds_read_b64_tr_b16 v[48:49], v4 offset:32768
    v_mfma_f32_16x16x32_bf16 v[196:199], v[32:35], v[76:79], v[196:199]
    ds_read_b64_tr_b16 v[50:51], v4 offset:33792
    s_add_u32 m0, s96, 98304
    s_mov_b32 s53, 1048576
    buffer_load_dwordx4 v3, s[60:63], s53 offen offset:0 lds
    v_mfma_f32_16x16x32_bf16 v[200:203], v[32:35], v[80:83], v[200:203]
    ds_read_b128 v[56:59], v15 offset:32768
    v_mfma_f32_16x16x32_bf16 v[204:207], v[32:35], v[84:87], v[204:207]
    s_mov_b32 s53, 1080320
    buffer_load_dwordx4 v3, s[60:63], s53 offen offset:1024 lds
    s_waitcnt lgkmcnt(7)
    v_mfma_f32_16x16x32_bf16 v[208:211], v[36:39], v[72:75], v[208:211]
    ds_read_b64_tr_b16 v[52:53], v5 offset:32768
    v_mfma_f32_16x16x32_bf16 v[212:215], v[36:39], v[76:79], v[212:215]
    ds_read_b64_tr_b16 v[54:55], v5 offset:33792
    s_add_u32 m0, s96, 106496
    s_mov_b32 s53, 1048576
    buffer_load_dwordx4 v3, s[64:67], s53 offen offset:0 lds
    v_mfma_f32_16x16x32_bf16 v[216:219], v[36:39], v[80:83], v[216:219]
    ds_read_b128 v[60:63], v15 offset:34816
    v_mfma_f32_16x16x32_bf16 v[220:223], v[36:39], v[84:87], v[220:223]
    s_mov_b32 s53, 1080320
    buffer_load_dwordx4 v3, s[64:67], s53 offen offset:1024 lds
    s_waitcnt lgkmcnt(8)
    v_mfma_f32_16x16x32_bf16 v[224:227], v[40:43], v[72:75], v[224:227]
    ds_read_b64_tr_b16 v[32:33], v6 offset:32768
    v_mfma_f32_16x16x32_bf16 v[228:231], v[40:43], v[76:79], v[228:231]
    ds_read_b64_tr_b16 v[34:35], v6 offset:33792
    v_mfma_f32_16x16x32_bf16 v[232:235], v[40:43], v[80:83], v[232:235]
    ds_read_b128 v[64:67], v15 offset:36864
    v_mfma_f32_16x16x32_bf16 v[236:239], v[40:43], v[84:87], v[236:239]
    s_waitcnt lgkmcnt(9)
    v_mfma_f32_16x16x32_bf16 v[240:243], v[44:47], v[72:75], v[240:243]
    ds_read_b64_tr_b16 v[36:37], v7 offset:32768
    v_mfma_f32_16x16x32_bf16 v[244:247], v[44:47], v[76:79], v[244:247]
    ds_read_b64_tr_b16 v[38:39], v7 offset:33792
    v_mfma_f32_16x16x32_bf16 v[248:251], v[44:47], v[80:83], v[248:251]
    ds_read_b128 v[68:71], v15 offset:38912
    v_mfma_f32_16x16x32_bf16 v[252:255], v[44:47], v[84:87], v[252:255]
    s_waitcnt lgkmcnt(9)
    v_mfma_f32_16x16x32_bf16 v[128:131], v[48:51], v[56:59], v[128:131]
    ds_read_b64_tr_b16 v[40:41], v8 offset:32768
    s_waitcnt lgkmcnt(7)
    v_mfma_f32_16x16x32_bf16 v[132:135], v[48:51], v[60:63], v[132:135]
    ds_read_b64_tr_b16 v[42:43], v8 offset:33792
    s_waitcnt lgkmcnt(5)
    v_mfma_f32_16x16x32_bf16 v[136:139], v[48:51], v[64:67], v[136:139]
    s_waitcnt lgkmcnt(2)
    v_mfma_f32_16x16x32_bf16 v[140:143], v[48:51], v[68:71], v[140:143]
    v_mfma_f32_16x16x32_bf16 v[144:147], v[52:55], v[56:59], v[144:147]
    ds_read_b64_tr_b16 v[44:45], v9 offset:32768
    v_mfma_f32_16x16x32_bf16 v[148:151], v[52:55], v[60:63], v[148:151]
    ds_read_b64_tr_b16 v[46:47], v9 offset:33792
    v_mfma_f32_16x16x32_bf16 v[152:155], v[52:55], v[64:67], v[152:155]
    v_mfma_f32_16x16x32_bf16 v[156:159], v[52:55], v[68:71], v[156:159]
    v_mfma_f32_16x16x32_bf16 v[160:163], v[32:35], v[56:59], v[160:163]
    ds_read_b64_tr_b16 v[48:49], v10 offset:32768
    v_mfma_f32_16x16x32_bf16 v[164:167], v[32:35], v[60:63], v[164:167]
    ds_read_b64_tr_b16 v[50:51], v10 offset:33792
    v_mfma_f32_16x16x32_bf16 v[168:171], v[32:35], v[64:67], v[168:171]
    v_mfma_f32_16x16x32_bf16 v[172:175], v[32:35], v[68:71], v[172:175]
    v_mfma_f32_16x16x32_bf16 v[176:179], v[36:39], v[56:59], v[176:179]
    ds_read_b64_tr_b16 v[52:53], v11 offset:32768
    v_mfma_f32_16x16x32_bf16 v[180:183], v[36:39], v[60:63], v[180:183]
    ds_read_b64_tr_b16 v[54:55], v11 offset:33792
    v_mfma_f32_16x16x32_bf16 v[184:187], v[36:39], v[64:67], v[184:187]
    v_mfma_f32_16x16x32_bf16 v[188:191], v[36:39], v[68:71], v[188:191]
    s_waitcnt lgkmcnt(6)
    v_mfma_f32_16x16x32_bf16 v[192:195], v[40:43], v[56:59], v[192:195]
    s_waitcnt vmcnt(8)
    s_barrier
    ds_read_b64_tr_b16 v[32:33], v4 offset:49152
    v_mfma_f32_16x16x32_bf16 v[196:199], v[40:43], v[60:63], v[196:199]
    ds_read_b64_tr_b16 v[34:35], v4 offset:50176
    s_add_u32 m0, s96, 114688
    s_mov_b32 s53, 1310720
    buffer_load_dwordx4 v3, s[60:63], s53 offen offset:0 lds
    v_mfma_f32_16x16x32_bf16 v[200:203], v[40:43], v[64:67], v[200:203]
    ds_read_b128 v[72:75], v16 offset:32768
    s_mov_b32 s53, 1342464
    buffer_load_dwordx4 v3, s[60:63], s53 offen offset:1024 lds
    v_mfma_f32_16x16x32_bf16 v[204:207], v[40:43], v[68:71], v[204:207]
    s_add_u32 m0, s96, 122880
    s_mov_b32 s53, 1310720
    buffer_load_dwordx4 v3, s[64:67], s53 offen offset:0 lds
    s_waitcnt lgkmcnt(7)
    v_mfma_f32_16x16x32_bf16 v[208:211], v[44:47], v[56:59], v[208:211]
    ds_read_b64_tr_b16 v[36:37], v5 offset:49152
    s_mov_b32 s53, 1342464
    buffer_load_dwordx4 v3, s[64:67], s53 offen offset:1024 lds
    v_mfma_f32_16x16x32_bf16 v[212:215], v[44:47], v[60:63], v[212:215]
    ds_read_b64_tr_b16 v[38:39], v5 offset:50176
    s_add_u32 m0, s80, 0
    s_mov_b32 s53, 384
    buffer_load_dwordx4 v13, s[56:59], s53 offen offset:0 lds
    v_mfma_f32_16x16x32_bf16 v[216:219], v[44:47], v[64:67], v[216:219]
    ds_read_b128 v[76:79], v16 offset:34816
    s_mov_b32 s53, 7552
    buffer_load_dwordx4 v14, s[56:59], s53 offen offset:1024 lds
    v_mfma_f32_16x16x32_bf16 v[220:223], v[44:47], v[68:71], v[220:223]
    s_mov_b32 s53, 14720
    buffer_load_dwordx4 v13, s[56:59], s53 offen offset:2048 lds
    s_waitcnt lgkmcnt(8)
    v_mfma_f32_16x16x32_bf16 v[224:227], v[48:51], v[56:59], v[224:227]
    ds_read_b64_tr_b16 v[40:41], v6 offset:49152
    s_mov_b32 s53, 21888
    buffer_load_dwordx4 v14, s[56:59], s53 offen offset:3072 lds
    v_mfma_f32_16x16x32_bf16 v[228:231], v[48:51], v[60:63], v[228:231]
    ds_read_b64_tr_b16 v[42:43], v6 offset:50176
    s_add_u32 m0, s80, 16384
    s_mov_b32 s53, 131456
    buffer_load_dwordx4 v13, s[56:59], s53 offen offset:0 lds
    v_mfma_f32_16x16x32_bf16 v[232:235], v[48:51], v[64:67], v[232:235]
    ds_read_b128 v[80:83], v16 offset:36864
    s_mov_b32 s53, 138624
    buffer_load_dwordx4 v14, s[56:59], s53 offen offset:1024 lds
    v_mfma_f32_16x16x32_bf16 v[236:239], v[48:51], v[68:71], v[236:239]
    s_mov_b32 s53, 145792
    buffer_load_dwordx4 v13, s[56:59], s53 offen offset:2048 lds
    s_waitcnt lgkmcnt(9)
    v_mfma_f32_16x16x32_bf16 v[240:243], v[52:55], v[56:59], v[240:243]
    ds_read_b64_tr_b16 v[44:45], v7 offset:49152
    s_mov_b32 s53, 152960
    buffer_load_dwordx4 v14, s[56:59], s53 offen offset:3072 lds
    v_mfma_f32_16x16x32_bf16 v[244:247], v[52:55], v[60:63], v[244:247]
    ds_read_b64_tr_b16 v[46:47], v7 offset:50176
    v_mfma_f32_16x16x32_bf16 v[248:251], v[52:55], v[64:67], v[248:251]
    ds_read_b128 v[84:87], v16 offset:38912
    v_mfma_f32_16x16x32_bf16 v[252:255], v[52:55], v[68:71], v[252:255]
    s_waitcnt lgkmcnt(9)
    v_mfma_f32_16x16x32_bf16 v[128:131], v[32:35], v[72:75], v[128:131]
    ds_read_b64_tr_b16 v[48:49], v8 offset:49152
    s_waitcnt lgkmcnt(7)
    v_mfma_f32_16x16x32_bf16 v[132:135], v[32:35], v[76:79], v[132:135]
    ds_read_b64_tr_b16 v[50:51], v8 offset:50176
    s_waitcnt lgkmcnt(5)
    v_mfma_f32_16x16x32_bf16 v[136:139], v[32:35], v[80:83], v[136:139]
    s_waitcnt lgkmcnt(2)
    v_mfma_f32_16x16x32_bf16 v[140:143], v[32:35], v[84:87], v[140:143]
    v_mfma_f32_16x16x32_bf16 v[144:147], v[36:39], v[72:75], v[144:147]
    ds_read_b64_tr_b16 v[52:53], v9 offset:49152
    v_mfma_f32_16x16x32_bf16 v[148:151], v[36:39], v[76:79], v[148:151]
    ds_read_b64_tr_b16 v[54:55], v9 offset:50176
    v_mfma_f32_16x16x32_bf16 v[152:155], v[36:39], v[80:83], v[152:155]
    v_mfma_f32_16x16x32_bf16 v[156:159], v[36:39], v[84:87], v[156:159]
    v_mfma_f32_16x16x32_bf16 v[160:163], v[40:43], v[72:75], v[160:163]
    ds_read_b64_tr_b16 v[32:33], v10 offset:49152
    v_mfma_f32_16x16x32_bf16 v[164:167], v[40:43], v[76:79], v[164:167]
    ds_read_b64_tr_b16 v[34:35], v10 offset:50176
    v_mfma_f32_16x16x32_bf16 v[168:171], v[40:43], v[80:83], v[168:171]
    v_mfma_f32_16x16x32_bf16 v[172:175], v[40:43], v[84:87], v[172:175]
    v_mfma_f32_16x16x32_bf16 v[176:179], v[44:47], v[72:75], v[176:179]
    ds_read_b64_tr_b16 v[36:37], v11 offset:49152
    v_mfma_f32_16x16x32_bf16 v[180:183], v[44:47], v[76:79], v[180:183]
    ds_read_b64_tr_b16 v[38:39], v11 offset:50176
    v_mfma_f32_16x16x32_bf16 v[184:187], v[44:47], v[80:83], v[184:187]
    v_mfma_f32_16x16x32_bf16 v[188:191], v[44:47], v[84:87], v[188:191]
    s_waitcnt lgkmcnt(6)
    v_mfma_f32_16x16x32_bf16 v[192:195], v[48:51], v[72:75], v[192:195]
    s_waitcnt vmcnt(12)
    s_barrier
    ds_read_b64_tr_b16 v[40:41], v4 offset:0
    v_mfma_f32_16x16x32_bf16 v[196:199], v[48:51], v[76:79], v[196:199]
    ds_read_b64_tr_b16 v[42:43], v4 offset:1024
    s_add_u32 m0, s96, 131072
    s_mov_b32 s53, 1572864
    buffer_load_dwordx4 v3, s[60:63], s53 offen offset:0 lds
    v_mfma_f32_16x16x32_bf16 v[200:203], v[48:51], v[80:83], v[200:203]
    ds_read_b128 v[56:59], v17 offset:0
    v_mfma_f32_16x16x32_bf16 v[204:207], v[48:51], v[84:87], v[204:207]
    s_mov_b32 s53, 1604608
    buffer_load_dwordx4 v3, s[60:63], s53 offen offset:1024 lds
    s_waitcnt lgkmcnt(7)
    v_mfma_f32_16x16x32_bf16 v[208:211], v[52:55], v[72:75], v[208:211]
    ds_read_b64_tr_b16 v[44:45], v5 offset:0
    v_mfma_f32_16x16x32_bf16 v[212:215], v[52:55], v[76:79], v[212:215]
    ds_read_b64_tr_b16 v[46:47], v5 offset:1024
    s_add_u32 m0, s96, 139264
    s_mov_b32 s53, 1572864
    buffer_load_dwordx4 v3, s[64:67], s53 offen offset:0 lds
    v_mfma_f32_16x16x32_bf16 v[216:219], v[52:55], v[80:83], v[216:219]
    ds_read_b128 v[60:63], v17 offset:2048
    v_mfma_f32_16x16x32_bf16 v[220:223], v[52:55], v[84:87], v[220:223]
    s_mov_b32 s53, 1604608
    buffer_load_dwordx4 v3, s[64:67], s53 offen offset:1024 lds
    s_waitcnt lgkmcnt(8)
    v_mfma_f32_16x16x32_bf16 v[224:227], v[32:35], v[72:75], v[224:227]
    ds_read_b64_tr_b16 v[48:49], v6 offset:0
    v_mfma_f32_16x16x32_bf16 v[228:231], v[32:35], v[76:79], v[228:231]
    ds_read_b64_tr_b16 v[50:51], v6 offset:1024
    v_mfma_f32_16x16x32_bf16 v[232:235], v[32:35], v[80:83], v[232:235]
    ds_read_b128 v[64:67], v17 offset:4096
    v_mfma_f32_16x16x32_bf16 v[236:239], v[32:35], v[84:87], v[236:239]
    s_waitcnt lgkmcnt(9)
    v_mfma_f32_16x16x32_bf16 v[240:243], v[36:39], v[72:75], v[240:243]
    ds_read_b64_tr_b16 v[52:53], v7 offset:0
    v_mfma_f32_16x16x32_bf16 v[244:247], v[36:39], v[76:79], v[244:247]
    ds_read_b64_tr_b16 v[54:55], v7 offset:1024
    v_mfma_f32_16x16x32_bf16 v[248:251], v[36:39], v[80:83], v[248:251]
    ds_read_b128 v[68:71], v17 offset:6144
    v_mfma_f32_16x16x32_bf16 v[252:255], v[36:39], v[84:87], v[252:255]
    s_waitcnt lgkmcnt(9)
    v_mfma_f32_16x16x32_bf16 v[128:131], v[40:43], v[56:59], v[128:131]
    ds_read_b64_tr_b16 v[32:33], v8 offset:0
    s_waitcnt lgkmcnt(7)
    v_mfma_f32_16x16x32_bf16 v[132:135], v[40:43], v[60:63], v[132:135]
    ds_read_b64_tr_b16 v[34:35], v8 offset:1024
    s_waitcnt lgkmcnt(5)
    v_mfma_f32_16x16x32_bf16 v[136:139], v[40:43], v[64:67], v[136:139]
    s_waitcnt lgkmcnt(2)
    v_mfma_f32_16x16x32_bf16 v[140:143], v[40:43], v[68:71], v[140:143]
    v_mfma_f32_16x16x32_bf16 v[144:147], v[44:47], v[56:59], v[144:147]
    ds_read_b64_tr_b16 v[36:37], v9 offset:0
    v_mfma_f32_16x16x32_bf16 v[148:151], v[44:47], v[60:63], v[148:151]
    ds_read_b64_tr_b16 v[38:39], v9 offset:1024
    v_mfma_f32_16x16x32_bf16 v[152:155], v[44:47], v[64:67], v[152:155]
    v_mfma_f32_16x16x32_bf16 v[156:159], v[44:47], v[68:71], v[156:159]
    v_mfma_f32_16x16x32_bf16 v[160:163], v[48:51], v[56:59], v[160:163]
    ds_read_b64_tr_b16 v[40:41], v10 offset:0
    v_mfma_f32_16x16x32_bf16 v[164:167], v[48:51], v[60:63], v[164:167]
    ds_read_b64_tr_b16 v[42:43], v10 offset:1024
    v_mfma_f32_16x16x32_bf16 v[168:171], v[48:51], v[64:67], v[168:171]
    v_mfma_f32_16x16x32_bf16 v[172:175], v[48:51], v[68:71], v[172:175]
    v_mfma_f32_16x16x32_bf16 v[176:179], v[52:55], v[56:59], v[176:179]
    ds_read_b64_tr_b16 v[44:45], v11 offset:0
    v_mfma_f32_16x16x32_bf16 v[180:183], v[52:55], v[60:63], v[180:183]
    ds_read_b64_tr_b16 v[46:47], v11 offset:1024
    v_mfma_f32_16x16x32_bf16 v[184:187], v[52:55], v[64:67], v[184:187]
    v_mfma_f32_16x16x32_bf16 v[188:191], v[52:55], v[68:71], v[188:191]
    s_waitcnt lgkmcnt(6)
    v_mfma_f32_16x16x32_bf16 v[192:195], v[32:35], v[56:59], v[192:195]
    s_waitcnt vmcnt(12)
    s_barrier
    ds_read_b64_tr_b16 v[48:49], v4 offset:16384
    v_mfma_f32_16x16x32_bf16 v[196:199], v[32:35], v[60:63], v[196:199]
    ds_read_b64_tr_b16 v[50:51], v4 offset:17408
    s_add_u32 m0, s96, 147456
    s_mov_b32 s53, 1835008
    buffer_load_dwordx4 v3, s[60:63], s53 offen offset:0 lds
    v_mfma_f32_16x16x32_bf16 v[200:203], v[32:35], v[64:67], v[200:203]
    ds_read_b128 v[72:75], v18 offset:0
    s_mov_b32 s53, 1866752
    buffer_load_dwordx4 v3, s[60:63], s53 offen offset:1024 lds
    v_mfma_f32_16x16x32_bf16 v[204:207], v[32:35], v[68:71], v[204:207]
    s_add_u32 m0, s96, 155648
    s_mov_b32 s53, 1835008
    buffer_load_dwordx4 v3, s[64:67], s53 offen offset:0 lds
    s_waitcnt lgkmcnt(7)
    v_mfma_f32_16x16x32_bf16 v[208:211], v[36:39], v[56:59], v[208:211]
    ds_read_b64_tr_b16 v[52:53], v5 offset:16384
    s_mov_b32 s53, 1866752
    buffer_load_dwordx4 v3, s[64:67], s53 offen offset:1024 lds
    v_mfma_f32_16x16x32_bf16 v[212:215], v[36:39], v[60:63], v[212:215]
    ds_read_b64_tr_b16 v[54:55], v5 offset:17408
    s_add_u32 m0, s80, 32768
    s_mov_b32 s53, 512
    buffer_load_dwordx4 v13, s[56:59], s53 offen offset:0 lds
    v_mfma_f32_16x16x32_bf16 v[216:219], v[36:39], v[64:67], v[216:219]
    ds_read_b128 v[76:79], v18 offset:2048
    s_mov_b32 s53, 7680
    buffer_load_dwordx4 v14, s[56:59], s53 offen offset:1024 lds
    v_mfma_f32_16x16x32_bf16 v[220:223], v[36:39], v[68:71], v[220:223]
    s_mov_b32 s53, 14848
    buffer_load_dwordx4 v13, s[56:59], s53 offen offset:2048 lds
    s_waitcnt lgkmcnt(8)
    v_mfma_f32_16x16x32_bf16 v[224:227], v[40:43], v[56:59], v[224:227]
    ds_read_b64_tr_b16 v[32:33], v6 offset:16384
    s_mov_b32 s53, 22016
    buffer_load_dwordx4 v14, s[56:59], s53 offen offset:3072 lds
    v_mfma_f32_16x16x32_bf16 v[228:231], v[40:43], v[60:63], v[228:231]
    ds_read_b64_tr_b16 v[34:35], v6 offset:17408
    s_add_u32 m0, s80, 49152
    s_mov_b32 s53, 131584
    buffer_load_dwordx4 v13, s[56:59], s53 offen offset:0 lds
    v_mfma_f32_16x16x32_bf16 v[232:235], v[40:43], v[64:67], v[232:235]
    ds_read_b128 v[80:83], v18 offset:4096
    s_mov_b32 s53, 138752
    buffer_load_dwordx4 v14, s[56:59], s53 offen offset:1024 lds
    v_mfma_f32_16x16x32_bf16 v[236:239], v[40:43], v[68:71], v[236:239]
    s_mov_b32 s53, 145920
    buffer_load_dwordx4 v13, s[56:59], s53 offen offset:2048 lds
    s_waitcnt lgkmcnt(9)
    v_mfma_f32_16x16x32_bf16 v[240:243], v[44:47], v[56:59], v[240:243]
    ds_read_b64_tr_b16 v[36:37], v7 offset:16384
    s_mov_b32 s53, 153088
    buffer_load_dwordx4 v14, s[56:59], s53 offen offset:3072 lds
    v_mfma_f32_16x16x32_bf16 v[244:247], v[44:47], v[60:63], v[244:247]
    ds_read_b64_tr_b16 v[38:39], v7 offset:17408
    v_mfma_f32_16x16x32_bf16 v[248:251], v[44:47], v[64:67], v[248:251]
    ds_read_b128 v[84:87], v18 offset:6144
    v_mfma_f32_16x16x32_bf16 v[252:255], v[44:47], v[68:71], v[252:255]
    s_waitcnt lgkmcnt(9)
    v_mfma_f32_16x16x32_bf16 v[128:131], v[48:51], v[72:75], v[128:131]
    ds_read_b64_tr_b16 v[40:41], v8 offset:16384
    s_waitcnt lgkmcnt(7)
    v_mfma_f32_16x16x32_bf16 v[132:135], v[48:51], v[76:79], v[132:135]
    ds_read_b64_tr_b16 v[42:43], v8 offset:17408
    s_waitcnt lgkmcnt(5)
    v_mfma_f32_16x16x32_bf16 v[136:139], v[48:51], v[80:83], v[136:139]
    s_waitcnt lgkmcnt(2)
    v_mfma_f32_16x16x32_bf16 v[140:143], v[48:51], v[84:87], v[140:143]
    v_mfma_f32_16x16x32_bf16 v[144:147], v[52:55], v[72:75], v[144:147]
    ds_read_b64_tr_b16 v[44:45], v9 offset:16384
    v_mfma_f32_16x16x32_bf16 v[148:151], v[52:55], v[76:79], v[148:151]
    ds_read_b64_tr_b16 v[46:47], v9 offset:17408
    v_mfma_f32_16x16x32_bf16 v[152:155], v[52:55], v[80:83], v[152:155]
    v_mfma_f32_16x16x32_bf16 v[156:159], v[52:55], v[84:87], v[156:159]
    v_mfma_f32_16x16x32_bf16 v[160:163], v[32:35], v[72:75], v[160:163]
    ds_read_b64_tr_b16 v[48:49], v10 offset:16384
    v_mfma_f32_16x16x32_bf16 v[164:167], v[32:35], v[76:79], v[164:167]
    ds_read_b64_tr_b16 v[50:51], v10 offset:17408
    v_mfma_f32_16x16x32_bf16 v[168:171], v[32:35], v[80:83], v[168:171]
    v_mfma_f32_16x16x32_bf16 v[172:175], v[32:35], v[84:87], v[172:175]
    v_mfma_f32_16x16x32_bf16 v[176:179], v[36:39], v[72:75], v[176:179]
    ds_read_b64_tr_b16 v[52:53], v11 offset:16384
    v_mfma_f32_16x16x32_bf16 v[180:183], v[36:39], v[76:79], v[180:183]
    ds_read_b64_tr_b16 v[54:55], v11 offset:17408
    v_mfma_f32_16x16x32_bf16 v[184:187], v[36:39], v[80:83], v[184:187]
    v_mfma_f32_16x16x32_bf16 v[188:191], v[36:39], v[84:87], v[188:191]
    s_waitcnt lgkmcnt(6)
    v_mfma_f32_16x16x32_bf16 v[192:195], v[40:43], v[72:75], v[192:195]
    s_waitcnt vmcnt(12)
    s_barrier
    ds_read_b64_tr_b16 v[32:33], v4 offset:32768
    v_mfma_f32_16x16x32_bf16 v[196:199], v[40:43], v[76:79], v[196:199]
    ds_read_b64_tr_b16 v[34:35], v4 offset:33792
    s_add_u32 m0, s96, 98304
    s_mov_b32 s53, 2097152
    buffer_load_dwordx4 v3, s[60:63], s53 offen offset:0 lds
    v_mfma_f32_16x16x32_bf16 v[200:203], v[40:43], v[80:83], v[200:203]
    ds_read_b128 v[56:59], v15 offset:0
    v_mfma_f32_16x16x32_bf16 v[204:207], v[40:43], v[84:87], v[204:207]
    s_mov_b32 s53, 2128896
    buffer_load_dwordx4 v3, s[60:63], s53 offen offset:1024 lds
    s_waitcnt lgkmcnt(7)
    v_mfma_f32_16x16x32_bf16 v[208:211], v[44:47], v[72:75], v[208:211]
    ds_read_b64_tr_b16 v[36:37], v5 offset:32768
    v_mfma_f32_16x16x32_bf16 v[212:215], v[44:47], v[76:79], v[212:215]
    ds_read_b64_tr_b16 v[38:39], v5 offset:33792
    s_add_u32 m0, s96, 106496
    s_mov_b32 s53, 2097152
    buffer_load_dwordx4 v3, s[64:67], s53 offen offset:0 lds
    v_mfma_f32_16x16x32_bf16 v[216:219], v[44:47], v[80:83], v[216:219]
    ds_read_b128 v[60:63], v15 offset:2048
    v_mfma_f32_16x16x32_bf16 v[220:223], v[44:47], v[84:87], v[220:223]
    s_mov_b32 s53, 2128896
    buffer_load_dwordx4 v3, s[64:67], s53 offen offset:1024 lds
    s_waitcnt lgkmcnt(8)
    v_mfma_f32_16x16x32_bf16 v[224:227], v[48:51], v[72:75], v[224:227]
    ds_read_b64_tr_b16 v[40:41], v6 offset:32768
    v_mfma_f32_16x16x32_bf16 v[228:231], v[48:51], v[76:79], v[228:231]
    ds_read_b64_tr_b16 v[42:43], v6 offset:33792
    v_mfma_f32_16x16x32_bf16 v[232:235], v[48:51], v[80:83], v[232:235]
    ds_read_b128 v[64:67], v15 offset:4096
    v_mfma_f32_16x16x32_bf16 v[236:239], v[48:51], v[84:87], v[236:239]
    s_waitcnt lgkmcnt(9)
    v_mfma_f32_16x16x32_bf16 v[240:243], v[52:55], v[72:75], v[240:243]
    ds_read_b64_tr_b16 v[44:45], v7 offset:32768
    v_mfma_f32_16x16x32_bf16 v[244:247], v[52:55], v[76:79], v[244:247]
    ds_read_b64_tr_b16 v[46:47], v7 offset:33792
    v_mfma_f32_16x16x32_bf16 v[248:251], v[52:55], v[80:83], v[248:251]
    ds_read_b128 v[68:71], v15 offset:6144
    v_mfma_f32_16x16x32_bf16 v[252:255], v[52:55], v[84:87], v[252:255]
    s_waitcnt lgkmcnt(9)
    v_mfma_f32_16x16x32_bf16 v[128:131], v[32:35], v[56:59], v[128:131]
    ds_read_b64_tr_b16 v[48:49], v8 offset:32768
    s_waitcnt lgkmcnt(7)
    v_mfma_f32_16x16x32_bf16 v[132:135], v[32:35], v[60:63], v[132:135]
    ds_read_b64_tr_b16 v[50:51], v8 offset:33792
    s_waitcnt lgkmcnt(5)
    v_mfma_f32_16x16x32_bf16 v[136:139], v[32:35], v[64:67], v[136:139]
    s_waitcnt lgkmcnt(2)
    v_mfma_f32_16x16x32_bf16 v[140:143], v[32:35], v[68:71], v[140:143]
    v_mfma_f32_16x16x32_bf16 v[144:147], v[36:39], v[56:59], v[144:147]
    ds_read_b64_tr_b16 v[52:53], v9 offset:32768
    v_mfma_f32_16x16x32_bf16 v[148:151], v[36:39], v[60:63], v[148:151]
    ds_read_b64_tr_b16 v[54:55], v9 offset:33792
    v_mfma_f32_16x16x32_bf16 v[152:155], v[36:39], v[64:67], v[152:155]
    v_mfma_f32_16x16x32_bf16 v[156:159], v[36:39], v[68:71], v[156:159]
    v_mfma_f32_16x16x32_bf16 v[160:163], v[40:43], v[56:59], v[160:163]
    ds_read_b64_tr_b16 v[32:33], v10 offset:32768
    v_mfma_f32_16x16x32_bf16 v[164:167], v[40:43], v[60:63], v[164:167]
    ds_read_b64_tr_b16 v[34:35], v10 offset:33792
    v_mfma_f32_16x16x32_bf16 v[168:171], v[40:43], v[64:67], v[168:171]
    v_mfma_f32_16x16x32_bf16 v[172:175], v[40:43], v[68:71], v[172:175]
    v_mfma_f32_16x16x32_bf16 v[176:179], v[44:47], v[56:59], v[176:179]
    ds_read_b64_tr_b16 v[36:37], v11 offset:32768
    v_mfma_f32_16x16x32_bf16 v[180:183], v[44:47], v[60:63], v[180:183]
    ds_read_b64_tr_b16 v[38:39], v11 offset:33792
    v_mfma_f32_16x16x32_bf16 v[184:187], v[44:47], v[64:67], v[184:187]
    v_mfma_f32_16x16x32_bf16 v[188:191], v[44:47], v[68:71], v[188:191]
    s_waitcnt lgkmcnt(6)
    v_mfma_f32_16x16x32_bf16 v[192:195], v[48:51], v[56:59], v[192:195]
    s_waitcnt vmcnt(12)
    s_barrier
    ds_read_b64_tr_b16 v[40:41], v4 offset:49152
    v_mfma_f32_16x16x32_bf16 v[196:199], v[48:51], v[60:63], v[196:199]
    ds_read_b64_tr_b16 v[42:43], v4 offset:50176
    s_add_u32 m0, s96, 114688
    s_mov_b32 s53, 2359296
    buffer_load_dwordx4 v3, s[60:63], s53 offen offset:0 lds
    v_mfma_f32_16x16x32_bf16 v[200:203], v[48:51], v[64:67], v[200:203]
    ds_read_b128 v[72:75], v16 offset:0
    s_mov_b32 s53, 2391040
    buffer_load_dwordx4 v3, s[60:63], s53 offen offset:1024 lds
    v_mfma_f32_16x16x32_bf16 v[204:207], v[48:51], v[68:71], v[204:207]
    s_add_u32 m0, s96, 122880
    s_mov_b32 s53, 2359296
    buffer_load_dwordx4 v3, s[64:67], s53 offen offset:0 lds
    s_waitcnt lgkmcnt(7)
    v_mfma_f32_16x16x32_bf16 v[208:211], v[52:55], v[56:59], v[208:211]
    ds_read_b64_tr_b16 v[44:45], v5 offset:49152
    s_mov_b32 s53, 2391040
    buffer_load_dwordx4 v3, s[64:67], s53 offen offset:1024 lds
    v_mfma_f32_16x16x32_bf16 v[212:215], v[52:55], v[60:63], v[212:215]
    ds_read_b64_tr_b16 v[46:47], v5 offset:50176
    s_add_u32 m0, s80, 65536
    s_mov_b32 s53, 640
    buffer_load_dwordx4 v13, s[56:59], s53 offen offset:0 lds
    v_mfma_f32_16x16x32_bf16 v[216:219], v[52:55], v[64:67], v[216:219]
    ds_read_b128 v[76:79], v16 offset:2048
    s_mov_b32 s53, 7808
    buffer_load_dwordx4 v14, s[56:59], s53 offen offset:1024 lds
    v_mfma_f32_16x16x32_bf16 v[220:223], v[52:55], v[68:71], v[220:223]
    s_mov_b32 s53, 14976
    buffer_load_dwordx4 v13, s[56:59], s53 offen offset:2048 lds
    s_waitcnt lgkmcnt(8)
    v_mfma_f32_16x16x32_bf16 v[224:227], v[32:35], v[56:59], v[224:227]
    ds_read_b64_tr_b16 v[48:49], v6 offset:49152
    s_mov_b32 s53, 22144
    buffer_load_dwordx4 v14, s[56:59], s53 offen offset:3072 lds
    v_mfma_f32_16x16x32_bf16 v[228:231], v[32:35], v[60:63], v[228:231]
    ds_read_b64_tr_b16 v[50:51], v6 offset:50176
    s_add_u32 m0, s80, 81920
    s_mov_b32 s53, 131712
    buffer_load_dwordx4 v13, s[56:59], s53 offen offset:0 lds
    v_mfma_f32_16x16x32_bf16 v[232:235], v[32:35], v[64:67], v[232:235]
    ds_read_b128 v[80:83], v16 offset:4096
    s_mov_b32 s53, 138880
    buffer_load_dwordx4 v14, s[56:59], s53 offen offset:1024 lds
    v_mfma_f32_16x16x32_bf16 v[236:239], v[32:35], v[68:71], v[236:239]
    s_mov_b32 s53, 146048
    buffer_load_dwordx4 v13, s[56:59], s53 offen offset:2048 lds
    s_waitcnt lgkmcnt(9)
    v_mfma_f32_16x16x32_bf16 v[240:243], v[36:39], v[56:59], v[240:243]
    ds_read_b64_tr_b16 v[52:53], v7 offset:49152
    s_mov_b32 s53, 153216
    buffer_load_dwordx4 v14, s[56:59], s53 offen offset:3072 lds
    v_mfma_f32_16x16x32_bf16 v[244:247], v[36:39], v[60:63], v[244:247]
    ds_read_b64_tr_b16 v[54:55], v7 offset:50176
    v_mfma_f32_16x16x32_bf16 v[248:251], v[36:39], v[64:67], v[248:251]
    ds_read_b128 v[84:87], v16 offset:6144
    v_mfma_f32_16x16x32_bf16 v[252:255], v[36:39], v[68:71], v[252:255]
    s_waitcnt lgkmcnt(9)
    v_mfma_f32_16x16x32_bf16 v[128:131], v[40:43], v[72:75], v[128:131]
    ds_read_b64_tr_b16 v[32:33], v8 offset:49152
    s_waitcnt lgkmcnt(7)
    v_mfma_f32_16x16x32_bf16 v[132:135], v[40:43], v[76:79], v[132:135]
    ds_read_b64_tr_b16 v[34:35], v8 offset:50176
    s_waitcnt lgkmcnt(5)
    v_mfma_f32_16x16x32_bf16 v[136:139], v[40:43], v[80:83], v[136:139]
    s_waitcnt lgkmcnt(2)
    v_mfma_f32_16x16x32_bf16 v[140:143], v[40:43], v[84:87], v[140:143]
    v_mfma_f32_16x16x32_bf16 v[144:147], v[44:47], v[72:75], v[144:147]
    ds_read_b64_tr_b16 v[36:37], v9 offset:49152
    v_mfma_f32_16x16x32_bf16 v[148:151], v[44:47], v[76:79], v[148:151]
    ds_read_b64_tr_b16 v[38:39], v9 offset:50176
    v_mfma_f32_16x16x32_bf16 v[152:155], v[44:47], v[80:83], v[152:155]
    v_mfma_f32_16x16x32_bf16 v[156:159], v[44:47], v[84:87], v[156:159]
    v_mfma_f32_16x16x32_bf16 v[160:163], v[48:51], v[72:75], v[160:163]
    ds_read_b64_tr_b16 v[40:41], v10 offset:49152
    v_mfma_f32_16x16x32_bf16 v[164:167], v[48:51], v[76:79], v[164:167]
    ds_read_b64_tr_b16 v[42:43], v10 offset:50176
    v_mfma_f32_16x16x32_bf16 v[168:171], v[48:51], v[80:83], v[168:171]
    v_mfma_f32_16x16x32_bf16 v[172:175], v[48:51], v[84:87], v[172:175]
    v_mfma_f32_16x16x32_bf16 v[176:179], v[52:55], v[72:75], v[176:179]
    ds_read_b64_tr_b16 v[44:45], v11 offset:49152
    v_mfma_f32_16x16x32_bf16 v[180:183], v[52:55], v[76:79], v[180:183]
    ds_read_b64_tr_b16 v[46:47], v11 offset:50176
    v_mfma_f32_16x16x32_bf16 v[184:187], v[52:55], v[80:83], v[184:187]
    v_mfma_f32_16x16x32_bf16 v[188:191], v[52:55], v[84:87], v[188:191]
    s_waitcnt lgkmcnt(6)
    v_mfma_f32_16x16x32_bf16 v[192:195], v[32:35], v[72:75], v[192:195]
    s_waitcnt vmcnt(12)
    s_barrier
    ds_read_b64_tr_b16 v[48:49], v4 offset:0
    v_mfma_f32_16x16x32_bf16 v[196:199], v[32:35], v[76:79], v[196:199]
    ds_read_b64_tr_b16 v[50:51], v4 offset:1024
    s_add_u32 m0, s96, 131072
    s_mov_b32 s53, 2621440
    buffer_load_dwordx4 v3, s[60:63], s53 offen offset:0 lds
    v_mfma_f32_16x16x32_bf16 v[200:203], v[32:35], v[80:83], v[200:203]
    ds_read_b128 v[56:59], v15 offset:32768
    v_mfma_f32_16x16x32_bf16 v[204:207], v[32:35], v[84:87], v[204:207]
    s_mov_b32 s53, 2653184
    buffer_load_dwordx4 v3, s[60:63], s53 offen offset:1024 lds
    s_waitcnt lgkmcnt(7)
    v_mfma_f32_16x16x32_bf16 v[208:211], v[36:39], v[72:75], v[208:211]
    ds_read_b64_tr_b16 v[52:53], v5 offset:0
    v_mfma_f32_16x16x32_bf16 v[212:215], v[36:39], v[76:79], v[212:215]
    ds_read_b64_tr_b16 v[54:55], v5 offset:1024
    s_add_u32 m0, s96, 139264
    s_mov_b32 s53, 2621440
    buffer_load_dwordx4 v3, s[64:67], s53 offen offset:0 lds
    v_mfma_f32_16x16x32_bf16 v[216:219], v[36:39], v[80:83], v[216:219]
    ds_read_b128 v[60:63], v15 offset:34816
    v_mfma_f32_16x16x32_bf16 v[220:223], v[36:39], v[84:87], v[220:223]
    s_mov_b32 s53, 2653184
    buffer_load_dwordx4 v3, s[64:67], s53 offen offset:1024 lds
    s_waitcnt lgkmcnt(8)
    v_mfma_f32_16x16x32_bf16 v[224:227], v[40:43], v[72:75], v[224:227]
    ds_read_b64_tr_b16 v[32:33], v6 offset:0
    v_mfma_f32_16x16x32_bf16 v[228:231], v[40:43], v[76:79], v[228:231]
    ds_read_b64_tr_b16 v[34:35], v6 offset:1024
    v_mfma_f32_16x16x32_bf16 v[232:235], v[40:43], v[80:83], v[232:235]
    ds_read_b128 v[64:67], v15 offset:36864
    v_mfma_f32_16x16x32_bf16 v[236:239], v[40:43], v[84:87], v[236:239]
    s_waitcnt lgkmcnt(9)
    v_mfma_f32_16x16x32_bf16 v[240:243], v[44:47], v[72:75], v[240:243]
    ds_read_b64_tr_b16 v[36:37], v7 offset:0
    v_mfma_f32_16x16x32_bf16 v[244:247], v[44:47], v[76:79], v[244:247]
    ds_read_b64_tr_b16 v[38:39], v7 offset:1024
    v_mfma_f32_16x16x32_bf16 v[248:251], v[44:47], v[80:83], v[248:251]
    ds_read_b128 v[68:71], v15 offset:38912
    v_mfma_f32_16x16x32_bf16 v[252:255], v[44:47], v[84:87], v[252:255]
    s_waitcnt lgkmcnt(9)
    v_mfma_f32_16x16x32_bf16 v[128:131], v[48:51], v[56:59], v[128:131]
    ds_read_b64_tr_b16 v[40:41], v8 offset:0
    s_waitcnt lgkmcnt(7)
    v_mfma_f32_16x16x32_bf16 v[132:135], v[48:51], v[60:63], v[132:135]
    ds_read_b64_tr_b16 v[42:43], v8 offset:1024
    s_waitcnt lgkmcnt(5)
    v_mfma_f32_16x16x32_bf16 v[136:139], v[48:51], v[64:67], v[136:139]
    s_waitcnt lgkmcnt(2)
    v_mfma_f32_16x16x32_bf16 v[140:143], v[48:51], v[68:71], v[140:143]
    v_mfma_f32_16x16x32_bf16 v[144:147], v[52:55], v[56:59], v[144:147]
    ds_read_b64_tr_b16 v[44:45], v9 offset:0
    v_mfma_f32_16x16x32_bf16 v[148:151], v[52:55], v[60:63], v[148:151]
    ds_read_b64_tr_b16 v[46:47], v9 offset:1024
    v_mfma_f32_16x16x32_bf16 v[152:155], v[52:55], v[64:67], v[152:155]
    v_mfma_f32_16x16x32_bf16 v[156:159], v[52:55], v[68:71], v[156:159]
    v_mfma_f32_16x16x32_bf16 v[160:163], v[32:35], v[56:59], v[160:163]
    ds_read_b64_tr_b16 v[48:49], v10 offset:0
    v_mfma_f32_16x16x32_bf16 v[164:167], v[32:35], v[60:63], v[164:167]
    ds_read_b64_tr_b16 v[50:51], v10 offset:1024
    v_mfma_f32_16x16x32_bf16 v[168:171], v[32:35], v[64:67], v[168:171]
    v_mfma_f32_16x16x32_bf16 v[172:175], v[32:35], v[68:71], v[172:175]
    v_mfma_f32_16x16x32_bf16 v[176:179], v[36:39], v[56:59], v[176:179]
    ds_read_b64_tr_b16 v[52:53], v11 offset:0
    v_mfma_f32_16x16x32_bf16 v[180:183], v[36:39], v[60:63], v[180:183]
    ds_read_b64_tr_b16 v[54:55], v11 offset:1024
    v_mfma_f32_16x16x32_bf16 v[184:187], v[36:39], v[64:67], v[184:187]
    v_mfma_f32_16x16x32_bf16 v[188:191], v[36:39], v[68:71], v[188:191]
    s_waitcnt lgkmcnt(6)
    v_mfma_f32_16x16x32_bf16 v[192:195], v[40:43], v[56:59], v[192:195]
    s_waitcnt vmcnt(12)
    s_barrier
    ds_read_b64_tr_b16 v[32:33], v4 offset:16384
    v_mfma_f32_16x16x32_bf16 v[196:199], v[40:43], v[60:63], v[196:199]
    ds_read_b64_tr_b16 v[34:35], v4 offset:17408
    s_add_u32 m0, s96, 147456
    s_mov_b32 s53, 2883584
    buffer_load_dwordx4 v3, s[60:63], s53 offen offset:0 lds
    v_mfma_f32_16x16x32_bf16 v[200:203], v[40:43], v[64:67], v[200:203]
    ds_read_b128 v[72:75], v16 offset:32768
    s_mov_b32 s53, 2915328
    buffer_load_dwordx4 v3, s[60:63], s53 offen offset:1024 lds
    v_mfma_f32_16x16x32_bf16 v[204:207], v[40:43], v[68:71], v[204:207]
    s_add_u32 m0, s96, 155648
    s_mov_b32 s53, 2883584
    buffer_load_dwordx4 v3, s[64:67], s53 offen offset:0 lds
    s_waitcnt lgkmcnt(7)
    v_mfma_f32_16x16x32_bf16 v[208:211], v[44:47], v[56:59], v[208:211]
    ds_read_b64_tr_b16 v[36:37], v5 offset:16384
    s_mov_b32 s53, 2915328
    buffer_load_dwordx4 v3, s[64:67], s53 offen offset:1024 lds
    v_mfma_f32_16x16x32_bf16 v[212:215], v[44:47], v[60:63], v[212:215]
    ds_read_b64_tr_b16 v[38:39], v5 offset:17408
    s_add_u32 m0, s80, 0
    s_mov_b32 s53, 768
    buffer_load_dwordx4 v13, s[56:59], s53 offen offset:0 lds
    v_mfma_f32_16x16x32_bf16 v[216:219], v[44:47], v[64:67], v[216:219]
    ds_read_b128 v[76:79], v16 offset:34816
    s_mov_b32 s53, 7936
    buffer_load_dwordx4 v14, s[56:59], s53 offen offset:1024 lds
    v_mfma_f32_16x16x32_bf16 v[220:223], v[44:47], v[68:71], v[220:223]
    s_mov_b32 s53, 15104
    buffer_load_dwordx4 v13, s[56:59], s53 offen offset:2048 lds
    s_waitcnt lgkmcnt(8)
    v_mfma_f32_16x16x32_bf16 v[224:227], v[48:51], v[56:59], v[224:227]
    ds_read_b64_tr_b16 v[40:41], v6 offset:16384
    s_mov_b32 s53, 22272
    buffer_load_dwordx4 v14, s[56:59], s53 offen offset:3072 lds
    v_mfma_f32_16x16x32_bf16 v[228:231], v[48:51], v[60:63], v[228:231]
    ds_read_b64_tr_b16 v[42:43], v6 offset:17408
    s_add_u32 m0, s80, 16384
    s_mov_b32 s53, 131840
    buffer_load_dwordx4 v13, s[56:59], s53 offen offset:0 lds
    v_mfma_f32_16x16x32_bf16 v[232:235], v[48:51], v[64:67], v[232:235]
    ds_read_b128 v[80:83], v16 offset:36864
    s_mov_b32 s53, 139008
    buffer_load_dwordx4 v14, s[56:59], s53 offen offset:1024 lds
    v_mfma_f32_16x16x32_bf16 v[236:239], v[48:51], v[68:71], v[236:239]
    s_mov_b32 s53, 146176
    buffer_load_dwordx4 v13, s[56:59], s53 offen offset:2048 lds
    s_waitcnt lgkmcnt(9)
    v_mfma_f32_16x16x32_bf16 v[240:243], v[52:55], v[56:59], v[240:243]
    ds_read_b64_tr_b16 v[44:45], v7 offset:16384
    s_mov_b32 s53, 153344
    buffer_load_dwordx4 v14, s[56:59], s53 offen offset:3072 lds
    v_mfma_f32_16x16x32_bf16 v[244:247], v[52:55], v[60:63], v[244:247]
    ds_read_b64_tr_b16 v[46:47], v7 offset:17408
    v_mfma_f32_16x16x32_bf16 v[248:251], v[52:55], v[64:67], v[248:251]
    ds_read_b128 v[84:87], v16 offset:38912
    v_mfma_f32_16x16x32_bf16 v[252:255], v[52:55], v[68:71], v[252:255]
    s_waitcnt lgkmcnt(9)
    v_mfma_f32_16x16x32_bf16 v[128:131], v[32:35], v[72:75], v[128:131]
    ds_read_b64_tr_b16 v[48:49], v8 offset:16384
    s_waitcnt lgkmcnt(7)
    v_mfma_f32_16x16x32_bf16 v[132:135], v[32:35], v[76:79], v[132:135]
    ds_read_b64_tr_b16 v[50:51], v8 offset:17408
    s_waitcnt lgkmcnt(5)
    v_mfma_f32_16x16x32_bf16 v[136:139], v[32:35], v[80:83], v[136:139]
    s_waitcnt lgkmcnt(2)
    v_mfma_f32_16x16x32_bf16 v[140:143], v[32:35], v[84:87], v[140:143]
    v_mfma_f32_16x16x32_bf16 v[144:147], v[36:39], v[72:75], v[144:147]
    ds_read_b64_tr_b16 v[52:53], v9 offset:16384
    v_mfma_f32_16x16x32_bf16 v[148:151], v[36:39], v[76:79], v[148:151]
    ds_read_b64_tr_b16 v[54:55], v9 offset:17408
    v_mfma_f32_16x16x32_bf16 v[152:155], v[36:39], v[80:83], v[152:155]
    v_mfma_f32_16x16x32_bf16 v[156:159], v[36:39], v[84:87], v[156:159]
    v_mfma_f32_16x16x32_bf16 v[160:163], v[40:43], v[72:75], v[160:163]
    ds_read_b64_tr_b16 v[32:33], v10 offset:16384
    v_mfma_f32_16x16x32_bf16 v[164:167], v[40:43], v[76:79], v[164:167]
    ds_read_b64_tr_b16 v[34:35], v10 offset:17408
    v_mfma_f32_16x16x32_bf16 v[168:171], v[40:43], v[80:83], v[168:171]
    v_mfma_f32_16x16x32_bf16 v[172:175], v[40:43], v[84:87], v[172:175]
    v_mfma_f32_16x16x32_bf16 v[176:179], v[44:47], v[72:75], v[176:179]
    ds_read_b64_tr_b16 v[36:37], v11 offset:16384
    v_mfma_f32_16x16x32_bf16 v[180:183], v[44:47], v[76:79], v[180:183]
    ds_read_b64_tr_b16 v[38:39], v11 offset:17408
    v_mfma_f32_16x16x32_bf16 v[184:187], v[44:47], v[80:83], v[184:187]
    v_mfma_f32_16x16x32_bf16 v[188:191], v[44:47], v[84:87], v[188:191]
    s_waitcnt lgkmcnt(6)
    v_mfma_f32_16x16x32_bf16 v[192:195], v[48:51], v[72:75], v[192:195]
    s_waitcnt vmcnt(12)
    s_barrier
    ds_read_b64_tr_b16 v[40:41], v4 offset:32768
    v_mfma_f32_16x16x32_bf16 v[196:199], v[48:51], v[76:79], v[196:199]
    ds_read_b64_tr_b16 v[42:43], v4 offset:33792
    s_add_u32 m0, s96, 98304
    s_mov_b32 s53, 3145728
    buffer_load_dwordx4 v3, s[60:63], s53 offen offset:0 lds
    v_mfma_f32_16x16x32_bf16 v[200:203], v[48:51], v[80:83], v[200:203]
    ds_read_b128 v[56:59], v17 offset:0
    v_mfma_f32_16x16x32_bf16 v[204:207], v[48:51], v[84:87], v[204:207]
    s_mov_b32 s53, 3177472
    buffer_load_dwordx4 v3, s[60:63], s53 offen offset:1024 lds
    s_waitcnt lgkmcnt(7)
    v_mfma_f32_16x16x32_bf16 v[208:211], v[52:55], v[72:75], v[208:211]
    ds_read_b64_tr_b16 v[44:45], v5 offset:32768
    v_mfma_f32_16x16x32_bf16 v[212:215], v[52:55], v[76:79], v[212:215]
    ds_read_b64_tr_b16 v[46:47], v5 offset:33792
    s_add_u32 m0, s96, 106496
    s_mov_b32 s53, 3145728
    buffer_load_dwordx4 v3, s[64:67], s53 offen offset:0 lds
    v_mfma_f32_16x16x32_bf16 v[216:219], v[52:55], v[80:83], v[216:219]
    ds_read_b128 v[60:63], v17 offset:2048
    v_mfma_f32_16x16x32_bf16 v[220:223], v[52:55], v[84:87], v[220:223]
    s_mov_b32 s53, 3177472
    buffer_load_dwordx4 v3, s[64:67], s53 offen offset:1024 lds
    s_waitcnt lgkmcnt(8)
    v_mfma_f32_16x16x32_bf16 v[224:227], v[32:35], v[72:75], v[224:227]
    ds_read_b64_tr_b16 v[48:49], v6 offset:32768
    v_mfma_f32_16x16x32_bf16 v[228:231], v[32:35], v[76:79], v[228:231]
    ds_read_b64_tr_b16 v[50:51], v6 offset:33792
    v_mfma_f32_16x16x32_bf16 v[232:235], v[32:35], v[80:83], v[232:235]
    ds_read_b128 v[64:67], v17 offset:4096
    v_mfma_f32_16x16x32_bf16 v[236:239], v[32:35], v[84:87], v[236:239]
    s_waitcnt lgkmcnt(9)
    v_mfma_f32_16x16x32_bf16 v[240:243], v[36:39], v[72:75], v[240:243]
    ds_read_b64_tr_b16 v[52:53], v7 offset:32768
    v_mfma_f32_16x16x32_bf16 v[244:247], v[36:39], v[76:79], v[244:247]
    ds_read_b64_tr_b16 v[54:55], v7 offset:33792
    v_mfma_f32_16x16x32_bf16 v[248:251], v[36:39], v[80:83], v[248:251]
    ds_read_b128 v[68:71], v17 offset:6144
    v_mfma_f32_16x16x32_bf16 v[252:255], v[36:39], v[84:87], v[252:255]
    s_waitcnt lgkmcnt(9)
    v_mfma_f32_16x16x32_bf16 v[128:131], v[40:43], v[56:59], v[128:131]
    ds_read_b64_tr_b16 v[32:33], v8 offset:32768
    s_waitcnt lgkmcnt(7)
    v_mfma_f32_16x16x32_bf16 v[132:135], v[40:43], v[60:63], v[132:135]
    ds_read_b64_tr_b16 v[34:35], v8 offset:33792
    s_waitcnt lgkmcnt(5)
    v_mfma_f32_16x16x32_bf16 v[136:139], v[40:43], v[64:67], v[136:139]
    s_waitcnt lgkmcnt(2)
    v_mfma_f32_16x16x32_bf16 v[140:143], v[40:43], v[68:71], v[140:143]
    v_mfma_f32_16x16x32_bf16 v[144:147], v[44:47], v[56:59], v[144:147]
    ds_read_b64_tr_b16 v[36:37], v9 offset:32768
    v_mfma_f32_16x16x32_bf16 v[148:151], v[44:47], v[60:63], v[148:151]
    ds_read_b64_tr_b16 v[38:39], v9 offset:33792
    v_mfma_f32_16x16x32_bf16 v[152:155], v[44:47], v[64:67], v[152:155]
    v_mfma_f32_16x16x32_bf16 v[156:159], v[44:47], v[68:71], v[156:159]
    v_mfma_f32_16x16x32_bf16 v[160:163], v[48:51], v[56:59], v[160:163]
    ds_read_b64_tr_b16 v[40:41], v10 offset:32768
    v_mfma_f32_16x16x32_bf16 v[164:167], v[48:51], v[60:63], v[164:167]
    ds_read_b64_tr_b16 v[42:43], v10 offset:33792
    v_mfma_f32_16x16x32_bf16 v[168:171], v[48:51], v[64:67], v[168:171]
    v_mfma_f32_16x16x32_bf16 v[172:175], v[48:51], v[68:71], v[172:175]
    v_mfma_f32_16x16x32_bf16 v[176:179], v[52:55], v[56:59], v[176:179]
    ds_read_b64_tr_b16 v[44:45], v11 offset:32768
    v_mfma_f32_16x16x32_bf16 v[180:183], v[52:55], v[60:63], v[180:183]
    ds_read_b64_tr_b16 v[46:47], v11 offset:33792
    v_mfma_f32_16x16x32_bf16 v[184:187], v[52:55], v[64:67], v[184:187]
    v_mfma_f32_16x16x32_bf16 v[188:191], v[52:55], v[68:71], v[188:191]
    s_waitcnt lgkmcnt(6)
    v_mfma_f32_16x16x32_bf16 v[192:195], v[32:35], v[56:59], v[192:195]
    s_waitcnt vmcnt(12)
    s_barrier
    ds_read_b64_tr_b16 v[48:49], v4 offset:49152
    v_mfma_f32_16x16x32_bf16 v[196:199], v[32:35], v[60:63], v[196:199]
    ds_read_b64_tr_b16 v[50:51], v4 offset:50176
    s_add_u32 m0, s96, 114688
    s_mov_b32 s53, 3407872
    buffer_load_dwordx4 v3, s[60:63], s53 offen offset:0 lds
    v_mfma_f32_16x16x32_bf16 v[200:203], v[32:35], v[64:67], v[200:203]
    ds_read_b128 v[72:75], v18 offset:0
    s_mov_b32 s53, 3439616
    buffer_load_dwordx4 v3, s[60:63], s53 offen offset:1024 lds
    v_mfma_f32_16x16x32_bf16 v[204:207], v[32:35], v[68:71], v[204:207]
    s_add_u32 m0, s96, 122880
    s_mov_b32 s53, 3407872
    buffer_load_dwordx4 v3, s[64:67], s53 offen offset:0 lds
    s_waitcnt lgkmcnt(7)
    v_mfma_f32_16x16x32_bf16 v[208:211], v[36:39], v[56:59], v[208:211]
    ds_read_b64_tr_b16 v[52:53], v5 offset:49152
    s_mov_b32 s53, 3439616
    buffer_load_dwordx4 v3, s[64:67], s53 offen offset:1024 lds
    v_mfma_f32_16x16x32_bf16 v[212:215], v[36:39], v[60:63], v[212:215]
    ds_read_b64_tr_b16 v[54:55], v5 offset:50176
    s_add_u32 m0, s80, 32768
    s_mov_b32 s53, 896
    buffer_load_dwordx4 v13, s[56:59], s53 offen offset:0 lds
    v_mfma_f32_16x16x32_bf16 v[216:219], v[36:39], v[64:67], v[216:219]
    ds_read_b128 v[76:79], v18 offset:2048
    s_mov_b32 s53, 8064
    buffer_load_dwordx4 v14, s[56:59], s53 offen offset:1024 lds
    v_mfma_f32_16x16x32_bf16 v[220:223], v[36:39], v[68:71], v[220:223]
    s_mov_b32 s53, 15232
    buffer_load_dwordx4 v13, s[56:59], s53 offen offset:2048 lds
    s_waitcnt lgkmcnt(8)
    v_mfma_f32_16x16x32_bf16 v[224:227], v[40:43], v[56:59], v[224:227]
    ds_read_b64_tr_b16 v[32:33], v6 offset:49152
    s_mov_b32 s53, 22400
    buffer_load_dwordx4 v14, s[56:59], s53 offen offset:3072 lds
    v_mfma_f32_16x16x32_bf16 v[228:231], v[40:43], v[60:63], v[228:231]
    ds_read_b64_tr_b16 v[34:35], v6 offset:50176
    s_add_u32 m0, s80, 49152
    s_mov_b32 s53, 131968
    buffer_load_dwordx4 v13, s[56:59], s53 offen offset:0 lds
    v_mfma_f32_16x16x32_bf16 v[232:235], v[40:43], v[64:67], v[232:235]
    ds_read_b128 v[80:83], v18 offset:4096
    s_mov_b32 s53, 139136
    buffer_load_dwordx4 v14, s[56:59], s53 offen offset:1024 lds
    v_mfma_f32_16x16x32_bf16 v[236:239], v[40:43], v[68:71], v[236:239]
    s_mov_b32 s53, 146304
    buffer_load_dwordx4 v13, s[56:59], s53 offen offset:2048 lds
    s_waitcnt lgkmcnt(9)
    v_mfma_f32_16x16x32_bf16 v[240:243], v[44:47], v[56:59], v[240:243]
    ds_read_b64_tr_b16 v[36:37], v7 offset:49152
    s_mov_b32 s53, 153472
    buffer_load_dwordx4 v14, s[56:59], s53 offen offset:3072 lds
    v_mfma_f32_16x16x32_bf16 v[244:247], v[44:47], v[60:63], v[244:247]
    ds_read_b64_tr_b16 v[38:39], v7 offset:50176
    v_mfma_f32_16x16x32_bf16 v[248:251], v[44:47], v[64:67], v[248:251]
    ds_read_b128 v[84:87], v18 offset:6144
    v_mfma_f32_16x16x32_bf16 v[252:255], v[44:47], v[68:71], v[252:255]
    s_waitcnt lgkmcnt(9)
    v_mfma_f32_16x16x32_bf16 v[128:131], v[48:51], v[72:75], v[128:131]
    ds_read_b64_tr_b16 v[40:41], v8 offset:49152
    s_waitcnt lgkmcnt(7)
    v_mfma_f32_16x16x32_bf16 v[132:135], v[48:51], v[76:79], v[132:135]
    ds_read_b64_tr_b16 v[42:43], v8 offset:50176
    s_waitcnt lgkmcnt(5)
    v_mfma_f32_16x16x32_bf16 v[136:139], v[48:51], v[80:83], v[136:139]
    s_waitcnt lgkmcnt(2)
    v_mfma_f32_16x16x32_bf16 v[140:143], v[48:51], v[84:87], v[140:143]
    v_mfma_f32_16x16x32_bf16 v[144:147], v[52:55], v[72:75], v[144:147]
    ds_read_b64_tr_b16 v[44:45], v9 offset:49152
    v_mfma_f32_16x16x32_bf16 v[148:151], v[52:55], v[76:79], v[148:151]
    ds_read_b64_tr_b16 v[46:47], v9 offset:50176
    v_mfma_f32_16x16x32_bf16 v[152:155], v[52:55], v[80:83], v[152:155]
    v_mfma_f32_16x16x32_bf16 v[156:159], v[52:55], v[84:87], v[156:159]
    v_mfma_f32_16x16x32_bf16 v[160:163], v[32:35], v[72:75], v[160:163]
    ds_read_b64_tr_b16 v[48:49], v10 offset:49152
    v_mfma_f32_16x16x32_bf16 v[164:167], v[32:35], v[76:79], v[164:167]
    ds_read_b64_tr_b16 v[50:51], v10 offset:50176
    v_mfma_f32_16x16x32_bf16 v[168:171], v[32:35], v[80:83], v[168:171]
    v_mfma_f32_16x16x32_bf16 v[172:175], v[32:35], v[84:87], v[172:175]
    v_mfma_f32_16x16x32_bf16 v[176:179], v[36:39], v[72:75], v[176:179]
    ds_read_b64_tr_b16 v[52:53], v11 offset:49152
    v_mfma_f32_16x16x32_bf16 v[180:183], v[36:39], v[76:79], v[180:183]
    ds_read_b64_tr_b16 v[54:55], v11 offset:50176
    v_mfma_f32_16x16x32_bf16 v[184:187], v[36:39], v[80:83], v[184:187]
    v_mfma_f32_16x16x32_bf16 v[188:191], v[36:39], v[84:87], v[188:191]
    s_waitcnt lgkmcnt(6)
    v_mfma_f32_16x16x32_bf16 v[192:195], v[40:43], v[72:75], v[192:195]
    s_waitcnt vmcnt(12)
    s_barrier
    ds_read_b64_tr_b16 v[32:33], v4 offset:0
    v_mfma_f32_16x16x32_bf16 v[196:199], v[40:43], v[76:79], v[196:199]
    ds_read_b64_tr_b16 v[34:35], v4 offset:1024
    s_add_u32 m0, s96, 131072
    s_mov_b32 s53, 3670016
    buffer_load_dwordx4 v3, s[60:63], s53 offen offset:0 lds
    v_mfma_f32_16x16x32_bf16 v[200:203], v[40:43], v[80:83], v[200:203]
    ds_read_b128 v[56:59], v15 offset:0
    v_mfma_f32_16x16x32_bf16 v[204:207], v[40:43], v[84:87], v[204:207]
    s_mov_b32 s53, 3701760
    buffer_load_dwordx4 v3, s[60:63], s53 offen offset:1024 lds
    s_waitcnt lgkmcnt(7)
    v_mfma_f32_16x16x32_bf16 v[208:211], v[44:47], v[72:75], v[208:211]
    ds_read_b64_tr_b16 v[36:37], v5 offset:0
    v_mfma_f32_16x16x32_bf16 v[212:215], v[44:47], v[76:79], v[212:215]
    ds_read_b64_tr_b16 v[38:39], v5 offset:1024
    s_add_u32 m0, s96, 139264
    s_mov_b32 s53, 3670016
    buffer_load_dwordx4 v3, s[64:67], s53 offen offset:0 lds
    v_mfma_f32_16x16x32_bf16 v[216:219], v[44:47], v[80:83], v[216:219]
    ds_read_b128 v[60:63], v15 offset:2048
    v_mfma_f32_16x16x32_bf16 v[220:223], v[44:47], v[84:87], v[220:223]
    s_mov_b32 s53, 3701760
    buffer_load_dwordx4 v3, s[64:67], s53 offen offset:1024 lds
    s_waitcnt lgkmcnt(8)
    v_mfma_f32_16x16x32_bf16 v[224:227], v[48:51], v[72:75], v[224:227]
    ds_read_b64_tr_b16 v[40:41], v6 offset:0
    v_mfma_f32_16x16x32_bf16 v[228:231], v[48:51], v[76:79], v[228:231]
    ds_read_b64_tr_b16 v[42:43], v6 offset:1024
    v_mfma_f32_16x16x32_bf16 v[232:235], v[48:51], v[80:83], v[232:235]
    ds_read_b128 v[64:67], v15 offset:4096
    v_mfma_f32_16x16x32_bf16 v[236:239], v[48:51], v[84:87], v[236:239]
    s_waitcnt lgkmcnt(9)
    v_mfma_f32_16x16x32_bf16 v[240:243], v[52:55], v[72:75], v[240:243]
    ds_read_b64_tr_b16 v[44:45], v7 offset:0
    v_mfma_f32_16x16x32_bf16 v[244:247], v[52:55], v[76:79], v[244:247]
    ds_read_b64_tr_b16 v[46:47], v7 offset:1024
    v_mfma_f32_16x16x32_bf16 v[248:251], v[52:55], v[80:83], v[248:251]
    ds_read_b128 v[68:71], v15 offset:6144
    v_mfma_f32_16x16x32_bf16 v[252:255], v[52:55], v[84:87], v[252:255]
    s_waitcnt lgkmcnt(9)
    v_mfma_f32_16x16x32_bf16 v[128:131], v[32:35], v[56:59], v[128:131]
    ds_read_b64_tr_b16 v[48:49], v8 offset:0
    s_waitcnt lgkmcnt(7)
    v_mfma_f32_16x16x32_bf16 v[132:135], v[32:35], v[60:63], v[132:135]
    ds_read_b64_tr_b16 v[50:51], v8 offset:1024
    s_waitcnt lgkmcnt(5)
    v_mfma_f32_16x16x32_bf16 v[136:139], v[32:35], v[64:67], v[136:139]
    s_waitcnt lgkmcnt(2)
    v_mfma_f32_16x16x32_bf16 v[140:143], v[32:35], v[68:71], v[140:143]
    v_mfma_f32_16x16x32_bf16 v[144:147], v[36:39], v[56:59], v[144:147]
    ds_read_b64_tr_b16 v[52:53], v9 offset:0
    v_mfma_f32_16x16x32_bf16 v[148:151], v[36:39], v[60:63], v[148:151]
    ds_read_b64_tr_b16 v[54:55], v9 offset:1024
    v_mfma_f32_16x16x32_bf16 v[152:155], v[36:39], v[64:67], v[152:155]
    v_mfma_f32_16x16x32_bf16 v[156:159], v[36:39], v[68:71], v[156:159]
    v_mfma_f32_16x16x32_bf16 v[160:163], v[40:43], v[56:59], v[160:163]
    ds_read_b64_tr_b16 v[32:33], v10 offset:0
    v_mfma_f32_16x16x32_bf16 v[164:167], v[40:43], v[60:63], v[164:167]
    ds_read_b64_tr_b16 v[34:35], v10 offset:1024
    v_mfma_f32_16x16x32_bf16 v[168:171], v[40:43], v[64:67], v[168:171]
    v_mfma_f32_16x16x32_bf16 v[172:175], v[40:43], v[68:71], v[172:175]
    v_mfma_f32_16x16x32_bf16 v[176:179], v[44:47], v[56:59], v[176:179]
    ds_read_b64_tr_b16 v[36:37], v11 offset:0
    v_mfma_f32_16x16x32_bf16 v[180:183], v[44:47], v[60:63], v[180:183]
    ds_read_b64_tr_b16 v[38:39], v11 offset:1024
    v_mfma_f32_16x16x32_bf16 v[184:187], v[44:47], v[64:67], v[184:187]
    v_mfma_f32_16x16x32_bf16 v[188:191], v[44:47], v[68:71], v[188:191]
    s_waitcnt lgkmcnt(6)
    v_mfma_f32_16x16x32_bf16 v[192:195], v[48:51], v[56:59], v[192:195]
    s_waitcnt vmcnt(12)
    s_barrier
    ds_read_b64_tr_b16 v[40:41], v4 offset:16384
    v_mfma_f32_16x16x32_bf16 v[196:199], v[48:51], v[60:63], v[196:199]
    ds_read_b64_tr_b16 v[42:43], v4 offset:17408
    s_add_u32 m0, s96, 147456
    s_mov_b32 s53, 3932160
    buffer_load_dwordx4 v3, s[60:63], s53 offen offset:0 lds
    v_mfma_f32_16x16x32_bf16 v[200:203], v[48:51], v[64:67], v[200:203]
    ds_read_b128 v[72:75], v16 offset:0
    s_mov_b32 s53, 3963904
    buffer_load_dwordx4 v3, s[60:63], s53 offen offset:1024 lds
    v_mfma_f32_16x16x32_bf16 v[204:207], v[48:51], v[68:71], v[204:207]
    s_add_u32 m0, s96, 155648
    s_mov_b32 s53, 3932160
    buffer_load_dwordx4 v3, s[64:67], s53 offen offset:0 lds
    s_waitcnt lgkmcnt(7)
    v_mfma_f32_16x16x32_bf16 v[208:211], v[52:55], v[56:59], v[208:211]
    ds_read_b64_tr_b16 v[44:45], v5 offset:16384
    s_mov_b32 s53, 3963904
    buffer_load_dwordx4 v3, s[64:67], s53 offen offset:1024 lds
    v_mfma_f32_16x16x32_bf16 v[212:215], v[52:55], v[60:63], v[212:215]
    ds_read_b64_tr_b16 v[46:47], v5 offset:17408
    s_add_u32 m0, s96, 65536
    s_mov_b32 s53, 0
    buffer_load_dwordx4 v3, s[92:95], s53 offen offset:0 lds
    v_mfma_f32_16x16x32_bf16 v[216:219], v[52:55], v[64:67], v[216:219]
    ds_read_b128 v[76:79], v16 offset:2048
    s_mov_b32 s53, 31744
    buffer_load_dwordx4 v3, s[92:95], s53 offen offset:1024 lds
    v_mfma_f32_16x16x32_bf16 v[220:223], v[52:55], v[68:71], v[220:223]
    s_add_u32 m0, s96, 81920
    s_mov_b32 s53, 524288
    buffer_load_dwordx4 v3, s[92:95], s53 offen offset:0 lds
    s_waitcnt lgkmcnt(8)
    v_mfma_f32_16x16x32_bf16 v[224:227], v[32:35], v[56:59], v[224:227]
    ds_read_b64_tr_b16 v[48:49], v6 offset:16384
    s_mov_b32 s53, 556032
    buffer_load_dwordx4 v3, s[92:95], s53 offen offset:1024 lds
    v_mfma_f32_16x16x32_bf16 v[228:231], v[32:35], v[60:63], v[228:231]
    ds_read_b64_tr_b16 v[50:51], v6 offset:17408
    v_mfma_f32_16x16x32_bf16 v[232:235], v[32:35], v[64:67], v[232:235]
    ds_read_b128 v[80:83], v16 offset:4096
    v_mfma_f32_16x16x32_bf16 v[236:239], v[32:35], v[68:71], v[236:239]
    s_waitcnt lgkmcnt(9)
    v_mfma_f32_16x16x32_bf16 v[240:243], v[36:39], v[56:59], v[240:243]
    ds_read_b64_tr_b16 v[52:53], v7 offset:16384
    v_mfma_f32_16x16x32_bf16 v[244:247], v[36:39], v[60:63], v[244:247]
    ds_read_b64_tr_b16 v[54:55], v7 offset:17408
    v_mfma_f32_16x16x32_bf16 v[248:251], v[36:39], v[64:67], v[248:251]
    ds_read_b128 v[84:87], v16 offset:6144
    v_mfma_f32_16x16x32_bf16 v[252:255], v[36:39], v[68:71], v[252:255]
    s_waitcnt lgkmcnt(9)
    v_mfma_f32_16x16x32_bf16 v[128:131], v[40:43], v[72:75], v[128:131]
    ds_read_b64_tr_b16 v[32:33], v8 offset:16384
    s_waitcnt lgkmcnt(7)
    v_mfma_f32_16x16x32_bf16 v[132:135], v[40:43], v[76:79], v[132:135]
    ds_read_b64_tr_b16 v[34:35], v8 offset:17408
    s_waitcnt lgkmcnt(5)
    v_mfma_f32_16x16x32_bf16 v[136:139], v[40:43], v[80:83], v[136:139]
    s_waitcnt lgkmcnt(2)
    v_mfma_f32_16x16x32_bf16 v[140:143], v[40:43], v[84:87], v[140:143]
    v_mfma_f32_16x16x32_bf16 v[144:147], v[44:47], v[72:75], v[144:147]
    ds_read_b64_tr_b16 v[36:37], v9 offset:16384
    v_mfma_f32_16x16x32_bf16 v[148:151], v[44:47], v[76:79], v[148:151]
    ds_read_b64_tr_b16 v[38:39], v9 offset:17408
    v_mfma_f32_16x16x32_bf16 v[152:155], v[44:47], v[80:83], v[152:155]
    v_mfma_f32_16x16x32_bf16 v[156:159], v[44:47], v[84:87], v[156:159]
    v_mfma_f32_16x16x32_bf16 v[160:163], v[48:51], v[72:75], v[160:163]
    ds_read_b64_tr_b16 v[40:41], v10 offset:16384
    v_mfma_f32_16x16x32_bf16 v[164:167], v[48:51], v[76:79], v[164:167]
    ds_read_b64_tr_b16 v[42:43], v10 offset:17408
    v_mfma_f32_16x16x32_bf16 v[168:171], v[48:51], v[80:83], v[168:171]
    v_mfma_f32_16x16x32_bf16 v[172:175], v[48:51], v[84:87], v[172:175]
    v_mfma_f32_16x16x32_bf16 v[176:179], v[52:55], v[72:75], v[176:179]
    ds_read_b64_tr_b16 v[44:45], v11 offset:16384
    v_mfma_f32_16x16x32_bf16 v[180:183], v[52:55], v[76:79], v[180:183]
    ds_read_b64_tr_b16 v[46:47], v11 offset:17408
    v_mfma_f32_16x16x32_bf16 v[184:187], v[52:55], v[80:83], v[184:187]
    v_mfma_f32_16x16x32_bf16 v[188:191], v[52:55], v[84:87], v[188:191]
    s_waitcnt lgkmcnt(6)
    v_mfma_f32_16x16x32_bf16 v[192:195], v[32:35], v[72:75], v[192:195]
    s_waitcnt vmcnt(8)
    s_barrier
    ds_read_b64_tr_b16 v[48:49], v4 offset:32768
    v_mfma_f32_16x16x32_bf16 v[196:199], v[32:35], v[76:79], v[196:199]
    ds_read_b64_tr_b16 v[50:51], v4 offset:33792
    s_add_u32 m0, s97, 98304
    s_add_u32 s53, s98, 0
    buffer_load_dwordx4 v2, s[44:47], s53 offen sc1 lds
    v_mfma_f32_16x16x32_bf16 v[200:203], v[32:35], v[80:83], v[200:203]
    ds_read_b128 v[56:59], v15 offset:32768
    v_mfma_f32_16x16x32_bf16 v[204:207], v[32:35], v[84:87], v[204:207]
    s_add_u32 m0, s97, 106496
    s_add_u32 s53, s98, 8192
    buffer_load_dwordx4 v2, s[44:47], s53 offen sc1 lds
    s_waitcnt lgkmcnt(7)
    v_mfma_f32_16x16x32_bf16 v[208:211], v[36:39], v[72:75], v[208:211]
    ds_read_b64_tr_b16 v[52:53], v5 offset:32768
    v_mfma_f32_16x16x32_bf16 v[212:215], v[36:39], v[76:79], v[212:215]
    ds_read_b64_tr_b16 v[54:55], v5 offset:33792
    v_mfma_f32_16x16x32_bf16 v[216:219], v[36:39], v[80:83], v[216:219]
    ds_read_b128 v[60:63], v15 offset:34816
    v_mfma_f32_16x16x32_bf16 v[220:223], v[36:39], v[84:87], v[220:223]
    s_waitcnt lgkmcnt(8)
    v_mfma_f32_16x16x32_bf16 v[224:227], v[40:43], v[72:75], v[224:227]
    ds_read_b64_tr_b16 v[32:33], v6 offset:32768
    s_add_u32 s53, s99, 0
    buffer_load_dwordx4 v[88:91], v2, s[44:47], s53 offen sc1
    v_mfma_f32_16x16x32_bf16 v[228:231], v[40:43], v[76:79], v[228:231]
    ds_read_b64_tr_b16 v[34:35], v6 offset:33792
    v_mfma_f32_16x16x32_bf16 v[232:235], v[40:43], v[80:83], v[232:235]
    ds_read_b128 v[64:67], v15 offset:36864
    s_add_u32 s53, s99, 18432
    buffer_load_dwordx4 v[92:95], v2, s[44:47], s53 offen sc1
    v_mfma_f32_16x16x32_bf16 v[236:239], v[40:43], v[84:87], v[236:239]
    s_waitcnt lgkmcnt(9)
    v_mfma_f32_16x16x32_bf16 v[240:243], v[44:47], v[72:75], v[240:243]
    ds_read_b64_tr_b16 v[36:37], v7 offset:32768
    s_add_u32 s53, s99, 1024
    buffer_load_dwordx4 v[96:99], v2, s[44:47], s53 offen sc1
    v_mfma_f32_16x16x32_bf16 v[244:247], v[44:47], v[76:79], v[244:247]
    ds_read_b64_tr_b16 v[38:39], v7 offset:33792
    v_mfma_f32_16x16x32_bf16 v[248:251], v[44:47], v[80:83], v[248:251]
    ds_read_b128 v[68:71], v15 offset:38912
    s_add_u32 s53, s99, 19456
    buffer_load_dwordx4 v[100:103], v2, s[44:47], s53 offen sc1
    v_mfma_f32_16x16x32_bf16 v[252:255], v[44:47], v[84:87], v[252:255]
    s_waitcnt lgkmcnt(9)
    v_mfma_f32_16x16x32_bf16 v[128:131], v[48:51], v[56:59], v[128:131]
    ds_read_b64_tr_b16 v[40:41], v8 offset:32768
    s_add_u32 s53, s99, 2048
    buffer_load_dwordx4 v[104:107], v2, s[44:47], s53 offen sc1
    s_waitcnt lgkmcnt(7)
    v_mfma_f32_16x16x32_bf16 v[132:135], v[48:51], v[60:63], v[132:135]
    ds_read_b64_tr_b16 v[42:43], v8 offset:33792
    s_waitcnt lgkmcnt(5)
    v_mfma_f32_16x16x32_bf16 v[136:139], v[48:51], v[64:67], v[136:139]
    s_add_u32 s53, s99, 20480
    buffer_load_dwordx4 v[108:111], v2, s[44:47], s53 offen sc1
    s_waitcnt lgkmcnt(2)
    v_mfma_f32_16x16x32_bf16 v[140:143], v[48:51], v[68:71], v[140:143]
    v_mfma_f32_16x16x32_bf16 v[144:147], v[52:55], v[56:59], v[144:147]
    ds_read_b64_tr_b16 v[44:45], v9 offset:32768
    s_add_u32 s53, s99, 3072
    buffer_load_dwordx4 v[112:115], v2, s[44:47], s53 offen sc1
    v_mfma_f32_16x16x32_bf16 v[148:151], v[52:55], v[60:63], v[148:151]
    ds_read_b64_tr_b16 v[46:47], v9 offset:33792
    v_mfma_f32_16x16x32_bf16 v[152:155], v[52:55], v[64:67], v[152:155]
    s_add_u32 s53, s99, 21504
    buffer_load_dwordx4 v[116:119], v2, s[44:47], s53 offen sc1
    v_mfma_f32_16x16x32_bf16 v[156:159], v[52:55], v[68:71], v[156:159]
    v_mfma_f32_16x16x32_bf16 v[160:163], v[32:35], v[56:59], v[160:163]
    ds_read_b64_tr_b16 v[48:49], v10 offset:32768
    s_add_u32 s53, s99, 4096
    buffer_load_dwordx4 v[120:123], v2, s[44:47], s53 offen sc1
    v_mfma_f32_16x16x32_bf16 v[164:167], v[32:35], v[60:63], v[164:167]
    ds_read_b64_tr_b16 v[50:51], v10 offset:33792
    v_mfma_f32_16x16x32_bf16 v[168:171], v[32:35], v[64:67], v[168:171]
    s_add_u32 s53, s99, 22528
    buffer_load_dwordx4 v[124:127], v2, s[44:47], s53 offen sc1
    v_mfma_f32_16x16x32_bf16 v[172:175], v[32:35], v[68:71], v[172:175]
    v_mfma_f32_16x16x32_bf16 v[176:179], v[36:39], v[56:59], v[176:179]
    ds_read_b64_tr_b16 v[52:53], v11 offset:32768
    v_mfma_f32_16x16x32_bf16 v[180:183], v[36:39], v[60:63], v[180:183]
    ds_read_b64_tr_b16 v[54:55], v11 offset:33792
    v_mfma_f32_16x16x32_bf16 v[184:187], v[36:39], v[64:67], v[184:187]
    v_mfma_f32_16x16x32_bf16 v[188:191], v[36:39], v[68:71], v[188:191]
    s_waitcnt lgkmcnt(6)
    v_mfma_f32_16x16x32_bf16 v[192:195], v[40:43], v[56:59], v[192:195]
    s_waitcnt vmcnt(16)
    s_barrier
    ds_read_b64_tr_b16 v[32:33], v4 offset:49152
    v_mfma_f32_16x16x32_bf16 v[196:199], v[40:43], v[60:63], v[196:199]
    ds_read_b64_tr_b16 v[34:35], v4 offset:50176
    s_add_u32 m0, s96, 114688
    s_mov_b32 s53, 1048576
    buffer_load_dwordx4 v3, s[92:95], s53 offen offset:0 lds
    v_mfma_f32_16x16x32_bf16 v[200:203], v[40:43], v[64:67], v[200:203]
    ds_read_b128 v[72:75], v16 offset:32768
    v_mfma_f32_16x16x32_bf16 v[204:207], v[40:43], v[68:71], v[204:207]
    s_mov_b32 s53, 1080320
    buffer_load_dwordx4 v3, s[92:95], s53 offen offset:1024 lds
    s_waitcnt lgkmcnt(7)
    v_mfma_f32_16x16x32_bf16 v[208:211], v[44:47], v[56:59], v[208:211]
    ds_read_b64_tr_b16 v[36:37], v5 offset:49152
    v_mfma_f32_16x16x32_bf16 v[212:215], v[44:47], v[60:63], v[212:215]
    ds_read_b64_tr_b16 v[38:39], v5 offset:50176
    s_add_u32 m0, s96, 16384
    s_mov_b32 s53, 1572864
    buffer_load_dwordx4 v3, s[92:95], s53 offen offset:0 lds
    v_mfma_f32_16x16x32_bf16 v[216:219], v[44:47], v[64:67], v[216:219]
    ds_read_b128 v[76:79], v16 offset:34816
    v_mfma_f32_16x16x32_bf16 v[220:223], v[44:47], v[68:71], v[220:223]
    s_mov_b32 s53, 1604608
    buffer_load_dwordx4 v3, s[92:95], s53 offen offset:1024 lds
    s_waitcnt lgkmcnt(8)
    v_mfma_f32_16x16x32_bf16 v[224:227], v[48:51], v[56:59], v[224:227]
    ds_read_b64_tr_b16 v[40:41], v6 offset:49152
    v_mfma_f32_16x16x32_bf16 v[228:231], v[48:51], v[60:63], v[228:231]
    ds_read_b64_tr_b16 v[42:43], v6 offset:50176
    s_add_u32 m0, s97, 0
    s_add_u32 s53, s98, 16384
    buffer_load_dwordx4 v2, s[44:47], s53 offen sc1 lds
    v_mfma_f32_16x16x32_bf16 v[232:235], v[48:51], v[64:67], v[232:235]
    ds_read_b128 v[80:83], v16 offset:36864
    v_mfma_f32_16x16x32_bf16 v[236:239], v[48:51], v[68:71], v[236:239]
    s_add_u32 m0, s97, 8192
    s_add_u32 s53, s98, 24576
    buffer_load_dwordx4 v2, s[44:47], s53 offen sc1 lds
    s_waitcnt lgkmcnt(9)
    v_mfma_f32_16x16x32_bf16 v[240:243], v[52:55], v[56:59], v[240:243]
    ds_read_b64_tr_b16 v[44:45], v7 offset:49152
    v_mfma_f32_16x16x32_bf16 v[244:247], v[52:55], v[60:63], v[244:247]
    ds_read_b64_tr_b16 v[46:47], v7 offset:50176
    v_mfma_f32_16x16x32_bf16 v[248:251], v[52:55], v[64:67], v[248:251]
    ds_read_b128 v[84:87], v16 offset:38912
    v_mfma_f32_16x16x32_bf16 v[252:255], v[52:55], v[68:71], v[252:255]
    s_waitcnt lgkmcnt(9)
    v_mfma_f32_16x16x32_bf16 v[128:131], v[32:35], v[72:75], v[128:131]
    ds_read_b64_tr_b16 v[48:49], v8 offset:49152
    s_waitcnt lgkmcnt(7)
    v_mfma_f32_16x16x32_bf16 v[132:135], v[32:35], v[76:79], v[132:135]
    ds_read_b64_tr_b16 v[50:51], v8 offset:50176
    s_waitcnt lgkmcnt(5)
    v_mfma_f32_16x16x32_bf16 v[136:139], v[32:35], v[80:83], v[136:139]
    s_waitcnt lgkmcnt(2)
    v_mfma_f32_16x16x32_bf16 v[140:143], v[32:35], v[84:87], v[140:143]
    v_mfma_f32_16x16x32_bf16 v[144:147], v[36:39], v[72:75], v[144:147]
    ds_read_b64_tr_b16 v[52:53], v9 offset:49152
    v_mfma_f32_16x16x32_bf16 v[148:151], v[36:39], v[76:79], v[148:151]
    ds_read_b64_tr_b16 v[54:55], v9 offset:50176
    v_mfma_f32_16x16x32_bf16 v[152:155], v[36:39], v[80:83], v[152:155]
    v_mfma_f32_16x16x32_bf16 v[156:159], v[36:39], v[84:87], v[156:159]
    v_mfma_f32_16x16x32_bf16 v[160:163], v[40:43], v[72:75], v[160:163]
    ds_read_b64_tr_b16 v[32:33], v10 offset:49152
    v_mfma_f32_16x16x32_bf16 v[164:167], v[40:43], v[76:79], v[164:167]
    ds_read_b64_tr_b16 v[34:35], v10 offset:50176
    v_mfma_f32_16x16x32_bf16 v[168:171], v[40:43], v[80:83], v[168:171]
    v_mfma_f32_16x16x32_bf16 v[172:175], v[40:43], v[84:87], v[172:175]
    v_mfma_f32_16x16x32_bf16 v[176:179], v[44:47], v[72:75], v[176:179]
    ds_read_b64_tr_b16 v[36:37], v11 offset:49152
    v_mfma_f32_16x16x32_bf16 v[180:183], v[44:47], v[76:79], v[180:183]
    ds_read_b64_tr_b16 v[38:39], v11 offset:50176
    v_mfma_f32_16x16x32_bf16 v[184:187], v[44:47], v[80:83], v[184:187]
    v_mfma_f32_16x16x32_bf16 v[188:191], v[44:47], v[84:87], v[188:191]
    s_waitcnt lgkmcnt(6)
    v_mfma_f32_16x16x32_bf16 v[192:195], v[48:51], v[72:75], v[192:195]
    v_mfma_f32_16x16x32_bf16 v[196:199], v[48:51], v[76:79], v[196:199]
    v_mfma_f32_16x16x32_bf16 v[200:203], v[48:51], v[80:83], v[200:203]
    v_mfma_f32_16x16x32_bf16 v[204:207], v[48:51], v[84:87], v[204:207]
    s_waitcnt lgkmcnt(4)
    v_mfma_f32_16x16x32_bf16 v[208:211], v[52:55], v[72:75], v[208:211]
    v_mfma_f32_16x16x32_bf16 v[212:215], v[52:55], v[76:79], v[212:215]
    v_mfma_f32_16x16x32_bf16 v[216:219], v[52:55], v[80:83], v[216:219]
    v_mfma_f32_16x16x32_bf16 v[220:223], v[52:55], v[84:87], v[220:223]
    s_waitcnt lgkmcnt(2)
    v_mfma_f32_16x16x32_bf16 v[224:227], v[32:35], v[72:75], v[224:227]
    v_mfma_f32_16x16x32_bf16 v[228:231], v[32:35], v[76:79], v[228:231]
    v_mfma_f32_16x16x32_bf16 v[232:235], v[32:35], v[80:83], v[232:235]
    v_mfma_f32_16x16x32_bf16 v[236:239], v[32:35], v[84:87], v[236:239]
    s_waitcnt lgkmcnt(0)
    v_mfma_f32_16x16x32_bf16 v[240:243], v[36:39], v[72:75], v[240:243]
    v_mfma_f32_16x16x32_bf16 v[244:247], v[36:39], v[76:79], v[244:247]
    v_mfma_f32_16x16x32_bf16 v[248:251], v[36:39], v[80:83], v[248:251]
    v_mfma_f32_16x16x32_bf16 v[252:255], v[36:39], v[84:87], v[252:255]
    v_add_u32 v4, 0xffff8000, v4
    v_add_u32 v5, 0xffff8000, v5
    v_add_u32 v6, 0xffff8000, v6
    v_add_u32 v7, 0xffff8000, v7
    v_add_u32 v8, 0xffff8000, v8
    v_add_u32 v9, 0xffff8000, v9
    v_add_u32 v10, 0xffff8000, v10
    v_add_u32 v11, 0xffff8000, v11
    v_lshrrev_b32 v13, 4, v1
    v_bfe_u32 v14, v1, 2, 2
    v_lshl_add_u32 v15, v13, 3, v14
    v_lshlrev_b32 v15, 7, v15
    v_lshrrev_b32 v14, 1, v14
    v_and_b32 v13, 1, v13
    v_lshl_add_u32 v14, v13, 1, v14
    v_lshl_add_u32 v15, v14, 5, v15
    v_and_b32 v14, 3, v1
    v_lshl_add_u32 v15, v14, 3, v15
    v_add_u32 v12, 98304, v15
    v_xor_b32 v16, 32, v12
    v_xor_b32 v17, 64, v12
    v_xor_b32 v18, 96, v12
    s_waitcnt vmcnt(17)
    s_barrier
    ds_read_b64_tr_b16 v[24:25], v4 offset:0
    ds_read_b64_tr_b16 v[26:27], v4 offset:1024
    ds_read_b64_tr_b16 v[28:29], v5 offset:0
    ds_read_b64_tr_b16 v[30:31], v5 offset:1024
    ds_read_b64_tr_b16 v[32:33], v6 offset:0
    ds_read_b64_tr_b16 v[34:35], v6 offset:1024
    ds_read_b64_tr_b16 v[36:37], v7 offset:0
    ds_read_b64_tr_b16 v[38:39], v7 offset:1024
    ds_read_b64_tr_b16 v[40:41], v8 offset:0
    ds_read_b64_tr_b16 v[42:43], v8 offset:1024
    v_cvt_pk_bf16_f32 v192, v192, v193
    v_cvt_pk_bf16_f32 v193, v194, v195
    v_cvt_pk_bf16_f32 v194, v208, v209
    v_cvt_pk_bf16_f32 v195, v210, v211
    v_cvt_pk_bf16_f32 v196, v196, v197
    v_cvt_pk_bf16_f32 v197, v198, v199
    v_cvt_pk_bf16_f32 v198, v212, v213
    v_cvt_pk_bf16_f32 v199, v214, v215
    v_cvt_pk_bf16_f32 v200, v200, v201
    v_cvt_pk_bf16_f32 v201, v202, v203
    v_cvt_pk_bf16_f32 v202, v216, v217
    v_cvt_pk_bf16_f32 v203, v218, v219
    v_cvt_pk_bf16_f32 v204, v204, v205
    v_cvt_pk_bf16_f32 v205, v206, v207
    v_cvt_pk_bf16_f32 v206, v220, v221
    v_cvt_pk_bf16_f32 v207, v222, v223
    v_cvt_pk_bf16_f32 v224, v224, v225
    v_cvt_pk_bf16_f32 v225, v226, v227
    v_cvt_pk_bf16_f32 v226, v240, v241
    v_cvt_pk_bf16_f32 v227, v242, v243
    v_cvt_pk_bf16_f32 v228, v228, v229
    v_cvt_pk_bf16_f32 v229, v230, v231
    v_cvt_pk_bf16_f32 v230, v244, v245
    v_cvt_pk_bf16_f32 v231, v246, v247
    v_cvt_pk_bf16_f32 v232, v232, v233
    v_cvt_pk_bf16_f32 v233, v234, v235
    v_cvt_pk_bf16_f32 v234, v248, v249
    v_cvt_pk_bf16_f32 v235, v250, v251
    v_cvt_pk_bf16_f32 v236, v236, v237
    v_cvt_pk_bf16_f32 v237, v238, v239
    v_cvt_pk_bf16_f32 v238, v252, v253
    v_cvt_pk_bf16_f32 v239, v254, v255
    v_cvt_pk_bf16_f32 v208, v128, v129
    v_cvt_pk_bf16_f32 v209, v130, v131
    v_cvt_pk_bf16_f32 v210, v144, v145
    v_cvt_pk_bf16_f32 v211, v146, v147
    v_cvt_pk_bf16_f32 v212, v132, v133
    v_cvt_pk_bf16_f32 v213, v134, v135
    v_cvt_pk_bf16_f32 v214, v148, v149
    v_cvt_pk_bf16_f32 v215, v150, v151
    v_cvt_pk_bf16_f32 v216, v136, v137
    v_cvt_pk_bf16_f32 v217, v138, v139
    v_cvt_pk_bf16_f32 v218, v152, v153
    v_cvt_pk_bf16_f32 v219, v154, v155
    v_cvt_pk_bf16_f32 v220, v140, v141
    v_cvt_pk_bf16_f32 v221, v142, v143
    v_cvt_pk_bf16_f32 v222, v156, v157
    v_cvt_pk_bf16_f32 v223, v158, v159
    v_cvt_pk_bf16_f32 v240, v160, v161
    v_cvt_pk_bf16_f32 v241, v162, v163
    v_cvt_pk_bf16_f32 v242, v176, v177
    v_cvt_pk_bf16_f32 v243, v178, v179
    v_cvt_pk_bf16_f32 v244, v164, v165
    v_cvt_pk_bf16_f32 v245, v166, v167
    v_cvt_pk_bf16_f32 v246, v180, v181
    v_cvt_pk_bf16_f32 v247, v182, v183
    v_cvt_pk_bf16_f32 v248, v168, v169
    v_cvt_pk_bf16_f32 v249, v170, v171
    v_cvt_pk_bf16_f32 v250, v184, v185
    v_cvt_pk_bf16_f32 v251, v186, v187
    v_cvt_pk_bf16_f32 v252, v172, v173
    v_cvt_pk_bf16_f32 v253, v174, v175
    v_cvt_pk_bf16_f32 v254, v188, v189
    v_cvt_pk_bf16_f32 v255, v190, v191
    s_waitcnt vmcnt(15) lgkmcnt(8)
    v_mfma_f32_16x16x32_bf16 v[56:59], v[24:27], v[88:91], 0
    ds_read_b64_tr_b16 v[44:45], v9 offset:0
    s_waitcnt vmcnt(14)
    v_mfma_f32_16x16x32_bf16 v[60:63], v[24:27], v[92:95], 0
    ds_read_b64_tr_b16 v[46:47], v9 offset:1024
    s_add_u32 m0, s96, 32768
    s_mov_b32 s53, 2097152
    buffer_load_dwordx4 v3, s[92:95], s53 offen offset:0 lds
    s_waitcnt lgkmcnt(8)
    v_mfma_f32_16x16x32_bf16 v[64:67], v[28:31], v[88:91], 0
    ds_read_b64_tr_b16 v[48:49], v10 offset:0
    s_mov_b32 s53, 2128896
    buffer_load_dwordx4 v3, s[92:95], s53 offen offset:1024 lds
    v_mfma_f32_16x16x32_bf16 v[68:71], v[28:31], v[92:95], 0
    ds_read_b64_tr_b16 v[50:51], v10 offset:1024
    s_add_u32 m0, s97, 131072
    s_add_u32 s53, s98, 32768
    buffer_load_dwordx4 v2, s[44:47], s53 offen sc1 lds
    s_waitcnt lgkmcnt(8)
    v_mfma_f32_16x16x32_bf16 v[72:75], v[32:35], v[88:91], 0
    ds_read_b64_tr_b16 v[52:53], v11 offset:0
    s_add_u32 m0, s96, 49152
    s_mov_b32 s53, 2621440
    buffer_load_dwordx4 v3, s[92:95], s53 offen offset:0 lds
    v_mfma_f32_16x16x32_bf16 v[76:79], v[32:35], v[92:95], 0
    ds_read_b64_tr_b16 v[54:55], v11 offset:1024
    s_mov_b32 s53, 2653184
    buffer_load_dwordx4 v3, s[92:95], s53 offen offset:1024 lds
    s_waitcnt lgkmcnt(8)
    v_mfma_f32_16x16x32_bf16 v[80:83], v[36:39], v[88:91], 0
    ds_read_b64_tr_b16 v[24:25], v12 offset:0
    s_add_u32 m0, s97, 139264
    s_add_u32 s53, s98, 40960
    buffer_load_dwordx4 v2, s[44:47], s53 offen sc1 lds
    v_mfma_f32_16x16x32_bf16 v[84:87], v[36:39], v[92:95], 0
    ds_read_b64_tr_b16 v[26:27], v12 offset:512
    s_mul_i32 s6, s3, 648
    s_add_u32 s56, s32, s6
    s_addc_u32 s57, s33, 0
    s_mov_b32 s58, 648
    s_mov_b32 s59, 0x00020000
    s_lshl_b32 s6, s5, 8
    s_add_u32 m0, s6, 147456
    v_lshrrev_b32 v13, 2, v2
    buffer_load_dword v13, s[56:59], s6 offen lds
    s_waitcnt lgkmcnt(8)
    v_mfma_f32_16x16x32_bf16 v[128:131], v[40:43], v[88:91], 0
    ds_read_b64_tr_b16 v[28:29], v16 offset:0
    s_cmp_ge_u32 s4, 7
    s_cbranch_scc0 KSAE0
    buffer_store_dwordx4 v[192:195], v2, s[44:47], s82 offen offset:2048 sc1
KSAE0:
    v_mfma_f32_16x16x32_bf16 v[132:135], v[40:43], v[92:95], 0
    ds_read_b64_tr_b16 v[30:31], v16 offset:512
    s_waitcnt lgkmcnt(8)
    v_mfma_f32_16x16x32_bf16 v[136:139], v[44:47], v[88:91], 0
    ds_read_b64_tr_b16 v[32:33], v17 offset:0
    v_mfma_f32_16x16x32_bf16 v[140:143], v[44:47], v[92:95], 0
    ds_read_b64_tr_b16 v[34:35], v17 offset:512
    s_waitcnt lgkmcnt(8)
    v_mfma_f32_16x16x32_bf16 v[144:147], v[48:51], v[88:91], 0
    ds_read_b64_tr_b16 v[36:37], v18 offset:0
    v_mfma_f32_16x16x32_bf16 v[148:151], v[48:51], v[92:95], 0
    ds_read_b64_tr_b16 v[38:39], v18 offset:512
    s_cmp_ge_u32 s4, 7
    s_cbranch_scc1 KSAL0
    buffer_store_dwordx4 v[192:195], v2, s[44:47], s82 offen offset:2048 sc1
KSAL0:
    s_waitcnt lgkmcnt(8)
    v_mfma_f32_16x16x32_bf16 v[152:155], v[52:55], v[88:91], 0
    ds_read_b64_tr_b16 v[40:41], v4 offset:8192
    v_mfma_f32_16x16x32_bf16 v[156:159], v[52:55], v[92:95], 0
    ds_read_b64_tr_b16 v[42:43], v4 offset:9216
    s_waitcnt lgkmcnt(8)
    v_mfma_f32_16x16x32_bf16 v[160:163], v[24:27], v[88:91], 0
    ds_read_b64_tr_b16 v[44:45], v5 offset:8192
    v_mfma_f32_16x16x32_bf16 v[164:167], v[24:27], v[92:95], 0
    ds_read_b64_tr_b16 v[46:47], v5 offset:9216
    s_waitcnt lgkmcnt(8)
    v_mfma_f32_16x16x32_bf16 v[168:171], v[28:31], v[88:91], 0
    ds_read_b64_tr_b16 v[48:49], v6 offset:8192
    s_cmp_ge_u32 s4, 7
    s_cbranch_scc0 KSAE1
    buffer_store_dwordx4 v[196:199], v2, s[44:47], s83 offen offset:2048 sc1
KSAE1:
    v_mfma_f32_16x16x32_bf16 v[172:175], v[28:31], v[92:95], 0
    ds_read_b64_tr_b16 v[50:51], v6 offset:9216
    s_waitcnt lgkmcnt(8)
    v_mfma_f32_16x16x32_bf16 v[176:179], v[32:35], v[88:91], 0
    ds_read_b64_tr_b16 v[52:53], v7 offset:8192
    v_mfma_f32_16x16x32_bf16 v[180:183], v[32:35], v[92:95], 0
    ds_read_b64_tr_b16 v[54:55], v7 offset:9216
    s_waitcnt lgkmcnt(8)
    v_mfma_f32_16x16x32_bf16 v[184:187], v[36:39], v[88:91], 0
    ds_read_b64_tr_b16 v[24:25], v8 offset:8192
    v_mfma_f32_16x16x32_bf16 v[188:191], v[36:39], v[92:95], 0
    ds_read_b64_tr_b16 v[26:27], v8 offset:9216
    s_waitcnt vmcnt(20) lgkmcnt(8)
    v_mfma_f32_16x16x32_bf16 v[56:59], v[40:43], v[96:99], v[56:59]
    ds_read_b64_tr_b16 v[28:29], v9 offset:8192
    s_add_u32 s53, s99, 5120
    buffer_load_dwordx4 v[88:91], v2, s[44:47], s53 offen sc1
    s_waitcnt vmcnt(20)
    v_mfma_f32_16x16x32_bf16 v[60:63], v[40:43], v[100:103], v[60:63]
    ds_read_b64_tr_b16 v[30:31], v9 offset:9216
    s_add_u32 s53, s99, 23552
    buffer_load_dwordx4 v[92:95], v2, s[44:47], s53 offen sc1
    s_waitcnt lgkmcnt(8)
    v_mfma_f32_16x16x32_bf16 v[64:67], v[44:47], v[96:99], v[64:67]
    ds_read_b64_tr_b16 v[32:33], v10 offset:8192
    v_mfma_f32_16x16x32_bf16 v[68:71], v[44:47], v[100:103], v[68:71]
    ds_read_b64_tr_b16 v[34:35], v10 offset:9216
    s_waitcnt lgkmcnt(8)
    v_mfma_f32_16x16x32_bf16 v[72:75], v[48:51], v[96:99], v[72:75]
    ds_read_b64_tr_b16 v[36:37], v11 offset:8192
    s_cmp_ge_u32 s4, 7
    s_cbranch_scc0 KSAE2
    buffer_store_dwordx4 v[200:203], v2, s[44:47], s84 offen offset:2048 sc1
KSAE2:
    v_mfma_f32_16x16x32_bf16 v[76:79], v[48:51], v[100:103], v[76:79]
    ds_read_b64_tr_b16 v[38:39], v11 offset:9216
    s_waitcnt lgkmcnt(8)
    v_mfma_f32_16x16x32_bf16 v[80:83], v[52:55], v[96:99], v[80:83]
    ds_read_b64_tr_b16 v[40:41], v12 offset:4096
    v_mfma_f32_16x16x32_bf16 v[84:87], v[52:55], v[100:103], v[84:87]
    ds_read_b64_tr_b16 v[42:43], v12 offset:4608
    s_waitcnt lgkmcnt(8)
    v_mfma_f32_16x16x32_bf16 v[128:131], v[24:27], v[96:99], v[128:131]
    ds_read_b64_tr_b16 v[44:45], v16 offset:4096
    v_mfma_f32_16x16x32_bf16 v[132:135], v[24:27], v[100:103], v[132:135]
    ds_read_b64_tr_b16 v[46:47], v16 offset:4608
    s_cmp_ge_u32 s4, 7
    s_cbranch_scc1 KSAL1
    buffer_store_dwordx4 v[196:199], v2, s[44:47], s83 offen offset:2048 sc1
KSAL1:
    s_waitcnt lgkmcnt(8)
    v_mfma_f32_16x16x32_bf16 v[136:139], v[28:31], v[96:99], v[136:139]
    ds_read_b64_tr_b16 v[48:49], v17 offset:4096
    v_mfma_f32_16x16x32_bf16 v[140:143], v[28:31], v[100:103], v[140:143]
    ds_read_b64_tr_b16 v[50:51], v17 offset:4608
    s_waitcnt lgkmcnt(8)
    v_mfma_f32_16x16x32_bf16 v[144:147], v[32:35], v[96:99], v[144:147]
    ds_read_b64_tr_b16 v[52:53], v18 offset:4096
    v_mfma_f32_16x16x32_bf16 v[148:151], v[32:35], v[100:103], v[148:151]
    ds_read_b64_tr_b16 v[54:55], v18 offset:4608
    s_waitcnt lgkmcnt(8)
    v_mfma_f32_16x16x32_bf16 v[152:155], v[36:39], v[96:99], v[152:155]
    v_add_u32 v4, 0x4000, v4
    v_add_u32 v5, 0x4000, v5
    v_add_u32 v6, 0x4000, v6
    v_add_u32 v7, 0x4000, v7
    v_add_u32 v8, 0x4000, v8
    v_add_u32 v9, 0x4000, v9
    v_add_u32 v10, 0x4000, v10
    v_add_u32 v11, 0x4000, v11
    v_add_u32 v12, 0x2000, v12
    v_add_u32 v16, 0x2000, v16
    v_add_u32 v17, 0x2000, v17
    v_add_u32 v18, 0x2000, v18
    s_barrier
    ds_read_b64_tr_b16 v[24:25], v4 offset:0
    s_cmp_ge_u32 s4, 7
    s_cbranch_scc0 KSAE3
    buffer_store_dwordx4 v[204:207], v2, s[44:47], s85 offen offset:2048 sc1
KSAE3:
    v_mfma_f32_16x16x32_bf16 v[156:159], v[36:39], v[100:103], v[156:159]
    ds_read_b64_tr_b16 v[26:27], v4 offset:1024
    s_waitcnt lgkmcnt(8)
    v_mfma_f32_16x16x32_bf16 v[160:163], v[40:43], v[96:99], v[160:163]
    ds_read_b64_tr_b16 v[28:29], v5 offset:0
    v_mfma_f32_16x16x32_bf16 v[164:167], v[40:43], v[100:103], v[164:167]
    ds_read_b64_tr_b16 v[30:31], v5 offset:1024
    s_waitcnt lgkmcnt(8)
    v_mfma_f32_16x16x32_bf16 v[168:171], v[44:47], v[96:99], v[168:171]
    ds_read_b64_tr_b16 v[32:33], v6 offset:0
    v_mfma_f32_16x16x32_bf16 v[172:175], v[44:47], v[100:103], v[172:175]
    ds_read_b64_tr_b16 v[34:35], v6 offset:1024
    s_waitcnt lgkmcnt(8)
    v_mfma_f32_16x16x32_bf16 v[176:179], v[48:51], v[96:99], v[176:179]
    ds_read_b64_tr_b16 v[36:37], v7 offset:0
    v_mfma_f32_16x16x32_bf16 v[180:183], v[48:51], v[100:103], v[180:183]
    ds_read_b64_tr_b16 v[38:39], v7 offset:1024
    s_waitcnt lgkmcnt(8)
    v_mfma_f32_16x16x32_bf16 v[184:187], v[52:55], v[96:99], v[184:187]
    ds_read_b64_tr_b16 v[40:41], v8 offset:0
    v_mfma_f32_16x16x32_bf16 v[188:191], v[52:55], v[100:103], v[188:191]
    ds_read_b64_tr_b16 v[42:43], v8 offset:1024
    s_waitcnt vmcnt(20) lgkmcnt(8)
    v_mfma_f32_16x16x32_bf16 v[56:59], v[24:27], v[104:107], v[56:59]
    ds_read_b64_tr_b16 v[44:45], v9 offset:0
    s_cmp_ge_u32 s4, 7
    s_cbranch_scc0 KSAE4
    buffer_store_dwordx4 v[208:211], v2, s[44:47], s82 offen offset:0 sc1
KSAE4:
    s_add_u32 s53, s99, 6144
    buffer_load_dwordx4 v[96:99], v2, s[44:47], s53 offen sc1
    s_waitcnt vmcnt(20)
    v_mfma_f32_16x16x32_bf16 v[60:63], v[24:27], v[108:111], v[60:63]
    ds_read_b64_tr_b16 v[46:47], v9 offset:1024
    s_add_u32 s53, s99, 24576
    buffer_load_dwordx4 v[100:103], v2, s[44:47], s53 offen sc1
    s_waitcnt lgkmcnt(8)
    v_mfma_f32_16x16x32_bf16 v[64:67], v[28:31], v[104:107], v[64:67]
    ds_read_b64_tr_b16 v[48:49], v10 offset:0
    v_mfma_f32_16x16x32_bf16 v[68:71], v[28:31], v[108:111], v[68:71]
    ds_read_b64_tr_b16 v[50:51], v10 offset:1024
    s_waitcnt lgkmcnt(8)
    v_mfma_f32_16x16x32_bf16 v[72:75], v[32:35], v[104:107], v[72:75]
    ds_read_b64_tr_b16 v[52:53], v11 offset:0
    v_mfma_f32_16x16x32_bf16 v[76:79], v[32:35], v[108:111], v[76:79]
    ds_read_b64_tr_b16 v[54:55], v11 offset:1024
    s_cmp_ge_u32 s4, 7
    s_cbranch_scc1 KSAL2
    buffer_store_dwordx4 v[200:203], v2, s[44:47], s84 offen offset:2048 sc1
KSAL2:
    s_waitcnt lgkmcnt(8)
    v_mfma_f32_16x16x32_bf16 v[80:83], v[36:39], v[104:107], v[80:83]
    ds_read_b64_tr_b16 v[24:25], v12 offset:0
    v_mfma_f32_16x16x32_bf16 v[84:87], v[36:39], v[108:111], v[84:87]
    ds_read_b64_tr_b16 v[26:27], v12 offset:512
    s_waitcnt lgkmcnt(8)
    v_mfma_f32_16x16x32_bf16 v[128:131], v[40:43], v[104:107], v[128:131]
    ds_read_b64_tr_b16 v[28:29], v16 offset:0
    v_mfma_f32_16x16x32_bf16 v[132:135], v[40:43], v[108:111], v[132:135]
    ds_read_b64_tr_b16 v[30:31], v16 offset:512
    s_waitcnt lgkmcnt(8)
    v_mfma_f32_16x16x32_bf16 v[136:139], v[44:47], v[104:107], v[136:139]
    ds_read_b64_tr_b16 v[32:33], v17 offset:0
    s_cmp_ge_u32 s4, 7
    s_cbranch_scc0 KSAE5
    buffer_store_dwordx4 v[212:215], v2, s[44:47], s83 offen offset:0 sc1
KSAE5:
    v_mfma_f32_16x16x32_bf16 v[140:143], v[44:47], v[108:111], v[140:143]
    ds_read_b64_tr_b16 v[34:35], v17 offset:512
    s_waitcnt lgkmcnt(8)
    v_mfma_f32_16x16x32_bf16 v[144:147], v[48:51], v[104:107], v[144:147]
    ds_read_b64_tr_b16 v[36:37], v18 offset:0
    v_mfma_f32_16x16x32_bf16 v[148:151], v[48:51], v[108:111], v[148:151]
    ds_read_b64_tr_b16 v[38:39], v18 offset:512
    s_waitcnt lgkmcnt(8)
    v_mfma_f32_16x16x32_bf16 v[152:155], v[52:55], v[104:107], v[152:155]
    ds_read_b64_tr_b16 v[40:41], v4 offset:8192
    v_mfma_f32_16x16x32_bf16 v[156:159], v[52:55], v[108:111], v[156:159]
    ds_read_b64_tr_b16 v[42:43], v4 offset:9216
    s_waitcnt lgkmcnt(8)
    v_mfma_f32_16x16x32_bf16 v[160:163], v[24:27], v[104:107], v[160:163]
    ds_read_b64_tr_b16 v[44:45], v5 offset:8192
    v_mfma_f32_16x16x32_bf16 v[164:167], v[24:27], v[108:111], v[164:167]
    ds_read_b64_tr_b16 v[46:47], v5 offset:9216
    s_waitcnt lgkmcnt(8)
    v_mfma_f32_16x16x32_bf16 v[168:171], v[28:31], v[104:107], v[168:171]
    ds_read_b64_tr_b16 v[48:49], v6 offset:8192
    v_mfma_f32_16x16x32_bf16 v[172:175], v[28:31], v[108:111], v[172:175]
    ds_read_b64_tr_b16 v[50:51], v6 offset:9216
    s_waitcnt lgkmcnt(8)
    v_mfma_f32_16x16x32_bf16 v[176:179], v[32:35], v[104:107], v[176:179]
    ds_read_b64_tr_b16 v[52:53], v7 offset:8192
    s_cmp_ge_u32 s4, 7
    s_cbranch_scc0 KSAE6
    buffer_store_dwordx4 v[216:219], v2, s[44:47], s84 offen offset:0 sc1
KSAE6:
    v_mfma_f32_16x16x32_bf16 v[180:183], v[32:35], v[108:111], v[180:183]
    ds_read_b64_tr_b16 v[54:55], v7 offset:9216
    s_waitcnt lgkmcnt(8)
    v_mfma_f32_16x16x32_bf16 v[184:187], v[36:39], v[104:107], v[184:187]
    ds_read_b64_tr_b16 v[24:25], v8 offset:8192
    v_mfma_f32_16x16x32_bf16 v[188:191], v[36:39], v[108:111], v[188:191]
    ds_read_b64_tr_b16 v[26:27], v8 offset:9216
    s_waitcnt vmcnt(20) lgkmcnt(8)
    v_mfma_f32_16x16x32_bf16 v[56:59], v[40:43], v[112:115], v[56:59]
    ds_read_b64_tr_b16 v[28:29], v9 offset:8192
    s_add_u32 s53, s99, 7168
    buffer_load_dwordx4 v[104:107], v2, s[44:47], s53 offen sc1
    s_waitcnt vmcnt(20)
    v_mfma_f32_16x16x32_bf16 v[60:63], v[40:43], v[116:119], v[60:63]
    ds_read_b64_tr_b16 v[30:31], v9 offset:9216
    s_cmp_ge_u32 s4, 7
    s_cbranch_scc1 KSAL3
    buffer_store_dwordx4 v[204:207], v2, s[44:47], s85 offen offset:2048 sc1
KSAL3:
    s_add_u32 s53, s99, 25600
    buffer_load_dwordx4 v[108:111], v2, s[44:47], s53 offen sc1
    s_waitcnt lgkmcnt(8)
    v_mfma_f32_16x16x32_bf16 v[64:67], v[44:47], v[112:115], v[64:67]
    ds_read_b64_tr_b16 v[32:33], v10 offset:8192
    v_mfma_f32_16x16x32_bf16 v[68:71], v[44:47], v[116:119], v[68:71]
    ds_read_b64_tr_b16 v[34:35], v10 offset:9216
    s_waitcnt lgkmcnt(8)
    v_mfma_f32_16x16x32_bf16 v[72:75], v[48:51], v[112:115], v[72:75]
    ds_read_b64_tr_b16 v[36:37], v11 offset:8192
    v_mfma_f32_16x16x32_bf16 v[76:79], v[48:51], v[116:119], v[76:79]
    ds_read_b64_tr_b16 v[38:39], v11 offset:9216
    s_waitcnt lgkmcnt(8)
    v_mfma_f32_16x16x32_bf16 v[80:83], v[52:55], v[112:115], v[80:83]
    ds_read_b64_tr_b16 v[40:41], v12 offset:4096
    s_cmp_ge_u32 s4, 7
    s_cbranch_scc0 KSAE7
    buffer_store_dwordx4 v[220:223], v2, s[44:47], s85 offen offset:0 sc1
KSAE7:
    v_mfma_f32_16x16x32_bf16 v[84:87], v[52:55], v[116:119], v[84:87]
    ds_read_b64_tr_b16 v[42:43], v12 offset:4608
    s_waitcnt lgkmcnt(8)
    v_mfma_f32_16x16x32_bf16 v[128:131], v[24:27], v[112:115], v[128:131]
    ds_read_b64_tr_b16 v[44:45], v16 offset:4096
    v_mfma_f32_16x16x32_bf16 v[132:135], v[24:27], v[116:119], v[132:135]
    ds_read_b64_tr_b16 v[46:47], v16 offset:4608
    s_waitcnt lgkmcnt(8)
    v_mfma_f32_16x16x32_bf16 v[136:139], v[28:31], v[112:115], v[136:139]
    ds_read_b64_tr_b16 v[48:49], v17 offset:4096
    v_mfma_f32_16x16x32_bf16 v[140:143], v[28:31], v[116:119], v[140:143]
    ds_read_b64_tr_b16 v[50:51], v17 offset:4608
    s_waitcnt lgkmcnt(8)
    v_mfma_f32_16x16x32_bf16 v[144:147], v[32:35], v[112:115], v[144:147]
    ds_read_b64_tr_b16 v[52:53], v18 offset:4096
    v_mfma_f32_16x16x32_bf16 v[148:151], v[32:35], v[116:119], v[148:151]
    ds_read_b64_tr_b16 v[54:55], v18 offset:4608
    s_waitcnt lgkmcnt(8)
    v_mfma_f32_16x16x32_bf16 v[152:155], v[36:39], v[112:115], v[152:155]
    v_add_u32 v4, 0x8000, v4
    v_add_u32 v5, 0x8000, v5
    v_add_u32 v6, 0x8000, v6
    v_add_u32 v7, 0x8000, v7
    v_add_u32 v8, 0x8000, v8
    v_add_u32 v9, 0x8000, v9
    v_add_u32 v10, 0x8000, v10
    v_add_u32 v11, 0x8000, v11
    v_add_u32 v12, 0xfffe6000, v12
    v_add_u32 v16, 0xfffe6000, v16
    v_add_u32 v17, 0xfffe6000, v17
    v_add_u32 v18, 0xfffe6000, v18
    s_waitcnt vmcnt(14)
    s_barrier
    ds_read_b64_tr_b16 v[24:25], v4 offset:0
    v_mfma_f32_16x16x32_bf16 v[156:159], v[36:39], v[116:119], v[156:159]
    ds_read_b64_tr_b16 v[26:27], v4 offset:1024
    s_waitcnt lgkmcnt(8)
    v_mfma_f32_16x16x32_bf16 v[160:163], v[40:43], v[112:115], v[160:163]
    ds_read_b64_tr_b16 v[28:29], v5 offset:0
    s_add_u32 m0, s96, 65536
    s_mov_b32 s53, 3145728
    buffer_load_dwordx4 v3, s[92:95], s53 offen offset:0 lds
    s_cmp_ge_u32 s4, 7
    s_cbranch_scc0 KSAE8
    buffer_store_dwordx4 v[224:227], v2, s[44:47], s82 offen offset:3072 sc1
KSAE8:
    v_mfma_f32_16x16x32_bf16 v[164:167], v[40:43], v[116:119], v[164:167]
    ds_read_b64_tr_b16 v[30:31], v5 offset:1024
    s_mov_b32 s53, 3177472
    buffer_load_dwordx4 v3, s[92:95], s53 offen offset:1024 lds
    s_waitcnt lgkmcnt(8)
    v_mfma_f32_16x16x32_bf16 v[168:171], v[44:47], v[112:115], v[168:171]
    ds_read_b64_tr_b16 v[32:33], v6 offset:0
    s_add_u32 m0, s97, 155648
    s_add_u32 s53, s98, 65536
    buffer_load_dwordx4 v2, s[44:47], s53 offen sc1 lds
    v_mfma_f32_16x16x32_bf16 v[172:175], v[44:47], v[116:119], v[172:175]
    ds_read_b64_tr_b16 v[34:35], v6 offset:1024
    s_waitcnt lgkmcnt(8)
    v_mfma_f32_16x16x32_bf16 v[176:179], v[48:51], v[112:115], v[176:179]
    ds_read_b64_tr_b16 v[36:37], v7 offset:0
    v_mfma_f32_16x16x32_bf16 v[180:183], v[48:51], v[116:119], v[180:183]
    ds_read_b64_tr_b16 v[38:39], v7 offset:1024
    s_cmp_ge_u32 s4, 7
    s_cbranch_scc1 KSAL4
    buffer_store_dwordx4 v[208:211], v2, s[44:47], s82 offen offset:0 sc1
KSAL4:
    s_waitcnt lgkmcnt(8)
    v_mfma_f32_16x16x32_bf16 v[184:187], v[52:55], v[112:115], v[184:187]
    ds_read_b64_tr_b16 v[40:41], v8 offset:0
    v_mfma_f32_16x16x32_bf16 v[188:191], v[52:55], v[116:119], v[188:191]
    ds_read_b64_tr_b16 v[42:43], v8 offset:1024
    s_waitcnt lgkmcnt(8)
    v_mfma_f32_16x16x32_bf16 v[56:59], v[24:27], v[120:123], v[56:59]
    ds_read_b64_tr_b16 v[44:45], v9 offset:0
    s_add_u32 s53, s99, 8192
    buffer_load_dwordx4 v[112:115], v2, s[44:47], s53 offen sc1
    v_mfma_f32_16x16x32_bf16 v[60:63], v[24:27], v[124:127], v[60:63]
    ds_read_b64_tr_b16 v[46:47], v9 offset:1024
    s_add_u32 s53, s99, 26624
    buffer_load_dwordx4 v[116:119], v2, s[44:47], s53 offen sc1
    s_waitcnt lgkmcnt(8)
    v_mfma_f32_16x16x32_bf16 v[64:67], v[28:31], v[120:123], v[64:67]
    ds_read_b64_tr_b16 v[48:49], v10 offset:0
    s_cmp_ge_u32 s4, 7
    s_cbranch_scc0 KSAE9
    buffer_store_dwordx4 v[228:231], v2, s[44:47], s83 offen offset:3072 sc1
KSAE9:
    v_mfma_f32_16x16x32_bf16 v[68:71], v[28:31], v[124:127], v[68:71]
    ds_read_b64_tr_b16 v[50:51], v10 offset:1024
    s_waitcnt lgkmcnt(8)
    v_mfma_f32_16x16x32_bf16 v[72:75], v[32:35], v[120:123], v[72:75]
    ds_read_b64_tr_b16 v[52:53], v11 offset:0
    v_mfma_f32_16x16x32_bf16 v[76:79], v[32:35], v[124:127], v[76:79]
    ds_read_b64_tr_b16 v[54:55], v11 offset:1024
    s_waitcnt lgkmcnt(8)
    v_mfma_f32_16x16x32_bf16 v[80:83], v[36:39], v[120:123], v[80:83]
    ds_read_b64_tr_b16 v[24:25], v12 offset:0
    v_mfma_f32_16x16x32_bf16 v[84:87], v[36:39], v[124:127], v[84:87]
    ds_read_b64_tr_b16 v[26:27], v12 offset:512
    s_waitcnt lgkmcnt(8)
    v_mfma_f32_16x16x32_bf16 v[128:131], v[40:43], v[120:123], v[128:131]
    ds_read_b64_tr_b16 v[28:29], v16 offset:0
    v_mfma_f32_16x16x32_bf16 v[132:135], v[40:43], v[124:127], v[132:135]
    ds_read_b64_tr_b16 v[30:31], v16 offset:512
    s_waitcnt lgkmcnt(8)
    v_mfma_f32_16x16x32_bf16 v[136:139], v[44:47], v[120:123], v[136:139]
    ds_read_b64_tr_b16 v[32:33], v17 offset:0
    v_mfma_f32_16x16x32_bf16 v[140:143], v[44:47], v[124:127], v[140:143]
    ds_read_b64_tr_b16 v[34:35], v17 offset:512
    s_waitcnt lgkmcnt(8)
    v_mfma_f32_16x16x32_bf16 v[144:147], v[48:51], v[120:123], v[144:147]
    ds_read_b64_tr_b16 v[36:37], v18 offset:0
    s_cmp_ge_u32 s4, 7
    s_cbranch_scc0 KSAE10
    buffer_store_dwordx4 v[232:235], v2, s[44:47], s84 offen offset:3072 sc1
KSAE10:
    v_mfma_f32_16x16x32_bf16 v[148:151], v[48:51], v[124:127], v[148:151]
    ds_read_b64_tr_b16 v[38:39], v18 offset:512
    s_waitcnt lgkmcnt(8)
    v_mfma_f32_16x16x32_bf16 v[152:155], v[52:55], v[120:123], v[152:155]
    ds_read_b64_tr_b16 v[40:41], v4 offset:8192
    v_mfma_f32_16x16x32_bf16 v[156:159], v[52:55], v[124:127], v[156:159]
    ds_read_b64_tr_b16 v[42:43], v4 offset:9216
    s_waitcnt lgkmcnt(8)
    v_mfma_f32_16x16x32_bf16 v[160:163], v[24:27], v[120:123], v[160:163]
    ds_read_b64_tr_b16 v[44:45], v5 offset:8192
    v_mfma_f32_16x16x32_bf16 v[164:167], v[24:27], v[124:127], v[164:167]
    ds_read_b64_tr_b16 v[46:47], v5 offset:9216
    s_cmp_ge_u32 s4, 7
    s_cbranch_scc1 KSAL5
    buffer_store_dwordx4 v[212:215], v2, s[44:47], s83 offen offset:0 sc1
KSAL5:
    s_waitcnt lgkmcnt(8)
    v_mfma_f32_16x16x32_bf16 v[168:171], v[28:31], v[120:123], v[168:171]
    ds_read_b64_tr_b16 v[48:49], v6 offset:8192
    v_mfma_f32_16x16x32_bf16 v[172:175], v[28:31], v[124:127], v[172:175]
    ds_read_b64_tr_b16 v[50:51], v6 offset:9216
    s_waitcnt lgkmcnt(8)
    v_mfma_f32_16x16x32_bf16 v[176:179], v[32:35], v[120:123], v[176:179]
    ds_read_b64_tr_b16 v[52:53], v7 offset:8192
    v_mfma_f32_16x16x32_bf16 v[180:183], v[32:35], v[124:127], v[180:183]
    ds_read_b64_tr_b16 v[54:55], v7 offset:9216
    s_waitcnt lgkmcnt(8)
    v_mfma_f32_16x16x32_bf16 v[184:187], v[36:39], v[120:123], v[184:187]
    ds_read_b64_tr_b16 v[24:25], v8 offset:8192
    s_cmp_ge_u32 s4, 7
    s_cbranch_scc0 KSAE11
    buffer_store_dwordx4 v[236:239], v2, s[44:47], s85 offen offset:3072 sc1
KSAE11:
    v_mfma_f32_16x16x32_bf16 v[188:191], v[36:39], v[124:127], v[188:191]
    ds_read_b64_tr_b16 v[26:27], v8 offset:9216
    s_waitcnt vmcnt(10) lgkmcnt(8)
    v_mfma_f32_16x16x32_bf16 v[56:59], v[40:43], v[88:91], v[56:59]
    ds_read_b64_tr_b16 v[28:29], v9 offset:8192
    s_add_u32 s53, s99, 9216
    buffer_load_dwordx4 v[120:123], v2, s[44:47], s53 offen sc1
    s_waitcnt vmcnt(10)
    v_mfma_f32_16x16x32_bf16 v[60:63], v[40:43], v[92:95], v[60:63]
    ds_read_b64_tr_b16 v[30:31], v9 offset:9216
    s_add_u32 s53, s99, 27648
    buffer_load_dwordx4 v[124:127], v2, s[44:47], s53 offen sc1
    s_waitcnt lgkmcnt(8)
    v_mfma_f32_16x16x32_bf16 v[64:67], v[44:47], v[88:91], v[64:67]
    ds_read_b64_tr_b16 v[32:33], v10 offset:8192
    v_mfma_f32_16x16x32_bf16 v[68:71], v[44:47], v[92:95], v[68:71]
    ds_read_b64_tr_b16 v[34:35], v10 offset:9216
    s_waitcnt lgkmcnt(8)
    v_mfma_f32_16x16x32_bf16 v[72:75], v[48:51], v[88:91], v[72:75]
    ds_read_b64_tr_b16 v[36:37], v11 offset:8192
    v_mfma_f32_16x16x32_bf16 v[76:79], v[48:51], v[92:95], v[76:79]
    ds_read_b64_tr_b16 v[38:39], v11 offset:9216
    s_waitcnt lgkmcnt(8)
    v_mfma_f32_16x16x32_bf16 v[80:83], v[52:55], v[88:91], v[80:83]
    ds_read_b64_tr_b16 v[40:41], v12 offset:4096
    v_mfma_f32_16x16x32_bf16 v[84:87], v[52:55], v[92:95], v[84:87]
    ds_read_b64_tr_b16 v[42:43], v12 offset:4608
    s_waitcnt lgkmcnt(8)
    v_mfma_f32_16x16x32_bf16 v[128:131], v[24:27], v[88:91], v[128:131]
    ds_read_b64_tr_b16 v[44:45], v16 offset:4096
    s_cmp_ge_u32 s4, 7
    s_cbranch_scc0 KSAE12
    buffer_store_dwordx4 v[240:243], v2, s[44:47], s82 offen offset:1024 sc1
KSAE12:
    v_mfma_f32_16x16x32_bf16 v[132:135], v[24:27], v[92:95], v[132:135]
    ds_read_b64_tr_b16 v[46:47], v16 offset:4608
    s_waitcnt lgkmcnt(8)
    v_mfma_f32_16x16x32_bf16 v[136:139], v[28:31], v[88:91], v[136:139]
    ds_read_b64_tr_b16 v[48:49], v17 offset:4096
    v_mfma_f32_16x16x32_bf16 v[140:143], v[28:31], v[92:95], v[140:143]
    ds_read_b64_tr_b16 v[50:51], v17 offset:4608
    s_waitcnt lgkmcnt(8)
    v_mfma_f32_16x16x32_bf16 v[144:147], v[32:35], v[88:91], v[144:147]
    ds_read_b64_tr_b16 v[52:53], v18 offset:4096
    v_mfma_f32_16x16x32_bf16 v[148:151], v[32:35], v[92:95], v[148:151]
    ds_read_b64_tr_b16 v[54:55], v18 offset:4608
    s_cmp_ge_u32 s4, 7
    s_cbranch_scc1 KSAL6
    buffer_store_dwordx4 v[216:219], v2, s[44:47], s84 offen offset:0 sc1
KSAL6:
    s_waitcnt lgkmcnt(8)
    v_mfma_f32_16x16x32_bf16 v[152:155], v[36:39], v[88:91], v[152:155]
    v_add_u32 v4, 0xfffe8000, v4
    v_add_u32 v5, 0xfffe8000, v5
    v_add_u32 v6, 0xfffe8000, v6
    v_add_u32 v7, 0xfffe8000, v7
    v_add_u32 v8, 0xfffe8000, v8
    v_add_u32 v9, 0xfffe8000, v9
    v_add_u32 v10, 0xfffe8000, v10
    v_add_u32 v11, 0xfffe8000, v11
    v_add_u32 v12, 0x2000, v12
    v_add_u32 v16, 0x2000, v16
    v_add_u32 v17, 0x2000, v17
    v_add_u32 v18, 0x2000, v18
    s_barrier
    ds_read_b64_tr_b16 v[24:25], v4 offset:0
    v_mfma_f32_16x16x32_bf16 v[156:159], v[36:39], v[92:95], v[156:159]
    ds_read_b64_tr_b16 v[26:27], v4 offset:1024
    s_waitcnt lgkmcnt(8)
    v_mfma_f32_16x16x32_bf16 v[160:163], v[40:43], v[88:91], v[160:163]
    ds_read_b64_tr_b16 v[28:29], v5 offset:0
    s_add_u32 m0, s96, 81920
    s_mov_b32 s53, 3670016
    buffer_load_dwordx4 v3, s[92:95], s53 offen offset:0 lds
    v_mfma_f32_16x16x32_bf16 v[164:167], v[40:43], v[92:95], v[164:167]
    ds_read_b64_tr_b16 v[30:31], v5 offset:1024
    s_mov_b32 s53, 3701760
    buffer_load_dwordx4 v3, s[92:95], s53 offen offset:1024 lds
    s_waitcnt lgkmcnt(8)
    v_mfma_f32_16x16x32_bf16 v[168:171], v[44:47], v[88:91], v[168:171]
    ds_read_b64_tr_b16 v[32:33], v6 offset:0
    s_add_u32 m0, s97, 98304
    s_add_u32 s53, s98, 49152
    buffer_load_dwordx4 v2, s[44:47], s53 offen sc1 lds
    s_cmp_ge_u32 s4, 7
    s_cbranch_scc0 KSAE13
    buffer_store_dwordx4 v[244:247], v2, s[44:47], s83 offen offset:1024 sc1
KSAE13:
    v_mfma_f32_16x16x32_bf16 v[172:175], v[44:47], v[92:95], v[172:175]
    ds_read_b64_tr_b16 v[34:35], v6 offset:1024
    s_add_u32 m0, s97, 106496
    s_add_u32 s53, s98, 57344
    buffer_load_dwordx4 v2, s[44:47], s53 offen sc1 lds
    s_waitcnt lgkmcnt(8)
    v_mfma_f32_16x16x32_bf16 v[176:179], v[48:51], v[88:91], v[176:179]
    ds_read_b64_tr_b16 v[36:37], v7 offset:0
    v_mfma_f32_16x16x32_bf16 v[180:183], v[48:51], v[92:95], v[180:183]
    ds_read_b64_tr_b16 v[38:39], v7 offset:1024
    s_waitcnt lgkmcnt(8)
    v_mfma_f32_16x16x32_bf16 v[184:187], v[52:55], v[88:91], v[184:187]
    ds_read_b64_tr_b16 v[40:41], v8 offset:0
    v_mfma_f32_16x16x32_bf16 v[188:191], v[52:55], v[92:95], v[188:191]
    ds_read_b64_tr_b16 v[42:43], v8 offset:1024
    s_waitcnt vmcnt(14) lgkmcnt(8)
    v_mfma_f32_16x16x32_bf16 v[56:59], v[24:27], v[96:99], v[56:59]
    ds_read_b64_tr_b16 v[44:45], v9 offset:0
    s_add_u32 s53, s99, 10240
    buffer_load_dwordx4 v[88:91], v2, s[44:47], s53 offen sc1
    s_waitcnt vmcnt(14)
    v_mfma_f32_16x16x32_bf16 v[60:63], v[24:27], v[100:103], v[60:63]
    ds_read_b64_tr_b16 v[46:47], v9 offset:1024
    s_add_u32 s53, s99, 28672
    buffer_load_dwordx4 v[92:95], v2, s[44:47], s53 offen sc1
    s_waitcnt lgkmcnt(8)
    v_mfma_f32_16x16x32_bf16 v[64:67], v[28:31], v[96:99], v[64:67]
    ds_read_b64_tr_b16 v[48:49], v10 offset:0
    v_mfma_f32_16x16x32_bf16 v[68:71], v[28:31], v[100:103], v[68:71]
    ds_read_b64_tr_b16 v[50:51], v10 offset:1024
    s_waitcnt lgkmcnt(8)
    v_mfma_f32_16x16x32_bf16 v[72:75], v[32:35], v[96:99], v[72:75]
    ds_read_b64_tr_b16 v[52:53], v11 offset:0
    s_cmp_ge_u32 s4, 7
    s_cbranch_scc0 KSAE14
    buffer_store_dwordx4 v[248:251], v2, s[44:47], s84 offen offset:1024 sc1
KSAE14:
    v_mfma_f32_16x16x32_bf16 v[76:79], v[32:35], v[100:103], v[76:79]
    ds_read_b64_tr_b16 v[54:55], v11 offset:1024
    s_waitcnt lgkmcnt(8)
    v_mfma_f32_16x16x32_bf16 v[80:83], v[36:39], v[96:99], v[80:83]
    ds_read_b64_tr_b16 v[24:25], v12 offset:0
    v_mfma_f32_16x16x32_bf16 v[84:87], v[36:39], v[100:103], v[84:87]
    ds_read_b64_tr_b16 v[26:27], v12 offset:512
    s_waitcnt lgkmcnt(8)
    v_mfma_f32_16x16x32_bf16 v[128:131], v[40:43], v[96:99], v[128:131]
    ds_read_b64_tr_b16 v[28:29], v16 offset:0
    v_mfma_f32_16x16x32_bf16 v[132:135], v[40:43], v[100:103], v[132:135]
    ds_read_b64_tr_b16 v[30:31], v16 offset:512
    s_cmp_ge_u32 s4, 7
    s_cbranch_scc1 KSAL7
    buffer_store_dwordx4 v[220:223], v2, s[44:47], s85 offen offset:0 sc1
KSAL7:
    s_waitcnt lgkmcnt(8)
    v_mfma_f32_16x16x32_bf16 v[136:139], v[44:47], v[96:99], v[136:139]
    ds_read_b64_tr_b16 v[32:33], v17 offset:0
    v_mfma_f32_16x16x32_bf16 v[140:143], v[44:47], v[100:103], v[140:143]
    ds_read_b64_tr_b16 v[34:35], v17 offset:512
    s_waitcnt lgkmcnt(8)
    v_mfma_f32_16x16x32_bf16 v[144:147], v[48:51], v[96:99], v[144:147]
    ds_read_b64_tr_b16 v[36:37], v18 offset:0
    v_mfma_f32_16x16x32_bf16 v[148:151], v[48:51], v[100:103], v[148:151]
    ds_read_b64_tr_b16 v[38:39], v18 offset:512
    s_waitcnt lgkmcnt(8)
    v_mfma_f32_16x16x32_bf16 v[152:155], v[52:55], v[96:99], v[152:155]
    ds_read_b64_tr_b16 v[40:41], v4 offset:8192
    s_cmp_ge_u32 s4, 7
    s_cbranch_scc0 KSAE15
    buffer_store_dwordx4 v[252:255], v2, s[44:47], s85 offen offset:1024 sc1
KSAE15:
    v_mfma_f32_16x16x32_bf16 v[156:159], v[52:55], v[100:103], v[156:159]
    ds_read_b64_tr_b16 v[42:43], v4 offset:9216
    s_waitcnt lgkmcnt(8)
    v_mfma_f32_16x16x32_bf16 v[160:163], v[24:27], v[96:99], v[160:163]
    ds_read_b64_tr_b16 v[44:45], v5 offset:8192
    v_mfma_f32_16x16x32_bf16 v[164:167], v[24:27], v[100:103], v[164:167]
    ds_read_b64_tr_b16 v[46:47], v5 offset:9216
    s_waitcnt lgkmcnt(8)
    v_mfma_f32_16x16x32_bf16 v[168:171], v[28:31], v[96:99], v[168:171]
    ds_read_b64_tr_b16 v[48:49], v6 offset:8192
    v_mfma_f32_16x16x32_bf16 v[172:175], v[28:31], v[100:103], v[172:175]
    ds_read_b64_tr_b16 v[50:51], v6 offset:9216
    s_waitcnt lgkmcnt(8)
    v_mfma_f32_16x16x32_bf16 v[176:179], v[32:35], v[96:99], v[176:179]
    ds_read_b64_tr_b16 v[52:53], v7 offset:8192
    v_mfma_f32_16x16x32_bf16 v[180:183], v[32:35], v[100:103], v[180:183]
    ds_read_b64_tr_b16 v[54:55], v7 offset:9216
    s_waitcnt lgkmcnt(8)
    v_mfma_f32_16x16x32_bf16 v[184:187], v[36:39], v[96:99], v[184:187]
    ds_read_b64_tr_b16 v[24:25], v8 offset:8192
    v_mfma_f32_16x16x32_bf16 v[188:191], v[36:39], v[100:103], v[188:191]
    ds_read_b64_tr_b16 v[26:27], v8 offset:9216
    s_waitcnt vmcnt(14) lgkmcnt(8)
    v_mfma_f32_16x16x32_bf16 v[56:59], v[40:43], v[104:107], v[56:59]
    ds_read_b64_tr_b16 v[28:29], v9 offset:8192
    s_add_u32 s53, s99, 11264
    buffer_load_dwordx4 v[96:99], v2, s[44:47], s53 offen sc1
    s_waitcnt vmcnt(14)
    v_mfma_f32_16x16x32_bf16 v[60:63], v[40:43], v[108:111], v[60:63]
    ds_read_b64_tr_b16 v[30:31], v9 offset:9216
    s_add_u32 s53, s99, 29696
    buffer_load_dwordx4 v[100:103], v2, s[44:47], s53 offen sc1
    s_waitcnt lgkmcnt(8)
    v_mfma_f32_16x16x32_bf16 v[64:67], v[44:47], v[104:107], v[64:67]
    ds_read_b64_tr_b16 v[32:33], v10 offset:8192
    v_mfma_f32_16x16x32_bf16 v[68:71], v[44:47], v[108:111], v[68:71]
    ds_read_b64_tr_b16 v[34:35], v10 offset:9216
    s_waitcnt lgkmcnt(8)
    v_mfma_f32_16x16x32_bf16 v[72:75], v[48:51], v[104:107], v[72:75]
    ds_read_b64_tr_b16 v[36:37], v11 offset:8192
    v_mfma_f32_16x16x32_bf16 v[76:79], v[48:51], v[108:111], v[76:79]
    ds_read_b64_tr_b16 v[38:39], v11 offset:9216
    s_cmp_ge_u32 s4, 7
    s_cbranch_scc1 KSAL8
    buffer_store_dwordx4 v[224:227], v2, s[44:47], s82 offen offset:3072 sc1
KSAL8:
    s_waitcnt lgkmcnt(8)
    v_mfma_f32_16x16x32_bf16 v[80:83], v[52:55], v[104:107], v[80:83]
    ds_read_b64_tr_b16 v[40:41], v12 offset:4096
    v_mfma_f32_16x16x32_bf16 v[84:87], v[52:55], v[108:111], v[84:87]
    ds_read_b64_tr_b16 v[42:43], v12 offset:4608
    s_waitcnt lgkmcnt(8)
    v_mfma_f32_16x16x32_bf16 v[128:131], v[24:27], v[104:107], v[128:131]
    ds_read_b64_tr_b16 v[44:45], v16 offset:4096
    v_mfma_f32_16x16x32_bf16 v[132:135], v[24:27], v[108:111], v[132:135]
    ds_read_b64_tr_b16 v[46:47], v16 offset:4608
    s_waitcnt lgkmcnt(8)
    v_mfma_f32_16x16x32_bf16 v[136:139], v[28:31], v[104:107], v[136:139]
    ds_read_b64_tr_b16 v[48:49], v17 offset:4096
    v_mfma_f32_16x16x32_bf16 v[140:143], v[28:31], v[108:111], v[140:143]
    ds_read_b64_tr_b16 v[50:51], v17 offset:4608
    s_waitcnt lgkmcnt(8)
    v_mfma_f32_16x16x32_bf16 v[144:147], v[32:35], v[104:107], v[144:147]
    ds_read_b64_tr_b16 v[52:53], v18 offset:4096
    v_mfma_f32_16x16x32_bf16 v[148:151], v[32:35], v[108:111], v[148:151]
    ds_read_b64_tr_b16 v[54:55], v18 offset:4608
    s_waitcnt lgkmcnt(8)
    v_mfma_f32_16x16x32_bf16 v[152:155], v[36:39], v[104:107], v[152:155]
    v_add_u32 v4, 0x4000, v4
    v_add_u32 v5, 0x4000, v5
    v_add_u32 v6, 0x4000, v6
    v_add_u32 v7, 0x4000, v7
    v_add_u32 v8, 0x4000, v8
    v_add_u32 v9, 0x4000, v9
    v_add_u32 v10, 0x4000, v10
    v_add_u32 v11, 0x4000, v11
    v_add_u32 v12, 0x1e000, v12
    v_add_u32 v16, 0x1e000, v16
    v_add_u32 v17, 0x1e000, v17
    v_add_u32 v18, 0x1e000, v18
    s_barrier
    ds_read_b64_tr_b16 v[24:25], v4 offset:0
    v_mfma_f32_16x16x32_bf16 v[156:159], v[36:39], v[108:111], v[156:159]
    ds_read_b64_tr_b16 v[26:27], v4 offset:1024
    s_waitcnt lgkmcnt(8)
    v_mfma_f32_16x16x32_bf16 v[160:163], v[40:43], v[104:107], v[160:163]
    ds_read_b64_tr_b16 v[28:29], v5 offset:0
    s_add_u32 m0, s96, 114688
    s_mov_b32 s53, 4194304
    buffer_load_dwordx4 v3, s[92:95], s53 offen offset:0 lds
    v_mfma_f32_16x16x32_bf16 v[164:167], v[40:43], v[108:111], v[164:167]
    ds_read_b64_tr_b16 v[30:31], v5 offset:1024
    s_mov_b32 s53, 4226048
    buffer_load_dwordx4 v3, s[92:95], s53 offen offset:1024 lds
    s_waitcnt lgkmcnt(8)
    v_mfma_f32_16x16x32_bf16 v[168:171], v[44:47], v[104:107], v[168:171]
    ds_read_b64_tr_b16 v[32:33], v6 offset:0
    v_mfma_f32_16x16x32_bf16 v[172:175], v[44:47], v[108:111], v[172:175]
    ds_read_b64_tr_b16 v[34:35], v6 offset:1024
    s_waitcnt lgkmcnt(8)
    v_mfma_f32_16x16x32_bf16 v[176:179], v[48:51], v[104:107], v[176:179]
    ds_read_b64_tr_b16 v[36:37], v7 offset:0
    v_mfma_f32_16x16x32_bf16 v[180:183], v[48:51], v[108:111], v[180:183]
    ds_read_b64_tr_b16 v[38:39], v7 offset:1024
    s_waitcnt lgkmcnt(8)
    v_mfma_f32_16x16x32_bf16 v[184:187], v[52:55], v[104:107], v[184:187]
    ds_read_b64_tr_b16 v[40:41], v8 offset:0
    v_mfma_f32_16x16x32_bf16 v[188:191], v[52:55], v[108:111], v[188:191]
    ds_read_b64_tr_b16 v[42:43], v8 offset:1024
    s_waitcnt vmcnt(13) lgkmcnt(8)
    v_mfma_f32_16x16x32_bf16 v[56:59], v[24:27], v[112:115], v[56:59]
    ds_read_b64_tr_b16 v[44:45], v9 offset:0
    s_add_u32 s53, s99, 12288
    buffer_load_dwordx4 v[104:107], v2, s[44:47], s53 offen sc1
    s_waitcnt vmcnt(13)
    v_mfma_f32_16x16x32_bf16 v[60:63], v[24:27], v[116:119], v[60:63]
    ds_read_b64_tr_b16 v[46:47], v9 offset:1024
    s_cmp_ge_u32 s4, 7
    s_cbranch_scc1 KSAL9
    buffer_store_dwordx4 v[228:231], v2, s[44:47], s83 offen offset:3072 sc1
KSAL9:
    s_add_u32 s53, s99, 30720
    buffer_load_dwordx4 v[108:111], v2, s[44:47], s53 offen sc1
    s_waitcnt lgkmcnt(8)
    v_mfma_f32_16x16x32_bf16 v[64:67], v[28:31], v[112:115], v[64:67]
    ds_read_b64_tr_b16 v[48:49], v10 offset:0
    v_mfma_f32_16x16x32_bf16 v[68:71], v[28:31], v[116:119], v[68:71]
    ds_read_b64_tr_b16 v[50:51], v10 offset:1024
    s_waitcnt lgkmcnt(8)
    v_mfma_f32_16x16x32_bf16 v[72:75], v[32:35], v[112:115], v[72:75]
    ds_read_b64_tr_b16 v[52:53], v11 offset:0
    v_mfma_f32_16x16x32_bf16 v[76:79], v[32:35], v[116:119], v[76:79]
    ds_read_b64_tr_b16 v[54:55], v11 offset:1024
    s_waitcnt lgkmcnt(8)
    v_mfma_f32_16x16x32_bf16 v[80:83], v[36:39], v[112:115], v[80:83]
    ds_read_b64_tr_b16 v[24:25], v12 offset:0
    v_mfma_f32_16x16x32_bf16 v[84:87], v[36:39], v[116:119], v[84:87]
    ds_read_b64_tr_b16 v[26:27], v12 offset:512
    s_waitcnt lgkmcnt(8)
    v_mfma_f32_16x16x32_bf16 v[128:131], v[40:43], v[112:115], v[128:131]
    ds_read_b64_tr_b16 v[28:29], v16 offset:0
    s_lshl_b32 s6, s3, 19
    v_mfma_f32_16x16x32_bf16 v[132:135], v[40:43], v[116:119], v[132:135]
    ds_read_b64_tr_b16 v[30:31], v16 offset:512
    s_add_u32 s60, s6, s80
    s_waitcnt lgkmcnt(8)
    v_mfma_f32_16x16x32_bf16 v[136:139], v[44:47], v[112:115], v[136:139]
    ds_read_b64_tr_b16 v[32:33], v17 offset:0
    s_add_u32 s61, s60, 16777216
    v_mfma_f32_16x16x32_bf16 v[140:143], v[44:47], v[116:119], v[140:143]
    ds_read_b64_tr_b16 v[34:35], v17 offset:512
    s_lshr_b32 s66, s7, 6
    s_waitcnt lgkmcnt(8)
    v_mfma_f32_16x16x32_bf16 v[144:147], v[48:51], v[112:115], v[144:147]
    ds_read_b64_tr_b16 v[36:37], v18 offset:0
    s_lshl_b32 s6, s4, 1
    v_mfma_f32_16x16x32_bf16 v[148:151], v[48:51], v[116:119], v[148:151]
    ds_read_b64_tr_b16 v[38:39], v18 offset:512
    s_sub_u32 s67, 31, s6
    s_waitcnt lgkmcnt(8)
    v_mfma_f32_16x16x32_bf16 v[152:155], v[52:55], v[112:115], v[152:155]
    ds_read_b64_tr_b16 v[40:41], v4 offset:8192
    s_mov_b32 s70, 0x3e0293ee
    v_mfma_f32_16x16x32_bf16 v[156:159], v[52:55], v[116:119], v[156:159]
    ds_read_b64_tr_b16 v[42:43], v4 offset:9216
    s_mov_b32 s71, 0x3e0293ee
    s_waitcnt lgkmcnt(8)
    v_mfma_f32_16x16x32_bf16 v[160:163], v[24:27], v[112:115], v[160:163]
    ds_read_b64_tr_b16 v[44:45], v5 offset:8192
    s_mov_b32 s68, 0x3fb8aa3b
    v_mfma_f32_16x16x32_bf16 v[164:167], v[24:27], v[116:119], v[164:167]
    ds_read_b64_tr_b16 v[46:47], v5 offset:9216
    s_mul_i32 s6, s66, 598016
    s_waitcnt lgkmcnt(8)
    v_mfma_f32_16x16x32_bf16 v[168:171], v[28:31], v[112:115], v[168:171]
    ds_read_b64_tr_b16 v[48:49], v6 offset:8192
    s_lshr_b32 s8, s7, 4
    v_mfma_f32_16x16x32_bf16 v[172:175], v[28:31], v[116:119], v[172:175]
    ds_read_b64_tr_b16 v[50:51], v6 offset:9216
    s_and_b32 s8, s8, 3
    s_waitcnt lgkmcnt(8)
    v_mfma_f32_16x16x32_bf16 v[176:179], v[32:35], v[112:115], v[176:179]
    ds_read_b64_tr_b16 v[52:53], v7 offset:8192
    s_lshl_b32 s8, s8, 10
    v_mfma_f32_16x16x32_bf16 v[180:183], v[32:35], v[116:119], v[180:183]
    ds_read_b64_tr_b16 v[54:55], v7 offset:9216
    s_cmp_ge_u32 s4, 7
    s_cbranch_scc1 KSAL10
    buffer_store_dwordx4 v[232:235], v2, s[44:47], s84 offen offset:3072 sc1
KSAL10:
    s_add_u32 s6, s6, s8
    s_waitcnt lgkmcnt(8)
    v_mfma_f32_16x16x32_bf16 v[184:187], v[36:39], v[112:115], v[184:187]
    ds_read_b64_tr_b16 v[24:25], v8 offset:8192
    s_add_u32 s69, s6, 33554432
    v_mfma_f32_16x16x32_bf16 v[188:191], v[36:39], v[116:119], v[188:191]
    ds_read_b64_tr_b16 v[26:27], v8 offset:9216
    v_lshrrev_b32 v22, 4, v1
    s_waitcnt vmcnt(13) lgkmcnt(8)
    v_mfma_f32_16x16x32_bf16 v[56:59], v[40:43], v[120:123], v[56:59]
    ds_read_b64_tr_b16 v[28:29], v9 offset:8192
    s_add_u32 s53, s99, 13312
    buffer_load_dwordx4 v[112:115], v2, s[44:47], s53 offen sc1
    v_cmp_gt_u32 vcc, 2, v22
    s_waitcnt vmcnt(13)
    v_mfma_f32_16x16x32_bf16 v[60:63], v[40:43], v[124:127], v[60:63]
    ds_read_b64_tr_b16 v[30:31], v9 offset:9216
    s_add_u32 s53, s99, 31744
    buffer_load_dwordx4 v[116:119], v2, s[44:47], s53 offen sc1
    v_cndmask_b32 v23, 0, 1.0, vcc
    s_waitcnt lgkmcnt(8)
    v_mfma_f32_16x16x32_bf16 v[64:67], v[44:47], v[120:123], v[64:67]
    ds_read_b64_tr_b16 v[32:33], v10 offset:8192
    v_mov_b32 v22, 0xff800000
    v_mfma_f32_16x16x32_bf16 v[68:71], v[44:47], v[124:127], v[68:71]
    ds_read_b64_tr_b16 v[34:35], v10 offset:9216
    s_waitcnt lgkmcnt(8)
    v_mfma_f32_16x16x32_bf16 v[72:75], v[48:51], v[120:123], v[72:75]
    ds_read_b64_tr_b16 v[36:37], v11 offset:8192
    v_mfma_f32_16x16x32_bf16 v[76:79], v[48:51], v[124:127], v[76:79]
    ds_read_b64_tr_b16 v[38:39], v11 offset:9216
    s_waitcnt lgkmcnt(8)
    v_mfma_f32_16x16x32_bf16 v[80:83], v[52:55], v[120:123], v[80:83]
    ds_read_b64_tr_b16 v[40:41], v12 offset:4096
    v_mfma_f32_16x16x32_bf16 v[84:87], v[52:55], v[124:127], v[84:87]
    ds_read_b64_tr_b16 v[42:43], v12 offset:4608
    s_waitcnt lgkmcnt(8)
    v_mfma_f32_16x16x32_bf16 v[128:131], v[24:27], v[120:123], v[128:131]
    ds_read_b64_tr_b16 v[44:45], v16 offset:4096
    v_mfma_f32_16x16x32_bf16 v[132:135], v[24:27], v[124:127], v[132:135]
    ds_read_b64_tr_b16 v[46:47], v16 offset:4608
    s_waitcnt lgkmcnt(8)
    v_mfma_f32_16x16x32_bf16 v[136:139], v[28:31], v[120:123], v[136:139]
    ds_read_b64_tr_b16 v[48:49], v17 offset:4096
    v_mfma_f32_16x16x32_bf16 v[140:143], v[28:31], v[124:127], v[140:143]
    ds_read_b64_tr_b16 v[50:51], v17 offset:4608
    s_waitcnt lgkmcnt(8)
    v_mfma_f32_16x16x32_bf16 v[144:147], v[32:35], v[120:123], v[144:147]
    ds_read_b64_tr_b16 v[52:53], v18 offset:4096
    v_mfma_f32_16x16x32_bf16 v[148:151], v[32:35], v[124:127], v[148:151]
    ds_read_b64_tr_b16 v[54:55], v18 offset:4608
    s_waitcnt lgkmcnt(8)
    v_mfma_f32_16x16x32_bf16 v[152:155], v[36:39], v[120:123], v[152:155]
    v_add_u32 v4, 0x4000, v4
    v_add_u32 v5, 0x4000, v5
    v_add_u32 v6, 0x4000, v6
    v_add_u32 v7, 0x4000, v7
    v_add_u32 v8, 0x4000, v8
    v_add_u32 v9, 0x4000, v9
    v_add_u32 v10, 0x4000, v10
    v_add_u32 v11, 0x4000, v11
    v_add_u32 v12, 0x2000, v12
    v_add_u32 v16, 0x2000, v16
    v_add_u32 v17, 0x2000, v17
    v_add_u32 v18, 0x2000, v18
    s_waitcnt vmcnt(6)
    s_barrier
    ds_read_b64_tr_b16 v[24:25], v4 offset:0
    v_mfma_f32_16x16x32_bf16 v[156:159], v[36:39], v[124:127], v[156:159]
    ds_read_b64_tr_b16 v[26:27], v4 offset:1024
    s_waitcnt lgkmcnt(8)
    v_mfma_f32_16x16x32_bf16 v[160:163], v[40:43], v[120:123], v[160:163]
    ds_read_b64_tr_b16 v[28:29], v5 offset:0
    v_mfma_f32_16x16x32_bf16 v[164:167], v[40:43], v[124:127], v[164:167]
    ds_read_b64_tr_b16 v[30:31], v5 offset:1024
    s_cmp_ge_u32 s4, 7
    s_cbranch_scc1 KSAL11
    buffer_store_dwordx4 v[236:239], v2, s[44:47], s85 offen offset:3072 sc1
KSAL11:
    s_waitcnt lgkmcnt(8)
    v_mfma_f32_16x16x32_bf16 v[168:171], v[44:47], v[120:123], v[168:171]
    ds_read_b64_tr_b16 v[32:33], v6 offset:0
    v_mfma_f32_16x16x32_bf16 v[172:175], v[44:47], v[124:127], v[172:175]
    ds_read_b64_tr_b16 v[34:35], v6 offset:1024
    s_waitcnt lgkmcnt(8)
    v_mfma_f32_16x16x32_bf16 v[176:179], v[48:51], v[120:123], v[176:179]
    ds_read_b64_tr_b16 v[36:37], v7 offset:0
    v_mfma_f32_16x16x32_bf16 v[180:183], v[48:51], v[124:127], v[180:183]
    ds_read_b64_tr_b16 v[38:39], v7 offset:1024
    s_waitcnt lgkmcnt(8)
    v_mfma_f32_16x16x32_bf16 v[184:187], v[52:55], v[120:123], v[184:187]
    ds_read_b64_tr_b16 v[40:41], v8 offset:0
    v_mfma_f32_16x16x32_bf16 v[188:191], v[52:55], v[124:127], v[188:191]
    ds_read_b64_tr_b16 v[42:43], v8 offset:1024
    s_waitcnt lgkmcnt(8)
    v_mfma_f32_16x16x32_bf16 v[56:59], v[24:27], v[88:91], v[56:59]
    ds_read_b64_tr_b16 v[44:45], v9 offset:0
    s_add_u32 s53, s99, 14336
    buffer_load_dwordx4 v[120:123], v2, s[44:47], s53 offen sc1
    v_mfma_f32_16x16x32_bf16 v[60:63], v[24:27], v[92:95], v[60:63]
    ds_read_b64_tr_b16 v[46:47], v9 offset:1024
    s_add_u32 s53, s99, 32768
    buffer_load_dwordx4 v[124:127], v2, s[44:47], s53 offen sc1
    s_waitcnt lgkmcnt(8)
    v_mfma_f32_16x16x32_bf16 v[64:67], v[28:31], v[88:91], v[64:67]
    ds_read_b64_tr_b16 v[48:49], v10 offset:0
    v_mfma_f32_16x16x32_bf16 v[68:71], v[28:31], v[92:95], v[68:71]
    ds_read_b64_tr_b16 v[50:51], v10 offset:1024
    s_waitcnt lgkmcnt(8)
    v_mfma_f32_16x16x32_bf16 v[72:75], v[32:35], v[88:91], v[72:75]
    ds_read_b64_tr_b16 v[52:53], v11 offset:0
    v_mfma_f32_16x16x32_bf16 v[76:79], v[32:35], v[92:95], v[76:79]
    ds_read_b64_tr_b16 v[54:55], v11 offset:1024
    s_waitcnt lgkmcnt(8)
    v_mfma_f32_16x16x32_bf16 v[80:83], v[36:39], v[88:91], v[80:83]
    ds_read_b64_tr_b16 v[24:25], v12 offset:0
    v_mfma_f32_16x16x32_bf16 v[84:87], v[36:39], v[92:95], v[84:87]
    ds_read_b64_tr_b16 v[26:27], v12 offset:512
    s_waitcnt lgkmcnt(8)
    v_mfma_f32_16x16x32_bf16 v[128:131], v[40:43], v[88:91], v[128:131]
    ds_read_b64_tr_b16 v[28:29], v16 offset:0
    v_mfma_f32_16x16x32_bf16 v[132:135], v[40:43], v[92:95], v[132:135]
    ds_read_b64_tr_b16 v[30:31], v16 offset:512
    s_waitcnt lgkmcnt(8)
    v_mfma_f32_16x16x32_bf16 v[136:139], v[44:47], v[88:91], v[136:139]
    ds_read_b64_tr_b16 v[32:33], v17 offset:0
    v_mfma_f32_16x16x32_bf16 v[140:143], v[44:47], v[92:95], v[140:143]
    ds_read_b64_tr_b16 v[34:35], v17 offset:512
    s_waitcnt lgkmcnt(8)
    v_mfma_f32_16x16x32_bf16 v[144:147], v[48:51], v[88:91], v[144:147]
    ds_read_b64_tr_b16 v[36:37], v18 offset:0
    v_mfma_f32_16x16x32_bf16 v[148:151], v[48:51], v[92:95], v[148:151]
    ds_read_b64_tr_b16 v[38:39], v18 offset:512
    s_cmp_ge_u32 s4, 7
    s_cbranch_scc1 KSAL12
    buffer_store_dwordx4 v[240:243], v2, s[44:47], s82 offen offset:1024 sc1
KSAL12:
    s_waitcnt lgkmcnt(8)
    v_mfma_f32_16x16x32_bf16 v[152:155], v[52:55], v[88:91], v[152:155]
    ds_read_b64_tr_b16 v[40:41], v4 offset:8192
    v_mfma_f32_16x16x32_bf16 v[156:159], v[52:55], v[92:95], v[156:159]
    ds_read_b64_tr_b16 v[42:43], v4 offset:9216
    s_waitcnt lgkmcnt(8)
    v_mfma_f32_16x16x32_bf16 v[160:163], v[24:27], v[88:91], v[160:163]
    ds_read_b64_tr_b16 v[44:45], v5 offset:8192
    v_mfma_f32_16x16x32_bf16 v[164:167], v[24:27], v[92:95], v[164:167]
    ds_read_b64_tr_b16 v[46:47], v5 offset:9216
    s_waitcnt lgkmcnt(8)
    v_mfma_f32_16x16x32_bf16 v[168:171], v[28:31], v[88:91], v[168:171]
    ds_read_b64_tr_b16 v[48:49], v6 offset:8192
    v_mfma_f32_16x16x32_bf16 v[172:175], v[28:31], v[92:95], v[172:175]
    ds_read_b64_tr_b16 v[50:51], v6 offset:9216
    s_waitcnt lgkmcnt(8)
    v_mfma_f32_16x16x32_bf16 v[176:179], v[32:35], v[88:91], v[176:179]
    ds_read_b64_tr_b16 v[52:53], v7 offset:8192
    v_mfma_f32_16x16x32_bf16 v[180:183], v[32:35], v[92:95], v[180:183]
    ds_read_b64_tr_b16 v[54:55], v7 offset:9216
    s_waitcnt lgkmcnt(8)
    v_mfma_f32_16x16x32_bf16 v[184:187], v[36:39], v[88:91], v[184:187]
    ds_read_b64_tr_b16 v[24:25], v8 offset:8192
    v_mfma_f32_16x16x32_bf16 v[188:191], v[36:39], v[92:95], v[188:191]
    ds_read_b64_tr_b16 v[26:27], v8 offset:9216
    s_waitcnt lgkmcnt(8)
    v_mfma_f32_16x16x32_bf16 v[56:59], v[40:43], v[96:99], v[56:59]
    ds_read_b64_tr_b16 v[28:29], v9 offset:8192
    s_add_u32 s53, s99, 15360
    buffer_load_dwordx4 v[88:91], v2, s[44:47], s53 offen sc1
    v_mfma_f32_16x16x32_bf16 v[60:63], v[40:43], v[100:103], v[60:63]
    ds_read_b64_tr_b16 v[30:31], v9 offset:9216
    s_add_u32 s53, s99, 33792
    buffer_load_dwordx4 v[92:95], v2, s[44:47], s53 offen sc1
    s_waitcnt lgkmcnt(8)
    v_mfma_f32_16x16x32_bf16 v[64:67], v[44:47], v[96:99], v[64:67]
    ds_read_b64_tr_b16 v[32:33], v10 offset:8192
    v_mfma_f32_16x16x32_bf16 v[68:71], v[44:47], v[100:103], v[68:71]
    ds_read_b64_tr_b16 v[34:35], v10 offset:9216
    s_waitcnt lgkmcnt(8)
    v_mfma_f32_16x16x32_bf16 v[72:75], v[48:51], v[96:99], v[72:75]
    ds_read_b64_tr_b16 v[36:37], v11 offset:8192
    v_mfma_f32_16x16x32_bf16 v[76:79], v[48:51], v[100:103], v[76:79]
    ds_read_b64_tr_b16 v[38:39], v11 offset:9216
    s_waitcnt lgkmcnt(8)
    v_mfma_f32_16x16x32_bf16 v[80:83], v[52:55], v[96:99], v[80:83]
    ds_read_b64_tr_b16 v[40:41], v12 offset:4096
    v_mfma_f32_16x16x32_bf16 v[84:87], v[52:55], v[100:103], v[84:87]
    ds_read_b64_tr_b16 v[42:43], v12 offset:4608
    s_waitcnt lgkmcnt(8)
    v_mfma_f32_16x16x32_bf16 v[128:131], v[24:27], v[96:99], v[128:131]
    ds_read_b64_tr_b16 v[44:45], v16 offset:4096
    v_mfma_f32_16x16x32_bf16 v[132:135], v[24:27], v[100:103], v[132:135]
    ds_read_b64_tr_b16 v[46:47], v16 offset:4608
    s_cmp_ge_u32 s4, 7
    s_cbranch_scc1 KSAL13
    buffer_store_dwordx4 v[244:247], v2, s[44:47], s83 offen offset:1024 sc1
KSAL13:
    s_waitcnt lgkmcnt(8)
    v_mfma_f32_16x16x32_bf16 v[136:139], v[28:31], v[96:99], v[136:139]
    ds_read_b64_tr_b16 v[48:49], v17 offset:4096
    v_mfma_f32_16x16x32_bf16 v[140:143], v[28:31], v[100:103], v[140:143]
    ds_read_b64_tr_b16 v[50:51], v17 offset:4608
    s_waitcnt lgkmcnt(8)
    v_mfma_f32_16x16x32_bf16 v[144:147], v[32:35], v[96:99], v[144:147]
    ds_read_b64_tr_b16 v[52:53], v18 offset:4096
    v_mfma_f32_16x16x32_bf16 v[148:151], v[32:35], v[100:103], v[148:151]
    ds_read_b64_tr_b16 v[54:55], v18 offset:4608
    s_waitcnt lgkmcnt(8)
    v_mfma_f32_16x16x32_bf16 v[152:155], v[36:39], v[96:99], v[152:155]
    v_add_u32 v4, 0x4000, v4
    v_add_u32 v5, 0x4000, v5
    v_add_u32 v6, 0x4000, v6
    v_add_u32 v7, 0x4000, v7
    v_add_u32 v8, 0x4000, v8
    v_add_u32 v9, 0x4000, v9
    v_add_u32 v10, 0x4000, v10
    v_add_u32 v11, 0x4000, v11
    v_add_u32 v12, 0xffff6000, v12
    v_add_u32 v16, 0xffff6000, v16
    v_add_u32 v17, 0xffff6000, v17
    v_add_u32 v18, 0xffff6000, v18
    s_barrier
    ds_read_b64_tr_b16 v[24:25], v4 offset:0
    v_mfma_f32_16x16x32_bf16 v[156:159], v[36:39], v[100:103], v[156:159]
    ds_read_b64_tr_b16 v[26:27], v4 offset:1024
    s_waitcnt lgkmcnt(8)
    v_mfma_f32_16x16x32_bf16 v[160:163], v[40:43], v[96:99], v[160:163]
    ds_read_b64_tr_b16 v[28:29], v5 offset:0
    v_lshrrev_b32 v13, 2, v2
    v_mov_b32 v15, s52
    v_xor_b32 v14, 7, v1
    v_cmp_gt_u32 vcc, 1, v14
    s_nop 1
    v_cndmask_b32 v13, v15, v13, vcc
    v_cndmask_b32 v15, 0, 1, vcc
    s_lshl_b32 s9, s3, 7
    s_add_u32 s9, s9, 83886080
    buffer_load_dword v14, v13, s[44:47], s9 offen sc1
    v_mfma_f32_16x16x32_bf16 v[164:167], v[40:43], v[100:103], v[164:167]
    ds_read_b64_tr_b16 v[30:31], v5 offset:1024
    s_waitcnt lgkmcnt(8)
    v_mfma_f32_16x16x32_bf16 v[168:171], v[44:47], v[96:99], v[168:171]
    ds_read_b64_tr_b16 v[32:33], v6 offset:0
    v_mfma_f32_16x16x32_bf16 v[172:175], v[44:47], v[100:103], v[172:175]
    ds_read_b64_tr_b16 v[34:35], v6 offset:1024
    s_waitcnt lgkmcnt(8)
    v_mfma_f32_16x16x32_bf16 v[176:179], v[48:51], v[96:99], v[176:179]
    ds_read_b64_tr_b16 v[36:37], v7 offset:0
    v_mfma_f32_16x16x32_bf16 v[180:183], v[48:51], v[100:103], v[180:183]
    ds_read_b64_tr_b16 v[38:39], v7 offset:1024
    s_waitcnt lgkmcnt(8)
    v_mfma_f32_16x16x32_bf16 v[184:187], v[52:55], v[96:99], v[184:187]
    ds_read_b64_tr_b16 v[40:41], v8 offset:0
    v_mfma_f32_16x16x32_bf16 v[188:191], v[52:55], v[100:103], v[188:191]
    ds_read_b64_tr_b16 v[42:43], v8 offset:1024
    s_waitcnt vmcnt(8) lgkmcnt(8)
    v_mfma_f32_16x16x32_bf16 v[56:59], v[24:27], v[104:107], v[56:59]
    ds_read_b64_tr_b16 v[44:45], v9 offset:0
    s_add_u32 s53, s99, 16384
    buffer_load_dwordx4 v[96:99], v2, s[44:47], s53 offen sc1
    s_waitcnt vmcnt(8)
    v_mfma_f32_16x16x32_bf16 v[60:63], v[24:27], v[108:111], v[60:63]
    ds_read_b64_tr_b16 v[46:47], v9 offset:1024
    s_add_u32 s53, s99, 34816
    buffer_load_dwordx4 v[100:103], v2, s[44:47], s53 offen sc1
    s_waitcnt lgkmcnt(8)
    v_mfma_f32_16x16x32_bf16 v[64:67], v[28:31], v[104:107], v[64:67]
    ds_read_b64_tr_b16 v[48:49], v10 offset:0
    v_mfma_f32_16x16x32_bf16 v[68:71], v[28:31], v[108:111], v[68:71]
    ds_read_b64_tr_b16 v[50:51], v10 offset:1024
    s_waitcnt lgkmcnt(8)
    v_mfma_f32_16x16x32_bf16 v[72:75], v[32:35], v[104:107], v[72:75]
    ds_read_b64_tr_b16 v[52:53], v11 offset:0
    v_mfma_f32_16x16x32_bf16 v[76:79], v[32:35], v[108:111], v[76:79]
    ds_read_b64_tr_b16 v[54:55], v11 offset:1024
    s_cmp_ge_u32 s4, 7
    s_cbranch_scc1 KSAL14
    buffer_store_dwordx4 v[248:251], v2, s[44:47], s84 offen offset:1024 sc1
KSAL14:
    s_waitcnt lgkmcnt(8)
    v_mfma_f32_16x16x32_bf16 v[80:83], v[36:39], v[104:107], v[80:83]
    ds_read_b64_tr_b16 v[24:25], v12 offset:0
    v_mfma_f32_16x16x32_bf16 v[84:87], v[36:39], v[108:111], v[84:87]
    ds_read_b64_tr_b16 v[26:27], v12 offset:512
    s_waitcnt lgkmcnt(8)
    v_mfma_f32_16x16x32_bf16 v[128:131], v[40:43], v[104:107], v[128:131]
    ds_read_b64_tr_b16 v[28:29], v16 offset:0
    v_mfma_f32_16x16x32_bf16 v[132:135], v[40:43], v[108:111], v[132:135]
    ds_read_b64_tr_b16 v[30:31], v16 offset:512
    s_waitcnt lgkmcnt(8)
    v_mfma_f32_16x16x32_bf16 v[136:139], v[44:47], v[104:107], v[136:139]
    ds_read_b64_tr_b16 v[32:33], v17 offset:0
    v_mfma_f32_16x16x32_bf16 v[140:143], v[44:47], v[108:111], v[140:143]
    ds_read_b64_tr_b16 v[34:35], v17 offset:512
    s_waitcnt lgkmcnt(8)
    v_mfma_f32_16x16x32_bf16 v[144:147], v[48:51], v[104:107], v[144:147]
    ds_read_b64_tr_b16 v[36:37], v18 offset:0
    v_mfma_f32_16x16x32_bf16 v[148:151], v[48:51], v[108:111], v[148:151]
    ds_read_b64_tr_b16 v[38:39], v18 offset:512
    s_waitcnt lgkmcnt(8)
    v_mfma_f32_16x16x32_bf16 v[152:155], v[52:55], v[104:107], v[152:155]
    ds_read_b64_tr_b16 v[40:41], v4 offset:8192
    v_mfma_f32_16x16x32_bf16 v[156:159], v[52:55], v[108:111], v[156:159]
    ds_read_b64_tr_b16 v[42:43], v4 offset:9216
    s_waitcnt lgkmcnt(8)
    v_mfma_f32_16x16x32_bf16 v[160:163], v[24:27], v[104:107], v[160:163]
    ds_read_b64_tr_b16 v[44:45], v5 offset:8192
    v_mfma_f32_16x16x32_bf16 v[164:167], v[24:27], v[108:111], v[164:167]
    ds_read_b64_tr_b16 v[46:47], v5 offset:9216
    s_waitcnt lgkmcnt(8)
    v_mfma_f32_16x16x32_bf16 v[168:171], v[28:31], v[104:107], v[168:171]
    ds_read_b64_tr_b16 v[48:49], v6 offset:8192
    v_mfma_f32_16x16x32_bf16 v[172:175], v[28:31], v[108:111], v[172:175]
    ds_read_b64_tr_b16 v[50:51], v6 offset:9216
    s_waitcnt lgkmcnt(8)
    v_mfma_f32_16x16x32_bf16 v[176:179], v[32:35], v[104:107], v[176:179]
    ds_read_b64_tr_b16 v[52:53], v7 offset:8192
    v_mfma_f32_16x16x32_bf16 v[180:183], v[32:35], v[108:111], v[180:183]
    ds_read_b64_tr_b16 v[54:55], v7 offset:9216
    s_waitcnt lgkmcnt(8)
    v_mfma_f32_16x16x32_bf16 v[184:187], v[36:39], v[104:107], v[184:187]
    ds_read_b64_tr_b16 v[24:25], v8 offset:8192
    v_mfma_f32_16x16x32_bf16 v[188:191], v[36:39], v[108:111], v[188:191]
    ds_read_b64_tr_b16 v[26:27], v8 offset:9216
    s_waitcnt vmcnt(8) lgkmcnt(8)
    v_mfma_f32_16x16x32_bf16 v[56:59], v[40:43], v[112:115], v[56:59]
    ds_read_b64_tr_b16 v[28:29], v9 offset:8192
    s_add_u32 s53, s99, 17408
    buffer_load_dwordx4 v[104:107], v2, s[44:47], s53 offen sc1
    s_waitcnt vmcnt(8)
    v_mfma_f32_16x16x32_bf16 v[60:63], v[40:43], v[116:119], v[60:63]
    ds_read_b64_tr_b16 v[30:31], v9 offset:9216
    s_cmp_ge_u32 s4, 7
    s_cbranch_scc1 KSAL15
    buffer_store_dwordx4 v[252:255], v2, s[44:47], s85 offen offset:1024 sc1
KSAL15:
    s_add_u32 s53, s99, 35840
    buffer_load_dwordx4 v[108:111], v2, s[44:47], s53 offen sc1
    s_waitcnt lgkmcnt(8)
    v_mfma_f32_16x16x32_bf16 v[64:67], v[44:47], v[112:115], v[64:67]
    ds_read_b64_tr_b16 v[32:33], v10 offset:8192
    v_mfma_f32_16x16x32_bf16 v[68:71], v[44:47], v[116:119], v[68:71]
    ds_read_b64_tr_b16 v[34:35], v10 offset:9216
    s_waitcnt lgkmcnt(8)
    v_mfma_f32_16x16x32_bf16 v[72:75], v[48:51], v[112:115], v[72:75]
    ds_read_b64_tr_b16 v[36:37], v11 offset:8192
    v_mfma_f32_16x16x32_bf16 v[76:79], v[48:51], v[116:119], v[76:79]
    ds_read_b64_tr_b16 v[38:39], v11 offset:9216
    s_waitcnt lgkmcnt(8)
    v_mfma_f32_16x16x32_bf16 v[80:83], v[52:55], v[112:115], v[80:83]
    ds_read_b64_tr_b16 v[40:41], v12 offset:4096
    v_mfma_f32_16x16x32_bf16 v[84:87], v[52:55], v[116:119], v[84:87]
    ds_read_b64_tr_b16 v[42:43], v12 offset:4608
    s_waitcnt lgkmcnt(8)
    v_mfma_f32_16x16x32_bf16 v[128:131], v[24:27], v[112:115], v[128:131]
    ds_read_b64_tr_b16 v[44:45], v16 offset:4096
    v_mfma_f32_16x16x32_bf16 v[132:135], v[24:27], v[116:119], v[132:135]
    ds_read_b64_tr_b16 v[46:47], v16 offset:4608
    s_waitcnt lgkmcnt(8)
    v_mfma_f32_16x16x32_bf16 v[136:139], v[28:31], v[112:115], v[136:139]
    ds_read_b64_tr_b16 v[48:49], v17 offset:4096
    v_mfma_f32_16x16x32_bf16 v[140:143], v[28:31], v[116:119], v[140:143]
    ds_read_b64_tr_b16 v[50:51], v17 offset:4608
    s_waitcnt lgkmcnt(8)
    v_mfma_f32_16x16x32_bf16 v[144:147], v[32:35], v[112:115], v[144:147]
    ds_read_b64_tr_b16 v[52:53], v18 offset:4096
    v_mfma_f32_16x16x32_bf16 v[148:151], v[32:35], v[116:119], v[148:151]
    ds_read_b64_tr_b16 v[54:55], v18 offset:4608
    s_waitcnt lgkmcnt(8)
    v_mfma_f32_16x16x32_bf16 v[152:155], v[36:39], v[112:115], v[152:155]
    v_add_u32 v4, 0x4000, v4
    v_add_u32 v5, 0x4000, v5
    v_add_u32 v6, 0x4000, v6
    v_add_u32 v7, 0x4000, v7
    v_add_u32 v8, 0x4000, v8
    v_add_u32 v9, 0x4000, v9
    v_add_u32 v10, 0x4000, v10
    v_add_u32 v11, 0x4000, v11
    v_add_u32 v12, 0x2000, v12
    v_add_u32 v16, 0x2000, v16
    v_add_u32 v17, 0x2000, v17
    v_add_u32 v18, 0x2000, v18
    s_barrier
    ds_read_b64_tr_b16 v[24:25], v4 offset:0
    v_mfma_f32_16x16x32_bf16 v[156:159], v[36:39], v[116:119], v[156:159]
    ds_read_b64_tr_b16 v[26:27], v4 offset:1024
    s_waitcnt lgkmcnt(8)
    v_mfma_f32_16x16x32_bf16 v[160:163], v[40:43], v[112:115], v[160:163]
    ds_read_b64_tr_b16 v[28:29], v5 offset:0
    s_waitcnt vmcnt(4)
    v_and_b32 v14, v14, v15
    v_cmp_ne_u32 vcc, v14, v15
    s_cbranch_vccz P2A_OK
    s_mov_b32 s55, 0x40000
P2A_SP:
    s_sleep 2
    buffer_load_dword v14, v13, s[44:47], s9 offen sc1
    s_waitcnt vmcnt(0)
    v_and_b32 v14, v14, v15
    v_cmp_ne_u32 vcc, v14, v15
    s_cbranch_vccz P2A_OK
    s_sub_u32 s55, s55, 1
    s_cmp_lg_u32 s55, 0
    s_cbranch_scc1 P2A_SP
P2A_OK:
    v_mfma_f32_16x16x32_bf16 v[164:167], v[40:43], v[116:119], v[164:167]
    ds_read_b64_tr_b16 v[30:31], v5 offset:1024
    s_add_u32 m0, s80, 0
    s_add_u32 s53, s60, 0
    buffer_load_dwordx4 v2, s[44:47], s53 offen offset:0 sc1 lds
    buffer_load_dwordx4 v2, s[44:47], s53 offen offset:1024 sc1 lds
    buffer_load_dwordx4 v2, s[44:47], s53 offen offset:2048 sc1 lds
    buffer_load_dwordx4 v2, s[44:47], s53 offen offset:3072 sc1 lds
    s_waitcnt lgkmcnt(8)
    v_mfma_f32_16x16x32_bf16 v[168:171], v[44:47], v[112:115], v[168:171]
    ds_read_b64_tr_b16 v[32:33], v6 offset:0
    s_add_u32 m0, s80, 16384
    s_add_u32 s53, s60, 16384
    buffer_load_dwordx4 v2, s[44:47], s53 offen offset:0 sc1 lds
    buffer_load_dwordx4 v2, s[44:47], s53 offen offset:1024 sc1 lds
    buffer_load_dwordx4 v2, s[44:47], s53 offen offset:2048 sc1 lds
    buffer_load_dwordx4 v2, s[44:47], s53 offen offset:3072 sc1 lds
    v_mfma_f32_16x16x32_bf16 v[172:175], v[44:47], v[116:119], v[172:175]
    ds_read_b64_tr_b16 v[34:35], v6 offset:1024
    s_waitcnt lgkmcnt(8)
    v_mfma_f32_16x16x32_bf16 v[176:179], v[48:51], v[112:115], v[176:179]
    ds_read_b64_tr_b16 v[36:37], v7 offset:0
    v_mfma_f32_16x16x32_bf16 v[180:183], v[48:51], v[116:119], v[180:183]
    ds_read_b64_tr_b16 v[38:39], v7 offset:1024
    s_waitcnt lgkmcnt(8)
    v_mfma_f32_16x16x32_bf16 v[184:187], v[52:55], v[112:115], v[184:187]
    ds_read_b64_tr_b16 v[40:41], v8 offset:0
    v_mfma_f32_16x16x32_bf16 v[188:191], v[52:55], v[116:119], v[188:191]
    ds_read_b64_tr_b16 v[42:43], v8 offset:1024
    s_waitcnt lgkmcnt(8)
    v_mfma_f32_16x16x32_bf16 v[56:59], v[24:27], v[120:123], v[56:59]
    ds_read_b64_tr_b16 v[44:45], v9 offset:0
    v_mfma_f32_16x16x32_bf16 v[60:63], v[24:27], v[124:127], v[60:63]
    ds_read_b64_tr_b16 v[46:47], v9 offset:1024
    s_waitcnt lgkmcnt(8)
    v_mfma_f32_16x16x32_bf16 v[64:67], v[28:31], v[120:123], v[64:67]
    ds_read_b64_tr_b16 v[48:49], v10 offset:0
    v_mfma_f32_16x16x32_bf16 v[68:71], v[28:31], v[124:127], v[68:71]
    ds_read_b64_tr_b16 v[50:51], v10 offset:1024
    s_waitcnt lgkmcnt(8)
    v_mfma_f32_16x16x32_bf16 v[72:75], v[32:35], v[120:123], v[72:75]
    ds_read_b64_tr_b16 v[52:53], v11 offset:0
    v_and_b32 v204, 15, v1
    v_mfma_f32_16x16x32_bf16 v[76:79], v[32:35], v[124:127], v[76:79]
    ds_read_b64_tr_b16 v[54:55], v11 offset:1024
    v_lshrrev_b32 v205, 4, v1
    s_waitcnt lgkmcnt(8)
    v_mfma_f32_16x16x32_bf16 v[80:83], v[36:39], v[120:123], v[80:83]
    ds_read_b64_tr_b16 v[24:25], v12 offset:0
    v_mul_u32_u24 v192, 144, v205
    v_mfma_f32_16x16x32_bf16 v[84:87], v[36:39], v[124:127], v[84:87]
    ds_read_b64_tr_b16 v[26:27], v12 offset:512
    v_add_u32 v192, 147456, v192
    s_waitcnt lgkmcnt(8)
    v_mfma_f32_16x16x32_bf16 v[128:131], v[40:43], v[120:123], v[128:131]
    ds_read_b64_tr_b16 v[28:29], v16 offset:0
    v_mov_b32 v205, 512
    v_mfma_f32_16x16x32_bf16 v[132:135], v[40:43], v[124:127], v[132:135]
    ds_read_b64_tr_b16 v[30:31], v16 offset:512
    v_cmp_eq_u32 vcc, 0, v204
    s_waitcnt lgkmcnt(8)
    v_mfma_f32_16x16x32_bf16 v[136:139], v[44:47], v[120:123], v[136:139]
    ds_read_b64_tr_b16 v[32:33], v17 offset:0
    v_cndmask_b32 v205, v205, 16, vcc
    v_mfma_f32_16x16x32_bf16 v[140:143], v[44:47], v[124:127], v[140:143]
    ds_read_b64_tr_b16 v[34:35], v17 offset:512
    v_cmp_eq_u32 vcc, 4, v204
    s_waitcnt lgkmcnt(8)
    v_mfma_f32_16x16x32_bf16 v[144:147], v[48:51], v[120:123], v[144:147]
    ds_read_b64_tr_b16 v[36:37], v18 offset:0
    v_cndmask_b32 v205, v205, 17, vcc
    v_mfma_f32_16x16x32_bf16 v[148:151], v[48:51], v[124:127], v[148:151]
    ds_read_b64_tr_b16 v[38:39], v18 offset:512
    v_cmp_eq_u32 vcc, 8, v204
    s_waitcnt lgkmcnt(8)
    v_mfma_f32_16x16x32_bf16 v[152:155], v[52:55], v[120:123], v[152:155]
    ds_read_b64_tr_b16 v[40:41], v4 offset:8192
    v_cndmask_b32 v205, v205, 8, vcc
    v_mfma_f32_16x16x32_bf16 v[156:159], v[52:55], v[124:127], v[156:159]
    ds_read_b64_tr_b16 v[42:43], v4 offset:9216
    v_cmp_eq_u32 vcc, 12, v204
    s_waitcnt lgkmcnt(8)
    v_mfma_f32_16x16x32_bf16 v[160:163], v[24:27], v[120:123], v[160:163]
    ds_read_b64_tr_b16 v[44:45], v5 offset:8192
    v_cndmask_b32 v205, v205, 12, vcc
    v_mfma_f32_16x16x32_bf16 v[164:167], v[24:27], v[124:127], v[164:167]
    ds_read_b64_tr_b16 v[46:47], v5 offset:9216
    v_lshl_add_u32 v205, v205, 1, v192
    s_waitcnt lgkmcnt(8)
    v_mfma_f32_16x16x32_bf16 v[168:171], v[28:31], v[120:123], v[168:171]
    ds_read_b64_tr_b16 v[48:49], v6 offset:8192
    v_lshl_add_u32 v204, v204, 1, v192
    v_mfma_f32_16x16x32_bf16 v[172:175], v[28:31], v[124:127], v[172:175]
    ds_read_b64_tr_b16 v[50:51], v6 offset:9216
    ds_read_u16 v192, v204 offset:0
    s_waitcnt lgkmcnt(9)
    v_mfma_f32_16x16x32_bf16 v[176:179], v[32:35], v[120:123], v[176:179]
    ds_read_b64_tr_b16 v[52:53], v7 offset:8192
    ds_read_u16 v193, v204 offset:36
    v_mfma_f32_16x16x32_bf16 v[180:183], v[32:35], v[124:127], v[180:183]
    ds_read_b64_tr_b16 v[54:55], v7 offset:9216
    ds_read_u16 v194, v204 offset:72
    s_waitcnt lgkmcnt(11)
    v_mfma_f32_16x16x32_bf16 v[184:187], v[36:39], v[120:123], v[184:187]
    ds_read_b64_tr_b16 v[24:25], v8 offset:8192
    ds_read_u16 v195, v204 offset:108
    v_mfma_f32_16x16x32_bf16 v[188:191], v[36:39], v[124:127], v[188:191]
    ds_read_b64_tr_b16 v[26:27], v8 offset:9216
    ds_read_u16 v196, v204 offset:576
    s_waitcnt lgkmcnt(13)
    v_mfma_f32_16x16x32_bf16 v[56:59], v[40:43], v[88:91], v[56:59]
    ds_read_b64_tr_b16 v[28:29], v9 offset:8192
    ds_read_u16 v197, v204 offset:612
    v_mfma_f32_16x16x32_bf16 v[60:63], v[40:43], v[92:95], v[60:63]
    ds_read_b64_tr_b16 v[30:31], v9 offset:9216
    ds_read_u16 v198, v205 offset:0
    s_waitcnt lgkmcnt(15)
    v_mfma_f32_16x16x32_bf16 v[64:67], v[44:47], v[88:91], v[64:67]
    ds_read_b64_tr_b16 v[32:33], v10 offset:8192
    ds_read_u16 v199, v205 offset:36
    v_mfma_f32_16x16x32_bf16 v[68:71], v[44:47], v[92:95], v[68:71]
    ds_read_b64_tr_b16 v[34:35], v10 offset:9216
    ds_read_u16 v200, v205 offset:72
    s_waitcnt lgkmcnt(15)
    v_mfma_f32_16x16x32_bf16 v[72:75], v[48:51], v[88:91], v[72:75]
    ds_read_b64_tr_b16 v[36:37], v11 offset:8192
    ds_read_u16 v201, v205 offset:108
    v_mfma_f32_16x16x32_bf16 v[76:79], v[48:51], v[92:95], v[76:79]
    ds_read_b64_tr_b16 v[38:39], v11 offset:9216
    ds_read_u16 v202, v205 offset:576
    s_waitcnt lgkmcnt(15)
    v_mfma_f32_16x16x32_bf16 v[80:83], v[52:55], v[88:91], v[80:83]
    ds_read_b64_tr_b16 v[40:41], v12 offset:4096
    ds_read_u16 v203, v205 offset:612
    v_mfma_f32_16x16x32_bf16 v[84:87], v[52:55], v[92:95], v[84:87]
    ds_read_b64_tr_b16 v[42:43], v12 offset:4608
    s_waitcnt lgkmcnt(15)
    v_mfma_f32_16x16x32_bf16 v[128:131], v[24:27], v[88:91], v[128:131]
    ds_read_b64_tr_b16 v[44:45], v16 offset:4096
    v_mfma_f32_16x16x32_bf16 v[132:135], v[24:27], v[92:95], v[132:135]
    ds_read_b64_tr_b16 v[46:47], v16 offset:4608
    s_waitcnt lgkmcnt(14)
    v_mfma_f32_16x16x32_bf16 v[136:139], v[28:31], v[88:91], v[136:139]
    ds_read_b64_tr_b16 v[48:49], v17 offset:4096
    v_mfma_f32_16x16x32_bf16 v[140:143], v[28:31], v[92:95], v[140:143]
    ds_read_b64_tr_b16 v[50:51], v17 offset:4608
    s_waitcnt lgkmcnt(12)
    v_mfma_f32_16x16x32_bf16 v[144:147], v[32:35], v[88:91], v[144:147]
    ds_read_b64_tr_b16 v[52:53], v18 offset:4096
    v_mfma_f32_16x16x32_bf16 v[148:151], v[32:35], v[92:95], v[148:151]
    ds_read_b64_tr_b16 v[54:55], v18 offset:4608
    s_waitcnt lgkmcnt(10)
    v_mfma_f32_16x16x32_bf16 v[152:155], v[36:39], v[88:91], v[152:155]
    v_add_u32 v4, 0x8000, v4
    v_add_u32 v5, 0x8000, v5
    v_add_u32 v6, 0x8000, v6
    v_add_u32 v7, 0x8000, v7
    v_add_u32 v8, 0x8000, v8
    v_add_u32 v9, 0x8000, v9
    v_add_u32 v10, 0x8000, v10
    v_add_u32 v11, 0x8000, v11
    v_add_u32 v12, 0xc000, v12
    v_add_u32 v16, 0xc000, v16
    v_add_u32 v17, 0xc000, v17
    v_add_u32 v18, 0xc000, v18
    s_barrier
    ds_read_b64_tr_b16 v[24:25], v12 offset:0
    v_mfma_f32_16x16x32_bf16 v[156:159], v[36:39], v[92:95], v[156:159]
    ds_read_b64_tr_b16 v[26:27], v12 offset:512
    s_waitcnt lgkmcnt(8)
    v_mfma_f32_16x16x32_bf16 v[160:163], v[40:43], v[88:91], v[160:163]
    ds_read_b64_tr_b16 v[28:29], v16 offset:0
    s_add_u32 m0, s80, 65536
    s_add_u32 s53, s61, 0
    buffer_load_dwordx4 v2, s[44:47], s53 offen offset:0 sc1 lds
    buffer_load_dwordx4 v2, s[44:47], s53 offen offset:1024 sc1 lds
    buffer_load_dwordx4 v2, s[44:47], s53 offen offset:2048 sc1 lds
    buffer_load_dwordx4 v2, s[44:47], s53 offen offset:3072 sc1 lds
    v_mfma_f32_16x16x32_bf16 v[164:167], v[40:43], v[92:95], v[164:167]
    ds_read_b64_tr_b16 v[30:31], v16 offset:512
    s_add_u32 m0, s80, 32768
    s_add_u32 s53, s60, 32768
    buffer_load_dwordx4 v2, s[44:47], s53 offen offset:0 sc1 lds
    buffer_load_dwordx4 v2, s[44:47], s53 offen offset:1024 sc1 lds
    buffer_load_dwordx4 v2, s[44:47], s53 offen offset:2048 sc1 lds
    buffer_load_dwordx4 v2, s[44:47], s53 offen offset:3072 sc1 lds
    s_waitcnt lgkmcnt(8)
    v_mfma_f32_16x16x32_bf16 v[168:171], v[44:47], v[88:91], v[168:171]
    ds_read_b64_tr_b16 v[32:33], v17 offset:0
    v_mfma_f32_16x16x32_bf16 v[172:175], v[44:47], v[92:95], v[172:175]
    ds_read_b64_tr_b16 v[34:35], v17 offset:512
    s_waitcnt lgkmcnt(8)
    v_mfma_f32_16x16x32_bf16 v[176:179], v[48:51], v[88:91], v[176:179]
    ds_read_b64_tr_b16 v[36:37], v18 offset:0
    v_mfma_f32_16x16x32_bf16 v[180:183], v[48:51], v[92:95], v[180:183]
    ds_read_b64_tr_b16 v[38:39], v18 offset:512
    s_waitcnt lgkmcnt(8)
    v_mfma_f32_16x16x32_bf16 v[184:187], v[52:55], v[88:91], v[184:187]
    ds_read_b64_tr_b16 v[40:41], v12 offset:4096
    v_mfma_f32_16x16x32_bf16 v[188:191], v[52:55], v[92:95], v[188:191]
    ds_read_b64_tr_b16 v[42:43], v12 offset:4608
    s_waitcnt vmcnt(19) lgkmcnt(8)
    v_mfma_f32_16x16x32_bf16 v[160:163], v[24:27], v[96:99], v[160:163]
    ds_read_b64_tr_b16 v[44:45], v16 offset:4096
    s_waitcnt vmcnt(18)
    v_mfma_f32_16x16x32_bf16 v[164:167], v[24:27], v[100:103], v[164:167]
    ds_read_b64_tr_b16 v[46:47], v16 offset:4608
    s_waitcnt lgkmcnt(8)
    v_mfma_f32_16x16x32_bf16 v[168:171], v[28:31], v[96:99], v[168:171]
    ds_read_b64_tr_b16 v[48:49], v17 offset:4096
    v_mfma_f32_16x16x32_bf16 v[172:175], v[28:31], v[100:103], v[172:175]
    ds_read_b64_tr_b16 v[50:51], v17 offset:4608
    s_waitcnt lgkmcnt(8)
    v_mfma_f32_16x16x32_bf16 v[176:179], v[32:35], v[96:99], v[176:179]
    ds_read_b64_tr_b16 v[52:53], v18 offset:4096
    v_mfma_f32_16x16x32_bf16 v[180:183], v[32:35], v[100:103], v[180:183]
    ds_read_b64_tr_b16 v[54:55], v18 offset:4608
    s_waitcnt lgkmcnt(8)
    v_mfma_f32_16x16x32_bf16 v[184:187], v[36:39], v[96:99], v[184:187]
    ds_read_b64_tr_b16 v[24:25], v4 offset:0
    v_mfma_f32_16x16x32_bf16 v[188:191], v[36:39], v[100:103], v[188:191]
    ds_read_b64_tr_b16 v[26:27], v4 offset:1024
    s_waitcnt vmcnt(17) lgkmcnt(8)
    v_mfma_f32_16x16x32_bf16 v[160:163], v[40:43], v[104:107], v[160:163]
    ds_read_b64_tr_b16 v[28:29], v5 offset:0
    s_waitcnt vmcnt(16)
    v_mfma_f32_16x16x32_bf16 v[164:167], v[40:43], v[108:111], v[164:167]
    ds_read_b64_tr_b16 v[30:31], v5 offset:1024
    s_waitcnt lgkmcnt(8)
    v_mfma_f32_16x16x32_bf16 v[168:171], v[44:47], v[104:107], v[168:171]
    ds_read_b64_tr_b16 v[32:33], v6 offset:0
    v_mfma_f32_16x16x32_bf16 v[172:175], v[44:47], v[108:111], v[172:175]
    ds_read_b64_tr_b16 v[34:35], v6 offset:1024
    s_waitcnt lgkmcnt(8)
    v_mfma_f32_16x16x32_bf16 v[176:179], v[48:51], v[104:107], v[176:179]
    ds_read_b64_tr_b16 v[36:37], v7 offset:0
    v_mfma_f32_16x16x32_bf16 v[180:183], v[48:51], v[108:111], v[180:183]
    ds_read_b64_tr_b16 v[38:39], v7 offset:1024
    s_waitcnt lgkmcnt(8)
    v_mfma_f32_16x16x32_bf16 v[184:187], v[52:55], v[104:107], v[184:187]
    ds_read_b64_tr_b16 v[40:41], v8 offset:0
    v_mfma_f32_16x16x32_bf16 v[188:191], v[52:55], v[108:111], v[188:191]
    ds_read_b64_tr_b16 v[42:43], v8 offset:1024
    s_waitcnt lgkmcnt(8)
    v_mfma_f32_16x16x32_bf16 v[56:59], v[24:27], v[96:99], v[56:59]
    ds_read_b64_tr_b16 v[44:45], v9 offset:0
    v_mfma_f32_16x16x32_bf16 v[60:63], v[24:27], v[100:103], v[60:63]
    ds_read_b64_tr_b16 v[46:47], v9 offset:1024
    s_waitcnt lgkmcnt(8)
    v_mfma_f32_16x16x32_bf16 v[64:67], v[28:31], v[96:99], v[64:67]
    ds_read_b64_tr_b16 v[48:49], v10 offset:0
    v_lshl_or_b32 v208, v193, 16, v192
    v_lshl_or_b32 v209, v195, 16, v194
    v_lshl_or_b32 v210, v197, 16, v196
    v_mov_b32 v211, 0
    v_lshl_or_b32 v212, v199, 16, v198
    v_lshl_or_b32 v213, v201, 16, v200
    v_lshl_or_b32 v214, v203, 16, v202
    v_mfma_f32_16x16x32_bf16 v[68:71], v[28:31], v[100:103], v[68:71]
    ds_read_b64_tr_b16 v[50:51], v10 offset:1024
    v_mov_b32 v215, 0
    v_and_b32 v120, 15, v1
    v_lshlrev_b32 v120, 2, v120
    v_add_u32 v120, 64, v120
    v_cvt_pk_bf16_f32 v88, v176, v177
    v_cvt_pk_bf16_f32 v89, v178, v179
    s_waitcnt lgkmcnt(8)
    v_mfma_f32_16x16x32_bf16 v[72:75], v[32:35], v[96:99], v[72:75]
    ds_read_b64_tr_b16 v[52:53], v11 offset:0
    v_cvt_pk_bf16_f32 v250, v184, v185
    v_cvt_pk_bf16_f32 v251, v186, v187
    v_mov_b32 v90, v251
    v_mov_b32 v91, v250
    v_cvt_pk_bf16_f32 v92, v180, v181
    v_cvt_pk_bf16_f32 v93, v182, v183
    v_mfma_f32_16x16x32_bf16 v[76:79], v[32:35], v[100:103], v[76:79]
    ds_read_b64_tr_b16 v[54:55], v11 offset:1024
    v_cvt_pk_bf16_f32 v254, v188, v189
    v_cvt_pk_bf16_f32 v255, v190, v191
    v_mov_b32 v94, v255
    v_mov_b32 v95, v254
    ds_bpermute_b32 v3, v120, v186
    ds_bpermute_b32 v12, v120, v190
    s_waitcnt lgkmcnt(10)
    v_mfma_f32_16x16x32_bf16 v[80:83], v[36:39], v[96:99], v[80:83]
    ds_read_b64_tr_b16 v[24:25], v4 offset:8192
    v_mfma_f32_16x16x32_bf16 v[216:219], v[208:211], v[88:91], 0
    v_mfma_f32_16x16x32_bf16 v[220:223], v[208:211], v[92:95], 0
    v_mfma_f32_16x16x32_bf16 v[224:227], v[212:215], v[88:91], 0
    v_mfma_f32_16x16x32_bf16 v[228:231], v[212:215], v[92:95], 0
    v_cvt_pk_bf16_f32 v248, v160, v161
    v_cvt_pk_bf16_f32 v249, v162, v163
    v_mfma_f32_16x16x32_bf16 v[84:87], v[36:39], v[100:103], v[84:87]
    ds_read_b64_tr_b16 v[26:27], v4 offset:9216
    v_cvt_pk_bf16_f32 v112, v168, v169
    v_cvt_pk_bf16_f32 v113, v170, v171
    v_mov_b32 v114, v250
    v_mov_b32 v115, 0x3f80
    v_cvt_pk_bf16_f32 v252, v164, v165
    v_cvt_pk_bf16_f32 v253, v166, v167
    s_waitcnt lgkmcnt(10)
    v_mfma_f32_16x16x32_bf16 v[128:131], v[40:43], v[96:99], v[128:131]
    ds_read_b64_tr_b16 v[28:29], v5 offset:8192
    v_cvt_pk_bf16_f32 v116, v172, v173
    v_cvt_pk_bf16_f32 v117, v174, v175
    v_mov_b32 v118, v254
    v_mov_b32 v119, 0x3f80
    s_waitcnt lgkmcnt(4)
    v_mul_f32 v3, s68, v3
    v_exp_f32 v3, -v3
    v_mfma_f32_16x16x32_bf16 v[132:135], v[40:43], v[100:103], v[132:135]
    ds_read_b64_tr_b16 v[30:31], v5 offset:9216
    v_add_f32 v3, 1.0, v3
    v_rcp_f32 v3, v3
    s_waitcnt lgkmcnt(4)
    v_mul_f32 v12, s68, v12
    v_exp_f32 v12, -v12
    s_nop 0
    v_add_f32 v12, 1.0, v12
    v_rcp_f32 v12, v12
    v_mfma_f32_16x16x32_bf16 v[136:139], v[44:47], v[96:99], v[136:139]
    ds_read_b64_tr_b16 v[32:33], v6 offset:8192
    v_max3_f32 v120, v216, v217, v218
    v_max3_f32 v121, -v216, -v217, -v218
    v_max3_f32 v120, v120, v219, v224
    v_max3_f32 v121, v121, -v219, -v224
    v_max3_f32 v122, v220, v221, v222
    v_max3_f32 v123, -v220, -v221, -v222
    v_mfma_f32_16x16x32_bf16 v[140:143], v[44:47], v[100:103], v[140:143]
    ds_read_b64_tr_b16 v[34:35], v6 offset:9216
    v_max3_f32 v122, v122, v223, v228
    v_max3_f32 v123, v123, -v223, -v228
    v_permlane16_swap_b32 v120, v121
    s_nop 0
    v_permlane16_swap_b32 v122, v123
    v_max_f32 v120, v120, v121
    v_max_f32 v122, v122, v123
    v_mfma_f32_16x16x32_bf16 v[144:147], v[48:51], v[96:99], v[144:147]
    ds_read_b64_tr_b16 v[36:37], v7 offset:8192
    v_permlane32_swap_b32 v120, v122
    v_max_f32 v120, v120, v122
    v_mov_b32 v122, v120
    s_nop 1
    v_permlane32_swap_b32 v120, v122
    v_mov_b32 v121, v120
    v_mov_b32 v123, v122
    v_mfma_f32_16x16x32_bf16 v[148:151], v[48:51], v[100:103], v[148:151]
    ds_read_b64_tr_b16 v[38:39], v7 offset:9216
    v_permlane16_swap_b32 v120, v121
    v_permlane16_swap_b32 v122, v123
    v_mul_f32 v120, s68, v120
    v_mul_f32 v121, s68, v121
    v_mul_f32 v122, s68, v122
    v_mul_f32 v123, s68, v123
    v_mfma_f32_16x16x32_bf16 v[152:155], v[52:55], v[96:99], v[152:155]
    ds_read_b64_tr_b16 v[40:41], v8 offset:8192
    v_fma_f32 v160, v216, s68, -v120
    v_fma_f32 v165, -v216, s68, -v121
    v_fma_f32 v161, v217, s68, -v120
    v_fma_f32 v166, -v217, s68, -v121
    v_fma_f32 v162, v218, s68, -v120
    v_fma_f32 v167, -v218, s68, -v121
    v_mfma_f32_16x16x32_bf16 v[156:159], v[52:55], v[100:103], v[156:159]
    ds_read_b64_tr_b16 v[42:43], v8 offset:9216
    v_fma_f32 v163, v219, s68, -v120
    v_fma_f32 v168, -v219, s68, -v121
    v_fma_f32 v164, v224, s68, -v120
    v_fma_f32 v169, -v224, s68, -v121
    v_fma_f32 v170, v220, s68, -v122
    v_fma_f32 v175, -v220, s68, -v123
    s_waitcnt lgkmcnt(8)
    v_mfma_f32_16x16x32_bf16 v[56:59], v[24:27], v[104:107], v[56:59]
    ds_read_b64_tr_b16 v[44:45], v9 offset:8192
    v_fma_f32 v171, v221, s68, -v122
    v_fma_f32 v176, -v221, s68, -v123
    v_fma_f32 v172, v222, s68, -v122
    v_fma_f32 v177, -v222, s68, -v123
    v_fma_f32 v173, v223, s68, -v122
    v_fma_f32 v178, -v223, s68, -v123
    v_mfma_f32_16x16x32_bf16 v[60:63], v[24:27], v[108:111], v[60:63]
    ds_read_b64_tr_b16 v[46:47], v9 offset:9216
    v_fma_f32 v174, v228, s68, -v122
    v_fma_f32 v179, -v228, s68, -v123
    v_exp_f32 v160, v160
    v_exp_f32 v161, v161
    v_exp_f32 v162, v162
    v_exp_f32 v163, v163
    s_waitcnt lgkmcnt(8)
    v_mfma_f32_16x16x32_bf16 v[64:67], v[28:31], v[104:107], v[64:67]
    ds_read_b64_tr_b16 v[48:49], v10 offset:8192
    v_exp_f32 v164, v164
    v_exp_f32 v165, v165
    v_exp_f32 v166, v166
    v_exp_f32 v167, v167
    v_exp_f32 v168, v168
    v_exp_f32 v169, v169
    v_mfma_f32_16x16x32_bf16 v[68:71], v[28:31], v[108:111], v[68:71]
    ds_read_b64_tr_b16 v[50:51], v10 offset:9216
    v_exp_f32 v170, v170
    v_exp_f32 v171, v171
    v_exp_f32 v172, v172
    v_exp_f32 v173, v173
    v_exp_f32 v174, v174
    v_exp_f32 v175, v175
    s_waitcnt lgkmcnt(8)
    v_mfma_f32_16x16x32_bf16 v[72:75], v[32:35], v[104:107], v[72:75]
    ds_read_b64_tr_b16 v[52:53], v11 offset:8192
    v_exp_f32 v176, v176
    v_exp_f32 v177, v177
    v_exp_f32 v178, v178
    v_exp_f32 v179, v179
    v_mul_f32 v164, v164, v23
    v_mul_f32 v169, v169, v23
    v_mfma_f32_16x16x32_bf16 v[76:79], v[32:35], v[108:111], v[76:79]
    ds_read_b64_tr_b16 v[54:55], v11 offset:9216
    v_mul_f32 v174, v174, v23
    v_mul_f32 v179, v179, v23
    v_add_f32 v120, v160, v161
    v_add_f32 v121, v165, v166
    v_add_f32 v122, v170, v171
    v_add_f32 v123, v175, v176
    s_waitcnt lgkmcnt(8)
    v_mfma_f32_16x16x32_bf16 v[80:83], v[36:39], v[104:107], v[80:83]
    v_add_f32 v120, v120, v162
    v_add_f32 v121, v121, v167
    v_add_f32 v122, v122, v172
    v_add_f32 v123, v123, v177
    v_add_f32 v120, v120, v163
    v_add_f32 v121, v121, v168
    v_mfma_f32_16x16x32_bf16 v[84:87], v[36:39], v[108:111], v[84:87]
    v_add_f32 v122, v122, v173
    v_add_f32 v123, v123, v178
    v_add_f32 v120, v120, v164
    v_add_f32 v121, v121, v169
    v_add_f32 v122, v122, v174
    v_add_f32 v123, v123, v179
    s_waitcnt lgkmcnt(6)
    v_mfma_f32_16x16x32_bf16 v[128:131], v[40:43], v[104:107], v[128:131]
    v_permlane16_swap_b32 v120, v121
    v_permlane16_swap_b32 v122, v123
    v_add_f32 v120, v120, v121
    v_add_f32 v122, v122, v123
    s_nop 1
    v_permlane32_swap_b32 v120, v122
    v_add_f32 v120, v120, v122
    v_mfma_f32_16x16x32_bf16 v[132:135], v[40:43], v[108:111], v[132:135]
    v_mov_b32 v122, v120
    s_nop 1
    v_permlane32_swap_b32 v120, v122
    v_mov_b32 v121, v120
    v_mov_b32 v123, v122
    s_nop 0
    v_permlane16_swap_b32 v120, v121
    v_permlane16_swap_b32 v122, v123
    s_waitcnt lgkmcnt(4)
    v_mfma_f32_16x16x32_bf16 v[136:139], v[44:47], v[104:107], v[136:139]
    v_rcp_f32 v120, v120
    v_rcp_f32 v121, v121
    v_rcp_f32 v122, v122
    v_rcp_f32 v123, v123
    v_mul_f32 v160, v160, v120
    v_mul_f32 v161, v161, v120
    v_mfma_f32_16x16x32_bf16 v[140:143], v[44:47], v[108:111], v[140:143]
    v_mul_f32 v162, v162, v120
    v_mul_f32 v163, v163, v120
    v_mul_f32 v164, v164, v120
    v_mul_f32 v165, v165, v121
    v_mul_f32 v166, v166, v121
    v_mul_f32 v167, v167, v121
    s_waitcnt lgkmcnt(2)
    v_mfma_f32_16x16x32_bf16 v[144:147], v[48:51], v[104:107], v[144:147]
    v_mul_f32 v168, v168, v121
    v_mul_f32 v169, v169, v121
    v_mul_f32 v170, v170, v122
    v_mul_f32 v171, v171, v122
    v_mul_f32 v172, v172, v122
    v_mul_f32 v173, v173, v122
    v_mfma_f32_16x16x32_bf16 v[148:151], v[48:51], v[108:111], v[148:151]
    v_mul_f32 v174, v174, v122
    v_mul_f32 v175, v175, v123
    v_mul_f32 v176, v176, v123
    v_mul_f32 v177, v177, v123
    v_mul_f32 v178, v178, v123
    v_mul_f32 v179, v179, v123
    s_waitcnt lgkmcnt(0)
    v_mfma_f32_16x16x32_bf16 v[152:155], v[52:55], v[104:107], v[152:155]
    v_cvt_pk_bf16_f32 v192, v160, v161
    v_cvt_pk_bf16_f32 v193, v162, v163
    v_cvt_pk_bf16_f32 v194, v165, v166
    v_cvt_pk_bf16_f32 v195, v167, v168
    v_cvt_pk_bf16_f32 v196, v164, v169
    v_mov_b32 v197, 0
    v_mfma_f32_16x16x32_bf16 v[156:159], v[52:55], v[108:111], v[156:159]
    v_cvt_pk_bf16_f32 v200, v170, v171
    v_cvt_pk_bf16_f32 v201, v172, v173
    v_cvt_pk_bf16_f32 v202, v175, v176
    v_cvt_pk_bf16_f32 v203, v177, v178
    v_cvt_pk_bf16_f32 v204, v174, v179
    v_mov_b32 v205, 0
    v_and_b32 v6, 15, v1
    v_lshrrev_b32 v7, 4, v1
    s_mul_i32 s6, s5, 5376
    s_add_u32 s6, s6, 98304
    v_mul_u32_u24 v8, 168, v6
    v_lshl_add_u32 v8, v7, 3, v8
    v_add_u32 v4, s6, v8
    v_mov_b32 v13, v2
    s_waitcnt vmcnt(12)
    s_barrier
    ds_write_b64 v4, v[192:193] offset:0
    ds_write_b64 v4, v[194:195] offset:32
    ds_write_b64 v4, v[196:197] offset:64
    ds_write_b64 v4, v[112:113] offset:96
    ds_write_b64 v4, v[114:115] offset:128
    ds_write_b64 v4, v[200:201] offset:2688
    ds_write_b64 v4, v[202:203] offset:2720
    ds_write_b64 v4, v[204:205] offset:2752
    ds_write_b64 v4, v[116:117] offset:2784
    ds_write_b64 v4, v[118:119] offset:2816
    s_add_u32 m0, s80, 81920
    s_add_u32 s53, s61, 16384
    buffer_load_dwordx4 v2, s[44:47], s53 offen offset:0 sc1 lds
    buffer_load_dwordx4 v2, s[44:47], s53 offen offset:1024 sc1 lds
    buffer_load_dwordx4 v2, s[44:47], s53 offen offset:2048 sc1 lds
    buffer_load_dwordx4 v2, s[44:47], s53 offen offset:3072 sc1 lds
    ds_read_b128 v[24:27], v13 offset:0
    ds_read_b128 v[28:31], v13 offset:1024
    ds_read_b128 v[32:35], v13 offset:2048
    ds_read_b128 v[36:39], v13 offset:3072
    ds_read_b128 v[40:43], v13 offset:4096
    ds_read_b128 v[44:47], v13 offset:5120
    ds_read_b128 v[48:51], v13 offset:6144
    ds_read_b128 v[52:55], v13 offset:7168
    v_pk_mul_f32 v[56:57], v[56:57], s[70:71]
    v_pk_mul_f32 v[58:59], v[58:59], s[70:71]
    v_cvt_pk_bf16_f32 v216, v56, v57
    v_cvt_pk_bf16_f32 v217, v58, v59
    v_pk_mul_f32 v[64:65], v[64:65], s[70:71]
    v_pk_mul_f32 v[66:67], v[66:67], s[70:71]
    v_cvt_pk_bf16_f32 v218, v64, v65
    v_cvt_pk_bf16_f32 v219, v66, v67
    v_pk_mul_f32 v[72:73], v[72:73], s[70:71]
    v_pk_mul_f32 v[74:75], v[74:75], s[70:71]
    v_cvt_pk_bf16_f32 v220, v72, v73
    v_cvt_pk_bf16_f32 v221, v74, v75
    v_pk_mul_f32 v[80:81], v[80:81], s[70:71]
    v_pk_mul_f32 v[82:83], v[82:83], s[70:71]
    v_cvt_pk_bf16_f32 v222, v80, v81
    v_cvt_pk_bf16_f32 v223, v82, v83
    v_pk_mul_f32 v[128:129], v[128:129], s[70:71]
    v_pk_mul_f32 v[130:131], v[130:131], s[70:71]
    v_cvt_pk_bf16_f32 v224, v128, v129
    v_cvt_pk_bf16_f32 v225, v130, v131
    v_pk_mul_f32 v[136:137], v[136:137], s[70:71]
    v_pk_mul_f32 v[138:139], v[138:139], s[70:71]
    v_cvt_pk_bf16_f32 v226, v136, v137
    v_cvt_pk_bf16_f32 v227, v138, v139
    v_pk_mul_f32 v[144:145], v[144:145], s[70:71]
    v_pk_mul_f32 v[146:147], v[146:147], s[70:71]
    v_cvt_pk_bf16_f32 v228, v144, v145
    v_cvt_pk_bf16_f32 v229, v146, v147
    v_pk_mul_f32 v[152:153], v[152:153], s[70:71]
    v_pk_mul_f32 v[154:155], v[154:155], s[70:71]
    v_cvt_pk_bf16_f32 v230, v152, v153
    v_cvt_pk_bf16_f32 v231, v154, v155
    v_pk_mul_f32 v[60:61], v[60:61], s[70:71]
    v_pk_mul_f32 v[62:63], v[62:63], s[70:71]
    v_cvt_pk_bf16_f32 v232, v60, v61
    v_cvt_pk_bf16_f32 v233, v62, v63
    v_pk_mul_f32 v[68:69], v[68:69], s[70:71]
    v_pk_mul_f32 v[70:71], v[70:71], s[70:71]
    v_cvt_pk_bf16_f32 v234, v68, v69
    v_cvt_pk_bf16_f32 v235, v70, v71
    v_pk_mul_f32 v[76:77], v[76:77], s[70:71]
    v_pk_mul_f32 v[78:79], v[78:79], s[70:71]
    v_cvt_pk_bf16_f32 v236, v76, v77
    v_cvt_pk_bf16_f32 v237, v78, v79
    v_pk_mul_f32 v[84:85], v[84:85], s[70:71]
    v_pk_mul_f32 v[86:87], v[86:87], s[70:71]
    v_cvt_pk_bf16_f32 v238, v84, v85
    v_cvt_pk_bf16_f32 v239, v86, v87
    v_pk_mul_f32 v[132:133], v[132:133], s[70:71]
    v_pk_mul_f32 v[134:135], v[134:135], s[70:71]
    v_cvt_pk_bf16_f32 v240, v132, v133
    v_cvt_pk_bf16_f32 v241, v134, v135
    v_pk_mul_f32 v[140:141], v[140:141], s[70:71]
    v_pk_mul_f32 v[142:143], v[142:143], s[70:71]
    v_cvt_pk_bf16_f32 v242, v140, v141
    v_cvt_pk_bf16_f32 v243, v142, v143
    v_pk_mul_f32 v[148:149], v[148:149], s[70:71]
    v_pk_mul_f32 v[150:151], v[150:151], s[70:71]
    v_cvt_pk_bf16_f32 v244, v148, v149
    v_cvt_pk_bf16_f32 v245, v150, v151
    v_pk_mul_f32 v[156:157], v[156:157], s[70:71]
    v_pk_mul_f32 v[158:159], v[158:159], s[70:71]
    v_cvt_pk_bf16_f32 v246, v156, v157
    v_cvt_pk_bf16_f32 v247, v158, v159
    v_lshlrev_b32 v8, 2, v7
    v_sub_u32 v8, v6, v8
    v_add_u32 v15, s7, v8
    v_add_u32 v16, 16, v15
    v_mov_b32 v17, 0
    v_mov_b32 v18, 0
    v_mov_b32 v11, 0x44800000
    s_mov_b32 s64, 0xffff
    v_mov_b32 v10, 0x10000
    v_add_u32 v14, 0x10000, v2
    s_mov_b32 s65, 0
    s_cmp_ge_u32 s5, 3
    s_cselect_b32 s6, 1, 0
    s_mul_i32 s8, s6, 3
    s_sub_u32 s8, s5, s8
    v_bfe_u32 v8, v1, 2, 2
    v_lshl_add_u32 v8, v7, 3, v8
    v_and_b32 v9, 3, v1
    v_lshlrev_b32 v9, 3, v9
    v_mul_u32_u24 v21, 168, v8
    v_add_u32 v21, v21, v9
    s_lshl_b32 s9, s8, 5
    s_add_u32 s9, s9, 98304
    v_add_u32 v4, s9, v21
    s_lshl_b32 s9, s6, 5
    s_add_u32 s9, s9, 98400
    v_add_u32 v6, s9, v21
    v_mov_b32 v68, 0
    v_mov_b32 v69, 0
    v_mov_b32 v70, 0
    v_mov_b32 v71, 0
    s_waitcnt lgkmcnt(8)
    s_barrier
    v_lshrrev_b32 v8, 2, v2
    v_mov_b32 v7, s52
    v_cmp_gt_u32 vcc, 8, v1
    s_nop 1
    v_cndmask_b32 v8, v7, v8, vcc
    v_cmp_eq_u32 vcc, 6, v1
    s_nop 1
    v_cndmask_b32 v7, 0, 1, vcc
    s_lshl_b32 s15, s3, 7
    s_add_u32 s15, s15, 83886080
    ds_read_b128 v[120:123], v13 offset:8192
    ds_read_b128 v[124:127], v13 offset:9216
    ds_read_b128 v[192:195], v13 offset:10240
    ds_read_b128 v[196:199], v13 offset:11264
    s_waitcnt lgkmcnt(11)
    v_mfma_f32_16x16x32_bf16 v[72:75], v[24:27], v[216:219], 0
    ds_read_b64_tr_b16 v[128:129], v4 offset:0
    ds_read_b64_tr_b16 v[130:131], v4 offset:672
    v_mfma_f32_16x16x32_bf16 v[76:79], v[24:27], v[232:235], 0
    ds_read_b128 v[200:203], v13 offset:12288
    ds_read_b64_tr_b16 v[160:161], v6 offset:0
    ds_read_b64_tr_b16 v[162:163], v6 offset:672
    s_waitcnt lgkmcnt(15)
    v_mfma_f32_16x16x32_bf16 v[72:75], v[28:31], v[220:223], v[72:75]
    ds_read_b64_tr_b16 v[132:133], v4 offset:5376
    ds_read_b64_tr_b16 v[134:135], v4 offset:6048
    v_mfma_f32_16x16x32_bf16 v[76:79], v[28:31], v[236:239], v[76:79]
    ds_read_b128 v[204:207], v13 offset:13312
    ds_read_b64_tr_b16 v[164:165], v6 offset:5376
    ds_read_b64_tr_b16 v[166:167], v6 offset:6048
    s_waitcnt lgkmcnt(15)
    v_mfma_f32_16x16x32_bf16 v[72:75], v[32:35], v[224:227], v[72:75]
    ds_read_b64_tr_b16 v[136:137], v4 offset:10752
    ds_read_b64_tr_b16 v[138:139], v4 offset:11424
    v_mfma_f32_16x16x32_bf16 v[76:79], v[32:35], v[240:243], v[76:79]
    ds_read_b128 v[208:211], v13 offset:14336
    ds_read_b64_tr_b16 v[168:169], v6 offset:10752
    ds_read_b64_tr_b16 v[170:171], v6 offset:11424
    v_mfma_f32_16x16x32_bf16 v[72:75], v[36:39], v[228:231], v[72:75]
    ds_read_b64_tr_b16 v[140:141], v4 offset:16128
    ds_read_b64_tr_b16 v[142:143], v4 offset:16800
    v_mfma_f32_16x16x32_bf16 v[76:79], v[36:39], v[244:247], v[76:79]
    ds_read_b128 v[212:215], v13 offset:15360
    ds_read_b64_tr_b16 v[172:173], v6 offset:16128
    ds_read_b64_tr_b16 v[174:175], v6 offset:16800
    v_mfma_f32_16x16x32_bf16 v[80:83], v[40:43], v[216:219], 0
    ds_read_b64_tr_b16 v[144:145], v4 offset:21504
    ds_read_b64_tr_b16 v[146:147], v4 offset:22176
    v_mfma_f32_16x16x32_bf16 v[84:87], v[40:43], v[232:235], 0
    ds_read_b64_tr_b16 v[176:177], v6 offset:21504
    ds_read_b64_tr_b16 v[178:179], v6 offset:22176
    v_mfma_f32_16x16x32_bf16 v[80:83], v[44:47], v[220:223], v[80:83]
    ds_read_b64_tr_b16 v[148:149], v4 offset:26880
    ds_read_b64_tr_b16 v[150:151], v4 offset:27552
    v_mfma_f32_16x16x32_bf16 v[84:87], v[44:47], v[236:239], v[84:87]
    ds_read_b64_tr_b16 v[180:181], v6 offset:26880
    ds_read_b64_tr_b16 v[182:183], v6 offset:27552
    v_mfma_f32_16x16x32_bf16 v[80:83], v[48:51], v[224:227], v[80:83]
    ds_read_b64_tr_b16 v[152:153], v4 offset:32256
    ds_read_b64_tr_b16 v[154:155], v4 offset:32928
    v_mfma_f32_16x16x32_bf16 v[84:87], v[48:51], v[240:243], v[84:87]
    ds_read_b64_tr_b16 v[184:185], v6 offset:32256
    ds_read_b64_tr_b16 v[186:187], v6 offset:32928
    s_waitcnt lgkmcnt(15)
    v_mfma_f32_16x16x32_bf16 v[80:83], v[52:55], v[228:231], v[80:83]
    ds_read_b64_tr_b16 v[156:157], v4 offset:37632
    ds_read_b64_tr_b16 v[158:159], v4 offset:38304
    v_mfma_f32_16x16x32_bf16 v[84:87], v[52:55], v[244:247], v[84:87]
    ds_read_b64_tr_b16 v[188:189], v6 offset:37632
    ds_read_b64_tr_b16 v[190:191], v6 offset:38304
    v_mfma_f32_16x16x32_bf16 v[64:67], v[128:131], v[160:163], 0
    v_mfma_f32_16x16x32_bf16 v[64:67], v[132:135], v[164:167], v[64:67]
    v_mfma_f32_16x16x32_bf16 v[64:67], v[136:139], v[168:171], v[64:67]
    s_waitcnt lgkmcnt(15)
    v_mfma_f32_16x16x32_bf16 v[64:67], v[140:143], v[172:175], v[64:67]
    s_waitcnt lgkmcnt(12)
    v_mfma_f32_16x16x32_bf16 v[64:67], v[144:147], v[176:179], v[64:67]
    s_waitcnt lgkmcnt(8)
    v_mfma_f32_16x16x32_bf16 v[64:67], v[148:151], v[180:183], v[64:67]
    s_waitcnt lgkmcnt(4)
    v_mfma_f32_16x16x32_bf16 v[64:67], v[152:155], v[184:187], v[64:67]
    s_waitcnt lgkmcnt(0)
    v_mfma_f32_16x16x32_bf16 v[64:67], v[156:159], v[188:191], v[64:67]
    s_cmp_lg_u32 s66, 0
    s_cbranch_scc1 A_NM
    s_nop 4
    v_cmp_gt_i32 s[74:75], 0, v15
    v_cmp_gt_i32 s[76:77], 1, v15
    v_cmp_gt_i32 s[78:79], 2, v15
    v_cmp_gt_i32 s[90:91], 3, v15
    v_cndmask_b32 v72, v72, v22, s[74:75]
    v_cndmask_b32 v73, v73, v22, s[76:77]
    v_cndmask_b32 v74, v74, v22, s[78:79]
    v_cndmask_b32 v75, v75, v22, s[90:91]
    v_cmp_gt_i32 s[74:75], 16, v15
    v_cmp_gt_i32 s[76:77], 17, v15
    v_cmp_gt_i32 s[78:79], 18, v15
    v_cmp_gt_i32 s[90:91], 19, v15
    v_cndmask_b32 v80, v80, v22, s[74:75]
    v_cndmask_b32 v81, v81, v22, s[76:77]
    v_cndmask_b32 v82, v82, v22, s[78:79]
    v_cndmask_b32 v83, v83, v22, s[90:91]
    v_cmp_gt_i32 s[74:75], 0, v16
    v_cmp_gt_i32 s[76:77], 1, v16
    v_cmp_gt_i32 s[78:79], 2, v16
    v_cmp_gt_i32 s[90:91], 3, v16
    v_cndmask_b32 v76, v76, v22, s[74:75]
    v_cndmask_b32 v77, v77, v22, s[76:77]
    v_cndmask_b32 v78, v78, v22, s[78:79]
    v_cndmask_b32 v79, v79, v22, s[90:91]
    v_cmp_gt_i32 s[74:75], 16, v16
    v_cmp_gt_i32 s[76:77], 17, v16
    v_cmp_gt_i32 s[78:79], 18, v16
    v_cmp_gt_i32 s[90:91], 19, v16
    v_cndmask_b32 v84, v84, v22, s[74:75]
    v_cndmask_b32 v85, v85, v22, s[76:77]
    v_cndmask_b32 v86, v86, v22, s[78:79]
    v_cndmask_b32 v87, v87, v22, s[90:91]
A_NM:
    v_max3_f32 v112, v72, v73, v74
    v_max3_f32 v112, v112, v75, v80
    v_max3_f32 v112, v112, v81, v82
    v_max_f32 v112, v83, v112
    v_max3_f32 v113, v76, v77, v78
    v_max3_f32 v113, v113, v79, v84
    v_max3_f32 v113, v113, v85, v86
    v_max_f32 v113, v87, v113
    s_lshl_b32 s9, s3, 3
    s_add_u32 s9, s9, s4
    s_mul_i32 s9, s9, 6144
    s_add_u32 s9, s9, s97
    s_add_u32 s9, s9, 67108864
    v_mfma_f32_16x16x32_bf16 v[128:131], v[68:71], v[68:71], 0
    v_permlane16_swap_b32 v112, v113
    v_max_f32 v112, v112, v113
    v_mfma_f32_16x16x32_bf16 v[132:135], v[68:71], v[68:71], 0
    v_mov_b32 v114, v112
    s_nop 1
    v_permlane32_swap_b32 v112, v114
    v_mfma_f32_16x16x32_bf16 v[136:139], v[68:71], v[68:71], 0
    v_max_f32 v112, v112, v114
    v_mov_b32 v113, v112
    v_mfma_f32_16x16x32_bf16 v[140:143], v[68:71], v[68:71], 0
    s_nop 0
    v_permlane16_swap_b32 v112, v113
    buffer_store_dwordx4 v[64:67], v2, s[44:47], s9 offen sc1
    v_mfma_f32_16x16x32_bf16 v[144:147], v[68:71], v[68:71], 0
    v_sub_f32 v104, 0, v112
    v_sub_f32 v105, 0, v112
    v_mfma_f32_16x16x32_bf16 v[148:151], v[68:71], v[68:71], 0
    v_sub_f32 v106, 0, v112
    v_sub_f32 v107, 0, v112
    v_mfma_f32_16x16x32_bf16 v[152:155], v[68:71], v[68:71], 0
    v_sub_f32 v108, 0, v113
    v_sub_f32 v109, 0, v113
    v_mfma_f32_16x16x32_bf16 v[156:159], v[68:71], v[68:71], 0
    v_sub_f32 v110, 0, v113
    v_sub_f32 v111, 0, v113
    v_mfma_f32_16x16x32_bf16 v[160:163], v[68:71], v[68:71], 0
    v_sub_f32 v72, v72, v112
    v_sub_f32 v73, v73, v112
    v_mfma_f32_16x16x32_bf16 v[164:167], v[68:71], v[68:71], 0
    v_sub_f32 v74, v74, v112
    v_sub_f32 v75, v75, v112
    v_mfma_f32_16x16x32_bf16 v[168:171], v[68:71], v[68:71], 0
    v_sub_f32 v80, v80, v112
    v_sub_f32 v81, v81, v112
    v_mfma_f32_16x16x32_bf16 v[172:175], v[68:71], v[68:71], 0
    v_sub_f32 v82, v82, v112
    v_sub_f32 v83, v83, v112
    v_mfma_f32_16x16x32_bf16 v[176:179], v[68:71], v[68:71], 0
    v_sub_f32 v76, v76, v113
    v_sub_f32 v77, v77, v113
    v_mfma_f32_16x16x32_bf16 v[180:183], v[68:71], v[68:71], 0
    v_sub_f32 v78, v78, v113
    v_sub_f32 v79, v79, v113
    v_mfma_f32_16x16x32_bf16 v[184:187], v[68:71], v[68:71], 0
    v_sub_f32 v84, v84, v113
    v_sub_f32 v85, v85, v113
    v_mfma_f32_16x16x32_bf16 v[188:191], v[68:71], v[68:71], 0
    v_sub_f32 v86, v86, v113
    v_sub_f32 v87, v87, v113
    s_lshl_b32 s6, s66, 6
    v_subrev_u32 v15, s6, v15
    v_subrev_u32 v16, s6, v16
    buffer_load_dword v9, v8, s[44:47], s15 offen sc1
    v_mfma_f32_16x16x32_bf16 v[88:91], v[120:123], v[216:219], v[104:107]
    v_exp_f32 v112, v72
    v_exp_f32 v113, v73
    v_mfma_f32_16x16x32_bf16 v[92:95], v[120:123], v[232:235], v[108:111]
    v_add_f32 v19, v112, v113
    v_cvt_pk_bf16_f32 v56, v112, v113
    v_mfma_f32_16x16x32_bf16 v[88:91], v[124:127], v[220:223], v[88:91]
    v_exp_f32 v114, v74
    v_exp_f32 v115, v75
    v_mfma_f32_16x16x32_bf16 v[92:95], v[124:127], v[236:239], v[92:95]
    v_add_f32 v19, v19, v114
    v_add_f32 v19, v19, v115
    v_cvt_pk_bf16_f32 v57, v114, v115
    v_mfma_f32_16x16x32_bf16 v[88:91], v[192:195], v[224:227], v[88:91]
    v_exp_f32 v116, v80
    v_exp_f32 v117, v81
    v_mfma_f32_16x16x32_bf16 v[92:95], v[192:195], v[240:243], v[92:95]
    v_add_f32 v19, v19, v116
    v_add_f32 v19, v19, v117
    v_cvt_pk_bf16_f32 v58, v116, v117
    v_mfma_f32_16x16x32_bf16 v[88:91], v[196:199], v[228:231], v[88:91]
    v_exp_f32 v118, v82
    v_exp_f32 v119, v83
    v_mfma_f32_16x16x32_bf16 v[92:95], v[196:199], v[244:247], v[92:95]
    v_add_f32 v19, v19, v118
    v_add_f32 v19, v19, v119
    v_cvt_pk_bf16_f32 v59, v118, v119
    v_mfma_f32_16x16x32_bf16 v[96:99], v[200:203], v[216:219], v[104:107]
    v_exp_f32 v112, v76
    v_exp_f32 v113, v77
    v_mfma_f32_16x16x32_bf16 v[100:103], v[200:203], v[232:235], v[108:111]
    v_add_f32 v20, v112, v113
    v_cvt_pk_bf16_f32 v60, v112, v113
    v_mfma_f32_16x16x32_bf16 v[96:99], v[204:207], v[220:223], v[96:99]
    v_exp_f32 v114, v78
    v_exp_f32 v115, v79
    v_mfma_f32_16x16x32_bf16 v[100:103], v[204:207], v[236:239], v[100:103]
    v_add_f32 v20, v20, v114
    v_add_f32 v20, v20, v115
    v_cvt_pk_bf16_f32 v61, v114, v115
    v_mfma_f32_16x16x32_bf16 v[96:99], v[208:211], v[224:227], v[96:99]
    v_exp_f32 v116, v84
    v_exp_f32 v117, v85
    v_mfma_f32_16x16x32_bf16 v[100:103], v[208:211], v[240:243], v[100:103]
    v_add_f32 v20, v20, v116
    v_add_f32 v20, v20, v117
    v_cvt_pk_bf16_f32 v62, v116, v117
    v_mfma_f32_16x16x32_bf16 v[96:99], v[212:215], v[228:231], v[96:99]
    v_exp_f32 v118, v86
    v_exp_f32 v119, v87
    v_mfma_f32_16x16x32_bf16 v[100:103], v[212:215], v[244:247], v[100:103]
    v_add_f32 v20, v20, v118
    v_add_f32 v20, v20, v119
    v_cvt_pk_bf16_f32 v63, v118, v119
    s_waitcnt vmcnt(10)
    s_barrier
    s_add_u32 s62, s80, 49152
    s_add_u32 s63, s80, 98304
    s_add_u32 s60, s60, 49152
    s_add_u32 s61, s61, 32768
    s_lshl_b32 s13, s4, 3
    s_and_b32 s8, s2, 4
    s_add_u32 s13, s13, s8
    s_lshr_b32 s8, s2, 6
    s_add_u32 s13, s13, s8
    s_lshl_b32 s13, s13, 2
    s_and_b32 s8, s2, 3
    s_add_u32 s13, s13, s8
    s_mul_i32 s13, s13, 40960
    s_mul_i32 s8, s5, 5120
    s_add_u32 s13, s13, s8
    s_add_u32 s13, s13, 100663296
    s_mov_b32 m0, s62
    s_nop 0
    buffer_load_dwordx4 v2, s[44:47], s60 offen offset:0 sc1 lds
    buffer_load_dwordx4 v2, s[44:47], s60 offen offset:1024 sc1 lds
    buffer_load_dwordx4 v2, s[44:47], s60 offen offset:2048 sc1 lds
    buffer_load_dwordx4 v2, s[44:47], s60 offen offset:3072 sc1 lds
    s_add_u32 s60, s60, 16384
    s_mov_b32 s62, s80
    s_waitcnt vmcnt(4)
    v_and_b32 v9, v9, v7
    v_cmp_ne_u32 vcc, v9, v7
    s_cbranch_vccz P2B_OK
    s_mov_b32 s55, 0x40000
P2B_SP:
    s_sleep 2
    buffer_load_dword v9, v8, s[44:47], s15 offen sc1
    s_waitcnt vmcnt(0)
    v_and_b32 v9, v9, v7
    v_cmp_ne_u32 vcc, v9, v7
    s_cbranch_vccz P2B_OK
    s_sub_u32 s55, s55, 1
    s_cmp_lg_u32 s55, 0
    s_cbranch_scc1 P2B_SP
P2B_OK:
    s_mov_b32 m0, s63
    s_add_u32 s63, s63, 16384
    buffer_load_dwordx4 v2, s[44:47], s61 offen offset:0 sc1 lds
    buffer_load_dwordx4 v2, s[44:47], s61 offen offset:1024 sc1 lds
    buffer_load_dwordx4 v2, s[44:47], s61 offen offset:2048 sc1 lds
    buffer_load_dwordx4 v2, s[44:47], s61 offen offset:3072 sc1 lds
    s_add_u32 s61, s61, 16384
    s_and_b32 s63, s63, 0xffff
    s_or_b32 s63, s63, 0x10000
    s_mov_b32 m0, s62
    s_add_u32 s62, s62, 16384
    buffer_load_dwordx4 v2, s[44:47], s60 offen offset:0 sc1 lds
    buffer_load_dwordx4 v2, s[44:47], s60 offen offset:1024 sc1 lds
    buffer_load_dwordx4 v2, s[44:47], s60 offen offset:2048 sc1 lds
    buffer_load_dwordx4 v2, s[44:47], s60 offen offset:3072 sc1 lds
    s_add_u32 s60, s60, 16384
    s_and_b32 s62, s62, 0xffff
    s_cmp_eq_u32 s66, 0
    s_cbranch_scc1 A_PV
    v_add_u32 v13, 0x4000, v13
    v_and_b32 v13, 0xffff, v13
    ds_read_b128 v[24:27], v13 offset:0
    ds_read_b128 v[28:31], v13 offset:1024
    ds_read_b128 v[32:35], v13 offset:2048
    ds_read_b128 v[36:39], v13 offset:3072
    ds_read_b128 v[40:43], v13 offset:4096
    ds_read_b128 v[44:47], v13 offset:5120
    ds_read_b128 v[48:51], v13 offset:6144
    ds_read_b128 v[52:55], v13 offset:7168
    ds_read_b128 v[120:123], v14 offset:0
    ds_read_b128 v[124:127], v14 offset:1024
    ds_read_b128 v[192:195], v14 offset:2048
    ds_read_b128 v[196:199], v14 offset:3072
    s_cmp_le_u32 s66, 1
    s_cbranch_scc1 A_S1
.p2align 6
    s_nop 0
    s_nop 0
    s_nop 0
    s_nop 0
A_LOOP:
    s_waitcnt lgkmcnt(8)
    v_mfma_f32_16x16x32_bf16 v[72:75], v[24:27], v[216:219], v[104:107]
    v_exp_f32 v112, v88
    v_mfma_f32_16x16x32_bf16 v[76:79], v[24:27], v[232:235], v[108:111]
    ds_read_b128 v[200:203], v14 offset:4096
    v_add_f32 v17, v17, v19
    v_mfma_f32_16x16x32_bf16 v[72:75], v[28:31], v[220:223], v[72:75]
    v_exp_f32 v113, v89
    v_mfma_f32_16x16x32_bf16 v[76:79], v[28:31], v[236:239], v[76:79]
    ds_read_b128 v[204:207], v14 offset:5120
    v_add_f32 v19, v112, v113
    v_cvt_pk_bf16_f32 v64, v112, v113
    v_mfma_f32_16x16x32_bf16 v[72:75], v[32:35], v[224:227], v[72:75]
    v_exp_f32 v114, v90
    v_mfma_f32_16x16x32_bf16 v[76:79], v[32:35], v[240:243], v[76:79]
    ds_read_b128 v[208:211], v14 offset:6144
    v_add_f32 v19, v19, v114
    v_mfma_f32_16x16x32_bf16 v[72:75], v[36:39], v[228:231], v[72:75]
    v_exp_f32 v115, v91
    v_mfma_f32_16x16x32_bf16 v[76:79], v[36:39], v[244:247], v[76:79]
    ds_read_b128 v[212:215], v14 offset:7168
    v_add_f32 v19, v19, v115
    v_cvt_pk_bf16_f32 v65, v114, v115
    s_waitcnt lgkmcnt(8)
    v_mfma_f32_16x16x32_bf16 v[80:83], v[40:43], v[216:219], v[104:107]
    v_exp_f32 v116, v96
    v_mfma_f32_16x16x32_bf16 v[84:87], v[40:43], v[232:235], v[108:111]
    ds_read_b128 v[24:27], v13 offset:8192
    v_add_f32 v19, v19, v116
    v_mfma_f32_16x16x32_bf16 v[80:83], v[44:47], v[220:223], v[80:83]
    v_exp_f32 v117, v97
    v_mfma_f32_16x16x32_bf16 v[84:87], v[44:47], v[236:239], v[84:87]
    ds_read_b128 v[28:31], v13 offset:9216
    v_add_f32 v19, v19, v117
    v_cvt_pk_bf16_f32 v66, v116, v117
    v_mfma_f32_16x16x32_bf16 v[80:83], v[48:51], v[224:227], v[80:83]
    v_exp_f32 v118, v98
    v_mfma_f32_16x16x32_bf16 v[84:87], v[48:51], v[240:243], v[84:87]
    ds_read_b128 v[32:35], v13 offset:10240
    v_add_f32 v19, v19, v118
    v_mfma_f32_16x16x32_bf16 v[80:83], v[52:55], v[228:231], v[80:83]
    v_exp_f32 v119, v99
    v_mfma_f32_16x16x32_bf16 v[84:87], v[52:55], v[244:247], v[84:87]
    ds_read_b128 v[36:39], v13 offset:11264
    v_add_f32 v19, v19, v119
    v_cvt_pk_bf16_f32 v67, v118, v119
    s_waitcnt lgkmcnt(8)
    v_mfma_f32_16x16x32_bf16 v[128:131], v[120:123], v[56:59], v[128:131]
    v_exp_f32 v112, v92
    v_mfma_f32_16x16x32_bf16 v[132:135], v[120:123], v[60:63], v[132:135]
    ds_read_b128 v[40:43], v13 offset:12288
    v_add_f32 v18, v18, v20
    v_mfma_f32_16x16x32_bf16 v[136:139], v[124:127], v[56:59], v[136:139]
    v_exp_f32 v113, v93
    v_mfma_f32_16x16x32_bf16 v[140:143], v[124:127], v[60:63], v[140:143]
    ds_read_b128 v[44:47], v13 offset:13312
    v_add_f32 v20, v112, v113
    v_cvt_pk_bf16_f32 v68, v112, v113
    v_mfma_f32_16x16x32_bf16 v[144:147], v[192:195], v[56:59], v[144:147]
    v_exp_f32 v114, v94
    v_mfma_f32_16x16x32_bf16 v[148:151], v[192:195], v[60:63], v[148:151]
    ds_read_b128 v[48:51], v13 offset:14336
    v_add_f32 v20, v20, v114
    v_mfma_f32_16x16x32_bf16 v[152:155], v[196:199], v[56:59], v[152:155]
    v_exp_f32 v115, v95
    v_mfma_f32_16x16x32_bf16 v[156:159], v[196:199], v[60:63], v[156:159]
    ds_read_b128 v[52:55], v13 offset:15360
    v_add_f32 v20, v20, v115
    v_cvt_pk_bf16_f32 v69, v114, v115
    s_waitcnt lgkmcnt(8)
    v_mfma_f32_16x16x32_bf16 v[160:163], v[200:203], v[56:59], v[160:163]
    v_exp_f32 v116, v100
    v_mfma_f32_16x16x32_bf16 v[164:167], v[200:203], v[60:63], v[164:167]
    ds_read_b128 v[120:123], v14 offset:8192
    v_add_f32 v20, v20, v116
    v_mfma_f32_16x16x32_bf16 v[168:171], v[204:207], v[56:59], v[168:171]
    v_exp_f32 v117, v101
    v_mfma_f32_16x16x32_bf16 v[172:175], v[204:207], v[60:63], v[172:175]
    ds_read_b128 v[124:127], v14 offset:9216
    v_add_f32 v20, v20, v117
    v_cvt_pk_bf16_f32 v70, v116, v117
    v_mfma_f32_16x16x32_bf16 v[176:179], v[208:211], v[56:59], v[176:179]
    v_exp_f32 v118, v102
    v_mfma_f32_16x16x32_bf16 v[180:183], v[208:211], v[60:63], v[180:183]
    ds_read_b128 v[192:195], v14 offset:10240
    v_add_f32 v20, v20, v118
    v_mfma_f32_16x16x32_bf16 v[184:187], v[212:215], v[56:59], v[184:187]
    v_exp_f32 v119, v103
    v_mfma_f32_16x16x32_bf16 v[188:191], v[212:215], v[60:63], v[188:191]
    ds_read_b128 v[196:199], v14 offset:11264
    v_add_f32 v20, v20, v119
    v_cvt_pk_bf16_f32 v71, v118, v119
    v_max_f32 v21, v19, v20
    v_cmp_nle_f32 vcc, v21, v11
    s_cbranch_vccnz RASa
RASa_R:
    s_waitcnt lgkmcnt(8)
    v_mfma_f32_16x16x32_bf16 v[88:91], v[24:27], v[216:219], v[104:107]
    v_exp_f32 v112, v72
    v_mfma_f32_16x16x32_bf16 v[92:95], v[24:27], v[232:235], v[108:111]
    ds_read_b128 v[200:203], v14 offset:12288
    v_add_f32 v17, v17, v19
    v_mfma_f32_16x16x32_bf16 v[88:91], v[28:31], v[220:223], v[88:91]
    v_exp_f32 v113, v73
    v_mfma_f32_16x16x32_bf16 v[92:95], v[28:31], v[236:239], v[92:95]
    ds_read_b128 v[204:207], v14 offset:13312
    v_add_f32 v19, v112, v113
    v_cvt_pk_bf16_f32 v56, v112, v113
    v_mfma_f32_16x16x32_bf16 v[88:91], v[32:35], v[224:227], v[88:91]
    v_exp_f32 v114, v74
    v_mfma_f32_16x16x32_bf16 v[92:95], v[32:35], v[240:243], v[92:95]
    ds_read_b128 v[208:211], v14 offset:14336
    v_add_u32 v13, 0x4000, v13
    v_and_b32 v13, 0xffff, v13
    v_add_f32 v19, v19, v114
    v_mfma_f32_16x16x32_bf16 v[88:91], v[36:39], v[228:231], v[88:91]
    v_exp_f32 v115, v75
    v_mfma_f32_16x16x32_bf16 v[92:95], v[36:39], v[244:247], v[92:95]
    ds_read_b128 v[212:215], v14 offset:15360
    v_add_f32 v19, v19, v115
    v_cvt_pk_bf16_f32 v57, v114, v115
    s_waitcnt lgkmcnt(8)
    v_mfma_f32_16x16x32_bf16 v[96:99], v[40:43], v[216:219], v[104:107]
    v_exp_f32 v116, v80
    v_mfma_f32_16x16x32_bf16 v[100:103], v[40:43], v[232:235], v[108:111]
    s_sub_u32 s72, s67, s65
    s_cmp_ge_u32 s72, 2
    s_cbranch_scc1 W12_AS
    s_waitcnt vmcnt(4)
W12_AS:
    s_cmp_eq_u32 s65, 4
    s_cbranch_scc1 W22_AS
    s_waitcnt vmcnt(12)
W22_AS:
    s_waitcnt vmcnt(22)
    s_barrier
    s_cmp_lt_u32 s72, 3
    s_cbranch_scc1 NP_AS
    s_and_b32 s8, s65, 3
    s_cmp_eq_u32 s8, 2
    s_cbranch_scc1 CQ_AS
    s_cmp_lg_u32 s8, 1
    s_cbranch_scc1 NQ_AS
    buffer_load_dword v9, v8, s[44:47], s15 offen sc1
    s_lshl_b32 s8, s65, 8
    s_or_b32 s8, s8, s5
    s_cmp_lg_u32 s8, 2304
    s_cbranch_scc1 N9_AS
    v_mov_b32 v21, 0x100
    s_and_b32 s8, s2, 7
    s_lshl_b32 s8, s8, 5
    s_mov_b64 exec, 1
    buffer_atomic_add v21, off, s[48:51], s8
    s_mov_b64 exec, -1
    s_branch NQ_AS
N9_AS:
    s_cmp_lg_u32 s8, 256
    s_cbranch_scc1 NQ_AS
    s_lshl_b32 s8, s4, 2
    s_add_u32 s8, s8, s15
    s_add_u32 s8, s8, 4096
    v_mov_b32 v21, 1
    s_mov_b64 exec, 1
    buffer_store_dword v21, off, s[44:47], s8 sc1
    s_mov_b64 exec, -1
    s_branch NQ_AS
CQ_AS:
    s_add_u32 s8, s65, 6
    s_lshr_b32 s8, s8, 2
    s_sub_u32 s8, 7, s8
    v_cmp_eq_u32 vcc, s8, v1
    s_nop 1
    v_cndmask_b32 v7, 0, 1, vcc
    s_waitcnt vmcnt(8)
    v_and_b32 v9, v9, v7
    v_cmp_ne_u32 vcc, v9, v7
    s_cbranch_vccz PQ_AS_OK
    s_mov_b32 s55, 0x40000
PQ_AS_SP:
    s_sleep 2
    buffer_load_dword v9, v8, s[44:47], s15 offen sc1
    s_waitcnt vmcnt(0)
    v_and_b32 v9, v9, v7
    v_cmp_ne_u32 vcc, v9, v7
    s_cbranch_vccz PQ_AS_OK
    s_sub_u32 s55, s55, 1
    s_cmp_lg_u32 s55, 0
    s_cbranch_scc1 PQ_AS_SP
PQ_AS_OK:
NQ_AS:
    s_mov_b32 m0, s63
    s_add_u32 s63, s63, 16384
    buffer_load_dwordx4 v2, s[44:47], s61 offen offset:0 sc1 lds
    buffer_load_dwordx4 v2, s[44:47], s61 offen offset:1024 sc1 lds
    buffer_load_dwordx4 v2, s[44:47], s61 offen offset:2048 sc1 lds
    buffer_load_dwordx4 v2, s[44:47], s61 offen offset:3072 sc1 lds
    s_add_u32 s61, s61, 16384
    s_and_b32 s63, s63, 0xffff
    s_or_b32 s63, s63, 0x10000
    s_mov_b32 m0, s62
    s_add_u32 s62, s62, 16384
    buffer_load_dwordx4 v2, s[44:47], s60 offen offset:0 sc1 lds
    buffer_load_dwordx4 v2, s[44:47], s60 offen offset:1024 sc1 lds
    buffer_load_dwordx4 v2, s[44:47], s60 offen offset:2048 sc1 lds
    buffer_load_dwordx4 v2, s[44:47], s60 offen offset:3072 sc1 lds
    s_add_u32 s60, s60, 16384
    s_and_b32 s62, s62, 0xffff
    s_sub_u32 s8, s65, 2
    s_cmp_ge_u32 s8, 2
    s_cbranch_scc1 NP_AS
    v_mov_b32 v24, 0x7fc17fc1
    v_mov_b32 v25, 0x7fc17fc1
    v_mov_b32 v26, 0x7fc17fc1
    v_mov_b32 v27, 0x7fc17fc1
    s_mul_i32 s8, s8, 20480
    s_add_u32 s8, s8, s13
    s_add_u32 s9, s8, 4096
    buffer_store_dwordx4 v[24:27], v2, s[44:47], s8 offen offset:0 sc1
    buffer_store_dwordx4 v[24:27], v2, s[44:47], s8 offen offset:1024 sc1
    buffer_store_dwordx4 v[24:27], v2, s[44:47], s8 offen offset:2048 sc1
    buffer_store_dwordx4 v[24:27], v2, s[44:47], s8 offen offset:3072 sc1
    buffer_store_dwordx4 v[24:27], v2, s[44:47], s9 offen offset:0 sc1
NP_AS:
    s_nop 1
    ds_read_b128 v[24:27], v13 offset:0
    v_add_f32 v19, v19, v116
    v_mfma_f32_16x16x32_bf16 v[96:99], v[44:47], v[220:223], v[96:99]
    v_exp_f32 v117, v81
    v_mfma_f32_16x16x32_bf16 v[100:103], v[44:47], v[236:239], v[100:103]
    ds_read_b128 v[28:31], v13 offset:1024
    v_add_f32 v19, v19, v117
    v_cvt_pk_bf16_f32 v58, v116, v117
    v_mfma_f32_16x16x32_bf16 v[96:99], v[48:51], v[224:227], v[96:99]
    v_exp_f32 v118, v82
    v_mfma_f32_16x16x32_bf16 v[100:103], v[48:51], v[240:243], v[100:103]
    ds_read_b128 v[32:35], v13 offset:2048
    v_add_u32 v14, 0x4000, v14
    v_and_or_b32 v14, v14, s64, v10
    v_add_f32 v19, v19, v118
    v_mfma_f32_16x16x32_bf16 v[96:99], v[52:55], v[228:231], v[96:99]
    v_exp_f32 v119, v83
    v_mfma_f32_16x16x32_bf16 v[100:103], v[52:55], v[244:247], v[100:103]
    ds_read_b128 v[36:39], v13 offset:3072
    v_add_f32 v19, v19, v119
    v_cvt_pk_bf16_f32 v59, v118, v119
    s_waitcnt lgkmcnt(8)
    v_mfma_f32_16x16x32_bf16 v[128:131], v[120:123], v[64:67], v[128:131]
    v_exp_f32 v112, v76
    v_mfma_f32_16x16x32_bf16 v[132:135], v[120:123], v[68:71], v[132:135]
    ds_read_b128 v[40:43], v13 offset:4096
    v_add_f32 v18, v18, v20
    v_mfma_f32_16x16x32_bf16 v[136:139], v[124:127], v[64:67], v[136:139]
    v_exp_f32 v113, v77
    v_mfma_f32_16x16x32_bf16 v[140:143], v[124:127], v[68:71], v[140:143]
    ds_read_b128 v[44:47], v13 offset:5120
    v_add_f32 v20, v112, v113
    v_cvt_pk_bf16_f32 v60, v112, v113
    v_mfma_f32_16x16x32_bf16 v[144:147], v[192:195], v[64:67], v[144:147]
    v_exp_f32 v114, v78
    v_mfma_f32_16x16x32_bf16 v[148:151], v[192:195], v[68:71], v[148:151]
    ds_read_b128 v[48:51], v13 offset:6144
    v_add_f32 v20, v20, v114
    v_mfma_f32_16x16x32_bf16 v[152:155], v[196:199], v[64:67], v[152:155]
    v_exp_f32 v115, v79
    v_mfma_f32_16x16x32_bf16 v[156:159], v[196:199], v[68:71], v[156:159]
    ds_read_b128 v[52:55], v13 offset:7168
    v_add_f32 v20, v20, v115
    v_cvt_pk_bf16_f32 v61, v114, v115
    s_waitcnt lgkmcnt(8)
    v_mfma_f32_16x16x32_bf16 v[160:163], v[200:203], v[64:67], v[160:163]
    v_exp_f32 v116, v84
    v_mfma_f32_16x16x32_bf16 v[164:167], v[200:203], v[68:71], v[164:167]
    ds_read_b128 v[120:123], v14 offset:0
    v_add_f32 v20, v20, v116
    v_mfma_f32_16x16x32_bf16 v[168:171], v[204:207], v[64:67], v[168:171]
    v_exp_f32 v117, v85
    v_mfma_f32_16x16x32_bf16 v[172:175], v[204:207], v[68:71], v[172:175]
    ds_read_b128 v[124:127], v14 offset:1024
    v_add_f32 v20, v20, v117
    v_cvt_pk_bf16_f32 v62, v116, v117
    s_add_u32 s65, s65, 1
    s_add_u32 s6, s65, 1
    v_mfma_f32_16x16x32_bf16 v[176:179], v[208:211], v[64:67], v[176:179]
    v_exp_f32 v118, v86
    v_mfma_f32_16x16x32_bf16 v[180:183], v[208:211], v[68:71], v[180:183]
    ds_read_b128 v[192:195], v14 offset:2048
    v_add_f32 v20, v20, v118
    v_mfma_f32_16x16x32_bf16 v[184:187], v[212:215], v[64:67], v[184:187]
    v_exp_f32 v119, v87
    v_mfma_f32_16x16x32_bf16 v[188:191], v[212:215], v[68:71], v[188:191]
    ds_read_b128 v[196:199], v14 offset:3072
    v_add_f32 v20, v20, v119
    v_cvt_pk_bf16_f32 v63, v118, v119
    v_max_f32 v21, v19, v20
    v_cmp_nle_f32 vcc, v21, v11
    s_cbranch_vccnz RASb
RASb_R:
    s_cmp_lt_u32 s6, s66
    s_cbranch_scc1 A_LOOP
    s_branch A_S1
A_PV:
    s_bitcmp0_b32 s7, 5
    s_cbranch_scc1 A_PE
    ds_read_b128 v[24:27], v14 offset:0
    ds_read_b128 v[28:31], v14 offset:1024
    ds_read_b128 v[32:35], v14 offset:2048
    ds_read_b128 v[36:39], v14 offset:3072
    ds_read_b128 v[40:43], v14 offset:4096
    ds_read_b128 v[44:47], v14 offset:5120
    ds_read_b128 v[48:51], v14 offset:6144
    ds_read_b128 v[52:55], v14 offset:7168
    ds_read_b128 v[120:123], v14 offset:8192
    ds_read_b128 v[124:127], v14 offset:9216
    ds_read_b128 v[192:195], v14 offset:10240
    ds_read_b128 v[196:199], v14 offset:11264
    s_branch A_S2
A_PE:
    ds_read_b128 v[120:123], v14 offset:0
    ds_read_b128 v[124:127], v14 offset:1024
    ds_read_b128 v[192:195], v14 offset:2048
    ds_read_b128 v[196:199], v14 offset:3072
    ds_read_b128 v[200:203], v14 offset:4096
    ds_read_b128 v[204:207], v14 offset:5120
    ds_read_b128 v[208:211], v14 offset:6144
    ds_read_b128 v[212:215], v14 offset:7168
    s_branch A_E2
A_E1:
    s_waitcnt lgkmcnt(8)
    v_mfma_f32_16x16x32_bf16 v[72:75], v[24:27], v[216:219], v[104:107]
    v_exp_f32 v112, v88
    v_mfma_f32_16x16x32_bf16 v[76:79], v[24:27], v[232:235], v[108:111]
    ds_read_b128 v[200:203], v14 offset:4096
    v_add_f32 v17, v17, v19
    v_mfma_f32_16x16x32_bf16 v[72:75], v[28:31], v[220:223], v[72:75]
    v_exp_f32 v113, v89
    v_mfma_f32_16x16x32_bf16 v[76:79], v[28:31], v[236:239], v[76:79]
    ds_read_b128 v[204:207], v14 offset:5120
    v_add_f32 v19, v112, v113
    v_cvt_pk_bf16_f32 v64, v112, v113
    v_mfma_f32_16x16x32_bf16 v[72:75], v[32:35], v[224:227], v[72:75]
    v_exp_f32 v114, v90
    v_mfma_f32_16x16x32_bf16 v[76:79], v[32:35], v[240:243], v[76:79]
    ds_read_b128 v[208:211], v14 offset:6144
    v_add_f32 v19, v19, v114
    v_mfma_f32_16x16x32_bf16 v[72:75], v[36:39], v[228:231], v[72:75]
    v_exp_f32 v115, v91
    v_mfma_f32_16x16x32_bf16 v[76:79], v[36:39], v[244:247], v[76:79]
    ds_read_b128 v[212:215], v14 offset:7168
    v_add_f32 v19, v19, v115
    v_cvt_pk_bf16_f32 v65, v114, v115
    s_waitcnt lgkmcnt(8)
    v_mfma_f32_16x16x32_bf16 v[80:83], v[40:43], v[216:219], v[104:107]
    v_exp_f32 v116, v96
    v_mfma_f32_16x16x32_bf16 v[84:87], v[40:43], v[232:235], v[108:111]
    ds_read_b128 v[24:27], v14 offset:8192
    v_add_f32 v19, v19, v116
    v_mfma_f32_16x16x32_bf16 v[80:83], v[44:47], v[220:223], v[80:83]
    v_exp_f32 v117, v97
    v_mfma_f32_16x16x32_bf16 v[84:87], v[44:47], v[236:239], v[84:87]
    ds_read_b128 v[28:31], v14 offset:9216
    v_add_f32 v19, v19, v117
    v_cvt_pk_bf16_f32 v66, v116, v117
    v_mfma_f32_16x16x32_bf16 v[80:83], v[48:51], v[224:227], v[80:83]
    v_exp_f32 v118, v98
    v_mfma_f32_16x16x32_bf16 v[84:87], v[48:51], v[240:243], v[84:87]
    ds_read_b128 v[32:35], v14 offset:10240
    v_add_f32 v19, v19, v118
    v_mfma_f32_16x16x32_bf16 v[80:83], v[52:55], v[228:231], v[80:83]
    v_exp_f32 v119, v99
    v_mfma_f32_16x16x32_bf16 v[84:87], v[52:55], v[244:247], v[84:87]
    ds_read_b128 v[36:39], v14 offset:11264
    v_add_f32 v19, v19, v119
    v_cvt_pk_bf16_f32 v67, v118, v119
    s_waitcnt lgkmcnt(8)
    v_mfma_f32_16x16x32_bf16 v[128:131], v[120:123], v[56:59], v[128:131]
    v_exp_f32 v112, v92
    v_mfma_f32_16x16x32_bf16 v[132:135], v[120:123], v[60:63], v[132:135]
    ds_read_b128 v[40:43], v14 offset:12288
    v_add_f32 v18, v18, v20
    v_mfma_f32_16x16x32_bf16 v[136:139], v[124:127], v[56:59], v[136:139]
    v_exp_f32 v113, v93
    v_mfma_f32_16x16x32_bf16 v[140:143], v[124:127], v[60:63], v[140:143]
    ds_read_b128 v[44:47], v14 offset:13312
    v_add_f32 v20, v112, v113
    v_cvt_pk_bf16_f32 v68, v112, v113
    v_mfma_f32_16x16x32_bf16 v[144:147], v[192:195], v[56:59], v[144:147]
    v_exp_f32 v114, v94
    v_mfma_f32_16x16x32_bf16 v[148:151], v[192:195], v[60:63], v[148:151]
    ds_read_b128 v[48:51], v14 offset:14336
    v_add_f32 v20, v20, v114
    v_mfma_f32_16x16x32_bf16 v[152:155], v[196:199], v[56:59], v[152:155]
    v_exp_f32 v115, v95
    v_mfma_f32_16x16x32_bf16 v[156:159], v[196:199], v[60:63], v[156:159]
    ds_read_b128 v[52:55], v14 offset:15360
    v_add_f32 v20, v20, v115
    v_cvt_pk_bf16_f32 v69, v114, v115
    v_add_u32 v14, 0x4000, v14
    v_and_or_b32 v14, v14, s64, v10
    s_waitcnt lgkmcnt(8)
    v_mfma_f32_16x16x32_bf16 v[160:163], v[200:203], v[56:59], v[160:163]
    v_exp_f32 v116, v100
    v_mfma_f32_16x16x32_bf16 v[164:167], v[200:203], v[60:63], v[164:167]
    s_sub_u32 s72, s67, s65
    s_cmp_ge_u32 s72, 2
    s_cbranch_scc1 W12_AE1
    s_waitcnt vmcnt(4)
W12_AE1:
    s_cmp_eq_u32 s65, 4
    s_cbranch_scc1 W22_AE1
    s_waitcnt vmcnt(12)
W22_AE1:
    s_waitcnt vmcnt(22)
    s_barrier
    s_cmp_lt_u32 s72, 3
    s_cbranch_scc1 NP_AE1
    s_and_b32 s8, s65, 3
    s_cmp_eq_u32 s8, 2
    s_cbranch_scc1 CQ_AE1
    s_cmp_lg_u32 s8, 1
    s_cbranch_scc1 NQ_AE1
    buffer_load_dword v9, v8, s[44:47], s15 offen sc1
    s_lshl_b32 s8, s65, 8
    s_or_b32 s8, s8, s5
    s_cmp_lg_u32 s8, 2304
    s_cbranch_scc1 N9_AE1
    v_mov_b32 v21, 0x100
    s_and_b32 s8, s2, 7
    s_lshl_b32 s8, s8, 5
    s_mov_b64 exec, 1
    buffer_atomic_add v21, off, s[48:51], s8
    s_mov_b64 exec, -1
    s_branch NQ_AE1
N9_AE1:
    s_cmp_lg_u32 s8, 256
    s_cbranch_scc1 NQ_AE1
    s_lshl_b32 s8, s4, 2
    s_add_u32 s8, s8, s15
    s_add_u32 s8, s8, 4096
    v_mov_b32 v21, 1
    s_mov_b64 exec, 1
    buffer_store_dword v21, off, s[44:47], s8 sc1
    s_mov_b64 exec, -1
    s_branch NQ_AE1
CQ_AE1:
    s_add_u32 s8, s65, 6
    s_lshr_b32 s8, s8, 2
    s_sub_u32 s8, 7, s8
    v_cmp_eq_u32 vcc, s8, v1
    s_nop 1
    v_cndmask_b32 v7, 0, 1, vcc
    s_waitcnt vmcnt(8)
    v_and_b32 v9, v9, v7
    v_cmp_ne_u32 vcc, v9, v7
    s_cbranch_vccz PQ_AE1_OK
    s_mov_b32 s55, 0x40000
PQ_AE1_SP:
    s_sleep 2
    buffer_load_dword v9, v8, s[44:47], s15 offen sc1
    s_waitcnt vmcnt(0)
    v_and_b32 v9, v9, v7
    v_cmp_ne_u32 vcc, v9, v7
    s_cbranch_vccz PQ_AE1_OK
    s_sub_u32 s55, s55, 1
    s_cmp_lg_u32 s55, 0
    s_cbranch_scc1 PQ_AE1_SP
PQ_AE1_OK:
NQ_AE1:
    s_mov_b32 m0, s63
    s_add_u32 s63, s63, 16384
    buffer_load_dwordx4 v2, s[44:47], s61 offen offset:0 sc1 lds
    buffer_load_dwordx4 v2, s[44:47], s61 offen offset:1024 sc1 lds
    buffer_load_dwordx4 v2, s[44:47], s61 offen offset:2048 sc1 lds
    buffer_load_dwordx4 v2, s[44:47], s61 offen offset:3072 sc1 lds
    s_add_u32 s61, s61, 16384
    s_and_b32 s63, s63, 0xffff
    s_or_b32 s63, s63, 0x10000
    s_mov_b32 m0, s62
    s_add_u32 s62, s62, 16384
    buffer_load_dwordx4 v2, s[44:47], s60 offen offset:0 sc1 lds
    buffer_load_dwordx4 v2, s[44:47], s60 offen offset:1024 sc1 lds
    buffer_load_dwordx4 v2, s[44:47], s60 offen offset:2048 sc1 lds
    buffer_load_dwordx4 v2, s[44:47], s60 offen offset:3072 sc1 lds
    s_add_u32 s60, s60, 16384
    s_and_b32 s62, s62, 0xffff
    s_sub_u32 s8, s65, 2
    s_cmp_ge_u32 s8, 2
    s_cbranch_scc1 NP_AE1
    v_mov_b32 v120, 0x7fc17fc1
    v_mov_b32 v121, 0x7fc17fc1
    v_mov_b32 v122, 0x7fc17fc1
    v_mov_b32 v123, 0x7fc17fc1
    s_mul_i32 s8, s8, 20480
    s_add_u32 s8, s8, s13
    s_add_u32 s9, s8, 4096
    buffer_store_dwordx4 v[120:123], v2, s[44:47], s8 offen offset:0 sc1
    buffer_store_dwordx4 v[120:123], v2, s[44:47], s8 offen offset:1024 sc1
    buffer_store_dwordx4 v[120:123], v2, s[44:47], s8 offen offset:2048 sc1
    buffer_store_dwordx4 v[120:123], v2, s[44:47], s8 offen offset:3072 sc1
    buffer_store_dwordx4 v[120:123], v2, s[44:47], s9 offen offset:0 sc1
NP_AE1:
    s_nop 1
    ds_read_b128 v[120:123], v14 offset:0
    v_add_f32 v20, v20, v116
    v_mfma_f32_16x16x32_bf16 v[168:171], v[204:207], v[56:59], v[168:171]
    v_exp_f32 v117, v101
    v_mfma_f32_16x16x32_bf16 v[172:175], v[204:207], v[60:63], v[172:175]
    ds_read_b128 v[124:127], v14 offset:1024
    v_add_f32 v20, v20, v117
    v_cvt_pk_bf16_f32 v70, v116, v117
    v_mfma_f32_16x16x32_bf16 v[176:179], v[208:211], v[56:59], v[176:179]
    v_exp_f32 v118, v102
    v_mfma_f32_16x16x32_bf16 v[180:183], v[208:211], v[60:63], v[180:183]
    ds_read_b128 v[192:195], v14 offset:2048
    v_add_f32 v20, v20, v118
    v_mfma_f32_16x16x32_bf16 v[184:187], v[212:215], v[56:59], v[184:187]
    v_exp_f32 v119, v103
    v_mfma_f32_16x16x32_bf16 v[188:191], v[212:215], v[60:63], v[188:191]
    ds_read_b128 v[196:199], v14 offset:3072
    v_add_f32 v20, v20, v119
    v_cvt_pk_bf16_f32 v71, v118, v119
    v_max_f32 v21, v19, v20
    v_cmp_nle_f32 vcc, v21, v11
    s_cbranch_vccnz RAE1a
RAE1a_R:
    s_waitcnt lgkmcnt(8)
    v_mfma_f32_16x16x32_bf16 v[128:131], v[24:27], v[64:67], v[128:131]
    v_cmp_gt_i32 s[74:75], 0, v15
    v_cmp_gt_i32 s[76:77], 1, v15
    v_cmp_gt_i32 s[78:79], 2, v15
    v_cmp_gt_i32 s[90:91], 3, v15
    v_cndmask_b32 v72, v72, v22, s[74:75]
    v_cndmask_b32 v73, v73, v22, s[76:77]
    v_cndmask_b32 v74, v74, v22, s[78:79]
    v_cndmask_b32 v75, v75, v22, s[90:91]
    v_exp_f32 v112, v72
    v_exp_f32 v113, v73
    v_mfma_f32_16x16x32_bf16 v[132:135], v[24:27], v[68:71], v[132:135]
    ds_read_b128 v[200:203], v14 offset:4096
    v_add_f32 v17, v17, v19
    v_add_f32 v18, v18, v20
    v_add_f32 v19, v112, v113
    v_cvt_pk_bf16_f32 v56, v112, v113
    v_mfma_f32_16x16x32_bf16 v[136:139], v[28:31], v[64:67], v[136:139]
    v_exp_f32 v114, v74
    v_exp_f32 v115, v75
    v_mfma_f32_16x16x32_bf16 v[140:143], v[28:31], v[68:71], v[140:143]
    ds_read_b128 v[204:207], v14 offset:5120
    v_add_f32 v19, v19, v114
    v_add_f32 v19, v19, v115
    v_cvt_pk_bf16_f32 v57, v114, v115
    v_mfma_f32_16x16x32_bf16 v[144:147], v[32:35], v[64:67], v[144:147]
    v_cmp_gt_i32 s[74:75], 16, v15
    v_cmp_gt_i32 s[76:77], 17, v15
    v_cmp_gt_i32 s[78:79], 18, v15
    v_cmp_gt_i32 s[90:91], 19, v15
    v_cndmask_b32 v80, v80, v22, s[74:75]
    v_cndmask_b32 v81, v81, v22, s[76:77]
    v_cndmask_b32 v82, v82, v22, s[78:79]
    v_cndmask_b32 v83, v83, v22, s[90:91]
    v_exp_f32 v116, v80
    v_exp_f32 v117, v81
    v_mfma_f32_16x16x32_bf16 v[148:151], v[32:35], v[68:71], v[148:151]
    ds_read_b128 v[208:211], v14 offset:6144
    v_add_f32 v19, v19, v116
    v_add_f32 v19, v19, v117
    v_cvt_pk_bf16_f32 v58, v116, v117
    v_mfma_f32_16x16x32_bf16 v[152:155], v[36:39], v[64:67], v[152:155]
    v_exp_f32 v118, v82
    v_exp_f32 v119, v83
    v_mfma_f32_16x16x32_bf16 v[156:159], v[36:39], v[68:71], v[156:159]
    ds_read_b128 v[212:215], v14 offset:7168
    v_add_f32 v19, v19, v118
    v_add_f32 v19, v19, v119
    v_cvt_pk_bf16_f32 v59, v118, v119
    s_waitcnt lgkmcnt(8)
    v_mfma_f32_16x16x32_bf16 v[160:163], v[40:43], v[64:67], v[160:163]
    v_cmp_gt_i32 s[74:75], 0, v16
    v_cmp_gt_i32 s[76:77], 1, v16
    v_cmp_gt_i32 s[78:79], 2, v16
    v_cmp_gt_i32 s[90:91], 3, v16
    v_cndmask_b32 v76, v76, v22, s[74:75]
    v_cndmask_b32 v77, v77, v22, s[76:77]
    v_cndmask_b32 v78, v78, v22, s[78:79]
    v_cndmask_b32 v79, v79, v22, s[90:91]
    v_exp_f32 v112, v76
    v_exp_f32 v113, v77
    v_mfma_f32_16x16x32_bf16 v[164:167], v[40:43], v[68:71], v[164:167]
    v_add_f32 v20, v112, v113
    v_cvt_pk_bf16_f32 v60, v112, v113
    v_mfma_f32_16x16x32_bf16 v[168:171], v[44:47], v[64:67], v[168:171]
    v_exp_f32 v114, v78
    v_exp_f32 v115, v79
    v_mfma_f32_16x16x32_bf16 v[172:175], v[44:47], v[68:71], v[172:175]
    v_add_f32 v20, v20, v114
    v_add_f32 v20, v20, v115
    v_cvt_pk_bf16_f32 v61, v114, v115
    v_mfma_f32_16x16x32_bf16 v[176:179], v[48:51], v[64:67], v[176:179]
    v_cmp_gt_i32 s[74:75], 16, v16
    v_cmp_gt_i32 s[76:77], 17, v16
    v_cmp_gt_i32 s[78:79], 18, v16
    v_cmp_gt_i32 s[90:91], 19, v16
    v_cndmask_b32 v84, v84, v22, s[74:75]
    v_cndmask_b32 v85, v85, v22, s[76:77]
    v_cndmask_b32 v86, v86, v22, s[78:79]
    v_cndmask_b32 v87, v87, v22, s[90:91]
    v_exp_f32 v116, v84
    v_exp_f32 v117, v85
    v_mfma_f32_16x16x32_bf16 v[180:183], v[48:51], v[68:71], v[180:183]
    v_add_f32 v20, v20, v116
    v_add_f32 v20, v20, v117
    v_cvt_pk_bf16_f32 v62, v116, v117
    v_mfma_f32_16x16x32_bf16 v[184:187], v[52:55], v[64:67], v[184:187]
    v_exp_f32 v118, v86
    v_exp_f32 v119, v87
    v_mfma_f32_16x16x32_bf16 v[188:191], v[52:55], v[68:71], v[188:191]
    v_add_f32 v20, v20, v118
    v_add_f32 v20, v20, v119
    v_cvt_pk_bf16_f32 v63, v118, v119
    v_max_f32 v21, v19, v20
    v_cmp_nle_f32 vcc, v21, v11
    s_cbranch_vccnz RAE1b
RAE1b_R:
    s_add_u32 s65, s65, 1
A_E2:
    s_waitcnt lgkmcnt(4)
    v_mfma_f32_16x16x32_bf16 v[128:131], v[120:123], v[56:59], v[128:131]
    v_mfma_f32_16x16x32_bf16 v[132:135], v[120:123], v[60:63], v[132:135]
    v_add_f32 v17, v17, v19
    v_add_f32 v18, v18, v20
    v_mfma_f32_16x16x32_bf16 v[136:139], v[124:127], v[56:59], v[136:139]
    v_mfma_f32_16x16x32_bf16 v[140:143], v[124:127], v[60:63], v[140:143]
    v_mfma_f32_16x16x32_bf16 v[144:147], v[192:195], v[56:59], v[144:147]
    v_mfma_f32_16x16x32_bf16 v[148:151], v[192:195], v[60:63], v[148:151]
    v_mfma_f32_16x16x32_bf16 v[152:155], v[196:199], v[56:59], v[152:155]
    v_mfma_f32_16x16x32_bf16 v[156:159], v[196:199], v[60:63], v[156:159]
    s_waitcnt lgkmcnt(0)
    v_mfma_f32_16x16x32_bf16 v[160:163], v[200:203], v[56:59], v[160:163]
    v_mfma_f32_16x16x32_bf16 v[164:167], v[200:203], v[60:63], v[164:167]
    s_sub_u32 s72, s67, s65
    s_cmp_ge_u32 s72, 2
    s_cbranch_scc1 W12_AE2
    s_waitcnt vmcnt(4)
W12_AE2:
    s_cmp_eq_u32 s65, 4
    s_cbranch_scc1 W22_AE2
    s_waitcnt vmcnt(12)
W22_AE2:
    s_waitcnt vmcnt(22)
    s_barrier
    s_cmp_lt_u32 s72, 3
    s_cbranch_scc1 NP_AE2
    s_and_b32 s8, s65, 3
    s_cmp_eq_u32 s8, 2
    s_cbranch_scc1 CQ_AE2
    s_cmp_lg_u32 s8, 1
    s_cbranch_scc1 NQ_AE2
    buffer_load_dword v9, v8, s[44:47], s15 offen sc1
    s_lshl_b32 s8, s65, 8
    s_or_b32 s8, s8, s5
    s_cmp_lg_u32 s8, 2304
    s_cbranch_scc1 N9_AE2
    v_mov_b32 v21, 0x100
    s_and_b32 s8, s2, 7
    s_lshl_b32 s8, s8, 5
    s_mov_b64 exec, 1
    buffer_atomic_add v21, off, s[48:51], s8
    s_mov_b64 exec, -1
    s_branch NQ_AE2
N9_AE2:
    s_cmp_lg_u32 s8, 256
    s_cbranch_scc1 NQ_AE2
    s_lshl_b32 s8, s4, 2
    s_add_u32 s8, s8, s15
    s_add_u32 s8, s8, 4096
    v_mov_b32 v21, 1
    s_mov_b64 exec, 1
    buffer_store_dword v21, off, s[44:47], s8 sc1
    s_mov_b64 exec, -1
    s_branch NQ_AE2
CQ_AE2:
    s_add_u32 s8, s65, 6
    s_lshr_b32 s8, s8, 2
    s_sub_u32 s8, 7, s8
    v_cmp_eq_u32 vcc, s8, v1
    s_nop 1
    v_cndmask_b32 v7, 0, 1, vcc
    s_waitcnt vmcnt(8)
    v_and_b32 v9, v9, v7
    v_cmp_ne_u32 vcc, v9, v7
    s_cbranch_vccz PQ_AE2_OK
    s_mov_b32 s55, 0x40000
PQ_AE2_SP:
    s_sleep 2
    buffer_load_dword v9, v8, s[44:47], s15 offen sc1
    s_waitcnt vmcnt(0)
    v_and_b32 v9, v9, v7
    v_cmp_ne_u32 vcc, v9, v7
    s_cbranch_vccz PQ_AE2_OK
    s_sub_u32 s55, s55, 1
    s_cmp_lg_u32 s55, 0
    s_cbranch_scc1 PQ_AE2_SP
PQ_AE2_OK:
NQ_AE2:
    s_mov_b32 m0, s63
    s_add_u32 s63, s63, 16384
    buffer_load_dwordx4 v2, s[44:47], s61 offen offset:0 sc1 lds
    buffer_load_dwordx4 v2, s[44:47], s61 offen offset:1024 sc1 lds
    buffer_load_dwordx4 v2, s[44:47], s61 offen offset:2048 sc1 lds
    buffer_load_dwordx4 v2, s[44:47], s61 offen offset:3072 sc1 lds
    s_add_u32 s61, s61, 16384
    s_and_b32 s63, s63, 0xffff
    s_or_b32 s63, s63, 0x10000
    s_mov_b32 m0, s62
    s_add_u32 s62, s62, 16384
    buffer_load_dwordx4 v2, s[44:47], s60 offen offset:0 sc1 lds
    buffer_load_dwordx4 v2, s[44:47], s60 offen offset:1024 sc1 lds
    buffer_load_dwordx4 v2, s[44:47], s60 offen offset:2048 sc1 lds
    buffer_load_dwordx4 v2, s[44:47], s60 offen offset:3072 sc1 lds
    s_add_u32 s60, s60, 16384
    s_and_b32 s62, s62, 0xffff
    s_sub_u32 s8, s65, 2
    s_cmp_ge_u32 s8, 2
    s_cbranch_scc1 NP_AE2
    v_mov_b32 v120, 0x7fc17fc1
    v_mov_b32 v121, 0x7fc17fc1
    v_mov_b32 v122, 0x7fc17fc1
    v_mov_b32 v123, 0x7fc17fc1
    s_mul_i32 s8, s8, 20480
    s_add_u32 s8, s8, s13
    s_add_u32 s9, s8, 4096
    buffer_store_dwordx4 v[120:123], v2, s[44:47], s8 offen offset:0 sc1
    buffer_store_dwordx4 v[120:123], v2, s[44:47], s8 offen offset:1024 sc1
    buffer_store_dwordx4 v[120:123], v2, s[44:47], s8 offen offset:2048 sc1
    buffer_store_dwordx4 v[120:123], v2, s[44:47], s8 offen offset:3072 sc1
    buffer_store_dwordx4 v[120:123], v2, s[44:47], s9 offen offset:0 sc1
NP_AE2:
    v_mfma_f32_16x16x32_bf16 v[168:171], v[204:207], v[56:59], v[168:171]
    v_mfma_f32_16x16x32_bf16 v[172:175], v[204:207], v[60:63], v[172:175]
    v_mfma_f32_16x16x32_bf16 v[176:179], v[208:211], v[56:59], v[176:179]
    v_mfma_f32_16x16x32_bf16 v[180:183], v[208:211], v[60:63], v[180:183]
    v_mfma_f32_16x16x32_bf16 v[184:187], v[212:215], v[56:59], v[184:187]
    v_mfma_f32_16x16x32_bf16 v[188:191], v[212:215], v[60:63], v[188:191]
    s_branch A_EP
A_S1:
    s_bitcmp0_b32 s7, 5
    s_cbranch_scc1 A_E1
    s_waitcnt lgkmcnt(8)
    v_mfma_f32_16x16x32_bf16 v[72:75], v[24:27], v[216:219], v[104:107]
    v_exp_f32 v112, v88
    v_mfma_f32_16x16x32_bf16 v[76:79], v[24:27], v[232:235], v[108:111]
    ds_read_b128 v[200:203], v14 offset:4096
    v_add_f32 v17, v17, v19
    v_mfma_f32_16x16x32_bf16 v[72:75], v[28:31], v[220:223], v[72:75]
    v_exp_f32 v113, v89
    v_mfma_f32_16x16x32_bf16 v[76:79], v[28:31], v[236:239], v[76:79]
    ds_read_b128 v[204:207], v14 offset:5120
    v_add_f32 v19, v112, v113
    v_cvt_pk_bf16_f32 v64, v112, v113
    v_mfma_f32_16x16x32_bf16 v[72:75], v[32:35], v[224:227], v[72:75]
    v_exp_f32 v114, v90
    v_mfma_f32_16x16x32_bf16 v[76:79], v[32:35], v[240:243], v[76:79]
    ds_read_b128 v[208:211], v14 offset:6144
    v_add_f32 v19, v19, v114
    v_mfma_f32_16x16x32_bf16 v[72:75], v[36:39], v[228:231], v[72:75]
    v_exp_f32 v115, v91
    v_mfma_f32_16x16x32_bf16 v[76:79], v[36:39], v[244:247], v[76:79]
    ds_read_b128 v[212:215], v14 offset:7168
    v_add_f32 v19, v19, v115
    v_cvt_pk_bf16_f32 v65, v114, v115
    s_waitcnt lgkmcnt(8)
    v_mfma_f32_16x16x32_bf16 v[80:83], v[40:43], v[216:219], v[104:107]
    v_exp_f32 v116, v96
    v_mfma_f32_16x16x32_bf16 v[84:87], v[40:43], v[232:235], v[108:111]
    ds_read_b128 v[24:27], v13 offset:8192
    v_add_f32 v19, v19, v116
    v_mfma_f32_16x16x32_bf16 v[80:83], v[44:47], v[220:223], v[80:83]
    v_exp_f32 v117, v97
    v_mfma_f32_16x16x32_bf16 v[84:87], v[44:47], v[236:239], v[84:87]
    ds_read_b128 v[28:31], v13 offset:9216
    v_add_f32 v19, v19, v117
    v_cvt_pk_bf16_f32 v66, v116, v117
    v_mfma_f32_16x16x32_bf16 v[80:83], v[48:51], v[224:227], v[80:83]
    v_exp_f32 v118, v98
    v_mfma_f32_16x16x32_bf16 v[84:87], v[48:51], v[240:243], v[84:87]
    ds_read_b128 v[32:35], v13 offset:10240
    v_add_f32 v19, v19, v118
    v_mfma_f32_16x16x32_bf16 v[80:83], v[52:55], v[228:231], v[80:83]
    v_exp_f32 v119, v99
    v_mfma_f32_16x16x32_bf16 v[84:87], v[52:55], v[244:247], v[84:87]
    ds_read_b128 v[36:39], v13 offset:11264
    v_add_f32 v19, v19, v119
    v_cvt_pk_bf16_f32 v67, v118, v119
    s_waitcnt lgkmcnt(8)
    v_mfma_f32_16x16x32_bf16 v[128:131], v[120:123], v[56:59], v[128:131]
    v_exp_f32 v112, v92
    v_mfma_f32_16x16x32_bf16 v[132:135], v[120:123], v[60:63], v[132:135]
    ds_read_b128 v[40:43], v13 offset:12288
    v_add_f32 v18, v18, v20
    v_mfma_f32_16x16x32_bf16 v[136:139], v[124:127], v[56:59], v[136:139]
    v_exp_f32 v113, v93
    v_mfma_f32_16x16x32_bf16 v[140:143], v[124:127], v[60:63], v[140:143]
    ds_read_b128 v[44:47], v13 offset:13312
    v_add_f32 v20, v112, v113
    v_cvt_pk_bf16_f32 v68, v112, v113
    v_mfma_f32_16x16x32_bf16 v[144:147], v[192:195], v[56:59], v[144:147]
    v_exp_f32 v114, v94
    v_mfma_f32_16x16x32_bf16 v[148:151], v[192:195], v[60:63], v[148:151]
    ds_read_b128 v[48:51], v13 offset:14336
    v_add_f32 v20, v20, v114
    v_mfma_f32_16x16x32_bf16 v[152:155], v[196:199], v[56:59], v[152:155]
    v_exp_f32 v115, v95
    v_mfma_f32_16x16x32_bf16 v[156:159], v[196:199], v[60:63], v[156:159]
    ds_read_b128 v[52:55], v13 offset:15360
    v_add_f32 v20, v20, v115
    v_cvt_pk_bf16_f32 v69, v114, v115
    s_waitcnt lgkmcnt(8)
    v_mfma_f32_16x16x32_bf16 v[160:163], v[200:203], v[56:59], v[160:163]
    v_exp_f32 v116, v100
    v_mfma_f32_16x16x32_bf16 v[164:167], v[200:203], v[60:63], v[164:167]
    ds_read_b128 v[120:123], v14 offset:8192
    v_add_f32 v20, v20, v116
    v_mfma_f32_16x16x32_bf16 v[168:171], v[204:207], v[56:59], v[168:171]
    v_exp_f32 v117, v101
    v_mfma_f32_16x16x32_bf16 v[172:175], v[204:207], v[60:63], v[172:175]
    ds_read_b128 v[124:127], v14 offset:9216
    v_add_f32 v20, v20, v117
    v_cvt_pk_bf16_f32 v70, v116, v117
    v_mfma_f32_16x16x32_bf16 v[176:179], v[208:211], v[56:59], v[176:179]
    v_exp_f32 v118, v102
    v_mfma_f32_16x16x32_bf16 v[180:183], v[208:211], v[60:63], v[180:183]
    ds_read_b128 v[192:195], v14 offset:10240
    v_add_f32 v20, v20, v118
    v_mfma_f32_16x16x32_bf16 v[184:187], v[212:215], v[56:59], v[184:187]
    v_exp_f32 v119, v103
    v_mfma_f32_16x16x32_bf16 v[188:191], v[212:215], v[60:63], v[188:191]
    ds_read_b128 v[196:199], v14 offset:11264
    v_add_f32 v20, v20, v119
    v_cvt_pk_bf16_f32 v71, v118, v119
    v_max_f32 v21, v19, v20
    v_cmp_nle_f32 vcc, v21, v11
    s_cbranch_vccnz RAS1a
RAS1a_R:
    s_waitcnt lgkmcnt(8)
    v_mfma_f32_16x16x32_bf16 v[88:91], v[24:27], v[216:219], v[104:107]
    v_cmp_gt_i32 s[74:75], 0, v15
    v_cmp_gt_i32 s[76:77], 1, v15
    v_cmp_gt_i32 s[78:79], 2, v15
    v_cmp_gt_i32 s[90:91], 3, v15
    v_cndmask_b32 v72, v72, v22, s[74:75]
    v_cndmask_b32 v73, v73, v22, s[76:77]
    v_cndmask_b32 v74, v74, v22, s[78:79]
    v_cndmask_b32 v75, v75, v22, s[90:91]
    v_exp_f32 v112, v72
    v_mfma_f32_16x16x32_bf16 v[92:95], v[24:27], v[232:235], v[108:111]
    ds_read_b128 v[200:203], v14 offset:12288
    v_add_f32 v17, v17, v19
    v_mfma_f32_16x16x32_bf16 v[88:91], v[28:31], v[220:223], v[88:91]
    v_exp_f32 v113, v73
    v_mfma_f32_16x16x32_bf16 v[92:95], v[28:31], v[236:239], v[92:95]
    ds_read_b128 v[204:207], v14 offset:13312
    v_add_f32 v19, v112, v113
    v_cvt_pk_bf16_f32 v56, v112, v113
    v_mfma_f32_16x16x32_bf16 v[88:91], v[32:35], v[224:227], v[88:91]
    v_exp_f32 v114, v74
    v_mfma_f32_16x16x32_bf16 v[92:95], v[32:35], v[240:243], v[92:95]
    ds_read_b128 v[208:211], v14 offset:14336
    v_add_f32 v19, v19, v114
    v_mfma_f32_16x16x32_bf16 v[88:91], v[36:39], v[228:231], v[88:91]
    v_exp_f32 v115, v75
    v_mfma_f32_16x16x32_bf16 v[92:95], v[36:39], v[244:247], v[92:95]
    ds_read_b128 v[212:215], v14 offset:15360
    v_add_f32 v19, v19, v115
    v_cvt_pk_bf16_f32 v57, v114, v115
    v_add_u32 v14, 0x4000, v14
    v_and_or_b32 v14, v14, s64, v10
    s_waitcnt lgkmcnt(8)
    v_mfma_f32_16x16x32_bf16 v[96:99], v[40:43], v[216:219], v[104:107]
    v_cmp_gt_i32 s[74:75], 16, v15
    v_cmp_gt_i32 s[76:77], 17, v15
    v_cmp_gt_i32 s[78:79], 18, v15
    v_cmp_gt_i32 s[90:91], 19, v15
    v_cndmask_b32 v80, v80, v22, s[74:75]
    v_cndmask_b32 v81, v81, v22, s[76:77]
    v_cndmask_b32 v82, v82, v22, s[78:79]
    v_cndmask_b32 v83, v83, v22, s[90:91]
    v_exp_f32 v116, v80
    v_mfma_f32_16x16x32_bf16 v[100:103], v[40:43], v[232:235], v[108:111]
    s_sub_u32 s72, s67, s65
    s_cmp_ge_u32 s72, 2
    s_cbranch_scc1 W12_AS1
    s_waitcnt vmcnt(4)
W12_AS1:
    s_cmp_eq_u32 s65, 4
    s_cbranch_scc1 W22_AS1
    s_waitcnt vmcnt(12)
W22_AS1:
    s_waitcnt vmcnt(22)
    s_barrier
    s_cmp_lt_u32 s72, 3
    s_cbranch_scc1 NP_AS1
    s_and_b32 s8, s65, 3
    s_cmp_eq_u32 s8, 2
    s_cbranch_scc1 CQ_AS1
    s_cmp_lg_u32 s8, 1
    s_cbranch_scc1 NQ_AS1
    buffer_load_dword v9, v8, s[44:47], s15 offen sc1
    s_lshl_b32 s8, s65, 8
    s_or_b32 s8, s8, s5
    s_cmp_lg_u32 s8, 2304
    s_cbranch_scc1 N9_AS1
    v_mov_b32 v21, 0x100
    s_and_b32 s8, s2, 7
    s_lshl_b32 s8, s8, 5
    s_mov_b64 exec, 1
    buffer_atomic_add v21, off, s[48:51], s8
    s_mov_b64 exec, -1
    s_branch NQ_AS1
N9_AS1:
    s_cmp_lg_u32 s8, 256
    s_cbranch_scc1 NQ_AS1
    s_lshl_b32 s8, s4, 2
    s_add_u32 s8, s8, s15
    s_add_u32 s8, s8, 4096
    v_mov_b32 v21, 1
    s_mov_b64 exec, 1
    buffer_store_dword v21, off, s[44:47], s8 sc1
    s_mov_b64 exec, -1
    s_branch NQ_AS1
CQ_AS1:
    s_add_u32 s8, s65, 6
    s_lshr_b32 s8, s8, 2
    s_sub_u32 s8, 7, s8
    v_cmp_eq_u32 vcc, s8, v1
    s_nop 1
    v_cndmask_b32 v7, 0, 1, vcc
    s_waitcnt vmcnt(8)
    v_and_b32 v9, v9, v7
    v_cmp_ne_u32 vcc, v9, v7
    s_cbranch_vccz PQ_AS1_OK
    s_mov_b32 s55, 0x40000
PQ_AS1_SP:
    s_sleep 2
    buffer_load_dword v9, v8, s[44:47], s15 offen sc1
    s_waitcnt vmcnt(0)
    v_and_b32 v9, v9, v7
    v_cmp_ne_u32 vcc, v9, v7
    s_cbranch_vccz PQ_AS1_OK
    s_sub_u32 s55, s55, 1
    s_cmp_lg_u32 s55, 0
    s_cbranch_scc1 PQ_AS1_SP
PQ_AS1_OK:
NQ_AS1:
    s_mov_b32 m0, s63
    s_add_u32 s63, s63, 16384
    buffer_load_dwordx4 v2, s[44:47], s61 offen offset:0 sc1 lds
    buffer_load_dwordx4 v2, s[44:47], s61 offen offset:1024 sc1 lds
    buffer_load_dwordx4 v2, s[44:47], s61 offen offset:2048 sc1 lds
    buffer_load_dwordx4 v2, s[44:47], s61 offen offset:3072 sc1 lds
    s_add_u32 s61, s61, 16384
    s_and_b32 s63, s63, 0xffff
    s_or_b32 s63, s63, 0x10000
    s_mov_b32 m0, s62
    s_add_u32 s62, s62, 16384
    buffer_load_dwordx4 v2, s[44:47], s60 offen offset:0 sc1 lds
    buffer_load_dwordx4 v2, s[44:47], s60 offen offset:1024 sc1 lds
    buffer_load_dwordx4 v2, s[44:47], s60 offen offset:2048 sc1 lds
    buffer_load_dwordx4 v2, s[44:47], s60 offen offset:3072 sc1 lds
    s_add_u32 s60, s60, 16384
    s_and_b32 s62, s62, 0xffff
    s_sub_u32 s8, s65, 2
    s_cmp_ge_u32 s8, 2
    s_cbranch_scc1 NP_AS1
    v_mov_b32 v24, 0x7fc17fc1
    v_mov_b32 v25, 0x7fc17fc1
    v_mov_b32 v26, 0x7fc17fc1
    v_mov_b32 v27, 0x7fc17fc1
    s_mul_i32 s8, s8, 20480
    s_add_u32 s8, s8, s13
    s_add_u32 s9, s8, 4096
    buffer_store_dwordx4 v[24:27], v2, s[44:47], s8 offen offset:0 sc1
    buffer_store_dwordx4 v[24:27], v2, s[44:47], s8 offen offset:1024 sc1
    buffer_store_dwordx4 v[24:27], v2, s[44:47], s8 offen offset:2048 sc1
    buffer_store_dwordx4 v[24:27], v2, s[44:47], s8 offen offset:3072 sc1
    buffer_store_dwordx4 v[24:27], v2, s[44:47], s9 offen offset:0 sc1
NP_AS1:
    s_nop 1
    ds_read_b128 v[24:27], v14 offset:0
    v_add_f32 v19, v19, v116
    v_mfma_f32_16x16x32_bf16 v[96:99], v[44:47], v[220:223], v[96:99]
    v_exp_f32 v117, v81
    v_mfma_f32_16x16x32_bf16 v[100:103], v[44:47], v[236:239], v[100:103]
    ds_read_b128 v[28:31], v14 offset:1024
    v_add_f32 v19, v19, v117
    v_cvt_pk_bf16_f32 v58, v116, v117
    v_mfma_f32_16x16x32_bf16 v[96:99], v[48:51], v[224:227], v[96:99]
    v_exp_f32 v118, v82
    v_mfma_f32_16x16x32_bf16 v[100:103], v[48:51], v[240:243], v[100:103]
    ds_read_b128 v[32:35], v14 offset:2048
    v_add_f32 v19, v19, v118
    v_mfma_f32_16x16x32_bf16 v[96:99], v[52:55], v[228:231], v[96:99]
    v_exp_f32 v119, v83
    v_mfma_f32_16x16x32_bf16 v[100:103], v[52:55], v[244:247], v[100:103]
    ds_read_b128 v[36:39], v14 offset:3072
    v_add_f32 v19, v19, v119
    v_cvt_pk_bf16_f32 v59, v118, v119
    s_waitcnt lgkmcnt(8)
    v_mfma_f32_16x16x32_bf16 v[128:131], v[120:123], v[64:67], v[128:131]
    v_cmp_gt_i32 s[74:75], 0, v16
    v_cmp_gt_i32 s[76:77], 1, v16
    v_cmp_gt_i32 s[78:79], 2, v16
    v_cmp_gt_i32 s[90:91], 3, v16
    v_cndmask_b32 v76, v76, v22, s[74:75]
    v_cndmask_b32 v77, v77, v22, s[76:77]
    v_cndmask_b32 v78, v78, v22, s[78:79]
    v_cndmask_b32 v79, v79, v22, s[90:91]
    v_exp_f32 v112, v76
    v_mfma_f32_16x16x32_bf16 v[132:135], v[120:123], v[68:71], v[132:135]
    ds_read_b128 v[40:43], v14 offset:4096
    v_add_f32 v18, v18, v20
    v_mfma_f32_16x16x32_bf16 v[136:139], v[124:127], v[64:67], v[136:139]
    v_exp_f32 v113, v77
    v_mfma_f32_16x16x32_bf16 v[140:143], v[124:127], v[68:71], v[140:143]
    ds_read_b128 v[44:47], v14 offset:5120
    v_add_f32 v20, v112, v113
    v_cvt_pk_bf16_f32 v60, v112, v113
    v_mfma_f32_16x16x32_bf16 v[144:147], v[192:195], v[64:67], v[144:147]
    v_exp_f32 v114, v78
    v_mfma_f32_16x16x32_bf16 v[148:151], v[192:195], v[68:71], v[148:151]
    ds_read_b128 v[48:51], v14 offset:6144
    v_add_f32 v20, v20, v114
    v_mfma_f32_16x16x32_bf16 v[152:155], v[196:199], v[64:67], v[152:155]
    v_exp_f32 v115, v79
    v_mfma_f32_16x16x32_bf16 v[156:159], v[196:199], v[68:71], v[156:159]
    ds_read_b128 v[52:55], v14 offset:7168
    v_add_f32 v20, v20, v115
    v_cvt_pk_bf16_f32 v61, v114, v115
    s_waitcnt lgkmcnt(8)
    v_mfma_f32_16x16x32_bf16 v[160:163], v[200:203], v[64:67], v[160:163]
    v_cmp_gt_i32 s[74:75], 16, v16
    v_cmp_gt_i32 s[76:77], 17, v16
    v_cmp_gt_i32 s[78:79], 18, v16
    v_cmp_gt_i32 s[90:91], 19, v16
    v_cndmask_b32 v84, v84, v22, s[74:75]
    v_cndmask_b32 v85, v85, v22, s[76:77]
    v_cndmask_b32 v86, v86, v22, s[78:79]
    v_cndmask_b32 v87, v87, v22, s[90:91]
    v_exp_f32 v116, v84
    v_mfma_f32_16x16x32_bf16 v[164:167], v[200:203], v[68:71], v[164:167]
    ds_read_b128 v[120:123], v14 offset:8192
    v_add_f32 v20, v20, v116
    v_mfma_f32_16x16x32_bf16 v[168:171], v[204:207], v[64:67], v[168:171]
    v_exp_f32 v117, v85
    v_mfma_f32_16x16x32_bf16 v[172:175], v[204:207], v[68:71], v[172:175]
    ds_read_b128 v[124:127], v14 offset:9216
    v_add_f32 v20, v20, v117
    v_cvt_pk_bf16_f32 v62, v116, v117
    v_mfma_f32_16x16x32_bf16 v[176:179], v[208:211], v[64:67], v[176:179]
    v_exp_f32 v118, v86
    v_mfma_f32_16x16x32_bf16 v[180:183], v[208:211], v[68:71], v[180:183]
    ds_read_b128 v[192:195], v14 offset:10240
    v_add_f32 v20, v20, v118
    v_mfma_f32_16x16x32_bf16 v[184:187], v[212:215], v[64:67], v[184:187]
    v_exp_f32 v119, v87
    v_mfma_f32_16x16x32_bf16 v[188:191], v[212:215], v[68:71], v[188:191]
    ds_read_b128 v[196:199], v14 offset:11264
    v_add_f32 v20, v20, v119
    v_cvt_pk_bf16_f32 v63, v118, v119
    v_max_f32 v21, v19, v20
    v_cmp_nle_f32 vcc, v21, v11
    s_cbranch_vccnz RAS1b
RAS1b_R:
    s_add_u32 s65, s65, 1
A_S2:
    s_waitcnt lgkmcnt(8)
    v_mfma_f32_16x16x32_bf16 v[128:131], v[24:27], v[56:59], v[128:131]
    v_cmp_gt_i32 s[74:75], 32, v15
    v_cmp_gt_i32 s[76:77], 33, v15
    v_cmp_gt_i32 s[78:79], 34, v15
    v_cmp_gt_i32 s[90:91], 35, v15
    v_cndmask_b32 v88, v88, v22, s[74:75]
    v_cndmask_b32 v89, v89, v22, s[76:77]
    v_cndmask_b32 v90, v90, v22, s[78:79]
    v_cndmask_b32 v91, v91, v22, s[90:91]
    v_exp_f32 v112, v88
    v_exp_f32 v113, v89
    v_mfma_f32_16x16x32_bf16 v[132:135], v[24:27], v[60:63], v[132:135]
    ds_read_b128 v[200:203], v14 offset:12288
    v_add_f32 v17, v17, v19
    v_add_f32 v18, v18, v20
    v_add_f32 v19, v112, v113
    v_cvt_pk_bf16_f32 v64, v112, v113
    v_mfma_f32_16x16x32_bf16 v[136:139], v[28:31], v[56:59], v[136:139]
    v_exp_f32 v114, v90
    v_exp_f32 v115, v91
    v_mfma_f32_16x16x32_bf16 v[140:143], v[28:31], v[60:63], v[140:143]
    ds_read_b128 v[204:207], v14 offset:13312
    v_add_f32 v19, v19, v114
    v_add_f32 v19, v19, v115
    v_cvt_pk_bf16_f32 v65, v114, v115
    v_mfma_f32_16x16x32_bf16 v[144:147], v[32:35], v[56:59], v[144:147]
    v_cmp_gt_i32 s[74:75], 48, v15
    v_cmp_gt_i32 s[76:77], 49, v15
    v_cmp_gt_i32 s[78:79], 50, v15
    v_cmp_gt_i32 s[90:91], 51, v15
    v_cndmask_b32 v96, v96, v22, s[74:75]
    v_cndmask_b32 v97, v97, v22, s[76:77]
    v_cndmask_b32 v98, v98, v22, s[78:79]
    v_cndmask_b32 v99, v99, v22, s[90:91]
    v_exp_f32 v116, v96
    v_exp_f32 v117, v97
    v_mfma_f32_16x16x32_bf16 v[148:151], v[32:35], v[60:63], v[148:151]
    ds_read_b128 v[208:211], v14 offset:14336
    v_add_f32 v19, v19, v116
    v_add_f32 v19, v19, v117
    v_cvt_pk_bf16_f32 v66, v116, v117
    v_mfma_f32_16x16x32_bf16 v[152:155], v[36:39], v[56:59], v[152:155]
    v_exp_f32 v118, v98
    v_exp_f32 v119, v99
    v_mfma_f32_16x16x32_bf16 v[156:159], v[36:39], v[60:63], v[156:159]
    ds_read_b128 v[212:215], v14 offset:15360
    v_add_f32 v19, v19, v118
    v_add_f32 v19, v19, v119
    v_cvt_pk_bf16_f32 v67, v118, v119
    s_waitcnt lgkmcnt(8)
    v_mfma_f32_16x16x32_bf16 v[160:163], v[40:43], v[56:59], v[160:163]
    v_cmp_gt_i32 s[74:75], 32, v16
    v_cmp_gt_i32 s[76:77], 33, v16
    v_cmp_gt_i32 s[78:79], 34, v16
    v_cmp_gt_i32 s[90:91], 35, v16
    v_cndmask_b32 v92, v92, v22, s[74:75]
    v_cndmask_b32 v93, v93, v22, s[76:77]
    v_cndmask_b32 v94, v94, v22, s[78:79]
    v_cndmask_b32 v95, v95, v22, s[90:91]
    v_exp_f32 v112, v92
    v_exp_f32 v113, v93
    v_mfma_f32_16x16x32_bf16 v[164:167], v[40:43], v[60:63], v[164:167]
    v_add_f32 v20, v112, v113
    v_cvt_pk_bf16_f32 v68, v112, v113
    v_mfma_f32_16x16x32_bf16 v[168:171], v[44:47], v[56:59], v[168:171]
    v_exp_f32 v114, v94
    v_exp_f32 v115, v95
    v_mfma_f32_16x16x32_bf16 v[172:175], v[44:47], v[60:63], v[172:175]
    v_add_f32 v20, v20, v114
    v_add_f32 v20, v20, v115
    v_cvt_pk_bf16_f32 v69, v114, v115
    v_mfma_f32_16x16x32_bf16 v[176:179], v[48:51], v[56:59], v[176:179]
    v_cmp_gt_i32 s[74:75], 48, v16
    v_cmp_gt_i32 s[76:77], 49, v16
    v_cmp_gt_i32 s[78:79], 50, v16
    v_cmp_gt_i32 s[90:91], 51, v16
    v_cndmask_b32 v100, v100, v22, s[74:75]
    v_cndmask_b32 v101, v101, v22, s[76:77]
    v_cndmask_b32 v102, v102, v22, s[78:79]
    v_cndmask_b32 v103, v103, v22, s[90:91]
    v_exp_f32 v116, v100
    v_exp_f32 v117, v101
    v_mfma_f32_16x16x32_bf16 v[180:183], v[48:51], v[60:63], v[180:183]
    v_add_f32 v20, v20, v116
    v_add_f32 v20, v20, v117
    v_cvt_pk_bf16_f32 v70, v116, v117
    v_mfma_f32_16x16x32_bf16 v[184:187], v[52:55], v[56:59], v[184:187]
    v_exp_f32 v118, v102
    v_exp_f32 v119, v103
    v_mfma_f32_16x16x32_bf16 v[188:191], v[52:55], v[60:63], v[188:191]
    v_add_f32 v20, v20, v118
    v_add_f32 v20, v20, v119
    v_cvt_pk_bf16_f32 v71, v118, v119
    v_max_f32 v21, v19, v20
    v_cmp_nle_f32 vcc, v21, v11
    s_cbranch_vccnz RAS2a
RAS2a_R:
    s_waitcnt lgkmcnt(4)
    v_mfma_f32_16x16x32_bf16 v[128:131], v[120:123], v[64:67], v[128:131]
    v_mfma_f32_16x16x32_bf16 v[132:135], v[120:123], v[68:71], v[132:135]
    v_add_f32 v17, v17, v19
    v_add_f32 v18, v18, v20
    v_mfma_f32_16x16x32_bf16 v[136:139], v[124:127], v[64:67], v[136:139]
    v_mfma_f32_16x16x32_bf16 v[140:143], v[124:127], v[68:71], v[140:143]
    s_sub_u32 s72, s67, s65
    s_cmp_ge_u32 s72, 2
    s_cbranch_scc1 W12_AS2
    s_waitcnt vmcnt(4)
W12_AS2:
    s_cmp_eq_u32 s65, 4
    s_cbranch_scc1 W22_AS2
    s_waitcnt vmcnt(12)
W22_AS2:
    s_waitcnt vmcnt(22)
    s_barrier
    s_cmp_lt_u32 s72, 3
    s_cbranch_scc1 NP_AS2
    s_and_b32 s8, s65, 3
    s_cmp_eq_u32 s8, 2
    s_cbranch_scc1 CQ_AS2
    s_cmp_lg_u32 s8, 1
    s_cbranch_scc1 NQ_AS2
    buffer_load_dword v9, v8, s[44:47], s15 offen sc1
    s_lshl_b32 s8, s65, 8
    s_or_b32 s8, s8, s5
    s_cmp_lg_u32 s8, 2304
    s_cbranch_scc1 N9_AS2
    v_mov_b32 v21, 0x100
    s_and_b32 s8, s2, 7
    s_lshl_b32 s8, s8, 5
    s_mov_b64 exec, 1
    buffer_atomic_add v21, off, s[48:51], s8
    s_mov_b64 exec, -1
    s_branch NQ_AS2
N9_AS2:
    s_cmp_lg_u32 s8, 256
    s_cbranch_scc1 NQ_AS2
    s_lshl_b32 s8, s4, 2
    s_add_u32 s8, s8, s15
    s_add_u32 s8, s8, 4096
    v_mov_b32 v21, 1
    s_mov_b64 exec, 1
    buffer_store_dword v21, off, s[44:47], s8 sc1
    s_mov_b64 exec, -1
    s_branch NQ_AS2
CQ_AS2:
    s_add_u32 s8, s65, 6
    s_lshr_b32 s8, s8, 2
    s_sub_u32 s8, 7, s8
    v_cmp_eq_u32 vcc, s8, v1
    s_nop 1
    v_cndmask_b32 v7, 0, 1, vcc
    s_waitcnt vmcnt(8)
    v_and_b32 v9, v9, v7
    v_cmp_ne_u32 vcc, v9, v7
    s_cbranch_vccz PQ_AS2_OK
    s_mov_b32 s55, 0x40000
PQ_AS2_SP:
    s_sleep 2
    buffer_load_dword v9, v8, s[44:47], s15 offen sc1
    s_waitcnt vmcnt(0)
    v_and_b32 v9, v9, v7
    v_cmp_ne_u32 vcc, v9, v7
    s_cbranch_vccz PQ_AS2_OK
    s_sub_u32 s55, s55, 1
    s_cmp_lg_u32 s55, 0
    s_cbranch_scc1 PQ_AS2_SP
PQ_AS2_OK:
NQ_AS2:
    s_mov_b32 m0, s63
    s_add_u32 s63, s63, 16384
    buffer_load_dwordx4 v2, s[44:47], s61 offen offset:0 sc1 lds
    buffer_load_dwordx4 v2, s[44:47], s61 offen offset:1024 sc1 lds
    buffer_load_dwordx4 v2, s[44:47], s61 offen offset:2048 sc1 lds
    buffer_load_dwordx4 v2, s[44:47], s61 offen offset:3072 sc1 lds
    s_add_u32 s61, s61, 16384
    s_and_b32 s63, s63, 0xffff
    s_or_b32 s63, s63, 0x10000
    s_mov_b32 m0, s62
    s_add_u32 s62, s62, 16384
    buffer_load_dwordx4 v2, s[44:47], s60 offen offset:0 sc1 lds
    buffer_load_dwordx4 v2, s[44:47], s60 offen offset:1024 sc1 lds
    buffer_load_dwordx4 v2, s[44:47], s60 offen offset:2048 sc1 lds
    buffer_load_dwordx4 v2, s[44:47], s60 offen offset:3072 sc1 lds
    s_add_u32 s60, s60, 16384
    s_and_b32 s62, s62, 0xffff
    s_sub_u32 s8, s65, 2
    s_cmp_ge_u32 s8, 2
    s_cbranch_scc1 NP_AS2
    v_mov_b32 v24, 0x7fc17fc1
    v_mov_b32 v25, 0x7fc17fc1
    v_mov_b32 v26, 0x7fc17fc1
    v_mov_b32 v27, 0x7fc17fc1
    s_mul_i32 s8, s8, 20480
    s_add_u32 s8, s8, s13
    s_add_u32 s9, s8, 4096
    buffer_store_dwordx4 v[24:27], v2, s[44:47], s8 offen offset:0 sc1
    buffer_store_dwordx4 v[24:27], v2, s[44:47], s8 offen offset:1024 sc1
    buffer_store_dwordx4 v[24:27], v2, s[44:47], s8 offen offset:2048 sc1
    buffer_store_dwordx4 v[24:27], v2, s[44:47], s8 offen offset:3072 sc1
    buffer_store_dwordx4 v[24:27], v2, s[44:47], s9 offen offset:0 sc1
NP_AS2:
    v_mfma_f32_16x16x32_bf16 v[144:147], v[192:195], v[64:67], v[144:147]
    v_mfma_f32_16x16x32_bf16 v[148:151], v[192:195], v[68:71], v[148:151]
    v_mfma_f32_16x16x32_bf16 v[152:155], v[196:199], v[64:67], v[152:155]
    v_mfma_f32_16x16x32_bf16 v[156:159], v[196:199], v[68:71], v[156:159]
    s_waitcnt lgkmcnt(0)
    v_mfma_f32_16x16x32_bf16 v[160:163], v[200:203], v[64:67], v[160:163]
    v_mfma_f32_16x16x32_bf16 v[164:167], v[200:203], v[68:71], v[164:167]
    v_mfma_f32_16x16x32_bf16 v[168:171], v[204:207], v[64:67], v[168:171]
    v_mfma_f32_16x16x32_bf16 v[172:175], v[204:207], v[68:71], v[172:175]
    v_mfma_f32_16x16x32_bf16 v[176:179], v[208:211], v[64:67], v[176:179]
    v_mfma_f32_16x16x32_bf16 v[180:183], v[208:211], v[68:71], v[180:183]
    v_mfma_f32_16x16x32_bf16 v[184:187], v[212:215], v[64:67], v[184:187]
    v_mfma_f32_16x16x32_bf16 v[188:191], v[212:215], v[68:71], v[188:191]
A_EP:
    s_nop 7
    s_setprio 0
    v_lshrrev_b32 v5, 2, v2
    v_mov_b32 v6, s52
    v_cmp_gt_u32 vcc, 8, v1
    s_nop 1
    v_cndmask_b32 v5, v6, v5, vcc
    v_cndmask_b32 v6, 0, 1, vcc
    s_lshl_b32 s14, s3, 7
    s_add_u32 s14, s14, 83890176
    buffer_load_dword v4, v5, s[44:47], s14 offen sc1
    v_permlane16_swap_b32 v17, v18
    v_add_f32 v17, v17, v18
    v_mov_b32 v112, v17
    s_nop 1
    v_permlane32_swap_b32 v17, v112
    v_add_f32 v17, v17, v112
    v_mov_b32 v18, v17
    s_nop 1
    v_permlane16_swap_b32 v17, v18
    v_rcp_f32 v17, v17
    s_nop 0
    v_mul_f32 v112, v17, v3
    v_mov_b32 v113, v112
    v_rcp_f32 v18, v18
    s_nop 0
    v_mul_f32 v114, v18, v12
    v_mov_b32 v115, v114
    s_lshl_b32 s6, s3, 14
    s_add_u32 s6, s6, s69
    v_pk_mul_f32 v[128:129], v[128:129], v[112:113]
    v_pk_mul_f32 v[130:131], v[130:131], v[112:113]
    v_cvt_pk_bf16_f32 v24, v128, v129
    v_cvt_pk_bf16_f32 v25, v130, v131
    v_pk_mul_f32 v[136:137], v[136:137], v[112:113]
    v_pk_mul_f32 v[138:139], v[138:139], v[112:113]
    v_cvt_pk_bf16_f32 v26, v136, v137
    v_cvt_pk_bf16_f32 v27, v138, v139
    buffer_store_dwordx4 v[24:27], v2, s[44:47], s6 offen offset:0 sc1
    v_pk_mul_f32 v[132:133], v[132:133], v[114:115]
    v_pk_mul_f32 v[134:135], v[134:135], v[114:115]
    v_cvt_pk_bf16_f32 v28, v132, v133
    v_cvt_pk_bf16_f32 v29, v134, v135
    v_pk_mul_f32 v[140:141], v[140:141], v[114:115]
    v_pk_mul_f32 v[142:143], v[142:143], v[114:115]
    v_cvt_pk_bf16_f32 v30, v140, v141
    v_cvt_pk_bf16_f32 v31, v142, v143
    buffer_store_dwordx4 v[28:31], v2, s[44:47], s6 offen offset:1024 sc1
    s_add_u32 s6, s6, 4096
    v_pk_mul_f32 v[144:145], v[144:145], v[112:113]
    v_pk_mul_f32 v[146:147], v[146:147], v[112:113]
    v_cvt_pk_bf16_f32 v32, v144, v145
    v_cvt_pk_bf16_f32 v33, v146, v147
    v_pk_mul_f32 v[152:153], v[152:153], v[112:113]
    v_pk_mul_f32 v[154:155], v[154:155], v[112:113]
    v_cvt_pk_bf16_f32 v34, v152, v153
    v_cvt_pk_bf16_f32 v35, v154, v155
    buffer_store_dwordx4 v[32:35], v2, s[44:47], s6 offen offset:0 sc1
    v_pk_mul_f32 v[148:149], v[148:149], v[114:115]
    v_pk_mul_f32 v[150:151], v[150:151], v[114:115]
    v_cvt_pk_bf16_f32 v36, v148, v149
    v_cvt_pk_bf16_f32 v37, v150, v151
    v_pk_mul_f32 v[156:157], v[156:157], v[114:115]
    v_pk_mul_f32 v[158:159], v[158:159], v[114:115]
    v_cvt_pk_bf16_f32 v38, v156, v157
    v_cvt_pk_bf16_f32 v39, v158, v159
    buffer_store_dwordx4 v[36:39], v2, s[44:47], s6 offen offset:1024 sc1
    s_add_u32 s6, s6, 4096
    v_pk_mul_f32 v[160:161], v[160:161], v[112:113]
    v_pk_mul_f32 v[162:163], v[162:163], v[112:113]
    v_cvt_pk_bf16_f32 v40, v160, v161
    v_cvt_pk_bf16_f32 v41, v162, v163
    v_pk_mul_f32 v[168:169], v[168:169], v[112:113]
    v_pk_mul_f32 v[170:171], v[170:171], v[112:113]
    v_cvt_pk_bf16_f32 v42, v168, v169
    v_cvt_pk_bf16_f32 v43, v170, v171
    buffer_store_dwordx4 v[40:43], v2, s[44:47], s6 offen offset:0 sc1
    v_pk_mul_f32 v[164:165], v[164:165], v[114:115]
    v_pk_mul_f32 v[166:167], v[166:167], v[114:115]
    v_cvt_pk_bf16_f32 v44, v164, v165
    v_cvt_pk_bf16_f32 v45, v166, v167
    v_pk_mul_f32 v[172:173], v[172:173], v[114:115]
    v_pk_mul_f32 v[174:175], v[174:175], v[114:115]
    v_cvt_pk_bf16_f32 v46, v172, v173
    v_cvt_pk_bf16_f32 v47, v174, v175
    buffer_store_dwordx4 v[44:47], v2, s[44:47], s6 offen offset:1024 sc1
    s_add_u32 s6, s6, 4096
    v_pk_mul_f32 v[176:177], v[176:177], v[112:113]
    v_pk_mul_f32 v[178:179], v[178:179], v[112:113]
    v_cvt_pk_bf16_f32 v48, v176, v177
    v_cvt_pk_bf16_f32 v49, v178, v179
    v_pk_mul_f32 v[184:185], v[184:185], v[112:113]
    v_pk_mul_f32 v[186:187], v[186:187], v[112:113]
    v_cvt_pk_bf16_f32 v50, v184, v185
    v_cvt_pk_bf16_f32 v51, v186, v187
    buffer_store_dwordx4 v[48:51], v2, s[44:47], s6 offen offset:0 sc1
    v_pk_mul_f32 v[180:181], v[180:181], v[114:115]
    v_pk_mul_f32 v[182:183], v[182:183], v[114:115]
    v_cvt_pk_bf16_f32 v52, v180, v181
    v_cvt_pk_bf16_f32 v53, v182, v183
    v_pk_mul_f32 v[188:189], v[188:189], v[114:115]
    v_pk_mul_f32 v[190:191], v[190:191], v[114:115]
    v_cvt_pk_bf16_f32 v54, v188, v189
    v_cvt_pk_bf16_f32 v55, v190, v191
    buffer_store_dwordx4 v[52:55], v2, s[44:47], s6 offen offset:1024 sc1
    s_sub_u32 s6, s4, 1
    s_cmp_ge_u32 s6, 5
    s_cbranch_scc1 A_LD
    s_mul_i32 s8, s3, 5
    s_add_u32 s6, s6, s8
    s_lshl_b32 s6, s6, 2
    s_add_u32 s6, s6, s5
    s_mul_i32 s73, s6, 9
    s_mov_b32 s81, 4718592
    s_mov_b32 s87, 0x00020000
    s_mov_b32 s92, s42
    s_mov_b32 s93, s43
    s_mov_b32 s94, 60284928
    s_mov_b32 s95, 0x00020000
    s_cmp_ge_u32 s5, 2
    s_cbranch_scc1 A_J0
    s_add_u32 s65, s65, 1
    s_sub_u32 s72, s67, s65
    s_cmp_ge_u32 s72, 2
    s_cbranch_scc1 W12_JP
    s_waitcnt vmcnt(4)
W12_JP:
    s_cmp_eq_u32 s65, 4
    s_cbranch_scc1 W22_JP
    s_waitcnt vmcnt(12)
W22_JP:
    s_waitcnt vmcnt(22)
    s_barrier
    s_cmp_lt_u32 s72, 3
    s_cbranch_scc1 NP_JP
    s_and_b32 s8, s65, 3
    s_cmp_eq_u32 s8, 2
    s_cbranch_scc1 CQ_JP
    s_cmp_lg_u32 s8, 1
    s_cbranch_scc1 NQ_JP
    buffer_load_dword v9, v8, s[44:47], s15 offen sc1
    s_lshl_b32 s8, s65, 8
    s_or_b32 s8, s8, s5
    s_cmp_lg_u32 s8, 2304
    s_cbranch_scc1 N9_JP
    v_mov_b32 v21, 0x100
    s_and_b32 s8, s2, 7
    s_lshl_b32 s8, s8, 5
    s_mov_b64 exec, 1
    buffer_atomic_add v21, off, s[48:51], s8
    s_mov_b64 exec, -1
    s_branch NQ_JP
N9_JP:
    s_cmp_lg_u32 s8, 256
    s_cbranch_scc1 NQ_JP
    s_lshl_b32 s8, s4, 2
    s_add_u32 s8, s8, s15
    s_add_u32 s8, s8, 4096
    v_mov_b32 v21, 1
    s_mov_b64 exec, 1
    buffer_store_dword v21, off, s[44:47], s8 sc1
    s_mov_b64 exec, -1
    s_branch NQ_JP
CQ_JP:
    s_add_u32 s8, s65, 6
    s_lshr_b32 s8, s8, 2
    s_sub_u32 s8, 7, s8
    v_cmp_eq_u32 vcc, s8, v1
    s_nop 1
    v_cndmask_b32 v7, 0, 1, vcc
    s_waitcnt vmcnt(8)
    v_and_b32 v9, v9, v7
    v_cmp_ne_u32 vcc, v9, v7
    s_cbranch_vccz PQ_JP_OK
    s_mov_b32 s55, 0x40000
PQ_JP_SP:
    s_sleep 2
    buffer_load_dword v9, v8, s[44:47], s15 offen sc1
    s_waitcnt vmcnt(0)
    v_and_b32 v9, v9, v7
    v_cmp_ne_u32 vcc, v9, v7
    s_cbranch_vccz PQ_JP_OK
    s_sub_u32 s55, s55, 1
    s_cmp_lg_u32 s55, 0
    s_cbranch_scc1 PQ_JP_SP
PQ_JP_OK:
NQ_JP:
    s_mov_b32 m0, s63
    s_add_u32 s63, s63, 16384
    buffer_load_dwordx4 v2, s[44:47], s61 offen offset:0 sc1 lds
    buffer_load_dwordx4 v2, s[44:47], s61 offen offset:1024 sc1 lds
    buffer_load_dwordx4 v2, s[44:47], s61 offen offset:2048 sc1 lds
    buffer_load_dwordx4 v2, s[44:47], s61 offen offset:3072 sc1 lds
    s_add_u32 s61, s61, 16384
    s_and_b32 s63, s63, 0xffff
    s_or_b32 s63, s63, 0x10000
    s_mov_b32 m0, s62
    s_add_u32 s62, s62, 16384
    buffer_load_dwordx4 v2, s[44:47], s60 offen offset:0 sc1 lds
    buffer_load_dwordx4 v2, s[44:47], s60 offen offset:1024 sc1 lds
    buffer_load_dwordx4 v2, s[44:47], s60 offen offset:2048 sc1 lds
    buffer_load_dwordx4 v2, s[44:47], s60 offen offset:3072 sc1 lds
    s_add_u32 s60, s60, 16384
    s_and_b32 s62, s62, 0xffff
    s_sub_u32 s8, s65, 2
    s_cmp_ge_u32 s8, 2
    s_cbranch_scc1 NP_JP
    v_mov_b32 v24, 0x7fc17fc1
    v_mov_b32 v25, 0x7fc17fc1
    v_mov_b32 v26, 0x7fc17fc1
    v_mov_b32 v27, 0x7fc17fc1
    s_mul_i32 s8, s8, 20480
    s_add_u32 s8, s8, s13
    s_add_u32 s9, s8, 4096
    buffer_store_dwordx4 v[24:27], v2, s[44:47], s8 offen offset:0 sc1
    buffer_store_dwordx4 v[24:27], v2, s[44:47], s8 offen offset:1024 sc1
    buffer_store_dwordx4 v[24:27], v2, s[44:47], s8 offen offset:2048 sc1
    buffer_store_dwordx4 v[24:27], v2, s[44:47], s8 offen offset:3072 sc1
    buffer_store_dwordx4 v[24:27], v2, s[44:47], s9 offen offset:0 sc1
NP_JP:
A_J0:
    s_add_u32 s65, s65, 1
    s_sub_u32 s72, s67, s65
W12_J0:
    s_cmp_eq_u32 s65, 4
    s_cbranch_scc1 W22_J0
    s_waitcnt vmcnt(12)
W22_J0:
    s_waitcnt vmcnt(22)
    s_barrier
    s_and_b32 s8, s65, 3
    s_cmp_eq_u32 s8, 2
    s_cbranch_scc1 CQ_J0
    s_cmp_lg_u32 s8, 1
    s_cbranch_scc1 NQ_J0
    buffer_load_dword v9, v8, s[44:47], s15 offen sc1
    s_lshl_b32 s8, s65, 8
    s_or_b32 s8, s8, s5
    s_cmp_lg_u32 s8, 2304
    s_cbranch_scc1 N9_J0
    v_mov_b32 v21, 0x100
    s_and_b32 s8, s2, 7
    s_lshl_b32 s8, s8, 5
    s_mov_b64 exec, 1
    buffer_atomic_add v21, off, s[48:51], s8
    s_mov_b64 exec, -1
    s_branch NQ_J0
N9_J0:
    s_branch NQ_J0
CQ_J0:
    s_add_u32 s8, s65, 6
    s_lshr_b32 s8, s8, 2
    s_sub_u32 s8, 7, s8
    v_cmp_eq_u32 vcc, s8, v1
    s_nop 1
    v_cndmask_b32 v7, 0, 1, vcc
    s_waitcnt vmcnt(8)
    v_and_b32 v9, v9, v7
    v_cmp_ne_u32 vcc, v9, v7
    s_cbranch_vccz PQ_J0_OK
    s_mov_b32 s55, 0x40000
PQ_J0_SP:
    s_sleep 2
    buffer_load_dword v9, v8, s[44:47], s15 offen sc1
    s_waitcnt vmcnt(0)
    v_and_b32 v9, v9, v7
    v_cmp_ne_u32 vcc, v9, v7
    s_cbranch_vccz PQ_J0_OK
    s_sub_u32 s55, s55, 1
    s_cmp_lg_u32 s55, 0
    s_cbranch_scc1 PQ_J0_SP
PQ_J0_OK:
NQ_J0:
    s_mov_b32 m0, s63
    s_add_u32 s63, s63, 16384
    buffer_load_dwordx4 v2, s[44:47], s61 offen offset:0 sc1 lds
    buffer_load_dwordx4 v2, s[44:47], s61 offen offset:1024 sc1 lds
    buffer_load_dwordx4 v2, s[44:47], s61 offen offset:2048 sc1 lds
    buffer_load_dwordx4 v2, s[44:47], s61 offen offset:3072 sc1 lds
    s_add_u32 s61, s61, 16384
    s_and_b32 s63, s63, 0xffff
    s_or_b32 s63, s63, 0x10000
    s_mov_b32 m0, s62
    s_add_u32 s62, s62, 16384
    buffer_load_dwordx4 v2, s[44:47], s60 offen offset:0 sc1 lds
    buffer_load_dwordx4 v2, s[44:47], s60 offen offset:1024 sc1 lds
    buffer_load_dwordx4 v2, s[44:47], s60 offen offset:2048 sc1 lds
    buffer_load_dwordx4 v2, s[44:47], s60 offen offset:3072 sc1 lds
    s_add_u32 s60, s60, 16384
    s_and_b32 s62, s62, 0xffff
    s_sub_u32 s8, s65, 2
    s_cmp_ge_u32 s8, 2
    s_cbranch_scc1 NP_J0
    v_mov_b32 v24, 0x7fc17fc1
    v_mov_b32 v25, 0x7fc17fc1
    v_mov_b32 v26, 0x7fc17fc1
    v_mov_b32 v27, 0x7fc17fc1
    s_mul_i32 s8, s8, 20480
    s_add_u32 s8, s8, s13
    s_add_u32 s9, s8, 4096
    buffer_store_dwordx4 v[24:27], v2, s[44:47], s8 offen offset:0 sc1
    buffer_store_dwordx4 v[24:27], v2, s[44:47], s8 offen offset:1024 sc1
    buffer_store_dwordx4 v[24:27], v2, s[44:47], s8 offen offset:2048 sc1
    buffer_store_dwordx4 v[24:27], v2, s[44:47], s8 offen offset:3072 sc1
    buffer_store_dwordx4 v[24:27], v2, s[44:47], s9 offen offset:0 sc1
NP_J0:
    s_add_u32 s8, s73, 0
    s_mul_i32 s9, s8, 12769
    s_lshr_b32 s9, s9, 24
    s_mul_i32 s10, s9, 1314
    s_sub_u32 s8, s8, s10
    s_mul_i32 s10, s8, 7282
    s_lshr_b32 s10, s10, 16
    s_mul_i32 s11, s10, 9
    s_sub_u32 s8, s8, s11
    s_lshl_b32 s8, s8, 6
    v_add_u32 v96, s8, v1
    v_mul_u32_u24 v97, 3641, v96
    v_lshrrev_b32 v97, 16, v97
    v_mul_u32_u24 v98, 18, v97
    v_sub_u32 v98, v96, v98
    v_lshrrev_b32 v99, 3, v97
    v_lshl_add_u32 v96, v99, 3, v96
    v_and_b32 v56, 3, v97
    v_lshl_add_u32 v99, v99, 2, v56
    v_bfe_u32 v56, v97, 2, 1
    v_lshl_add_u32 v99, v56, 4, v99
    s_lshl_b32 s8, s10, 5
    s_mov_b32 s84, s26
    s_mov_b32 s85, s27
    s_mov_b32 s86, s81
    s_cmp_lt_u32 s10, 128
    s_cbranch_scc1 J2_0
    s_mov_b32 s84, s34
    s_mov_b32 s85, s35
    s_mov_b32 s86, 663552
    v_lshrrev_b32 v99, 4, v97
    v_lshl_add_u32 v99, v99, 1, v97
    s_mul_i32 s8, s10, 36
    s_sub_u32 s8, s8, 4608
    s_cmp_lt_u32 s10, 144
    s_cbranch_scc1 J2_0
    v_lshrrev_b32 v99, 1, v97
    v_mul_u32_u24 v99, 18, v99
    v_and_b32 v97, 1, v97
    v_add_u32 v99, v99, v97
    s_mul_i32 s8, s10, 288
    s_sub_u32 s8, s8, 41456
J2_0:
    v_add_u32 v99, s8, v99
    v_mul_u32_u24 v99, 1152, v99
    v_lshl_add_u32 v99, v98, 4, v99
    s_mul_i32 s8, s9, 288
    buffer_load_dwordx4 v[56:59], v99, s[84:87], s8 offen
    s_lshr_b32 s8, s10, 5
    s_mul_i32 s8, s8, 37
    s_lshl_b32 s11, s9, 8
    s_sub_u32 s11, s10, s11
    s_and_b32 s11, s11, 31
    s_add_u32 s8, s8, s11
    s_sub_u32 s11, s10, 128
    s_lshr_b32 s6, s11, 2
    s_mul_i32 s6, s6, 37
    s_and_b32 s11, s11, 3
    s_add_u32 s6, s6, s11
    s_add_u32 s6, s6, 32
    s_cmp_ge_u32 s10, 128
    s_cselect_b32 s8, s6, s8
    s_mul_i32 s6, s10, 74
    s_sub_u32 s6, s6, 10620
    s_cmp_ge_u32 s10, 144
    s_cselect_b32 s8, s6, s8
    s_mul_i32 s9, s9, 148
    s_add_u32 s9, s9, s8
    s_mul_i32 s9, s9, 9728
    s_add_u32 s9, s9, 54525952
    v_lshlrev_b32 v96, 4, v96
    v_add_u32 v100, s9, v96
    s_add_u32 s8, s73, 1
    s_mul_i32 s9, s8, 12769
    s_lshr_b32 s9, s9, 24
    s_mul_i32 s10, s9, 1314
    s_sub_u32 s8, s8, s10
    s_mul_i32 s10, s8, 7282
    s_lshr_b32 s10, s10, 16
    s_mul_i32 s11, s10, 9
    s_sub_u32 s8, s8, s11
    s_lshl_b32 s8, s8, 6
    v_add_u32 v96, s8, v1
    v_mul_u32_u24 v97, 3641, v96
    v_lshrrev_b32 v97, 16, v97
    v_mul_u32_u24 v98, 18, v97
    v_sub_u32 v98, v96, v98
    v_lshrrev_b32 v99, 3, v97
    v_lshl_add_u32 v96, v99, 3, v96
    v_and_b32 v60, 3, v97
    v_lshl_add_u32 v99, v99, 2, v60
    v_bfe_u32 v60, v97, 2, 1
    v_lshl_add_u32 v99, v60, 4, v99
    s_lshl_b32 s8, s10, 5
    s_mov_b32 s84, s26
    s_mov_b32 s85, s27
    s_mov_b32 s86, s81
    s_cmp_lt_u32 s10, 128
    s_cbranch_scc1 J2_1
    s_mov_b32 s84, s34
    s_mov_b32 s85, s35
    s_mov_b32 s86, 663552
    v_lshrrev_b32 v99, 4, v97
    v_lshl_add_u32 v99, v99, 1, v97
    s_mul_i32 s8, s10, 36
    s_sub_u32 s8, s8, 4608
    s_cmp_lt_u32 s10, 144
    s_cbranch_scc1 J2_1
    v_lshrrev_b32 v99, 1, v97
    v_mul_u32_u24 v99, 18, v99
    v_and_b32 v97, 1, v97
    v_add_u32 v99, v99, v97
    s_mul_i32 s8, s10, 288
    s_sub_u32 s8, s8, 41456
J2_1:
    v_add_u32 v99, s8, v99
    v_mul_u32_u24 v99, 1152, v99
    v_lshl_add_u32 v99, v98, 4, v99
    s_mul_i32 s8, s9, 288
    buffer_load_dwordx4 v[60:63], v99, s[84:87], s8 offen
    s_lshr_b32 s8, s10, 5
    s_mul_i32 s8, s8, 37
    s_lshl_b32 s11, s9, 8
    s_sub_u32 s11, s10, s11
    s_and_b32 s11, s11, 31
    s_add_u32 s8, s8, s11
    s_sub_u32 s11, s10, 128
    s_lshr_b32 s6, s11, 2
    s_mul_i32 s6, s6, 37
    s_and_b32 s11, s11, 3
    s_add_u32 s6, s6, s11
    s_add_u32 s6, s6, 32
    s_cmp_ge_u32 s10, 128
    s_cselect_b32 s8, s6, s8
    s_mul_i32 s6, s10, 74
    s_sub_u32 s6, s6, 10620
    s_cmp_ge_u32 s10, 144
    s_cselect_b32 s8, s6, s8
    s_mul_i32 s9, s9, 148
    s_add_u32 s9, s9, s8
    s_mul_i32 s9, s9, 9728
    s_add_u32 s9, s9, 54525952
    v_lshlrev_b32 v96, 4, v96
    v_add_u32 v101, s9, v96
    s_add_u32 s8, s73, 2
    s_mul_i32 s9, s8, 12769
    s_lshr_b32 s9, s9, 24
    s_mul_i32 s10, s9, 1314
    s_sub_u32 s8, s8, s10
    s_mul_i32 s10, s8, 7282
    s_lshr_b32 s10, s10, 16
    s_mul_i32 s11, s10, 9
    s_sub_u32 s8, s8, s11
    s_lshl_b32 s8, s8, 6
    v_add_u32 v96, s8, v1
    v_mul_u32_u24 v97, 3641, v96
    v_lshrrev_b32 v97, 16, v97
    v_mul_u32_u24 v98, 18, v97
    v_sub_u32 v98, v96, v98
    v_lshrrev_b32 v99, 3, v97
    v_lshl_add_u32 v96, v99, 3, v96
    v_and_b32 v64, 3, v97
    v_lshl_add_u32 v99, v99, 2, v64
    v_bfe_u32 v64, v97, 2, 1
    v_lshl_add_u32 v99, v64, 4, v99
    s_lshl_b32 s8, s10, 5
    s_mov_b32 s84, s26
    s_mov_b32 s85, s27
    s_mov_b32 s86, s81
    s_cmp_lt_u32 s10, 128
    s_cbranch_scc1 J2_2
    s_mov_b32 s84, s34
    s_mov_b32 s85, s35
    s_mov_b32 s86, 663552
    v_lshrrev_b32 v99, 4, v97
    v_lshl_add_u32 v99, v99, 1, v97
    s_mul_i32 s8, s10, 36
    s_sub_u32 s8, s8, 4608
    s_cmp_lt_u32 s10, 144
    s_cbranch_scc1 J2_2
    v_lshrrev_b32 v99, 1, v97
    v_mul_u32_u24 v99, 18, v99
    v_and_b32 v97, 1, v97
    v_add_u32 v99, v99, v97
    s_mul_i32 s8, s10, 288
    s_sub_u32 s8, s8, 41456
J2_2:
    v_add_u32 v99, s8, v99
    v_mul_u32_u24 v99, 1152, v99
    v_lshl_add_u32 v99, v98, 4, v99
    s_mul_i32 s8, s9, 288
    buffer_load_dwordx4 v[64:67], v99, s[84:87], s8 offen
    s_lshr_b32 s8, s10, 5
    s_mul_i32 s8, s8, 37
    s_lshl_b32 s11, s9, 8
    s_sub_u32 s11, s10, s11
    s_and_b32 s11, s11, 31
    s_add_u32 s8, s8, s11
    s_sub_u32 s11, s10, 128
    s_lshr_b32 s6, s11, 2
    s_mul_i32 s6, s6, 37
    s_and_b32 s11, s11, 3
    s_add_u32 s6, s6, s11
    s_add_u32 s6, s6, 32
    s_cmp_ge_u32 s10, 128
    s_cselect_b32 s8, s6, s8
    s_mul_i32 s6, s10, 74
    s_sub_u32 s6, s6, 10620
    s_cmp_ge_u32 s10, 144
    s_cselect_b32 s8, s6, s8
    s_mul_i32 s9, s9, 148
    s_add_u32 s9, s9, s8
    s_mul_i32 s9, s9, 9728
    s_add_u32 s9, s9, 54525952
    v_lshlrev_b32 v96, 4, v96
    v_add_u32 v102, s9, v96
    s_add_u32 s65, s65, 1
    s_sub_u32 s72, s67, s65
W12_J1:
    s_cmp_eq_u32 s65, 4
    s_cbranch_scc1 W22_J1
    s_waitcnt vmcnt(15)
W22_J1:
    s_waitcnt vmcnt(25)
    s_barrier
    s_and_b32 s8, s65, 3
    s_cmp_eq_u32 s8, 2
    s_cbranch_scc1 CQ_J1
    s_cmp_lg_u32 s8, 1
    s_cbranch_scc1 NQ_J1
    buffer_load_dword v9, v8, s[44:47], s15 offen sc1
    s_lshl_b32 s8, s65, 8
    s_or_b32 s8, s8, s5
    s_cmp_lg_u32 s8, 2304
    s_cbranch_scc1 N9_J1
    v_mov_b32 v21, 0x100
    s_and_b32 s8, s2, 7
    s_lshl_b32 s8, s8, 5
    s_mov_b64 exec, 1
    buffer_atomic_add v21, off, s[48:51], s8
    s_mov_b64 exec, -1
    s_branch NQ_J1
N9_J1:
    s_branch NQ_J1
CQ_J1:
    s_add_u32 s8, s65, 6
    s_lshr_b32 s8, s8, 2
    s_sub_u32 s8, 7, s8
    v_cmp_eq_u32 vcc, s8, v1
    s_nop 1
    v_cndmask_b32 v7, 0, 1, vcc
    s_waitcnt vmcnt(11)
    v_and_b32 v9, v9, v7
    v_cmp_ne_u32 vcc, v9, v7
    s_cbranch_vccz PQ_J1_OK
    s_mov_b32 s55, 0x40000
PQ_J1_SP:
    s_sleep 2
    buffer_load_dword v9, v8, s[44:47], s15 offen sc1
    s_waitcnt vmcnt(0)
    v_and_b32 v9, v9, v7
    v_cmp_ne_u32 vcc, v9, v7
    s_cbranch_vccz PQ_J1_OK
    s_sub_u32 s55, s55, 1
    s_cmp_lg_u32 s55, 0
    s_cbranch_scc1 PQ_J1_SP
PQ_J1_OK:
NQ_J1:
    s_mov_b32 m0, s63
    s_add_u32 s63, s63, 16384
    buffer_load_dwordx4 v2, s[44:47], s61 offen offset:0 sc1 lds
    buffer_load_dwordx4 v2, s[44:47], s61 offen offset:1024 sc1 lds
    buffer_load_dwordx4 v2, s[44:47], s61 offen offset:2048 sc1 lds
    buffer_load_dwordx4 v2, s[44:47], s61 offen offset:3072 sc1 lds
    s_add_u32 s61, s61, 16384
    s_and_b32 s63, s63, 0xffff
    s_or_b32 s63, s63, 0x10000
    s_mov_b32 m0, s62
    s_add_u32 s62, s62, 16384
    buffer_load_dwordx4 v2, s[44:47], s60 offen offset:0 sc1 lds
    buffer_load_dwordx4 v2, s[44:47], s60 offen offset:1024 sc1 lds
    buffer_load_dwordx4 v2, s[44:47], s60 offen offset:2048 sc1 lds
    buffer_load_dwordx4 v2, s[44:47], s60 offen offset:3072 sc1 lds
    s_add_u32 s60, s60, 16384
    s_and_b32 s62, s62, 0xffff
    s_sub_u32 s8, s65, 2
    s_cmp_ge_u32 s8, 2
    s_cbranch_scc1 NP_J1
    v_mov_b32 v24, 0x7fc17fc1
    v_mov_b32 v25, 0x7fc17fc1
    v_mov_b32 v26, 0x7fc17fc1
    v_mov_b32 v27, 0x7fc17fc1
    s_mul_i32 s8, s8, 20480
    s_add_u32 s8, s8, s13
    s_add_u32 s9, s8, 4096
    buffer_store_dwordx4 v[24:27], v2, s[44:47], s8 offen offset:0 sc1
    buffer_store_dwordx4 v[24:27], v2, s[44:47], s8 offen offset:1024 sc1
    buffer_store_dwordx4 v[24:27], v2, s[44:47], s8 offen offset:2048 sc1
    buffer_store_dwordx4 v[24:27], v2, s[44:47], s8 offen offset:3072 sc1
    buffer_store_dwordx4 v[24:27], v2, s[44:47], s9 offen offset:0 sc1
NP_J1:
    s_waitcnt vmcnt(8)
    buffer_store_dwordx4 v[56:59], v100, s[92:95], 0 offen sc1
    buffer_store_dwordx4 v[60:63], v101, s[92:95], 0 offen sc1
    buffer_store_dwordx4 v[64:67], v102, s[92:95], 0 offen sc1
    s_add_u32 s8, s73, 3
    s_mul_i32 s9, s8, 12769
    s_lshr_b32 s9, s9, 24
    s_mul_i32 s10, s9, 1314
    s_sub_u32 s8, s8, s10
    s_mul_i32 s10, s8, 7282
    s_lshr_b32 s10, s10, 16
    s_mul_i32 s11, s10, 9
    s_sub_u32 s8, s8, s11
    s_lshl_b32 s8, s8, 6
    v_add_u32 v96, s8, v1
    v_mul_u32_u24 v97, 3641, v96
    v_lshrrev_b32 v97, 16, v97
    v_mul_u32_u24 v98, 18, v97
    v_sub_u32 v98, v96, v98
    v_lshrrev_b32 v99, 3, v97
    v_lshl_add_u32 v96, v99, 3, v96
    v_and_b32 v68, 3, v97
    v_lshl_add_u32 v99, v99, 2, v68
    v_bfe_u32 v68, v97, 2, 1
    v_lshl_add_u32 v99, v68, 4, v99
    s_lshl_b32 s8, s10, 5
    s_mov_b32 s84, s26
    s_mov_b32 s85, s27
    s_mov_b32 s86, s81
    s_cmp_lt_u32 s10, 128
    s_cbranch_scc1 J2_3
    s_mov_b32 s84, s34
    s_mov_b32 s85, s35
    s_mov_b32 s86, 663552
    v_lshrrev_b32 v99, 4, v97
    v_lshl_add_u32 v99, v99, 1, v97
    s_mul_i32 s8, s10, 36
    s_sub_u32 s8, s8, 4608
    s_cmp_lt_u32 s10, 144
    s_cbranch_scc1 J2_3
    v_lshrrev_b32 v99, 1, v97
    v_mul_u32_u24 v99, 18, v99
    v_and_b32 v97, 1, v97
    v_add_u32 v99, v99, v97
    s_mul_i32 s8, s10, 288
    s_sub_u32 s8, s8, 41456
J2_3:
    v_add_u32 v99, s8, v99
    v_mul_u32_u24 v99, 1152, v99
    v_lshl_add_u32 v99, v98, 4, v99
    s_mul_i32 s8, s9, 288
    buffer_load_dwordx4 v[68:71], v99, s[84:87], s8 offen
    s_lshr_b32 s8, s10, 5
    s_mul_i32 s8, s8, 37
    s_lshl_b32 s11, s9, 8
    s_sub_u32 s11, s10, s11
    s_and_b32 s11, s11, 31
    s_add_u32 s8, s8, s11
    s_sub_u32 s11, s10, 128
    s_lshr_b32 s6, s11, 2
    s_mul_i32 s6, s6, 37
    s_and_b32 s11, s11, 3
    s_add_u32 s6, s6, s11
    s_add_u32 s6, s6, 32
    s_cmp_ge_u32 s10, 128
    s_cselect_b32 s8, s6, s8
    s_mul_i32 s6, s10, 74
    s_sub_u32 s6, s6, 10620
    s_cmp_ge_u32 s10, 144
    s_cselect_b32 s8, s6, s8
    s_mul_i32 s9, s9, 148
    s_add_u32 s9, s9, s8
    s_mul_i32 s9, s9, 9728
    s_add_u32 s9, s9, 54525952
    v_lshlrev_b32 v96, 4, v96
    v_add_u32 v103, s9, v96
    s_add_u32 s8, s73, 4
    s_mul_i32 s9, s8, 12769
    s_lshr_b32 s9, s9, 24
    s_mul_i32 s10, s9, 1314
    s_sub_u32 s8, s8, s10
    s_mul_i32 s10, s8, 7282
    s_lshr_b32 s10, s10, 16
    s_mul_i32 s11, s10, 9
    s_sub_u32 s8, s8, s11
    s_lshl_b32 s8, s8, 6
    v_add_u32 v96, s8, v1
    v_mul_u32_u24 v97, 3641, v96
    v_lshrrev_b32 v97, 16, v97
    v_mul_u32_u24 v98, 18, v97
    v_sub_u32 v98, v96, v98
    v_lshrrev_b32 v99, 3, v97
    v_lshl_add_u32 v96, v99, 3, v96
    v_and_b32 v72, 3, v97
    v_lshl_add_u32 v99, v99, 2, v72
    v_bfe_u32 v72, v97, 2, 1
    v_lshl_add_u32 v99, v72, 4, v99
    s_lshl_b32 s8, s10, 5
    s_mov_b32 s84, s26
    s_mov_b32 s85, s27
    s_mov_b32 s86, s81
    s_cmp_lt_u32 s10, 128
    s_cbranch_scc1 J2_4
    s_mov_b32 s84, s34
    s_mov_b32 s85, s35
    s_mov_b32 s86, 663552
    v_lshrrev_b32 v99, 4, v97
    v_lshl_add_u32 v99, v99, 1, v97
    s_mul_i32 s8, s10, 36
    s_sub_u32 s8, s8, 4608
    s_cmp_lt_u32 s10, 144
    s_cbranch_scc1 J2_4
    v_lshrrev_b32 v99, 1, v97
    v_mul_u32_u24 v99, 18, v99
    v_and_b32 v97, 1, v97
    v_add_u32 v99, v99, v97
    s_mul_i32 s8, s10, 288
    s_sub_u32 s8, s8, 41456
J2_4:
    v_add_u32 v99, s8, v99
    v_mul_u32_u24 v99, 1152, v99
    v_lshl_add_u32 v99, v98, 4, v99
    s_mul_i32 s8, s9, 288
    buffer_load_dwordx4 v[72:75], v99, s[84:87], s8 offen
    s_lshr_b32 s8, s10, 5
    s_mul_i32 s8, s8, 37
    s_lshl_b32 s11, s9, 8
    s_sub_u32 s11, s10, s11
    s_and_b32 s11, s11, 31
    s_add_u32 s8, s8, s11
    s_sub_u32 s11, s10, 128
    s_lshr_b32 s6, s11, 2
    s_mul_i32 s6, s6, 37
    s_and_b32 s11, s11, 3
    s_add_u32 s6, s6, s11
    s_add_u32 s6, s6, 32
    s_cmp_ge_u32 s10, 128
    s_cselect_b32 s8, s6, s8
    s_mul_i32 s6, s10, 74
    s_sub_u32 s6, s6, 10620
    s_cmp_ge_u32 s10, 144
    s_cselect_b32 s8, s6, s8
    s_mul_i32 s9, s9, 148
    s_add_u32 s9, s9, s8
    s_mul_i32 s9, s9, 9728
    s_add_u32 s9, s9, 54525952
    v_lshlrev_b32 v96, 4, v96
    v_add_u32 v104, s9, v96
    s_add_u32 s8, s73, 5
    s_mul_i32 s9, s8, 12769
    s_lshr_b32 s9, s9, 24
    s_mul_i32 s10, s9, 1314
    s_sub_u32 s8, s8, s10
    s_mul_i32 s10, s8, 7282
    s_lshr_b32 s10, s10, 16
    s_mul_i32 s11, s10, 9
    s_sub_u32 s8, s8, s11
    s_lshl_b32 s8, s8, 6
    v_add_u32 v96, s8, v1
    v_mul_u32_u24 v97, 3641, v96
    v_lshrrev_b32 v97, 16, v97
    v_mul_u32_u24 v98, 18, v97
    v_sub_u32 v98, v96, v98
    v_lshrrev_b32 v99, 3, v97
    v_lshl_add_u32 v96, v99, 3, v96
    v_and_b32 v76, 3, v97
    v_lshl_add_u32 v99, v99, 2, v76
    v_bfe_u32 v76, v97, 2, 1
    v_lshl_add_u32 v99, v76, 4, v99
    s_lshl_b32 s8, s10, 5
    s_mov_b32 s84, s26
    s_mov_b32 s85, s27
    s_mov_b32 s86, s81
    s_cmp_lt_u32 s10, 128
    s_cbranch_scc1 J2_5
    s_mov_b32 s84, s34
    s_mov_b32 s85, s35
    s_mov_b32 s86, 663552
    v_lshrrev_b32 v99, 4, v97
    v_lshl_add_u32 v99, v99, 1, v97
    s_mul_i32 s8, s10, 36
    s_sub_u32 s8, s8, 4608
    s_cmp_lt_u32 s10, 144
    s_cbranch_scc1 J2_5
    v_lshrrev_b32 v99, 1, v97
    v_mul_u32_u24 v99, 18, v99
    v_and_b32 v97, 1, v97
    v_add_u32 v99, v99, v97
    s_mul_i32 s8, s10, 288
    s_sub_u32 s8, s8, 41456
J2_5:
    v_add_u32 v99, s8, v99
    v_mul_u32_u24 v99, 1152, v99
    v_lshl_add_u32 v99, v98, 4, v99
    s_mul_i32 s8, s9, 288
    buffer_load_dwordx4 v[76:79], v99, s[84:87], s8 offen
    s_lshr_b32 s8, s10, 5
    s_mul_i32 s8, s8, 37
    s_lshl_b32 s11, s9, 8
    s_sub_u32 s11, s10, s11
    s_and_b32 s11, s11, 31
    s_add_u32 s8, s8, s11
    s_sub_u32 s11, s10, 128
    s_lshr_b32 s6, s11, 2
    s_mul_i32 s6, s6, 37
    s_and_b32 s11, s11, 3
    s_add_u32 s6, s6, s11
    s_add_u32 s6, s6, 32
    s_cmp_ge_u32 s10, 128
    s_cselect_b32 s8, s6, s8
    s_mul_i32 s6, s10, 74
    s_sub_u32 s6, s6, 10620
    s_cmp_ge_u32 s10, 144
    s_cselect_b32 s8, s6, s8
    s_mul_i32 s9, s9, 148
    s_add_u32 s9, s9, s8
    s_mul_i32 s9, s9, 9728
    s_add_u32 s9, s9, 54525952
    v_lshlrev_b32 v96, 4, v96
    v_add_u32 v105, s9, v96
    s_add_u32 s65, s65, 1
    s_sub_u32 s72, s67, s65
W12_J2:
    s_cmp_eq_u32 s65, 4
    s_cbranch_scc1 W22_J2
    s_waitcnt vmcnt(21)
W22_J2:
    s_waitcnt vmcnt(31)
    s_barrier
    s_and_b32 s8, s65, 3
    s_cmp_eq_u32 s8, 2
    s_cbranch_scc1 CQ_J2
    s_cmp_lg_u32 s8, 1
    s_cbranch_scc1 NQ_J2
    buffer_load_dword v9, v8, s[44:47], s15 offen sc1
    s_lshl_b32 s8, s65, 8
    s_or_b32 s8, s8, s5
    s_cmp_lg_u32 s8, 2304
    s_cbranch_scc1 N9_J2
    v_mov_b32 v21, 0x100
    s_and_b32 s8, s2, 7
    s_lshl_b32 s8, s8, 5
    s_mov_b64 exec, 1
    buffer_atomic_add v21, off, s[48:51], s8
    s_mov_b64 exec, -1
    s_branch NQ_J2
N9_J2:
    s_branch NQ_J2
CQ_J2:
    s_add_u32 s8, s65, 6
    s_lshr_b32 s8, s8, 2
    s_sub_u32 s8, 7, s8
    v_cmp_eq_u32 vcc, s8, v1
    s_nop 1
    v_cndmask_b32 v7, 0, 1, vcc
    s_waitcnt vmcnt(14)
    v_and_b32 v9, v9, v7
    v_cmp_ne_u32 vcc, v9, v7
    s_cbranch_vccz PQ_J2_OK
    s_mov_b32 s55, 0x40000
PQ_J2_SP:
    s_sleep 2
    buffer_load_dword v9, v8, s[44:47], s15 offen sc1
    s_waitcnt vmcnt(0)
    v_and_b32 v9, v9, v7
    v_cmp_ne_u32 vcc, v9, v7
    s_cbranch_vccz PQ_J2_OK
    s_sub_u32 s55, s55, 1
    s_cmp_lg_u32 s55, 0
    s_cbranch_scc1 PQ_J2_SP
PQ_J2_OK:
NQ_J2:
    s_mov_b32 m0, s63
    s_add_u32 s63, s63, 16384
    buffer_load_dwordx4 v2, s[44:47], s61 offen offset:0 sc1 lds
    buffer_load_dwordx4 v2, s[44:47], s61 offen offset:1024 sc1 lds
    buffer_load_dwordx4 v2, s[44:47], s61 offen offset:2048 sc1 lds
    buffer_load_dwordx4 v2, s[44:47], s61 offen offset:3072 sc1 lds
    s_add_u32 s61, s61, 16384
    s_and_b32 s63, s63, 0xffff
    s_or_b32 s63, s63, 0x10000
    s_mov_b32 m0, s62
    s_add_u32 s62, s62, 16384
    buffer_load_dwordx4 v2, s[44:47], s60 offen offset:0 sc1 lds
    buffer_load_dwordx4 v2, s[44:47], s60 offen offset:1024 sc1 lds
    buffer_load_dwordx4 v2, s[44:47], s60 offen offset:2048 sc1 lds
    buffer_load_dwordx4 v2, s[44:47], s60 offen offset:3072 sc1 lds
    s_add_u32 s60, s60, 16384
    s_and_b32 s62, s62, 0xffff
    s_sub_u32 s8, s65, 2
    s_cmp_ge_u32 s8, 2
    s_cbranch_scc1 NP_J2
    v_mov_b32 v24, 0x7fc17fc1
    v_mov_b32 v25, 0x7fc17fc1
    v_mov_b32 v26, 0x7fc17fc1
    v_mov_b32 v27, 0x7fc17fc1
    s_mul_i32 s8, s8, 20480
    s_add_u32 s8, s8, s13
    s_add_u32 s9, s8, 4096
    buffer_store_dwordx4 v[24:27], v2, s[44:47], s8 offen offset:0 sc1
    buffer_store_dwordx4 v[24:27], v2, s[44:47], s8 offen offset:1024 sc1
    buffer_store_dwordx4 v[24:27], v2, s[44:47], s8 offen offset:2048 sc1
    buffer_store_dwordx4 v[24:27], v2, s[44:47], s8 offen offset:3072 sc1
    buffer_store_dwordx4 v[24:27], v2, s[44:47], s9 offen offset:0 sc1
NP_J2:
    s_waitcnt vmcnt(8)
    buffer_store_dwordx4 v[68:71], v103, s[92:95], 0 offen sc1
    buffer_store_dwordx4 v[72:75], v104, s[92:95], 0 offen sc1
    buffer_store_dwordx4 v[76:79], v105, s[92:95], 0 offen sc1
    s_add_u32 s8, s73, 6
    s_mul_i32 s9, s8, 12769
    s_lshr_b32 s9, s9, 24
    s_mul_i32 s10, s9, 1314
    s_sub_u32 s8, s8, s10
    s_mul_i32 s10, s8, 7282
    s_lshr_b32 s10, s10, 16
    s_mul_i32 s11, s10, 9
    s_sub_u32 s8, s8, s11
    s_lshl_b32 s8, s8, 6
    v_add_u32 v96, s8, v1
    v_mul_u32_u24 v97, 3641, v96
    v_lshrrev_b32 v97, 16, v97
    v_mul_u32_u24 v98, 18, v97
    v_sub_u32 v98, v96, v98
    v_lshrrev_b32 v99, 3, v97
    v_lshl_add_u32 v96, v99, 3, v96
    v_and_b32 v80, 3, v97
    v_lshl_add_u32 v99, v99, 2, v80
    v_bfe_u32 v80, v97, 2, 1
    v_lshl_add_u32 v99, v80, 4, v99
    s_lshl_b32 s8, s10, 5
    s_mov_b32 s84, s26
    s_mov_b32 s85, s27
    s_mov_b32 s86, s81
    s_cmp_lt_u32 s10, 128
    s_cbranch_scc1 J2_6
    s_mov_b32 s84, s34
    s_mov_b32 s85, s35
    s_mov_b32 s86, 663552
    v_lshrrev_b32 v99, 4, v97
    v_lshl_add_u32 v99, v99, 1, v97
    s_mul_i32 s8, s10, 36
    s_sub_u32 s8, s8, 4608
    s_cmp_lt_u32 s10, 144
    s_cbranch_scc1 J2_6
    v_lshrrev_b32 v99, 1, v97
    v_mul_u32_u24 v99, 18, v99
    v_and_b32 v97, 1, v97
    v_add_u32 v99, v99, v97
    s_mul_i32 s8, s10, 288
    s_sub_u32 s8, s8, 41456
J2_6:
    v_add_u32 v99, s8, v99
    v_mul_u32_u24 v99, 1152, v99
    v_lshl_add_u32 v99, v98, 4, v99
    s_mul_i32 s8, s9, 288
    buffer_load_dwordx4 v[80:83], v99, s[84:87], s8 offen
    s_lshr_b32 s8, s10, 5
    s_mul_i32 s8, s8, 37
    s_lshl_b32 s11, s9, 8
    s_sub_u32 s11, s10, s11
    s_and_b32 s11, s11, 31
    s_add_u32 s8, s8, s11
    s_sub_u32 s11, s10, 128
    s_lshr_b32 s6, s11, 2
    s_mul_i32 s6, s6, 37
    s_and_b32 s11, s11, 3
    s_add_u32 s6, s6, s11
    s_add_u32 s6, s6, 32
    s_cmp_ge_u32 s10, 128
    s_cselect_b32 s8, s6, s8
    s_mul_i32 s6, s10, 74
    s_sub_u32 s6, s6, 10620
    s_cmp_ge_u32 s10, 144
    s_cselect_b32 s8, s6, s8
    s_mul_i32 s9, s9, 148
    s_add_u32 s9, s9, s8
    s_mul_i32 s9, s9, 9728
    s_add_u32 s9, s9, 54525952
    v_lshlrev_b32 v96, 4, v96
    v_add_u32 v106, s9, v96
    s_add_u32 s8, s73, 7
    s_mul_i32 s9, s8, 12769
    s_lshr_b32 s9, s9, 24
    s_mul_i32 s10, s9, 1314
    s_sub_u32 s8, s8, s10
    s_mul_i32 s10, s8, 7282
    s_lshr_b32 s10, s10, 16
    s_mul_i32 s11, s10, 9
    s_sub_u32 s8, s8, s11
    s_lshl_b32 s8, s8, 6
    v_add_u32 v96, s8, v1
    v_mul_u32_u24 v97, 3641, v96
    v_lshrrev_b32 v97, 16, v97
    v_mul_u32_u24 v98, 18, v97
    v_sub_u32 v98, v96, v98
    v_lshrrev_b32 v99, 3, v97
    v_lshl_add_u32 v96, v99, 3, v96
    v_and_b32 v84, 3, v97
    v_lshl_add_u32 v99, v99, 2, v84
    v_bfe_u32 v84, v97, 2, 1
    v_lshl_add_u32 v99, v84, 4, v99
    s_lshl_b32 s8, s10, 5
    s_mov_b32 s84, s26
    s_mov_b32 s85, s27
    s_mov_b32 s86, s81
    s_cmp_lt_u32 s10, 128
    s_cbranch_scc1 J2_7
    s_mov_b32 s84, s34
    s_mov_b32 s85, s35
    s_mov_b32 s86, 663552
    v_lshrrev_b32 v99, 4, v97
    v_lshl_add_u32 v99, v99, 1, v97
    s_mul_i32 s8, s10, 36
    s_sub_u32 s8, s8, 4608
    s_cmp_lt_u32 s10, 144
    s_cbranch_scc1 J2_7
    v_lshrrev_b32 v99, 1, v97
    v_mul_u32_u24 v99, 18, v99
    v_and_b32 v97, 1, v97
    v_add_u32 v99, v99, v97
    s_mul_i32 s8, s10, 288
    s_sub_u32 s8, s8, 41456
J2_7:
    v_add_u32 v99, s8, v99
    v_mul_u32_u24 v99, 1152, v99
    v_lshl_add_u32 v99, v98, 4, v99
    s_mul_i32 s8, s9, 288
    buffer_load_dwordx4 v[84:87], v99, s[84:87], s8 offen
    s_lshr_b32 s8, s10, 5
    s_mul_i32 s8, s8, 37
    s_lshl_b32 s11, s9, 8
    s_sub_u32 s11, s10, s11
    s_and_b32 s11, s11, 31
    s_add_u32 s8, s8, s11
    s_sub_u32 s11, s10, 128
    s_lshr_b32 s6, s11, 2
    s_mul_i32 s6, s6, 37
    s_and_b32 s11, s11, 3
    s_add_u32 s6, s6, s11
    s_add_u32 s6, s6, 32
    s_cmp_ge_u32 s10, 128
    s_cselect_b32 s8, s6, s8
    s_mul_i32 s6, s10, 74
    s_sub_u32 s6, s6, 10620
    s_cmp_ge_u32 s10, 144
    s_cselect_b32 s8, s6, s8
    s_mul_i32 s9, s9, 148
    s_add_u32 s9, s9, s8
    s_mul_i32 s9, s9, 9728
    s_add_u32 s9, s9, 54525952
    v_lshlrev_b32 v96, 4, v96
    v_add_u32 v107, s9, v96
    s_add_u32 s8, s73, 8
    s_mul_i32 s9, s8, 12769
    s_lshr_b32 s9, s9, 24
    s_mul_i32 s10, s9, 1314
    s_sub_u32 s8, s8, s10
    s_mul_i32 s10, s8, 7282
    s_lshr_b32 s10, s10, 16
    s_mul_i32 s11, s10, 9
    s_sub_u32 s8, s8, s11
    s_lshl_b32 s8, s8, 6
    v_add_u32 v96, s8, v1
    v_mul_u32_u24 v97, 3641, v96
    v_lshrrev_b32 v97, 16, v97
    v_mul_u32_u24 v98, 18, v97
    v_sub_u32 v98, v96, v98
    v_lshrrev_b32 v99, 3, v97
    v_lshl_add_u32 v96, v99, 3, v96
    v_and_b32 v88, 3, v97
    v_lshl_add_u32 v99, v99, 2, v88
    v_bfe_u32 v88, v97, 2, 1
    v_lshl_add_u32 v99, v88, 4, v99
    s_lshl_b32 s8, s10, 5
    s_mov_b32 s84, s26
    s_mov_b32 s85, s27
    s_mov_b32 s86, s81
    s_cmp_lt_u32 s10, 128
    s_cbranch_scc1 J2_8
    s_mov_b32 s84, s34
    s_mov_b32 s85, s35
    s_mov_b32 s86, 663552
    v_lshrrev_b32 v99, 4, v97
    v_lshl_add_u32 v99, v99, 1, v97
    s_mul_i32 s8, s10, 36
    s_sub_u32 s8, s8, 4608
    s_cmp_lt_u32 s10, 144
    s_cbranch_scc1 J2_8
    v_lshrrev_b32 v99, 1, v97
    v_mul_u32_u24 v99, 18, v99
    v_and_b32 v97, 1, v97
    v_add_u32 v99, v99, v97
    s_mul_i32 s8, s10, 288
    s_sub_u32 s8, s8, 41456
J2_8:
    v_add_u32 v99, s8, v99
    v_mul_u32_u24 v99, 1152, v99
    v_lshl_add_u32 v99, v98, 4, v99
    s_mul_i32 s8, s9, 288
    buffer_load_dwordx4 v[88:91], v99, s[84:87], s8 offen
    s_lshr_b32 s8, s10, 5
    s_mul_i32 s8, s8, 37
    s_lshl_b32 s11, s9, 8
    s_sub_u32 s11, s10, s11
    s_and_b32 s11, s11, 31
    s_add_u32 s8, s8, s11
    s_sub_u32 s11, s10, 128
    s_lshr_b32 s6, s11, 2
    s_mul_i32 s6, s6, 37
    s_and_b32 s11, s11, 3
    s_add_u32 s6, s6, s11
    s_add_u32 s6, s6, 32
    s_cmp_ge_u32 s10, 128
    s_cselect_b32 s8, s6, s8
    s_mul_i32 s6, s10, 74
    s_sub_u32 s6, s6, 10620
    s_cmp_ge_u32 s10, 144
    s_cselect_b32 s8, s6, s8
    s_mul_i32 s9, s9, 148
    s_add_u32 s9, s9, s8
    s_mul_i32 s9, s9, 9728
    s_add_u32 s9, s9, 54525952
    v_lshlrev_b32 v96, 4, v96
    v_add_u32 v108, s9, v96
    s_add_u32 s65, s65, 1
    s_sub_u32 s72, s67, s65
W12_J3:
    s_cmp_eq_u32 s65, 4
    s_cbranch_scc1 W22_J3
    s_waitcnt vmcnt(24)
W22_J3:
    s_waitcnt vmcnt(34)
    s_barrier
    s_and_b32 s8, s65, 3
    s_cmp_eq_u32 s8, 2
    s_cbranch_scc1 CQ_J3
    s_cmp_lg_u32 s8, 1
    s_cbranch_scc1 NQ_J3
    buffer_load_dword v9, v8, s[44:47], s15 offen sc1
    s_lshl_b32 s8, s65, 8
    s_or_b32 s8, s8, s5
    s_cmp_lg_u32 s8, 2304
    s_cbranch_scc1 N9_J3
    v_mov_b32 v21, 0x100
    s_and_b32 s8, s2, 7
    s_lshl_b32 s8, s8, 5
    s_mov_b64 exec, 1
    buffer_atomic_add v21, off, s[48:51], s8
    s_mov_b64 exec, -1
    s_branch NQ_J3
N9_J3:
    s_branch NQ_J3
CQ_J3:
    s_add_u32 s8, s65, 6
    s_lshr_b32 s8, s8, 2
    s_sub_u32 s8, 7, s8
    v_cmp_eq_u32 vcc, s8, v1
    s_nop 1
    v_cndmask_b32 v7, 0, 1, vcc
    s_waitcnt vmcnt(14)
    v_and_b32 v9, v9, v7
    v_cmp_ne_u32 vcc, v9, v7
    s_cbranch_vccz PQ_J3_OK
    s_mov_b32 s55, 0x40000
PQ_J3_SP:
    s_sleep 2
    buffer_load_dword v9, v8, s[44:47], s15 offen sc1
    s_waitcnt vmcnt(0)
    v_and_b32 v9, v9, v7
    v_cmp_ne_u32 vcc, v9, v7
    s_cbranch_vccz PQ_J3_OK
    s_sub_u32 s55, s55, 1
    s_cmp_lg_u32 s55, 0
    s_cbranch_scc1 PQ_J3_SP
PQ_J3_OK:
NQ_J3:
    s_mov_b32 m0, s63
    s_add_u32 s63, s63, 16384
    buffer_load_dwordx4 v2, s[44:47], s61 offen offset:0 sc1 lds
    buffer_load_dwordx4 v2, s[44:47], s61 offen offset:1024 sc1 lds
    buffer_load_dwordx4 v2, s[44:47], s61 offen offset:2048 sc1 lds
    buffer_load_dwordx4 v2, s[44:47], s61 offen offset:3072 sc1 lds
    s_add_u32 s61, s61, 16384
    s_and_b32 s63, s63, 0xffff
    s_or_b32 s63, s63, 0x10000
    s_mov_b32 m0, s62
    s_add_u32 s62, s62, 16384
    buffer_load_dwordx4 v2, s[44:47], s60 offen offset:0 sc1 lds
    buffer_load_dwordx4 v2, s[44:47], s60 offen offset:1024 sc1 lds
    buffer_load_dwordx4 v2, s[44:47], s60 offen offset:2048 sc1 lds
    buffer_load_dwordx4 v2, s[44:47], s60 offen offset:3072 sc1 lds
    s_add_u32 s60, s60, 16384
    s_and_b32 s62, s62, 0xffff
    s_sub_u32 s8, s65, 2
    s_cmp_ge_u32 s8, 2
    s_cbranch_scc1 NP_J3
    v_mov_b32 v24, 0x7fc17fc1
    v_mov_b32 v25, 0x7fc17fc1
    v_mov_b32 v26, 0x7fc17fc1
    v_mov_b32 v27, 0x7fc17fc1
    s_mul_i32 s8, s8, 20480
    s_add_u32 s8, s8, s13
    s_add_u32 s9, s8, 4096
    buffer_store_dwordx4 v[24:27], v2, s[44:47], s8 offen offset:0 sc1
    buffer_store_dwordx4 v[24:27], v2, s[44:47], s8 offen offset:1024 sc1
    buffer_store_dwordx4 v[24:27], v2, s[44:47], s8 offen offset:2048 sc1
    buffer_store_dwordx4 v[24:27], v2, s[44:47], s8 offen offset:3072 sc1
    buffer_store_dwordx4 v[24:27], v2, s[44:47], s9 offen offset:0 sc1
NP_J3:
    s_waitcnt vmcnt(8)
    buffer_store_dwordx4 v[80:83], v106, s[92:95], 0 offen sc1
    buffer_store_dwordx4 v[84:87], v107, s[92:95], 0 offen sc1
    buffer_store_dwordx4 v[88:91], v108, s[92:95], 0 offen sc1
    s_add_u32 s65, s65, 1
    s_sub_u32 s72, s67, s65
W12_J4:
    s_cmp_eq_u32 s65, 4
    s_cbranch_scc1 W22_J4
    s_waitcnt vmcnt(21)
W22_J4:
    s_waitcnt vmcnt(31)
    s_barrier
    s_and_b32 s8, s65, 3
    s_cmp_eq_u32 s8, 2
    s_cbranch_scc1 CQ_J4
    s_cmp_lg_u32 s8, 1
    s_cbranch_scc1 NQ_J4
    buffer_load_dword v9, v8, s[44:47], s15 offen sc1
    s_lshl_b32 s8, s65, 8
    s_or_b32 s8, s8, s5
    s_cmp_lg_u32 s8, 2304
    s_cbranch_scc1 N9_J4
    v_mov_b32 v21, 0x100
    s_and_b32 s8, s2, 7
    s_lshl_b32 s8, s8, 5
    s_mov_b64 exec, 1
    buffer_atomic_add v21, off, s[48:51], s8
    s_mov_b64 exec, -1
    s_branch NQ_J4
N9_J4:
    s_branch NQ_J4
CQ_J4:
    s_add_u32 s8, s65, 6
    s_lshr_b32 s8, s8, 2
    s_sub_u32 s8, 7, s8
    v_cmp_eq_u32 vcc, s8, v1
    s_nop 1
    v_cndmask_b32 v7, 0, 1, vcc
    s_waitcnt vmcnt(11)
    v_and_b32 v9, v9, v7
    v_cmp_ne_u32 vcc, v9, v7
    s_cbranch_vccz PQ_J4_OK
    s_mov_b32 s55, 0x40000
PQ_J4_SP:
    s_sleep 2
    buffer_load_dword v9, v8, s[44:47], s15 offen sc1
    s_waitcnt vmcnt(0)
    v_and_b32 v9, v9, v7
    v_cmp_ne_u32 vcc, v9, v7
    s_cbranch_vccz PQ_J4_OK
    s_sub_u32 s55, s55, 1
    s_cmp_lg_u32 s55, 0
    s_cbranch_scc1 PQ_J4_SP
PQ_J4_OK:
NQ_J4:
    s_mov_b32 m0, s63
    s_add_u32 s63, s63, 16384
    buffer_load_dwordx4 v2, s[44:47], s61 offen offset:0 sc1 lds
    buffer_load_dwordx4 v2, s[44:47], s61 offen offset:1024 sc1 lds
    buffer_load_dwordx4 v2, s[44:47], s61 offen offset:2048 sc1 lds
    buffer_load_dwordx4 v2, s[44:47], s61 offen offset:3072 sc1 lds
    s_add_u32 s61, s61, 16384
    s_and_b32 s63, s63, 0xffff
    s_or_b32 s63, s63, 0x10000
    s_mov_b32 m0, s62
    s_add_u32 s62, s62, 16384
    buffer_load_dwordx4 v2, s[44:47], s60 offen offset:0 sc1 lds
    buffer_load_dwordx4 v2, s[44:47], s60 offen offset:1024 sc1 lds
    buffer_load_dwordx4 v2, s[44:47], s60 offen offset:2048 sc1 lds
    buffer_load_dwordx4 v2, s[44:47], s60 offen offset:3072 sc1 lds
    s_add_u32 s60, s60, 16384
    s_and_b32 s62, s62, 0xffff
    s_sub_u32 s8, s65, 2
    s_cmp_ge_u32 s8, 2
    s_cbranch_scc1 NP_J4
    v_mov_b32 v24, 0x7fc17fc1
    v_mov_b32 v25, 0x7fc17fc1
    v_mov_b32 v26, 0x7fc17fc1
    v_mov_b32 v27, 0x7fc17fc1
    s_mul_i32 s8, s8, 20480
    s_add_u32 s8, s8, s13
    s_add_u32 s9, s8, 4096
    buffer_store_dwordx4 v[24:27], v2, s[44:47], s8 offen offset:0 sc1
    buffer_store_dwordx4 v[24:27], v2, s[44:47], s8 offen offset:1024 sc1
    buffer_store_dwordx4 v[24:27], v2, s[44:47], s8 offen offset:2048 sc1
    buffer_store_dwordx4 v[24:27], v2, s[44:47], s8 offen offset:3072 sc1
    buffer_store_dwordx4 v[24:27], v2, s[44:47], s9 offen offset:0 sc1
NP_J4:
    s_add_u32 s65, s65, 1
    s_sub_u32 s72, s67, s65
W12_J5:
    s_waitcnt vmcnt(8)
    s_barrier
    s_and_b32 s8, s65, 3
    s_cmp_eq_u32 s8, 2
    s_cbranch_scc1 CQ_J5
    s_cmp_lg_u32 s8, 1
    s_cbranch_scc1 NQ_J5
    buffer_load_dword v9, v8, s[44:47], s15 offen sc1
    s_lshl_b32 s8, s65, 8
    s_or_b32 s8, s8, s5
    s_cmp_lg_u32 s8, 2304
    s_cbranch_scc1 N9_J5
    v_mov_b32 v21, 0x100
    s_and_b32 s8, s2, 7
    s_lshl_b32 s8, s8, 5
    s_mov_b64 exec, 1
    buffer_atomic_add v21, off, s[48:51], s8
    s_mov_b64 exec, -1
    s_branch NQ_J5
N9_J5:
    s_branch NQ_J5
CQ_J5:
    s_add_u32 s8, s65, 6
    s_lshr_b32 s8, s8, 2
    s_sub_u32 s8, 7, s8
    v_cmp_eq_u32 vcc, s8, v1
    s_nop 1
    v_cndmask_b32 v7, 0, 1, vcc
    s_waitcnt vmcnt(8)
    v_and_b32 v9, v9, v7
    v_cmp_ne_u32 vcc, v9, v7
    s_cbranch_vccz PQ_J5_OK
    s_mov_b32 s55, 0x40000
PQ_J5_SP:
    s_sleep 2
    buffer_load_dword v9, v8, s[44:47], s15 offen sc1
    s_waitcnt vmcnt(0)
    v_and_b32 v9, v9, v7
    v_cmp_ne_u32 vcc, v9, v7
    s_cbranch_vccz PQ_J5_OK
    s_sub_u32 s55, s55, 1
    s_cmp_lg_u32 s55, 0
    s_cbranch_scc1 PQ_J5_SP
PQ_J5_OK:
NQ_J5:
    s_mov_b32 m0, s63
    s_add_u32 s63, s63, 16384
    buffer_load_dwordx4 v2, s[44:47], s61 offen offset:0 sc1 lds
    buffer_load_dwordx4 v2, s[44:47], s61 offen offset:1024 sc1 lds
    buffer_load_dwordx4 v2, s[44:47], s61 offen offset:2048 sc1 lds
    buffer_load_dwordx4 v2, s[44:47], s61 offen offset:3072 sc1 lds
    s_add_u32 s61, s61, 16384
    s_and_b32 s63, s63, 0xffff
    s_or_b32 s63, s63, 0x10000
    s_mov_b32 m0, s62
    s_add_u32 s62, s62, 16384
    buffer_load_dwordx4 v2, s[44:47], s60 offen offset:0 sc1 lds
    buffer_load_dwordx4 v2, s[44:47], s60 offen offset:1024 sc1 lds
    buffer_load_dwordx4 v2, s[44:47], s60 offen offset:2048 sc1 lds
    buffer_load_dwordx4 v2, s[44:47], s60 offen offset:3072 sc1 lds
    s_add_u32 s60, s60, 16384
    s_and_b32 s62, s62, 0xffff
    s_sub_u32 s8, s65, 2
    s_cmp_ge_u32 s8, 2
    s_cbranch_scc1 NP_J5
    v_mov_b32 v24, 0x7fc17fc1
    v_mov_b32 v25, 0x7fc17fc1
    v_mov_b32 v26, 0x7fc17fc1
    v_mov_b32 v27, 0x7fc17fc1
    s_mul_i32 s8, s8, 20480
    s_add_u32 s8, s8, s13
    s_add_u32 s9, s8, 4096
    buffer_store_dwordx4 v[24:27], v2, s[44:47], s8 offen offset:0 sc1
    buffer_store_dwordx4 v[24:27], v2, s[44:47], s8 offen offset:1024 sc1
    buffer_store_dwordx4 v[24:27], v2, s[44:47], s8 offen offset:2048 sc1
    buffer_store_dwordx4 v[24:27], v2, s[44:47], s8 offen offset:3072 sc1
    buffer_store_dwordx4 v[24:27], v2, s[44:47], s9 offen offset:0 sc1
NP_J5:
    s_cmp_lg_u32 s5, 0
    s_cbranch_scc1 A_LD
    v_mov_b32 v24, 0x10000
    s_and_b32 s8, s2, 7
    s_lshl_b32 s8, s8, 5
    s_mov_b64 exec, 1
    buffer_atomic_add v24, off, s[48:51], s8
    s_mov_b64 exec, -1
A_LD:
    s_add_u32 s65, s65, 1
    s_cmp_ge_u32 s65, s67
    s_cbranch_scc1 A_FIN
    s_sub_u32 s72, s67, s65
    s_cmp_ge_u32 s72, 2
    s_cbranch_scc1 W12_LD
    s_waitcnt vmcnt(4)
W12_LD:
    s_cmp_eq_u32 s65, 4
    s_cbranch_scc1 W22_LD
    s_waitcnt vmcnt(12)
W22_LD:
    s_waitcnt vmcnt(22)
    s_barrier
    s_cmp_lt_u32 s72, 3
    s_cbranch_scc1 NP_LD
    s_and_b32 s8, s65, 3
    s_cmp_eq_u32 s8, 2
    s_cbranch_scc1 CQ_LD
    s_cmp_lg_u32 s8, 1
    s_cbranch_scc1 NQ_LD
    buffer_load_dword v9, v8, s[44:47], s15 offen sc1
    s_lshl_b32 s8, s65, 8
    s_or_b32 s8, s8, s5
    s_cmp_lg_u32 s8, 2304
    s_cbranch_scc1 N9_LD
    v_mov_b32 v21, 0x100
    s_and_b32 s8, s2, 7
    s_lshl_b32 s8, s8, 5
    s_mov_b64 exec, 1
    buffer_atomic_add v21, off, s[48:51], s8
    s_mov_b64 exec, -1
    s_branch NQ_LD
N9_LD:
    s_cmp_lg_u32 s8, 256
    s_cbranch_scc1 NQ_LD
    s_lshl_b32 s8, s4, 2
    s_add_u32 s8, s8, s15
    s_add_u32 s8, s8, 4096
    v_mov_b32 v21, 1
    s_mov_b64 exec, 1
    buffer_store_dword v21, off, s[44:47], s8 sc1
    s_mov_b64 exec, -1
    s_branch NQ_LD
CQ_LD:
    s_add_u32 s8, s65, 6
    s_lshr_b32 s8, s8, 2
    s_sub_u32 s8, 7, s8
    v_cmp_eq_u32 vcc, s8, v1
    s_nop 1
    v_cndmask_b32 v7, 0, 1, vcc
    s_waitcnt vmcnt(8)
    v_and_b32 v9, v9, v7
    v_cmp_ne_u32 vcc, v9, v7
    s_cbranch_vccz PQ_LD_OK
    s_mov_b32 s55, 0x40000
PQ_LD_SP:
    s_sleep 2
    buffer_load_dword v9, v8, s[44:47], s15 offen sc1
    s_waitcnt vmcnt(0)
    v_and_b32 v9, v9, v7
    v_cmp_ne_u32 vcc, v9, v7
    s_cbranch_vccz PQ_LD_OK
    s_sub_u32 s55, s55, 1
    s_cmp_lg_u32 s55, 0
    s_cbranch_scc1 PQ_LD_SP
PQ_LD_OK:
NQ_LD:
    s_mov_b32 m0, s63
    s_add_u32 s63, s63, 16384
    buffer_load_dwordx4 v2, s[44:47], s61 offen offset:0 sc1 lds
    buffer_load_dwordx4 v2, s[44:47], s61 offen offset:1024 sc1 lds
    buffer_load_dwordx4 v2, s[44:47], s61 offen offset:2048 sc1 lds
    buffer_load_dwordx4 v2, s[44:47], s61 offen offset:3072 sc1 lds
    s_add_u32 s61, s61, 16384
    s_and_b32 s63, s63, 0xffff
    s_or_b32 s63, s63, 0x10000
    s_mov_b32 m0, s62
    s_add_u32 s62, s62, 16384
    buffer_load_dwordx4 v2, s[44:47], s60 offen offset:0 sc1 lds
    buffer_load_dwordx4 v2, s[44:47], s60 offen offset:1024 sc1 lds
    buffer_load_dwordx4 v2, s[44:47], s60 offen offset:2048 sc1 lds
    buffer_load_dwordx4 v2, s[44:47], s60 offen offset:3072 sc1 lds
    s_add_u32 s60, s60, 16384
    s_and_b32 s62, s62, 0xffff
    s_sub_u32 s8, s65, 2
    s_cmp_ge_u32 s8, 2
    s_cbranch_scc1 NP_LD
    v_mov_b32 v24, 0x7fc17fc1
    v_mov_b32 v25, 0x7fc17fc1
    v_mov_b32 v26, 0x7fc17fc1
    v_mov_b32 v27, 0x7fc17fc1
    s_mul_i32 s8, s8, 20480
    s_add_u32 s8, s8, s13
    s_add_u32 s9, s8, 4096
    buffer_store_dwordx4 v[24:27], v2, s[44:47], s8 offen offset:0 sc1
    buffer_store_dwordx4 v[24:27], v2, s[44:47], s8 offen offset:1024 sc1
    buffer_store_dwordx4 v[24:27], v2, s[44:47], s8 offen offset:2048 sc1
    buffer_store_dwordx4 v[24:27], v2, s[44:47], s8 offen offset:3072 sc1
    buffer_store_dwordx4 v[24:27], v2, s[44:47], s9 offen offset:0 sc1
NP_LD:
    s_cmp_ge_u32 s5, 2
    s_cbranch_scc1 A_LD
    s_cmp_eq_u32 s72, 3
    s_cbranch_scc0 A_N3
    s_waitcnt vmcnt(0)
    buffer_load_dword v4, v5, s[44:47], s14 offen sc1
    s_branch A_LD
A_N3:
    s_cmp_eq_u32 s72, 2
    s_cbranch_scc0 A_LD
    s_waitcnt vmcnt(0)
    v_and_b32 v4, v4, v6
    v_cmp_ne_u32 vcc, v4, v6
    s_cbranch_vccz P3A_OK
    s_mov_b32 s55, 0x40000
P3A_SP:
    s_sleep 2
    buffer_load_dword v4, v5, s[44:47], s14 offen sc1
    s_waitcnt vmcnt(0)
    v_and_b32 v4, v4, v6
    v_cmp_ne_u32 vcc, v4, v6
    s_cbranch_vccz P3A_OK
    s_sub_u32 s55, s55, 1
    s_cmp_lg_u32 s55, 0
    s_cbranch_scc1 P3A_SP
P3A_OK:
    s_mul_i32 s6, s3, 49152
    s_mul_i32 s8, s5, 3072
    s_add_u32 s6, s6, s8
    s_add_u32 s6, s6, 67108864
    buffer_load_dwordx4 v[56:59], v2, s[44:47], s6 offen offset:0 sc1
    buffer_load_dwordx4 v[60:63], v2, s[44:47], s6 offen offset:1024 sc1
    buffer_load_dwordx4 v[64:67], v2, s[44:47], s6 offen offset:2048 sc1
    s_add_u32 s6, s6, 6144
    buffer_load_dwordx4 v[68:71], v2, s[44:47], s6 offen offset:0 sc1
    buffer_load_dwordx4 v[72:75], v2, s[44:47], s6 offen offset:1024 sc1
    buffer_load_dwordx4 v[76:79], v2, s[44:47], s6 offen offset:2048 sc1
    s_add_u32 s6, s6, 6144
    buffer_load_dwordx4 v[80:83], v2, s[44:47], s6 offen offset:0 sc1
    buffer_load_dwordx4 v[84:87], v2, s[44:47], s6 offen offset:1024 sc1
    buffer_load_dwordx4 v[88:91], v2, s[44:47], s6 offen offset:2048 sc1
    s_add_u32 s6, s6, 6144
    buffer_load_dwordx4 v[92:95], v2, s[44:47], s6 offen offset:0 sc1
    buffer_load_dwordx4 v[96:99], v2, s[44:47], s6 offen offset:1024 sc1
    buffer_load_dwordx4 v[100:103], v2, s[44:47], s6 offen offset:2048 sc1
    s_add_u32 s6, s6, 6144
    buffer_load_dwordx4 v[104:107], v2, s[44:47], s6 offen offset:0 sc1
    buffer_load_dwordx4 v[108:111], v2, s[44:47], s6 offen offset:1024 sc1
    buffer_load_dwordx4 v[112:115], v2, s[44:47], s6 offen offset:2048 sc1
    s_add_u32 s6, s6, 6144
    buffer_load_dwordx4 v[116:119], v2, s[44:47], s6 offen offset:0 sc1
    buffer_load_dwordx4 v[120:123], v2, s[44:47], s6 offen offset:1024 sc1
    buffer_load_dwordx4 v[124:127], v2, s[44:47], s6 offen offset:2048 sc1
    s_add_u32 s6, s6, 6144
    buffer_load_dwordx4 v[128:131], v2, s[44:47], s6 offen offset:0 sc1
    buffer_load_dwordx4 v[132:135], v2, s[44:47], s6 offen offset:1024 sc1
    buffer_load_dwordx4 v[136:139], v2, s[44:47], s6 offen offset:2048 sc1
    s_add_u32 s6, s6, 6144
    buffer_load_dwordx4 v[140:143], v2, s[44:47], s6 offen offset:0 sc1
    buffer_load_dwordx4 v[144:147], v2, s[44:47], s6 offen offset:1024 sc1
    buffer_load_dwordx4 v[148:151], v2, s[44:47], s6 offen offset:2048 sc1
    s_waitcnt vmcnt(20)
    v_add_f32 v56, v56, v68
    v_add_f32 v57, v57, v69
    v_add_f32 v58, v58, v70
    v_add_f32 v59, v59, v71
    s_waitcnt vmcnt(19)
    v_add_f32 v60, v60, v72
    v_add_f32 v61, v61, v73
    v_add_f32 v62, v62, v74
    v_add_f32 v63, v63, v75
    s_waitcnt vmcnt(18)
    v_add_f32 v64, v64, v76
    v_add_f32 v65, v65, v77
    v_add_f32 v66, v66, v78
    v_add_f32 v67, v67, v79
    s_waitcnt vmcnt(17)
    v_add_f32 v56, v56, v80
    v_add_f32 v57, v57, v81
    v_add_f32 v58, v58, v82
    v_add_f32 v59, v59, v83
    s_waitcnt vmcnt(16)
    v_add_f32 v60, v60, v84
    v_add_f32 v61, v61, v85
    v_add_f32 v62, v62, v86
    v_add_f32 v63, v63, v87
    s_waitcnt vmcnt(15)
    v_add_f32 v64, v64, v88
    v_add_f32 v65, v65, v89
    v_add_f32 v66, v66, v90
    v_add_f32 v67, v67, v91
    s_waitcnt vmcnt(14)
    v_add_f32 v56, v56, v92
    v_add_f32 v57, v57, v93
    v_add_f32 v58, v58, v94
    v_add_f32 v59, v59, v95
    s_waitcnt vmcnt(13)
    v_add_f32 v60, v60, v96
    v_add_f32 v61, v61, v97
    v_add_f32 v62, v62, v98
    v_add_f32 v63, v63, v99
    s_waitcnt vmcnt(12)
    v_add_f32 v64, v64, v100
    v_add_f32 v65, v65, v101
    v_add_f32 v66, v66, v102
    v_add_f32 v67, v67, v103
    s_waitcnt vmcnt(11)
    v_add_f32 v56, v56, v104
    v_add_f32 v57, v57, v105
    v_add_f32 v58, v58, v106
    v_add_f32 v59, v59, v107
    s_waitcnt vmcnt(10)
    v_add_f32 v60, v60, v108
    v_add_f32 v61, v61, v109
    v_add_f32 v62, v62, v110
    v_add_f32 v63, v63, v111
    s_waitcnt vmcnt(9)
    v_add_f32 v64, v64, v112
    v_add_f32 v65, v65, v113
    v_add_f32 v66, v66, v114
    v_add_f32 v67, v67, v115
    s_waitcnt vmcnt(8)
    v_add_f32 v56, v56, v116
    v_add_f32 v57, v57, v117
    v_add_f32 v58, v58, v118
    v_add_f32 v59, v59, v119
    s_waitcnt vmcnt(7)
    v_add_f32 v60, v60, v120
    v_add_f32 v61, v61, v121
    v_add_f32 v62, v62, v122
    v_add_f32 v63, v63, v123
    s_waitcnt vmcnt(6)
    v_add_f32 v64, v64, v124
    v_add_f32 v65, v65, v125
    v_add_f32 v66, v66, v126
    v_add_f32 v67, v67, v127
    s_waitcnt vmcnt(5)
    v_add_f32 v56, v56, v128
    v_add_f32 v57, v57, v129
    v_add_f32 v58, v58, v130
    v_add_f32 v59, v59, v131
    s_waitcnt vmcnt(4)
    v_add_f32 v60, v60, v132
    v_add_f32 v61, v61, v133
    v_add_f32 v62, v62, v134
    v_add_f32 v63, v63, v135
    s_waitcnt vmcnt(3)
    v_add_f32 v64, v64, v136
    v_add_f32 v65, v65, v137
    v_add_f32 v66, v66, v138
    v_add_f32 v67, v67, v139
    s_waitcnt vmcnt(2)
    v_add_f32 v56, v56, v140
    v_add_f32 v57, v57, v141
    v_add_f32 v58, v58, v142
    v_add_f32 v59, v59, v143
    s_waitcnt vmcnt(1)
    v_add_f32 v60, v60, v144
    v_add_f32 v61, v61, v145
    v_add_f32 v62, v62, v146
    v_add_f32 v63, v63, v147
    s_waitcnt vmcnt(0)
    v_add_f32 v64, v64, v148
    v_add_f32 v65, v65, v149
    v_add_f32 v66, v66, v150
    v_add_f32 v67, v67, v151
    v_cvt_pk_bf16_f32 v24, v56, v57
    v_cvt_pk_bf16_f32 v25, v58, v59
    v_cvt_pk_bf16_f32 v26, v60, v61
    v_cvt_pk_bf16_f32 v27, v62, v63
    v_cvt_pk_bf16_f32 v28, v64, v65
    v_cvt_pk_bf16_f32 v29, v66, v67
    v_mov_b32 v30, 0
    v_mov_b32 v31, 0
    s_lshl_b32 s6, s5, 11
    s_add_u32 s6, s6, 149504
    v_add_u32 v21, s6, v2
    ds_write_b128 v21, v[24:27]
    ds_write_b128 v21, v[28:31] offset:1024
    s_waitcnt lgkmcnt(0)
    s_branch A_LD
A_FIN:
    s_waitcnt vmcnt(0)
    s_branch F_FIN
F_B:
    s_lshr_b32 s8, s2, 1
    s_and_b32 s9, s2, 1
    s_mul_i32 s9, s9, 9
    s_add_u32 s9, s9, s54
    v_lshrrev_b32 v20, 2, v1
    s_lshl_b32 s10, s8, 4
    v_add_u32 v20, s10, v20
    v_mul_u32_u24 v20, 1152, v20
    v_and_b32 v21, 3, v1
    v_lshl_add_u32 v20, v21, 4, v20
    v_and_b32 v127, 15, v1
    v_lshlrev_b32 v127, 4, v127
    v_lshrrev_b32 v21, 4, v1
    v_lshl_add_u32 v127, v21, 2, v127
    s_lshl_b32 s10, s9, 6
    v_add_u32 v112, s10, v20
    s_mul_i32 s8, s8, 18
    s_add_u32 s8, s8, s9
    s_lshl_b32 s8, s8, 10
    s_add_u32 s86, s8, 75497472
    s_lshr_b32 s8, s2, 1
    s_and_b32 s9, s2, 1
    s_mul_i32 s9, s9, 9
    s_add_u32 s9, s9, s54
    s_add_u32 s9, s9, 4
    v_lshrrev_b32 v20, 2, v1
    s_lshl_b32 s10, s8, 4
    v_add_u32 v20, s10, v20
    v_mul_u32_u24 v20, 1152, v20
    v_and_b32 v21, 3, v1
    v_lshl_add_u32 v20, v21, 4, v20
    s_lshl_b32 s10, s9, 6
    v_add_u32 v116, s10, v20
    s_mul_i32 s8, s8, 18
    s_add_u32 s8, s8, s9
    s_lshl_b32 s8, s8, 10
    s_add_u32 s87, s8, 75497472
    s_lshr_b32 s8, s2, 1
    s_and_b32 s9, s2, 1
    s_mul_i32 s9, s9, 9
    s_add_u32 s9, s9, 8
    v_lshrrev_b32 v20, 2, v1
    s_lshl_b32 s10, s8, 4
    v_add_u32 v20, s10, v20
    v_mul_u32_u24 v20, 1152, v20
    v_and_b32 v21, 3, v1
    v_lshl_add_u32 v20, v21, 4, v20
    s_lshl_b32 s10, s9, 6
    v_add_u32 v120, s10, v20
    s_mul_i32 s8, s8, 18
    s_add_u32 s8, s8, s9
    s_lshl_b32 s8, s8, 10
    s_add_u32 s88, s8, 75497472
    s_mul_i32 s8, s2, 9
    s_add_u32 s8, s8, s54
    s_lshr_b32 s9, s8, 2
    s_and_b32 s8, s8, 3
    s_lshl_b32 s8, s8, 3
    v_lshrrev_b32 v21, 3, v1
    v_add_u32 v21, s8, v21
    s_bfe_u32 s10, s9, 0x10001
    s_bfe_u32 s11, s9, 0x10003
    s_lshl_b32 s11, s11, 1
    s_or_b32 s10, s10, s11
    s_lshl_b32 s10, s10, 1
    v_and_b32 v22, 7, v1
    v_xor_b32 v23, s10, v22
    s_lshl_b32 s8, s9, 7
    s_add_u32 s8, s8, 79691776
    v_mul_u32_u24 v124, 73728, v21
    v_lshl_add_u32 v124, v23, 4, v124
    v_add_u32 v124, s8, v124
    s_mul_i32 s8, s9, 3456
    v_mul_u32_u24 v23, 36, v21
    v_add_u32 v93, s8, v23
    s_lshl_b32 s8, s9, 1
    v_mov_b32 v94, s8
    v_mov_b32 v95, v22
    v_mov_b32 v88, 0
    v_mov_b32 v89, 0
    v_mov_b32 v90, 0
    v_mov_b32 v91, 0
    v_lshrrev_b32 v21, 1, v22
    v_and_b32 v29, 1, v22
    v_lshl_add_u32 v23, v29, 4, v93
    v_mov_b32 v29, 2304
    v_cmp_eq_u32 vcc, 1, v21
    s_nop 1
    v_cndmask_b32 v29, 0, v29, vcc
    v_add_u32 v23, v23, v29
    v_mov_b32 v29, 1152
    v_cmp_eq_u32 vcc, 2, v21
    s_nop 1
    v_cndmask_b32 v29, 0, v29, vcc
    v_add_u32 v92, v23, v29
    s_mul_i32 s8, s2, 9
    s_add_u32 s8, s8, s54
    s_add_u32 s8, s8, 4
    s_lshr_b32 s9, s8, 2
    s_and_b32 s8, s8, 3
    s_lshl_b32 s8, s8, 3
    v_lshrrev_b32 v21, 3, v1
    v_add_u32 v21, s8, v21
    s_bfe_u32 s10, s9, 0x10001
    s_bfe_u32 s11, s9, 0x10003
    s_lshl_b32 s11, s11, 1
    s_or_b32 s10, s10, s11
    s_lshl_b32 s10, s10, 1
    v_and_b32 v22, 7, v1
    v_xor_b32 v23, s10, v22
    s_lshl_b32 s8, s9, 7
    s_add_u32 s8, s8, 79691776
    v_mul_u32_u24 v125, 73728, v21
    v_lshl_add_u32 v125, v23, 4, v125
    v_add_u32 v125, s8, v125
    s_mul_i32 s8, s9, 3456
    v_mul_u32_u24 v23, 36, v21
    v_add_u32 v101, s8, v23
    s_lshl_b32 s8, s9, 1
    v_mov_b32 v102, s8
    v_mov_b32 v103, v22
    v_mov_b32 v96, 0
    v_mov_b32 v97, 0
    v_mov_b32 v98, 0
    v_mov_b32 v99, 0
    v_lshrrev_b32 v21, 1, v22
    v_and_b32 v29, 1, v22
    v_lshl_add_u32 v23, v29, 4, v101
    v_mov_b32 v29, 2304
    v_cmp_eq_u32 vcc, 1, v21
    s_nop 1
    v_cndmask_b32 v29, 0, v29, vcc
    v_add_u32 v23, v23, v29
    v_mov_b32 v29, 1152
    v_cmp_eq_u32 vcc, 2, v21
    s_nop 1
    v_cndmask_b32 v29, 0, v29, vcc
    v_add_u32 v100, v23, v29
    s_mul_i32 s8, s2, 9
    s_add_u32 s8, s8, 8
    s_lshr_b32 s9, s8, 2
    s_and_b32 s8, s8, 3
    s_lshl_b32 s8, s8, 3
    v_lshrrev_b32 v21, 3, v1
    v_add_u32 v21, s8, v21
    s_bfe_u32 s10, s9, 0x10001
    s_bfe_u32 s11, s9, 0x10003
    s_lshl_b32 s11, s11, 1
    s_or_b32 s10, s10, s11
    s_lshl_b32 s10, s10, 1
    v_and_b32 v22, 7, v1
    v_xor_b32 v23, s10, v22
    s_lshl_b32 s8, s9, 7
    s_add_u32 s8, s8, 79691776
    v_mul_u32_u24 v126, 73728, v21
    v_lshl_add_u32 v126, v23, 4, v126
    v_add_u32 v126, s8, v126
    s_mul_i32 s8, s9, 3456
    v_mul_u32_u24 v23, 36, v21
    v_add_u32 v109, s8, v23
    s_lshl_b32 s8, s9, 1
    v_mov_b32 v110, s8
    v_mov_b32 v111, v22
    v_mov_b32 v104, 0
    v_mov_b32 v105, 0
    v_mov_b32 v106, 0
    v_mov_b32 v107, 0
    v_lshrrev_b32 v21, 1, v22
    v_and_b32 v29, 1, v22
    v_lshl_add_u32 v23, v29, 4, v109
    v_mov_b32 v29, 2304
    v_cmp_eq_u32 vcc, 1, v21
    s_nop 1
    v_cndmask_b32 v29, 0, v29, vcc
    v_add_u32 v23, v23, v29
    v_mov_b32 v29, 1152
    v_cmp_eq_u32 vcc, 2, v21
    s_nop 1
    v_cndmask_b32 v29, 0, v29, vcc
    v_add_u32 v108, v23, v29
    s_cmp_lg_u32 s5, 4
    s_cbranch_scc1 F_Z4
    buffer_load_dwordx4 v[120:123], v120, s[64:67], 0 offen
    v_cmp_eq_u32 vcc, 6, v111
    v_cmp_gt_u32 s[8:9], 6, v111
    s_mov_b64 exec, vcc
    buffer_load_ushort v107, v110, s[72:75], 0 offen
    buffer_load_dword v104, v109, s[68:71], 0 offen offset:32
    buffer_load_dword v105, v109, s[68:71], 0 offen offset:1184
    buffer_load_dword v106, v109, s[68:71], 0 offen offset:2336
    s_mov_b64 exec, s[8:9]
    buffer_load_dwordx4 v[104:107], v108, s[68:71], 0 offen
    s_mov_b64 exec, -1
F_Z4:
    buffer_load_dwordx4 v[112:115], v112, s[64:67], 0 offen
    buffer_load_dwordx4 v[116:119], v116, s[64:67], 0 offen
    v_cmp_eq_u32 vcc, 6, v95
    v_cmp_gt_u32 s[8:9], 6, v95
    s_mov_b64 exec, vcc
    buffer_load_ushort v91, v94, s[72:75], 0 offen
    buffer_load_dword v88, v93, s[68:71], 0 offen offset:32
    buffer_load_dword v89, v93, s[68:71], 0 offen offset:1184
    buffer_load_dword v90, v93, s[68:71], 0 offen offset:2336
    s_mov_b64 exec, s[8:9]
    buffer_load_dwordx4 v[88:91], v92, s[68:71], 0 offen
    s_mov_b64 exec, -1
    v_cmp_eq_u32 vcc, 6, v103
    v_cmp_gt_u32 s[8:9], 6, v103
    s_mov_b64 exec, vcc
    buffer_load_ushort v99, v102, s[72:75], 0 offen
    buffer_load_dword v96, v101, s[68:71], 0 offen offset:32
    buffer_load_dword v97, v101, s[68:71], 0 offen offset:1184
    buffer_load_dword v98, v101, s[68:71], 0 offen offset:2336
    s_mov_b64 exec, s[8:9]
    buffer_load_dwordx4 v[96:99], v100, s[68:71], 0 offen
    s_mov_b64 exec, -1
    s_waitcnt vmcnt(26)
    s_barrier
    ds_read_b128 v[56:59], v15 offset:0
    ds_read_b128 v[60:63], v15 offset:2048
    ds_read_b128 v[64:67], v15 offset:4096
    ds_read_b128 v[68:71], v15 offset:6144
    ds_read_b64_tr_b16 v[32:33], v4 offset:0
    ds_read_b64_tr_b16 v[34:35], v4 offset:1024
    ds_read_b64_tr_b16 v[36:37], v5 offset:0
    ds_read_b64_tr_b16 v[38:39], v5 offset:1024
    ds_read_b64_tr_b16 v[40:41], v6 offset:0
    ds_read_b64_tr_b16 v[42:43], v6 offset:1024
    ds_read_b64_tr_b16 v[44:45], v7 offset:0
    ds_read_b64_tr_b16 v[46:47], v7 offset:1024
    s_waitcnt lgkmcnt(6)
    v_mfma_f32_16x16x32_bf16 v[128:131], v[56:59], v[32:35], 0
    ds_read_b64_tr_b16 v[48:49], v8 offset:0
    v_mfma_f32_16x16x32_bf16 v[132:135], v[60:63], v[32:35], 0
    ds_read_b64_tr_b16 v[50:51], v8 offset:1024
    v_mfma_f32_16x16x32_bf16 v[136:139], v[64:67], v[32:35], 0
    v_mfma_f32_16x16x32_bf16 v[140:143], v[68:71], v[32:35], 0
    s_waitcnt lgkmcnt(6)
    v_mfma_f32_16x16x32_bf16 v[144:147], v[56:59], v[36:39], 0
    ds_read_b64_tr_b16 v[52:53], v9 offset:0
    v_mfma_f32_16x16x32_bf16 v[148:151], v[60:63], v[36:39], 0
    ds_read_b64_tr_b16 v[54:55], v9 offset:1024
    v_mfma_f32_16x16x32_bf16 v[152:155], v[64:67], v[36:39], 0
    v_mfma_f32_16x16x32_bf16 v[156:159], v[68:71], v[36:39], 0
    s_waitcnt lgkmcnt(6)
    v_mfma_f32_16x16x32_bf16 v[160:163], v[56:59], v[40:43], 0
    ds_read_b64_tr_b16 v[32:33], v10 offset:0
    v_mfma_f32_16x16x32_bf16 v[164:167], v[60:63], v[40:43], 0
    ds_read_b64_tr_b16 v[34:35], v10 offset:1024
    v_mfma_f32_16x16x32_bf16 v[168:171], v[64:67], v[40:43], 0
    v_mfma_f32_16x16x32_bf16 v[172:175], v[68:71], v[40:43], 0
    s_waitcnt lgkmcnt(6)
    v_mfma_f32_16x16x32_bf16 v[176:179], v[56:59], v[44:47], 0
    ds_read_b64_tr_b16 v[36:37], v11 offset:0
    v_mfma_f32_16x16x32_bf16 v[180:183], v[60:63], v[44:47], 0
    ds_read_b64_tr_b16 v[38:39], v11 offset:1024
    v_mfma_f32_16x16x32_bf16 v[184:187], v[64:67], v[44:47], 0
    v_mfma_f32_16x16x32_bf16 v[188:191], v[68:71], v[44:47], 0
    s_waitcnt lgkmcnt(6)
    v_mfma_f32_16x16x32_bf16 v[192:195], v[56:59], v[48:51], 0
    s_waitcnt vmcnt(24)
    s_barrier
    ds_read_b64_tr_b16 v[40:41], v4 offset:16384
    v_mfma_f32_16x16x32_bf16 v[196:199], v[60:63], v[48:51], 0
    ds_read_b64_tr_b16 v[42:43], v4 offset:17408
    v_mfma_f32_16x16x32_bf16 v[200:203], v[64:67], v[48:51], 0
    ds_read_b128 v[72:75], v16 offset:0
    v_mfma_f32_16x16x32_bf16 v[204:207], v[68:71], v[48:51], 0
    s_waitcnt lgkmcnt(7)
    v_mfma_f32_16x16x32_bf16 v[208:211], v[56:59], v[52:55], 0
    ds_read_b64_tr_b16 v[44:45], v5 offset:16384
    v_mfma_f32_16x16x32_bf16 v[212:215], v[60:63], v[52:55], 0
    ds_read_b64_tr_b16 v[46:47], v5 offset:17408
    v_mfma_f32_16x16x32_bf16 v[216:219], v[64:67], v[52:55], 0
    ds_read_b128 v[76:79], v16 offset:2048
    v_mfma_f32_16x16x32_bf16 v[220:223], v[68:71], v[52:55], 0
    s_waitcnt lgkmcnt(8)
    v_mfma_f32_16x16x32_bf16 v[224:227], v[56:59], v[32:35], 0
    ds_read_b64_tr_b16 v[48:49], v6 offset:16384
    v_mfma_f32_16x16x32_bf16 v[228:231], v[60:63], v[32:35], 0
    ds_read_b64_tr_b16 v[50:51], v6 offset:17408
    v_mfma_f32_16x16x32_bf16 v[232:235], v[64:67], v[32:35], 0
    ds_read_b128 v[80:83], v16 offset:4096
    v_mfma_f32_16x16x32_bf16 v[236:239], v[68:71], v[32:35], 0
    s_waitcnt lgkmcnt(9)
    v_mfma_f32_16x16x32_bf16 v[240:243], v[56:59], v[36:39], 0
    ds_read_b64_tr_b16 v[52:53], v7 offset:16384
    v_mfma_f32_16x16x32_bf16 v[244:247], v[60:63], v[36:39], 0
    ds_read_b64_tr_b16 v[54:55], v7 offset:17408
    v_mfma_f32_16x16x32_bf16 v[248:251], v[64:67], v[36:39], 0
    ds_read_b128 v[84:87], v16 offset:6144
    v_mfma_f32_16x16x32_bf16 v[252:255], v[68:71], v[36:39], 0
    s_waitcnt lgkmcnt(9)
    v_mfma_f32_16x16x32_bf16 v[128:131], v[72:75], v[40:43], v[128:131]
    ds_read_b64_tr_b16 v[32:33], v8 offset:16384
    s_waitcnt lgkmcnt(7)
    v_mfma_f32_16x16x32_bf16 v[132:135], v[76:79], v[40:43], v[132:135]
    ds_read_b64_tr_b16 v[34:35], v8 offset:17408
    s_waitcnt lgkmcnt(5)
    v_mfma_f32_16x16x32_bf16 v[136:139], v[80:83], v[40:43], v[136:139]
    s_waitcnt lgkmcnt(2)
    v_mfma_f32_16x16x32_bf16 v[140:143], v[84:87], v[40:43], v[140:143]
    v_mfma_f32_16x16x32_bf16 v[144:147], v[72:75], v[44:47], v[144:147]
    ds_read_b64_tr_b16 v[36:37], v9 offset:16384
    v_mfma_f32_16x16x32_bf16 v[148:151], v[76:79], v[44:47], v[148:151]
    ds_read_b64_tr_b16 v[38:39], v9 offset:17408
    v_mfma_f32_16x16x32_bf16 v[152:155], v[80:83], v[44:47], v[152:155]
    v_mfma_f32_16x16x32_bf16 v[156:159], v[84:87], v[44:47], v[156:159]
    v_mfma_f32_16x16x32_bf16 v[160:163], v[72:75], v[48:51], v[160:163]
    ds_read_b64_tr_b16 v[40:41], v10 offset:16384
    v_mfma_f32_16x16x32_bf16 v[164:167], v[76:79], v[48:51], v[164:167]
    ds_read_b64_tr_b16 v[42:43], v10 offset:17408
    v_mfma_f32_16x16x32_bf16 v[168:171], v[80:83], v[48:51], v[168:171]
    v_mfma_f32_16x16x32_bf16 v[172:175], v[84:87], v[48:51], v[172:175]
    v_mfma_f32_16x16x32_bf16 v[176:179], v[72:75], v[52:55], v[176:179]
    ds_read_b64_tr_b16 v[44:45], v11 offset:16384
    v_mfma_f32_16x16x32_bf16 v[180:183], v[76:79], v[52:55], v[180:183]
    ds_read_b64_tr_b16 v[46:47], v11 offset:17408
    v_mfma_f32_16x16x32_bf16 v[184:187], v[80:83], v[52:55], v[184:187]
    v_mfma_f32_16x16x32_bf16 v[188:191], v[84:87], v[52:55], v[188:191]
    s_waitcnt lgkmcnt(6)
    v_mfma_f32_16x16x32_bf16 v[192:195], v[72:75], v[32:35], v[192:195]
    s_waitcnt vmcnt(18)
    s_barrier
    ds_read_b64_tr_b16 v[48:49], v4 offset:32768
    v_mfma_f32_16x16x32_bf16 v[196:199], v[76:79], v[32:35], v[196:199]
    ds_read_b64_tr_b16 v[50:51], v4 offset:33792
    v_mfma_f32_16x16x32_bf16 v[200:203], v[80:83], v[32:35], v[200:203]
    ds_read_b128 v[56:59], v15 offset:32768
    v_mfma_f32_16x16x32_bf16 v[204:207], v[84:87], v[32:35], v[204:207]
    s_waitcnt lgkmcnt(7)
    v_mfma_f32_16x16x32_bf16 v[208:211], v[72:75], v[36:39], v[208:211]
    ds_read_b64_tr_b16 v[52:53], v5 offset:32768
    v_mfma_f32_16x16x32_bf16 v[212:215], v[76:79], v[36:39], v[212:215]
    ds_read_b64_tr_b16 v[54:55], v5 offset:33792
    v_mfma_f32_16x16x32_bf16 v[216:219], v[80:83], v[36:39], v[216:219]
    ds_read_b128 v[60:63], v15 offset:34816
    v_mfma_f32_16x16x32_bf16 v[220:223], v[84:87], v[36:39], v[220:223]
    s_waitcnt lgkmcnt(8)
    v_mfma_f32_16x16x32_bf16 v[224:227], v[72:75], v[40:43], v[224:227]
    ds_read_b64_tr_b16 v[32:33], v6 offset:32768
    v_mfma_f32_16x16x32_bf16 v[228:231], v[76:79], v[40:43], v[228:231]
    ds_read_b64_tr_b16 v[34:35], v6 offset:33792
    v_mfma_f32_16x16x32_bf16 v[232:235], v[80:83], v[40:43], v[232:235]
    ds_read_b128 v[64:67], v15 offset:36864
    v_mfma_f32_16x16x32_bf16 v[236:239], v[84:87], v[40:43], v[236:239]
    s_waitcnt lgkmcnt(9)
    v_mfma_f32_16x16x32_bf16 v[240:243], v[72:75], v[44:47], v[240:243]
    ds_read_b64_tr_b16 v[36:37], v7 offset:32768
    v_mfma_f32_16x16x32_bf16 v[244:247], v[76:79], v[44:47], v[244:247]
    ds_read_b64_tr_b16 v[38:39], v7 offset:33792
    v_mfma_f32_16x16x32_bf16 v[248:251], v[80:83], v[44:47], v[248:251]
    ds_read_b128 v[68:71], v15 offset:38912
    v_mfma_f32_16x16x32_bf16 v[252:255], v[84:87], v[44:47], v[252:255]
    s_waitcnt lgkmcnt(9)
    v_mfma_f32_16x16x32_bf16 v[128:131], v[56:59], v[48:51], v[128:131]
    ds_read_b64_tr_b16 v[40:41], v8 offset:32768
    s_waitcnt lgkmcnt(7)
    v_mfma_f32_16x16x32_bf16 v[132:135], v[60:63], v[48:51], v[132:135]
    ds_read_b64_tr_b16 v[42:43], v8 offset:33792
    s_waitcnt lgkmcnt(5)
    v_mfma_f32_16x16x32_bf16 v[136:139], v[64:67], v[48:51], v[136:139]
    s_waitcnt lgkmcnt(2)
    v_mfma_f32_16x16x32_bf16 v[140:143], v[68:71], v[48:51], v[140:143]
    v_mfma_f32_16x16x32_bf16 v[144:147], v[56:59], v[52:55], v[144:147]
    ds_read_b64_tr_b16 v[44:45], v9 offset:32768
    v_mfma_f32_16x16x32_bf16 v[148:151], v[60:63], v[52:55], v[148:151]
    ds_read_b64_tr_b16 v[46:47], v9 offset:33792
    v_mfma_f32_16x16x32_bf16 v[152:155], v[64:67], v[52:55], v[152:155]
    v_mfma_f32_16x16x32_bf16 v[156:159], v[68:71], v[52:55], v[156:159]
    v_mfma_f32_16x16x32_bf16 v[160:163], v[56:59], v[32:35], v[160:163]
    ds_read_b64_tr_b16 v[48:49], v10 offset:32768
    v_mfma_f32_16x16x32_bf16 v[164:167], v[60:63], v[32:35], v[164:167]
    ds_read_b64_tr_b16 v[50:51], v10 offset:33792
    v_mfma_f32_16x16x32_bf16 v[168:171], v[64:67], v[32:35], v[168:171]
    v_mfma_f32_16x16x32_bf16 v[172:175], v[68:71], v[32:35], v[172:175]
    v_mfma_f32_16x16x32_bf16 v[176:179], v[56:59], v[36:39], v[176:179]
    ds_read_b64_tr_b16 v[52:53], v11 offset:32768
    v_mfma_f32_16x16x32_bf16 v[180:183], v[60:63], v[36:39], v[180:183]
    ds_read_b64_tr_b16 v[54:55], v11 offset:33792
    v_mfma_f32_16x16x32_bf16 v[184:187], v[64:67], v[36:39], v[184:187]
    v_mfma_f32_16x16x32_bf16 v[188:191], v[68:71], v[36:39], v[188:191]
    s_waitcnt lgkmcnt(6)
    v_mfma_f32_16x16x32_bf16 v[192:195], v[56:59], v[40:43], v[192:195]
    s_waitcnt vmcnt(16)
    s_barrier
    ds_read_b64_tr_b16 v[32:33], v4 offset:49152
    v_mfma_f32_16x16x32_bf16 v[196:199], v[60:63], v[40:43], v[196:199]
    ds_read_b64_tr_b16 v[34:35], v4 offset:50176
    v_mfma_f32_16x16x32_bf16 v[200:203], v[64:67], v[40:43], v[200:203]
    ds_read_b128 v[72:75], v16 offset:32768
    v_mfma_f32_16x16x32_bf16 v[204:207], v[68:71], v[40:43], v[204:207]
    s_waitcnt lgkmcnt(7)
    v_mfma_f32_16x16x32_bf16 v[208:211], v[56:59], v[44:47], v[208:211]
    ds_read_b64_tr_b16 v[36:37], v5 offset:49152
    v_mfma_f32_16x16x32_bf16 v[212:215], v[60:63], v[44:47], v[212:215]
    ds_read_b64_tr_b16 v[38:39], v5 offset:50176
    v_mfma_f32_16x16x32_bf16 v[216:219], v[64:67], v[44:47], v[216:219]
    ds_read_b128 v[76:79], v16 offset:34816
    v_mfma_f32_16x16x32_bf16 v[220:223], v[68:71], v[44:47], v[220:223]
    s_waitcnt lgkmcnt(8)
    v_mfma_f32_16x16x32_bf16 v[224:227], v[56:59], v[48:51], v[224:227]
    ds_read_b64_tr_b16 v[40:41], v6 offset:49152
    v_mfma_f32_16x16x32_bf16 v[228:231], v[60:63], v[48:51], v[228:231]
    ds_read_b64_tr_b16 v[42:43], v6 offset:50176
    v_mfma_f32_16x16x32_bf16 v[232:235], v[64:67], v[48:51], v[232:235]
    ds_read_b128 v[80:83], v16 offset:36864
    v_mfma_f32_16x16x32_bf16 v[236:239], v[68:71], v[48:51], v[236:239]
    s_waitcnt lgkmcnt(9)
    v_mfma_f32_16x16x32_bf16 v[240:243], v[56:59], v[52:55], v[240:243]
    ds_read_b64_tr_b16 v[44:45], v7 offset:49152
    v_mfma_f32_16x16x32_bf16 v[244:247], v[60:63], v[52:55], v[244:247]
    ds_read_b64_tr_b16 v[46:47], v7 offset:50176
    v_mfma_f32_16x16x32_bf16 v[248:251], v[64:67], v[52:55], v[248:251]
    ds_read_b128 v[84:87], v16 offset:38912
    v_mfma_f32_16x16x32_bf16 v[252:255], v[68:71], v[52:55], v[252:255]
    s_waitcnt lgkmcnt(9)
    v_mfma_f32_16x16x32_bf16 v[128:131], v[72:75], v[32:35], v[128:131]
    ds_read_b64_tr_b16 v[48:49], v8 offset:49152
    s_waitcnt lgkmcnt(7)
    v_mfma_f32_16x16x32_bf16 v[132:135], v[76:79], v[32:35], v[132:135]
    ds_read_b64_tr_b16 v[50:51], v8 offset:50176
    s_waitcnt lgkmcnt(5)
    v_mfma_f32_16x16x32_bf16 v[136:139], v[80:83], v[32:35], v[136:139]
    s_waitcnt lgkmcnt(2)
    v_mfma_f32_16x16x32_bf16 v[140:143], v[84:87], v[32:35], v[140:143]
    v_mfma_f32_16x16x32_bf16 v[144:147], v[72:75], v[36:39], v[144:147]
    ds_read_b64_tr_b16 v[52:53], v9 offset:49152
    s_waitcnt vmcnt(0)
    buffer_store_dwordx4 v[96:99], v125, s[44:47], 0 offen sc1
    v_mfma_f32_16x16x32_bf16 v[148:151], v[76:79], v[36:39], v[148:151]
    ds_read_b64_tr_b16 v[54:55], v9 offset:50176
    v_mfma_f32_16x16x32_bf16 v[152:155], v[80:83], v[36:39], v[152:155]
    s_cmp_lg_u32 s5, 4
    s_cbranch_scc1 F_Y4
    ds_bpermute_b32 v120, v127, v120
    ds_bpermute_b32 v121, v127, v121
    ds_bpermute_b32 v122, v127, v122
    ds_bpermute_b32 v123, v127, v123
    s_waitcnt lgkmcnt(0)
    buffer_store_dwordx4 v[120:123], v2, s[44:47], s88 offen sc1
    buffer_store_dwordx4 v[104:107], v126, s[44:47], 0 offen sc1
F_Y4:
    v_mfma_f32_16x16x32_bf16 v[156:159], v[84:87], v[36:39], v[156:159]
    v_mfma_f32_16x16x32_bf16 v[160:163], v[72:75], v[40:43], v[160:163]
    ds_read_b64_tr_b16 v[32:33], v10 offset:49152
    ds_bpermute_b32 v112, v127, v112
    ds_bpermute_b32 v113, v127, v113
    ds_bpermute_b32 v114, v127, v114
    ds_bpermute_b32 v115, v127, v115
    s_waitcnt lgkmcnt(0)
    buffer_store_dwordx4 v[112:115], v2, s[44:47], s86 offen sc1
    v_mfma_f32_16x16x32_bf16 v[164:167], v[76:79], v[40:43], v[164:167]
    ds_read_b64_tr_b16 v[34:35], v10 offset:50176
    v_mfma_f32_16x16x32_bf16 v[168:171], v[80:83], v[40:43], v[168:171]
    ds_bpermute_b32 v116, v127, v116
    ds_bpermute_b32 v117, v127, v117
    ds_bpermute_b32 v118, v127, v118
    ds_bpermute_b32 v119, v127, v119
    s_waitcnt lgkmcnt(0)
    buffer_store_dwordx4 v[116:119], v2, s[44:47], s87 offen sc1
    v_mfma_f32_16x16x32_bf16 v[172:175], v[84:87], v[40:43], v[172:175]
    v_mfma_f32_16x16x32_bf16 v[176:179], v[72:75], v[44:47], v[176:179]
    ds_read_b64_tr_b16 v[36:37], v11 offset:49152
    buffer_store_dwordx4 v[88:91], v124, s[44:47], 0 offen sc1
    v_mfma_f32_16x16x32_bf16 v[180:183], v[76:79], v[44:47], v[180:183]
    ds_read_b64_tr_b16 v[38:39], v11 offset:50176
    v_mfma_f32_16x16x32_bf16 v[184:187], v[80:83], v[44:47], v[184:187]
    v_mfma_f32_16x16x32_bf16 v[188:191], v[84:87], v[44:47], v[188:191]
    v_mfma_f32_16x16x32_bf16 v[192:195], v[72:75], v[48:51], v[192:195]
    s_barrier
    ds_read_b64_tr_b16 v[40:41], v4 offset:0
    v_mfma_f32_16x16x32_bf16 v[196:199], v[76:79], v[48:51], v[196:199]
    ds_read_b64_tr_b16 v[42:43], v4 offset:1024
    v_mfma_f32_16x16x32_bf16 v[200:203], v[80:83], v[48:51], v[200:203]
    ds_read_b128 v[56:59], v17 offset:0
    v_mfma_f32_16x16x32_bf16 v[204:207], v[84:87], v[48:51], v[204:207]
    v_mfma_f32_16x16x32_bf16 v[208:211], v[72:75], v[52:55], v[208:211]
    ds_read_b64_tr_b16 v[44:45], v5 offset:0
    v_mfma_f32_16x16x32_bf16 v[212:215], v[76:79], v[52:55], v[212:215]
    ds_read_b64_tr_b16 v[46:47], v5 offset:1024
    v_mfma_f32_16x16x32_bf16 v[216:219], v[80:83], v[52:55], v[216:219]
    ds_read_b128 v[60:63], v17 offset:2048
    s_lshr_b32 s8, s2, 3
    s_lshl_b32 s8, s8, 2
    s_add_u32 s8, s8, s54
    s_add_u32 s8, s8, 0
    s_lshl_b32 s8, s8, 15
    v_and_b32 v24, 1, v1
    v_lshlrev_b32 v24, 7, v24
    v_lshrrev_b32 v25, 4, v1
    v_lshl_add_u32 v24, v25, 13, v24
    v_bfe_u32 v25, v1, 2, 2
    v_lshl_add_u32 v24, v25, 8, v24
    s_and_b32 s11, s2, 7
    s_lshl_b32 s11, s11, 10
    v_add_u32 v24, s11, v24
    buffer_load_dword v29, v24, s[92:95], s8 offen
    v_mfma_f32_16x16x32_bf16 v[220:223], v[84:87], v[52:55], v[220:223]
    v_mfma_f32_16x16x32_bf16 v[224:227], v[72:75], v[32:35], v[224:227]
    ds_read_b64_tr_b16 v[48:49], v6 offset:0
    v_mfma_f32_16x16x32_bf16 v[228:231], v[76:79], v[32:35], v[228:231]
    ds_read_b64_tr_b16 v[50:51], v6 offset:1024
    v_mfma_f32_16x16x32_bf16 v[232:235], v[80:83], v[32:35], v[232:235]
    ds_read_b128 v[64:67], v17 offset:4096
    v_mfma_f32_16x16x32_bf16 v[236:239], v[84:87], v[32:35], v[236:239]
    s_waitcnt lgkmcnt(9)
    v_mfma_f32_16x16x32_bf16 v[240:243], v[72:75], v[36:39], v[240:243]
    ds_read_b64_tr_b16 v[52:53], v7 offset:0
    v_mfma_f32_16x16x32_bf16 v[244:247], v[76:79], v[36:39], v[244:247]
    ds_read_b64_tr_b16 v[54:55], v7 offset:1024
    v_mfma_f32_16x16x32_bf16 v[248:251], v[80:83], v[36:39], v[248:251]
    ds_read_b128 v[68:71], v17 offset:6144
    s_cmp_ge_u32 s2, 32
    s_cbranch_scc1 F_TQ
    s_lshr_b32 s8, s2, 3
    s_lshl_b32 s8, s8, 2
    s_add_u32 s8, s8, s54
    s_add_u32 s8, s8, 128
    s_lshl_b32 s8, s8, 15
    v_and_b32 v24, 1, v1
    v_lshlrev_b32 v24, 7, v24
    v_lshrrev_b32 v25, 4, v1
    v_lshl_add_u32 v24, v25, 13, v24
    v_bfe_u32 v25, v1, 2, 2
    v_lshl_add_u32 v24, v25, 8, v24
    s_and_b32 s11, s2, 7
    s_lshl_b32 s11, s11, 10
    v_add_u32 v24, s11, v24
    buffer_load_dword v19, v24, s[92:95], s8 offen
F_TQ:
    v_mfma_f32_16x16x32_bf16 v[252:255], v[84:87], v[36:39], v[252:255]
    s_waitcnt lgkmcnt(9)
    v_mfma_f32_16x16x32_bf16 v[128:131], v[56:59], v[40:43], v[128:131]
    ds_read_b64_tr_b16 v[32:33], v8 offset:0
    s_waitcnt lgkmcnt(7)
    v_mfma_f32_16x16x32_bf16 v[132:135], v[60:63], v[40:43], v[132:135]
    ds_read_b64_tr_b16 v[34:35], v8 offset:1024
    s_waitcnt lgkmcnt(5)
    v_mfma_f32_16x16x32_bf16 v[136:139], v[64:67], v[40:43], v[136:139]
    s_waitcnt lgkmcnt(2)
    v_mfma_f32_16x16x32_bf16 v[140:143], v[68:71], v[40:43], v[140:143]
    v_mfma_f32_16x16x32_bf16 v[144:147], v[56:59], v[44:47], v[144:147]
    ds_read_b64_tr_b16 v[36:37], v9 offset:0
    v_mfma_f32_16x16x32_bf16 v[148:151], v[60:63], v[44:47], v[148:151]
    ds_read_b64_tr_b16 v[38:39], v9 offset:1024
    v_mfma_f32_16x16x32_bf16 v[152:155], v[64:67], v[44:47], v[152:155]
    v_mfma_f32_16x16x32_bf16 v[156:159], v[68:71], v[44:47], v[156:159]
    v_mfma_f32_16x16x32_bf16 v[160:163], v[56:59], v[48:51], v[160:163]
    ds_read_b64_tr_b16 v[40:41], v10 offset:0
    v_mfma_f32_16x16x32_bf16 v[164:167], v[60:63], v[48:51], v[164:167]
    ds_read_b64_tr_b16 v[42:43], v10 offset:1024
    v_mfma_f32_16x16x32_bf16 v[168:171], v[64:67], v[48:51], v[168:171]
    v_mfma_f32_16x16x32_bf16 v[172:175], v[68:71], v[48:51], v[172:175]
    v_mfma_f32_16x16x32_bf16 v[176:179], v[56:59], v[52:55], v[176:179]
    ds_read_b64_tr_b16 v[44:45], v11 offset:0
    v_mfma_f32_16x16x32_bf16 v[180:183], v[60:63], v[52:55], v[180:183]
    ds_read_b64_tr_b16 v[46:47], v11 offset:1024
    v_mfma_f32_16x16x32_bf16 v[184:187], v[64:67], v[52:55], v[184:187]
    v_mfma_f32_16x16x32_bf16 v[188:191], v[68:71], v[52:55], v[188:191]
    s_waitcnt lgkmcnt(6)
    v_mfma_f32_16x16x32_bf16 v[192:195], v[56:59], v[32:35], v[192:195]
    s_barrier
    ds_read_b64_tr_b16 v[48:49], v4 offset:16384
    v_mfma_f32_16x16x32_bf16 v[196:199], v[60:63], v[32:35], v[196:199]
    ds_read_b64_tr_b16 v[50:51], v4 offset:17408
    v_mfma_f32_16x16x32_bf16 v[200:203], v[64:67], v[32:35], v[200:203]
    ds_read_b128 v[72:75], v18 offset:0
    v_mfma_f32_16x16x32_bf16 v[204:207], v[68:71], v[32:35], v[204:207]
    s_waitcnt lgkmcnt(7)
    v_mfma_f32_16x16x32_bf16 v[208:211], v[56:59], v[36:39], v[208:211]
    ds_read_b64_tr_b16 v[52:53], v5 offset:16384
    v_mfma_f32_16x16x32_bf16 v[212:215], v[60:63], v[36:39], v[212:215]
    ds_read_b64_tr_b16 v[54:55], v5 offset:17408
    v_mfma_f32_16x16x32_bf16 v[216:219], v[64:67], v[36:39], v[216:219]
    ds_read_b128 v[76:79], v18 offset:2048
    v_mfma_f32_16x16x32_bf16 v[220:223], v[68:71], v[36:39], v[220:223]
    s_waitcnt lgkmcnt(8)
    v_mfma_f32_16x16x32_bf16 v[224:227], v[56:59], v[40:43], v[224:227]
    ds_read_b64_tr_b16 v[32:33], v6 offset:16384
    v_mfma_f32_16x16x32_bf16 v[228:231], v[60:63], v[40:43], v[228:231]
    ds_read_b64_tr_b16 v[34:35], v6 offset:17408
    v_mfma_f32_16x16x32_bf16 v[232:235], v[64:67], v[40:43], v[232:235]
    ds_read_b128 v[80:83], v18 offset:4096
    v_mfma_f32_16x16x32_bf16 v[236:239], v[68:71], v[40:43], v[236:239]
    s_waitcnt lgkmcnt(9)
    v_mfma_f32_16x16x32_bf16 v[240:243], v[56:59], v[44:47], v[240:243]
    ds_read_b64_tr_b16 v[36:37], v7 offset:16384
    v_mfma_f32_16x16x32_bf16 v[244:247], v[60:63], v[44:47], v[244:247]
    ds_read_b64_tr_b16 v[38:39], v7 offset:17408
    v_mfma_f32_16x16x32_bf16 v[248:251], v[64:67], v[44:47], v[248:251]
    ds_read_b128 v[84:87], v18 offset:6144
    v_mfma_f32_16x16x32_bf16 v[252:255], v[68:71], v[44:47], v[252:255]
    s_waitcnt lgkmcnt(9)
    v_mfma_f32_16x16x32_bf16 v[128:131], v[72:75], v[48:51], v[128:131]
    ds_read_b64_tr_b16 v[40:41], v8 offset:16384
    s_waitcnt lgkmcnt(7)
    v_mfma_f32_16x16x32_bf16 v[132:135], v[76:79], v[48:51], v[132:135]
    ds_read_b64_tr_b16 v[42:43], v8 offset:17408
    s_waitcnt lgkmcnt(5)
    v_mfma_f32_16x16x32_bf16 v[136:139], v[80:83], v[48:51], v[136:139]
    s_waitcnt lgkmcnt(2)
    v_mfma_f32_16x16x32_bf16 v[140:143], v[84:87], v[48:51], v[140:143]
    v_mfma_f32_16x16x32_bf16 v[144:147], v[72:75], v[52:55], v[144:147]
    ds_read_b64_tr_b16 v[44:45], v9 offset:16384
    v_mfma_f32_16x16x32_bf16 v[148:151], v[76:79], v[52:55], v[148:151]
    ds_read_b64_tr_b16 v[46:47], v9 offset:17408
    v_mfma_f32_16x16x32_bf16 v[152:155], v[80:83], v[52:55], v[152:155]
    v_mfma_f32_16x16x32_bf16 v[156:159], v[84:87], v[52:55], v[156:159]
    v_mfma_f32_16x16x32_bf16 v[160:163], v[72:75], v[32:35], v[160:163]
    ds_read_b64_tr_b16 v[48:49], v10 offset:16384
    v_mfma_f32_16x16x32_bf16 v[164:167], v[76:79], v[32:35], v[164:167]
    ds_read_b64_tr_b16 v[50:51], v10 offset:17408
    v_mfma_f32_16x16x32_bf16 v[168:171], v[80:83], v[32:35], v[168:171]
    v_mfma_f32_16x16x32_bf16 v[172:175], v[84:87], v[32:35], v[172:175]
    v_mfma_f32_16x16x32_bf16 v[176:179], v[72:75], v[36:39], v[176:179]
    ds_read_b64_tr_b16 v[52:53], v11 offset:16384
    v_mfma_f32_16x16x32_bf16 v[180:183], v[76:79], v[36:39], v[180:183]
    ds_read_b64_tr_b16 v[54:55], v11 offset:17408
    v_mfma_f32_16x16x32_bf16 v[184:187], v[80:83], v[36:39], v[184:187]
    v_mfma_f32_16x16x32_bf16 v[188:191], v[84:87], v[36:39], v[188:191]
    s_waitcnt lgkmcnt(6)
    v_mfma_f32_16x16x32_bf16 v[192:195], v[72:75], v[40:43], v[192:195]
    s_barrier
    ds_read_b64_tr_b16 v[32:33], v4 offset:32768
    v_mfma_f32_16x16x32_bf16 v[196:199], v[76:79], v[40:43], v[196:199]
    ds_read_b64_tr_b16 v[34:35], v4 offset:33792
    v_mfma_f32_16x16x32_bf16 v[200:203], v[80:83], v[40:43], v[200:203]
    ds_read_b128 v[56:59], v15 offset:0
    v_mfma_f32_16x16x32_bf16 v[204:207], v[84:87], v[40:43], v[204:207]
    s_waitcnt lgkmcnt(7)
    v_mfma_f32_16x16x32_bf16 v[208:211], v[72:75], v[44:47], v[208:211]
    ds_read_b64_tr_b16 v[36:37], v5 offset:32768
    v_mfma_f32_16x16x32_bf16 v[212:215], v[76:79], v[44:47], v[212:215]
    ds_read_b64_tr_b16 v[38:39], v5 offset:33792
    v_mfma_f32_16x16x32_bf16 v[216:219], v[80:83], v[44:47], v[216:219]
    ds_read_b128 v[60:63], v15 offset:2048
    v_mfma_f32_16x16x32_bf16 v[220:223], v[84:87], v[44:47], v[220:223]
    s_waitcnt lgkmcnt(8)
    v_mfma_f32_16x16x32_bf16 v[224:227], v[72:75], v[48:51], v[224:227]
    ds_read_b64_tr_b16 v[40:41], v6 offset:32768
    v_mfma_f32_16x16x32_bf16 v[228:231], v[76:79], v[48:51], v[228:231]
    ds_read_b64_tr_b16 v[42:43], v6 offset:33792
    v_mfma_f32_16x16x32_bf16 v[232:235], v[80:83], v[48:51], v[232:235]
    ds_read_b128 v[64:67], v15 offset:4096
    v_mfma_f32_16x16x32_bf16 v[236:239], v[84:87], v[48:51], v[236:239]
    s_waitcnt lgkmcnt(9)
    v_mfma_f32_16x16x32_bf16 v[240:243], v[72:75], v[52:55], v[240:243]
    ds_read_b64_tr_b16 v[44:45], v7 offset:32768
    v_mfma_f32_16x16x32_bf16 v[244:247], v[76:79], v[52:55], v[244:247]
    ds_read_b64_tr_b16 v[46:47], v7 offset:33792
    v_mfma_f32_16x16x32_bf16 v[248:251], v[80:83], v[52:55], v[248:251]
    ds_read_b128 v[68:71], v15 offset:6144
    v_mfma_f32_16x16x32_bf16 v[252:255], v[84:87], v[52:55], v[252:255]
    s_waitcnt lgkmcnt(9)
    v_mfma_f32_16x16x32_bf16 v[128:131], v[56:59], v[32:35], v[128:131]
    ds_read_b64_tr_b16 v[48:49], v8 offset:32768
    s_waitcnt lgkmcnt(7)
    v_mfma_f32_16x16x32_bf16 v[132:135], v[60:63], v[32:35], v[132:135]
    ds_read_b64_tr_b16 v[50:51], v8 offset:33792
    s_waitcnt lgkmcnt(5)
    v_mfma_f32_16x16x32_bf16 v[136:139], v[64:67], v[32:35], v[136:139]
    s_waitcnt lgkmcnt(2)
    v_mfma_f32_16x16x32_bf16 v[140:143], v[68:71], v[32:35], v[140:143]
    v_mfma_f32_16x16x32_bf16 v[144:147], v[56:59], v[36:39], v[144:147]
    ds_read_b64_tr_b16 v[52:53], v9 offset:32768
    v_mfma_f32_16x16x32_bf16 v[148:151], v[60:63], v[36:39], v[148:151]
    ds_read_b64_tr_b16 v[54:55], v9 offset:33792
    v_mfma_f32_16x16x32_bf16 v[152:155], v[64:67], v[36:39], v[152:155]
    v_mfma_f32_16x16x32_bf16 v[156:159], v[68:71], v[36:39], v[156:159]
    v_mfma_f32_16x16x32_bf16 v[160:163], v[56:59], v[40:43], v[160:163]
    ds_read_b64_tr_b16 v[32:33], v10 offset:32768
    v_mfma_f32_16x16x32_bf16 v[164:167], v[60:63], v[40:43], v[164:167]
    ds_read_b64_tr_b16 v[34:35], v10 offset:33792
    v_mfma_f32_16x16x32_bf16 v[168:171], v[64:67], v[40:43], v[168:171]
    v_mfma_f32_16x16x32_bf16 v[172:175], v[68:71], v[40:43], v[172:175]
    v_mfma_f32_16x16x32_bf16 v[176:179], v[56:59], v[44:47], v[176:179]
    ds_read_b64_tr_b16 v[36:37], v11 offset:32768
    v_mfma_f32_16x16x32_bf16 v[180:183], v[60:63], v[44:47], v[180:183]
    ds_read_b64_tr_b16 v[38:39], v11 offset:33792
    v_mfma_f32_16x16x32_bf16 v[184:187], v[64:67], v[44:47], v[184:187]
    v_mfma_f32_16x16x32_bf16 v[188:191], v[68:71], v[44:47], v[188:191]
    s_waitcnt lgkmcnt(6)
    v_mfma_f32_16x16x32_bf16 v[192:195], v[56:59], v[48:51], v[192:195]
    s_barrier
    ds_read_b64_tr_b16 v[40:41], v4 offset:49152
    v_mfma_f32_16x16x32_bf16 v[196:199], v[60:63], v[48:51], v[196:199]
    ds_read_b64_tr_b16 v[42:43], v4 offset:50176
    v_mfma_f32_16x16x32_bf16 v[200:203], v[64:67], v[48:51], v[200:203]
    ds_read_b128 v[72:75], v16 offset:0
    v_mfma_f32_16x16x32_bf16 v[204:207], v[68:71], v[48:51], v[204:207]
    s_waitcnt lgkmcnt(7)
    v_mfma_f32_16x16x32_bf16 v[208:211], v[56:59], v[52:55], v[208:211]
    ds_read_b64_tr_b16 v[44:45], v5 offset:49152
    v_mfma_f32_16x16x32_bf16 v[212:215], v[60:63], v[52:55], v[212:215]
    ds_read_b64_tr_b16 v[46:47], v5 offset:50176
    v_mfma_f32_16x16x32_bf16 v[216:219], v[64:67], v[52:55], v[216:219]
    ds_read_b128 v[76:79], v16 offset:2048
    v_mfma_f32_16x16x32_bf16 v[220:223], v[68:71], v[52:55], v[220:223]
    s_waitcnt lgkmcnt(8)
    v_mfma_f32_16x16x32_bf16 v[224:227], v[56:59], v[32:35], v[224:227]
    ds_read_b64_tr_b16 v[48:49], v6 offset:49152
    v_mfma_f32_16x16x32_bf16 v[228:231], v[60:63], v[32:35], v[228:231]
    ds_read_b64_tr_b16 v[50:51], v6 offset:50176
    v_mfma_f32_16x16x32_bf16 v[232:235], v[64:67], v[32:35], v[232:235]
    ds_read_b128 v[80:83], v16 offset:4096
    v_mfma_f32_16x16x32_bf16 v[236:239], v[68:71], v[32:35], v[236:239]
    s_waitcnt lgkmcnt(9)
    v_mfma_f32_16x16x32_bf16 v[240:243], v[56:59], v[36:39], v[240:243]
    ds_read_b64_tr_b16 v[52:53], v7 offset:49152
    v_mfma_f32_16x16x32_bf16 v[244:247], v[60:63], v[36:39], v[244:247]
    ds_read_b64_tr_b16 v[54:55], v7 offset:50176
    v_mfma_f32_16x16x32_bf16 v[248:251], v[64:67], v[36:39], v[248:251]
    ds_read_b128 v[84:87], v16 offset:6144
    v_mfma_f32_16x16x32_bf16 v[252:255], v[68:71], v[36:39], v[252:255]
    s_waitcnt lgkmcnt(9)
    v_mfma_f32_16x16x32_bf16 v[128:131], v[72:75], v[40:43], v[128:131]
    ds_read_b64_tr_b16 v[32:33], v8 offset:49152
    s_waitcnt lgkmcnt(7)
    v_mfma_f32_16x16x32_bf16 v[132:135], v[76:79], v[40:43], v[132:135]
    ds_read_b64_tr_b16 v[34:35], v8 offset:50176
    s_waitcnt lgkmcnt(5)
    v_mfma_f32_16x16x32_bf16 v[136:139], v[80:83], v[40:43], v[136:139]
    s_waitcnt lgkmcnt(2)
    v_mfma_f32_16x16x32_bf16 v[140:143], v[84:87], v[40:43], v[140:143]
    v_mfma_f32_16x16x32_bf16 v[144:147], v[72:75], v[44:47], v[144:147]
    ds_read_b64_tr_b16 v[36:37], v9 offset:49152
    v_mfma_f32_16x16x32_bf16 v[148:151], v[76:79], v[44:47], v[148:151]
    ds_read_b64_tr_b16 v[38:39], v9 offset:50176
    v_mfma_f32_16x16x32_bf16 v[152:155], v[80:83], v[44:47], v[152:155]
    v_mfma_f32_16x16x32_bf16 v[156:159], v[84:87], v[44:47], v[156:159]
    v_mfma_f32_16x16x32_bf16 v[160:163], v[72:75], v[48:51], v[160:163]
    ds_read_b64_tr_b16 v[40:41], v10 offset:49152
    v_mfma_f32_16x16x32_bf16 v[164:167], v[76:79], v[48:51], v[164:167]
    ds_read_b64_tr_b16 v[42:43], v10 offset:50176
    v_mfma_f32_16x16x32_bf16 v[168:171], v[80:83], v[48:51], v[168:171]
    v_mfma_f32_16x16x32_bf16 v[172:175], v[84:87], v[48:51], v[172:175]
    v_mfma_f32_16x16x32_bf16 v[176:179], v[72:75], v[52:55], v[176:179]
    ds_read_b64_tr_b16 v[44:45], v11 offset:49152
    v_mfma_f32_16x16x32_bf16 v[180:183], v[76:79], v[52:55], v[180:183]
    ds_read_b64_tr_b16 v[46:47], v11 offset:50176
    v_mfma_f32_16x16x32_bf16 v[184:187], v[80:83], v[52:55], v[184:187]
    v_mfma_f32_16x16x32_bf16 v[188:191], v[84:87], v[52:55], v[188:191]
    s_waitcnt lgkmcnt(6)
    v_mfma_f32_16x16x32_bf16 v[192:195], v[72:75], v[32:35], v[192:195]
    s_waitcnt vmcnt(1)
    s_barrier
    ds_read_b64_tr_b16 v[48:49], v4 offset:0
    v_mfma_f32_16x16x32_bf16 v[196:199], v[76:79], v[32:35], v[196:199]
    ds_read_b64_tr_b16 v[50:51], v4 offset:1024
    s_cmp_lg_u32 s5, 7
    s_cbranch_scc1 F_AR1
    v_mov_b32 v30, 0x1
    s_and_b32 s8, s2, 7
    s_lshl_b32 s8, s8, 5
    s_mov_b64 exec, 1
    buffer_atomic_add v30, off, s[48:51], s8
    s_mov_b64 exec, -1
F_AR1:
    v_mfma_f32_16x16x32_bf16 v[200:203], v[80:83], v[32:35], v[200:203]
    ds_read_b128 v[56:59], v15 offset:32768
    v_mfma_f32_16x16x32_bf16 v[204:207], v[84:87], v[32:35], v[204:207]
    s_waitcnt lgkmcnt(7)
    v_mfma_f32_16x16x32_bf16 v[208:211], v[72:75], v[36:39], v[208:211]
    ds_read_b64_tr_b16 v[52:53], v5 offset:0
    v_mfma_f32_16x16x32_bf16 v[212:215], v[76:79], v[36:39], v[212:215]
    ds_read_b64_tr_b16 v[54:55], v5 offset:1024
    v_mfma_f32_16x16x32_bf16 v[216:219], v[80:83], v[36:39], v[216:219]
    ds_read_b128 v[60:63], v15 offset:34816
    v_mfma_f32_16x16x32_bf16 v[220:223], v[84:87], v[36:39], v[220:223]
    s_waitcnt lgkmcnt(8)
    v_mfma_f32_16x16x32_bf16 v[224:227], v[72:75], v[40:43], v[224:227]
    ds_read_b64_tr_b16 v[32:33], v6 offset:0
    v_mfma_f32_16x16x32_bf16 v[228:231], v[76:79], v[40:43], v[228:231]
    ds_read_b64_tr_b16 v[34:35], v6 offset:1024
    v_mfma_f32_16x16x32_bf16 v[232:235], v[80:83], v[40:43], v[232:235]
    ds_read_b128 v[64:67], v15 offset:36864
    v_mfma_f32_16x16x32_bf16 v[236:239], v[84:87], v[40:43], v[236:239]
    s_waitcnt lgkmcnt(9)
    v_mfma_f32_16x16x32_bf16 v[240:243], v[72:75], v[44:47], v[240:243]
    ds_read_b64_tr_b16 v[36:37], v7 offset:0
    v_mfma_f32_16x16x32_bf16 v[244:247], v[76:79], v[44:47], v[244:247]
    ds_read_b64_tr_b16 v[38:39], v7 offset:1024
    v_mfma_f32_16x16x32_bf16 v[248:251], v[80:83], v[44:47], v[248:251]
    ds_read_b128 v[68:71], v15 offset:38912
    v_mfma_f32_16x16x32_bf16 v[252:255], v[84:87], v[44:47], v[252:255]
    s_waitcnt lgkmcnt(9)
    v_mfma_f32_16x16x32_bf16 v[128:131], v[56:59], v[48:51], v[128:131]
    ds_read_b64_tr_b16 v[40:41], v8 offset:0
    s_waitcnt lgkmcnt(7)
    v_mfma_f32_16x16x32_bf16 v[132:135], v[60:63], v[48:51], v[132:135]
    ds_read_b64_tr_b16 v[42:43], v8 offset:1024
    s_waitcnt lgkmcnt(5)
    v_mfma_f32_16x16x32_bf16 v[136:139], v[64:67], v[48:51], v[136:139]
    s_waitcnt lgkmcnt(2)
    v_mfma_f32_16x16x32_bf16 v[140:143], v[68:71], v[48:51], v[140:143]
    v_mfma_f32_16x16x32_bf16 v[144:147], v[56:59], v[52:55], v[144:147]
    ds_read_b64_tr_b16 v[44:45], v9 offset:0
    v_mfma_f32_16x16x32_bf16 v[148:151], v[60:63], v[52:55], v[148:151]
    ds_read_b64_tr_b16 v[46:47], v9 offset:1024
    v_mfma_f32_16x16x32_bf16 v[152:155], v[64:67], v[52:55], v[152:155]
    v_mfma_f32_16x16x32_bf16 v[156:159], v[68:71], v[52:55], v[156:159]
    v_mfma_f32_16x16x32_bf16 v[160:163], v[56:59], v[32:35], v[160:163]
    ds_read_b64_tr_b16 v[48:49], v10 offset:0
    v_mfma_f32_16x16x32_bf16 v[164:167], v[60:63], v[32:35], v[164:167]
    ds_read_b64_tr_b16 v[50:51], v10 offset:1024
    v_mfma_f32_16x16x32_bf16 v[168:171], v[64:67], v[32:35], v[168:171]
    v_mfma_f32_16x16x32_bf16 v[172:175], v[68:71], v[32:35], v[172:175]
    v_mfma_f32_16x16x32_bf16 v[176:179], v[56:59], v[36:39], v[176:179]
    ds_read_b64_tr_b16 v[52:53], v11 offset:0
    v_mfma_f32_16x16x32_bf16 v[180:183], v[60:63], v[36:39], v[180:183]
    ds_read_b64_tr_b16 v[54:55], v11 offset:1024
    v_mfma_f32_16x16x32_bf16 v[184:187], v[64:67], v[36:39], v[184:187]
    v_mfma_f32_16x16x32_bf16 v[188:191], v[68:71], v[36:39], v[188:191]
    s_waitcnt lgkmcnt(6)
    v_mfma_f32_16x16x32_bf16 v[192:195], v[56:59], v[40:43], v[192:195]
    s_barrier
    ds_read_b64_tr_b16 v[32:33], v4 offset:16384
    v_mfma_f32_16x16x32_bf16 v[196:199], v[60:63], v[40:43], v[196:199]
    ds_read_b64_tr_b16 v[34:35], v4 offset:17408
    v_mfma_f32_16x16x32_bf16 v[200:203], v[64:67], v[40:43], v[200:203]
    ds_read_b128 v[72:75], v16 offset:32768
    v_mfma_f32_16x16x32_bf16 v[204:207], v[68:71], v[40:43], v[204:207]
    s_waitcnt lgkmcnt(7)
    v_mfma_f32_16x16x32_bf16 v[208:211], v[56:59], v[44:47], v[208:211]
    ds_read_b64_tr_b16 v[36:37], v5 offset:16384
    v_mfma_f32_16x16x32_bf16 v[212:215], v[60:63], v[44:47], v[212:215]
    ds_read_b64_tr_b16 v[38:39], v5 offset:17408
    v_mfma_f32_16x16x32_bf16 v[216:219], v[64:67], v[44:47], v[216:219]
    ds_read_b128 v[76:79], v16 offset:34816
    v_mfma_f32_16x16x32_bf16 v[220:223], v[68:71], v[44:47], v[220:223]
    s_waitcnt lgkmcnt(8)
    v_mfma_f32_16x16x32_bf16 v[224:227], v[56:59], v[48:51], v[224:227]
    ds_read_b64_tr_b16 v[40:41], v6 offset:16384
    v_mfma_f32_16x16x32_bf16 v[228:231], v[60:63], v[48:51], v[228:231]
    ds_read_b64_tr_b16 v[42:43], v6 offset:17408
    v_mfma_f32_16x16x32_bf16 v[232:235], v[64:67], v[48:51], v[232:235]
    ds_read_b128 v[80:83], v16 offset:36864
    v_mfma_f32_16x16x32_bf16 v[236:239], v[68:71], v[48:51], v[236:239]
    s_waitcnt lgkmcnt(9)
    v_mfma_f32_16x16x32_bf16 v[240:243], v[56:59], v[52:55], v[240:243]
    ds_read_b64_tr_b16 v[44:45], v7 offset:16384
    v_mfma_f32_16x16x32_bf16 v[244:247], v[60:63], v[52:55], v[244:247]
    ds_read_b64_tr_b16 v[46:47], v7 offset:17408
    v_mfma_f32_16x16x32_bf16 v[248:251], v[64:67], v[52:55], v[248:251]
    ds_read_b128 v[84:87], v16 offset:38912
    v_mfma_f32_16x16x32_bf16 v[252:255], v[68:71], v[52:55], v[252:255]
    s_waitcnt lgkmcnt(9)
    v_mfma_f32_16x16x32_bf16 v[128:131], v[72:75], v[32:35], v[128:131]
    ds_read_b64_tr_b16 v[48:49], v8 offset:16384
    s_waitcnt lgkmcnt(7)
    v_mfma_f32_16x16x32_bf16 v[132:135], v[76:79], v[32:35], v[132:135]
    ds_read_b64_tr_b16 v[50:51], v8 offset:17408
    s_waitcnt lgkmcnt(5)
    v_mfma_f32_16x16x32_bf16 v[136:139], v[80:83], v[32:35], v[136:139]
    s_waitcnt lgkmcnt(2)
    v_mfma_f32_16x16x32_bf16 v[140:143], v[84:87], v[32:35], v[140:143]
    v_mfma_f32_16x16x32_bf16 v[144:147], v[72:75], v[36:39], v[144:147]
    ds_read_b64_tr_b16 v[52:53], v9 offset:16384
    v_mfma_f32_16x16x32_bf16 v[148:151], v[76:79], v[36:39], v[148:151]
    ds_read_b64_tr_b16 v[54:55], v9 offset:17408
    v_mfma_f32_16x16x32_bf16 v[152:155], v[80:83], v[36:39], v[152:155]
    v_mfma_f32_16x16x32_bf16 v[156:159], v[84:87], v[36:39], v[156:159]
    v_mfma_f32_16x16x32_bf16 v[160:163], v[72:75], v[40:43], v[160:163]
    ds_read_b64_tr_b16 v[32:33], v10 offset:16384
    v_mfma_f32_16x16x32_bf16 v[164:167], v[76:79], v[40:43], v[164:167]
    ds_read_b64_tr_b16 v[34:35], v10 offset:17408
    v_mfma_f32_16x16x32_bf16 v[168:171], v[80:83], v[40:43], v[168:171]
    v_mfma_f32_16x16x32_bf16 v[172:175], v[84:87], v[40:43], v[172:175]
    v_mfma_f32_16x16x32_bf16 v[176:179], v[72:75], v[44:47], v[176:179]
    ds_read_b64_tr_b16 v[36:37], v11 offset:16384
    v_mfma_f32_16x16x32_bf16 v[180:183], v[76:79], v[44:47], v[180:183]
    ds_read_b64_tr_b16 v[38:39], v11 offset:17408
    v_mfma_f32_16x16x32_bf16 v[184:187], v[80:83], v[44:47], v[184:187]
    v_mfma_f32_16x16x32_bf16 v[188:191], v[84:87], v[44:47], v[188:191]
    s_waitcnt lgkmcnt(6)
    v_mfma_f32_16x16x32_bf16 v[192:195], v[72:75], v[48:51], v[192:195]
    s_barrier
    ds_read_b64_tr_b16 v[40:41], v4 offset:32768
    v_mfma_f32_16x16x32_bf16 v[196:199], v[76:79], v[48:51], v[196:199]
    ds_read_b64_tr_b16 v[42:43], v4 offset:33792
    v_mfma_f32_16x16x32_bf16 v[200:203], v[80:83], v[48:51], v[200:203]
    ds_read_b128 v[56:59], v17 offset:0
    v_mfma_f32_16x16x32_bf16 v[204:207], v[84:87], v[48:51], v[204:207]
    s_waitcnt lgkmcnt(7)
    v_mfma_f32_16x16x32_bf16 v[208:211], v[72:75], v[52:55], v[208:211]
    ds_read_b64_tr_b16 v[44:45], v5 offset:32768
    v_mfma_f32_16x16x32_bf16 v[212:215], v[76:79], v[52:55], v[212:215]
    ds_read_b64_tr_b16 v[46:47], v5 offset:33792
    v_mfma_f32_16x16x32_bf16 v[216:219], v[80:83], v[52:55], v[216:219]
    ds_read_b128 v[60:63], v17 offset:2048
    v_mfma_f32_16x16x32_bf16 v[220:223], v[84:87], v[52:55], v[220:223]
    s_waitcnt lgkmcnt(8)
    v_mfma_f32_16x16x32_bf16 v[224:227], v[72:75], v[32:35], v[224:227]
    ds_read_b64_tr_b16 v[48:49], v6 offset:32768
    v_mfma_f32_16x16x32_bf16 v[228:231], v[76:79], v[32:35], v[228:231]
    ds_read_b64_tr_b16 v[50:51], v6 offset:33792
    v_mfma_f32_16x16x32_bf16 v[232:235], v[80:83], v[32:35], v[232:235]
    ds_read_b128 v[64:67], v17 offset:4096
    v_mfma_f32_16x16x32_bf16 v[236:239], v[84:87], v[32:35], v[236:239]
    s_waitcnt lgkmcnt(9)
    v_mfma_f32_16x16x32_bf16 v[240:243], v[72:75], v[36:39], v[240:243]
    ds_read_b64_tr_b16 v[52:53], v7 offset:32768
    v_mfma_f32_16x16x32_bf16 v[244:247], v[76:79], v[36:39], v[244:247]
    ds_read_b64_tr_b16 v[54:55], v7 offset:33792
    v_mfma_f32_16x16x32_bf16 v[248:251], v[80:83], v[36:39], v[248:251]
    ds_read_b128 v[68:71], v17 offset:6144
    v_mfma_f32_16x16x32_bf16 v[252:255], v[84:87], v[36:39], v[252:255]
    s_waitcnt lgkmcnt(9)
    v_mfma_f32_16x16x32_bf16 v[128:131], v[56:59], v[40:43], v[128:131]
    ds_read_b64_tr_b16 v[32:33], v8 offset:32768
    s_waitcnt lgkmcnt(7)
    v_mfma_f32_16x16x32_bf16 v[132:135], v[60:63], v[40:43], v[132:135]
    ds_read_b64_tr_b16 v[34:35], v8 offset:33792
    s_waitcnt lgkmcnt(5)
    v_mfma_f32_16x16x32_bf16 v[136:139], v[64:67], v[40:43], v[136:139]
    s_waitcnt lgkmcnt(2)
    v_mfma_f32_16x16x32_bf16 v[140:143], v[68:71], v[40:43], v[140:143]
    v_mfma_f32_16x16x32_bf16 v[144:147], v[56:59], v[44:47], v[144:147]
    ds_read_b64_tr_b16 v[36:37], v9 offset:32768
    v_mfma_f32_16x16x32_bf16 v[148:151], v[60:63], v[44:47], v[148:151]
    ds_read_b64_tr_b16 v[38:39], v9 offset:33792
    v_mfma_f32_16x16x32_bf16 v[152:155], v[64:67], v[44:47], v[152:155]
    v_mfma_f32_16x16x32_bf16 v[156:159], v[68:71], v[44:47], v[156:159]
    v_mfma_f32_16x16x32_bf16 v[160:163], v[56:59], v[48:51], v[160:163]
    ds_read_b64_tr_b16 v[40:41], v10 offset:32768
    v_mfma_f32_16x16x32_bf16 v[164:167], v[60:63], v[48:51], v[164:167]
    ds_read_b64_tr_b16 v[42:43], v10 offset:33792
    v_mfma_f32_16x16x32_bf16 v[168:171], v[64:67], v[48:51], v[168:171]
    v_mfma_f32_16x16x32_bf16 v[172:175], v[68:71], v[48:51], v[172:175]
    v_mfma_f32_16x16x32_bf16 v[176:179], v[56:59], v[52:55], v[176:179]
    ds_read_b64_tr_b16 v[44:45], v11 offset:32768
    v_mfma_f32_16x16x32_bf16 v[180:183], v[60:63], v[52:55], v[180:183]
    ds_read_b64_tr_b16 v[46:47], v11 offset:33792
    v_mfma_f32_16x16x32_bf16 v[184:187], v[64:67], v[52:55], v[184:187]
    v_mfma_f32_16x16x32_bf16 v[188:191], v[68:71], v[52:55], v[188:191]
    s_waitcnt lgkmcnt(6)
    v_mfma_f32_16x16x32_bf16 v[192:195], v[56:59], v[32:35], v[192:195]
    s_barrier
    ds_read_b64_tr_b16 v[48:49], v4 offset:49152
    v_mfma_f32_16x16x32_bf16 v[196:199], v[60:63], v[32:35], v[196:199]
    ds_read_b64_tr_b16 v[50:51], v4 offset:50176
    v_mfma_f32_16x16x32_bf16 v[200:203], v[64:67], v[32:35], v[200:203]
    ds_read_b128 v[72:75], v18 offset:0
    v_mfma_f32_16x16x32_bf16 v[204:207], v[68:71], v[32:35], v[204:207]
    s_waitcnt lgkmcnt(7)
    v_mfma_f32_16x16x32_bf16 v[208:211], v[56:59], v[36:39], v[208:211]
    ds_read_b64_tr_b16 v[52:53], v5 offset:49152
    v_mfma_f32_16x16x32_bf16 v[212:215], v[60:63], v[36:39], v[212:215]
    ds_read_b64_tr_b16 v[54:55], v5 offset:50176
    v_mfma_f32_16x16x32_bf16 v[216:219], v[64:67], v[36:39], v[216:219]
    ds_read_b128 v[76:79], v18 offset:2048
    v_mfma_f32_16x16x32_bf16 v[220:223], v[68:71], v[36:39], v[220:223]
    s_waitcnt lgkmcnt(8)
    v_mfma_f32_16x16x32_bf16 v[224:227], v[56:59], v[40:43], v[224:227]
    ds_read_b64_tr_b16 v[32:33], v6 offset:49152
    v_mfma_f32_16x16x32_bf16 v[228:231], v[60:63], v[40:43], v[228:231]
    ds_read_b64_tr_b16 v[34:35], v6 offset:50176
    v_mfma_f32_16x16x32_bf16 v[232:235], v[64:67], v[40:43], v[232:235]
    ds_read_b128 v[80:83], v18 offset:4096
    v_mfma_f32_16x16x32_bf16 v[236:239], v[68:71], v[40:43], v[236:239]
    s_waitcnt lgkmcnt(9)
    v_mfma_f32_16x16x32_bf16 v[240:243], v[56:59], v[44:47], v[240:243]
    ds_read_b64_tr_b16 v[36:37], v7 offset:49152
    v_mfma_f32_16x16x32_bf16 v[244:247], v[60:63], v[44:47], v[244:247]
    ds_read_b64_tr_b16 v[38:39], v7 offset:50176
    v_mfma_f32_16x16x32_bf16 v[248:251], v[64:67], v[44:47], v[248:251]
    ds_read_b128 v[84:87], v18 offset:6144
    v_mfma_f32_16x16x32_bf16 v[252:255], v[68:71], v[44:47], v[252:255]
    s_waitcnt lgkmcnt(9)
    v_mfma_f32_16x16x32_bf16 v[128:131], v[72:75], v[48:51], v[128:131]
    ds_read_b64_tr_b16 v[40:41], v8 offset:49152
    s_waitcnt lgkmcnt(7)
    v_mfma_f32_16x16x32_bf16 v[132:135], v[76:79], v[48:51], v[132:135]
    ds_read_b64_tr_b16 v[42:43], v8 offset:50176
    s_waitcnt lgkmcnt(5)
    v_mfma_f32_16x16x32_bf16 v[136:139], v[80:83], v[48:51], v[136:139]
    s_waitcnt lgkmcnt(2)
    v_mfma_f32_16x16x32_bf16 v[140:143], v[84:87], v[48:51], v[140:143]
    v_mfma_f32_16x16x32_bf16 v[144:147], v[72:75], v[52:55], v[144:147]
    ds_read_b64_tr_b16 v[44:45], v9 offset:49152
    v_mfma_f32_16x16x32_bf16 v[148:151], v[76:79], v[52:55], v[148:151]
    ds_read_b64_tr_b16 v[46:47], v9 offset:50176
    v_mfma_f32_16x16x32_bf16 v[152:155], v[80:83], v[52:55], v[152:155]
    v_mfma_f32_16x16x32_bf16 v[156:159], v[84:87], v[52:55], v[156:159]
    v_mfma_f32_16x16x32_bf16 v[160:163], v[72:75], v[32:35], v[160:163]
    ds_read_b64_tr_b16 v[48:49], v10 offset:49152
    v_mfma_f32_16x16x32_bf16 v[164:167], v[76:79], v[32:35], v[164:167]
    ds_read_b64_tr_b16 v[50:51], v10 offset:50176
    v_mfma_f32_16x16x32_bf16 v[168:171], v[80:83], v[32:35], v[168:171]
    v_mfma_f32_16x16x32_bf16 v[172:175], v[84:87], v[32:35], v[172:175]
    v_mfma_f32_16x16x32_bf16 v[176:179], v[72:75], v[36:39], v[176:179]
    ds_read_b64_tr_b16 v[52:53], v11 offset:49152
    v_mfma_f32_16x16x32_bf16 v[180:183], v[76:79], v[36:39], v[180:183]
    ds_read_b64_tr_b16 v[54:55], v11 offset:50176
    v_mfma_f32_16x16x32_bf16 v[184:187], v[80:83], v[36:39], v[184:187]
    v_mfma_f32_16x16x32_bf16 v[188:191], v[84:87], v[36:39], v[188:191]
    s_waitcnt lgkmcnt(6)
    v_mfma_f32_16x16x32_bf16 v[192:195], v[72:75], v[40:43], v[192:195]
    s_barrier
    ds_read_b64_tr_b16 v[32:33], v4 offset:0
    v_mfma_f32_16x16x32_bf16 v[196:199], v[76:79], v[40:43], v[196:199]
    ds_read_b64_tr_b16 v[34:35], v4 offset:1024
    s_cmp_lg_u32 s5, 7
    s_cbranch_scc1 F_P1I
    v_lshrrev_b32 v24, 2, v2
    v_and_b32 v25, 7, v1
    v_cmp_eq_u32 vcc, 0, v25
    s_nop 1
    v_cndmask_b32 v25, 0, 32, vcc
    buffer_load_dword v26, v24, s[48:51], 0 offen sc1
F_P1I:
    v_mfma_f32_16x16x32_bf16 v[200:203], v[80:83], v[40:43], v[200:203]
    ds_read_b128 v[56:59], v15 offset:0
    v_mfma_f32_16x16x32_bf16 v[204:207], v[84:87], v[40:43], v[204:207]
    s_waitcnt lgkmcnt(7)
    v_mfma_f32_16x16x32_bf16 v[208:211], v[72:75], v[44:47], v[208:211]
    ds_read_b64_tr_b16 v[36:37], v5 offset:0
    v_mfma_f32_16x16x32_bf16 v[212:215], v[76:79], v[44:47], v[212:215]
    ds_read_b64_tr_b16 v[38:39], v5 offset:1024
    v_mfma_f32_16x16x32_bf16 v[216:219], v[80:83], v[44:47], v[216:219]
    ds_read_b128 v[60:63], v15 offset:2048
    v_mfma_f32_16x16x32_bf16 v[220:223], v[84:87], v[44:47], v[220:223]
    s_waitcnt lgkmcnt(8)
    v_mfma_f32_16x16x32_bf16 v[224:227], v[72:75], v[48:51], v[224:227]
    ds_read_b64_tr_b16 v[40:41], v6 offset:0
    v_mfma_f32_16x16x32_bf16 v[228:231], v[76:79], v[48:51], v[228:231]
    ds_read_b64_tr_b16 v[42:43], v6 offset:1024
    v_mfma_f32_16x16x32_bf16 v[232:235], v[80:83], v[48:51], v[232:235]
    ds_read_b128 v[64:67], v15 offset:4096
    v_mfma_f32_16x16x32_bf16 v[236:239], v[84:87], v[48:51], v[236:239]
    s_waitcnt lgkmcnt(9)
    v_mfma_f32_16x16x32_bf16 v[240:243], v[72:75], v[52:55], v[240:243]
    ds_read_b64_tr_b16 v[44:45], v7 offset:0
    v_mfma_f32_16x16x32_bf16 v[244:247], v[76:79], v[52:55], v[244:247]
    ds_read_b64_tr_b16 v[46:47], v7 offset:1024
    v_mfma_f32_16x16x32_bf16 v[248:251], v[80:83], v[52:55], v[248:251]
    ds_read_b128 v[68:71], v15 offset:6144
    v_mfma_f32_16x16x32_bf16 v[252:255], v[84:87], v[52:55], v[252:255]
    s_waitcnt lgkmcnt(9)
    v_mfma_f32_16x16x32_bf16 v[128:131], v[56:59], v[32:35], v[128:131]
    ds_read_b64_tr_b16 v[48:49], v8 offset:0
    s_waitcnt lgkmcnt(7)
    v_mfma_f32_16x16x32_bf16 v[132:135], v[60:63], v[32:35], v[132:135]
    ds_read_b64_tr_b16 v[50:51], v8 offset:1024
    s_waitcnt lgkmcnt(5)
    v_mfma_f32_16x16x32_bf16 v[136:139], v[64:67], v[32:35], v[136:139]
    s_waitcnt lgkmcnt(2)
    v_mfma_f32_16x16x32_bf16 v[140:143], v[68:71], v[32:35], v[140:143]
    v_mfma_f32_16x16x32_bf16 v[144:147], v[56:59], v[36:39], v[144:147]
    ds_read_b64_tr_b16 v[52:53], v9 offset:0
    v_mfma_f32_16x16x32_bf16 v[148:151], v[60:63], v[36:39], v[148:151]
    ds_read_b64_tr_b16 v[54:55], v9 offset:1024
    v_mfma_f32_16x16x32_bf16 v[152:155], v[64:67], v[36:39], v[152:155]
    v_mfma_f32_16x16x32_bf16 v[156:159], v[68:71], v[36:39], v[156:159]
    v_mfma_f32_16x16x32_bf16 v[160:163], v[56:59], v[40:43], v[160:163]
    ds_read_b64_tr_b16 v[32:33], v10 offset:0
    v_mfma_f32_16x16x32_bf16 v[164:167], v[60:63], v[40:43], v[164:167]
    ds_read_b64_tr_b16 v[34:35], v10 offset:1024
    v_mfma_f32_16x16x32_bf16 v[168:171], v[64:67], v[40:43], v[168:171]
    v_mfma_f32_16x16x32_bf16 v[172:175], v[68:71], v[40:43], v[172:175]
    v_mfma_f32_16x16x32_bf16 v[176:179], v[56:59], v[44:47], v[176:179]
    ds_read_b64_tr_b16 v[36:37], v11 offset:0
    v_mfma_f32_16x16x32_bf16 v[180:183], v[60:63], v[44:47], v[180:183]
    ds_read_b64_tr_b16 v[38:39], v11 offset:1024
    v_mfma_f32_16x16x32_bf16 v[184:187], v[64:67], v[44:47], v[184:187]
    v_mfma_f32_16x16x32_bf16 v[188:191], v[68:71], v[44:47], v[188:191]
    s_waitcnt lgkmcnt(6)
    v_mfma_f32_16x16x32_bf16 v[192:195], v[56:59], v[48:51], v[192:195]
    s_barrier
    ds_read_b64_tr_b16 v[40:41], v4 offset:16384
    v_mfma_f32_16x16x32_bf16 v[196:199], v[60:63], v[48:51], v[196:199]
    ds_read_b64_tr_b16 v[42:43], v4 offset:17408
    s_add_u32 m0, s96, 65536
    s_mov_b32 s53, 262144
    buffer_load_dwordx4 v3, s[92:95], s53 offen offset:0 lds
    v_mfma_f32_16x16x32_bf16 v[200:203], v[64:67], v[48:51], v[200:203]
    ds_read_b128 v[72:75], v16 offset:0
    v_mfma_f32_16x16x32_bf16 v[204:207], v[68:71], v[48:51], v[204:207]
    s_mov_b32 s53, 293888
    buffer_load_dwordx4 v3, s[92:95], s53 offen offset:1024 lds
    s_waitcnt lgkmcnt(7)
    v_mfma_f32_16x16x32_bf16 v[208:211], v[56:59], v[52:55], v[208:211]
    ds_read_b64_tr_b16 v[44:45], v5 offset:16384
    v_mfma_f32_16x16x32_bf16 v[212:215], v[60:63], v[52:55], v[212:215]
    ds_read_b64_tr_b16 v[46:47], v5 offset:17408
    s_add_u32 m0, s96, 81920
    s_mov_b32 s53, 786432
    buffer_load_dwordx4 v3, s[92:95], s53 offen offset:0 lds
    v_mfma_f32_16x16x32_bf16 v[216:219], v[64:67], v[52:55], v[216:219]
    ds_read_b128 v[76:79], v16 offset:2048
    v_mfma_f32_16x16x32_bf16 v[220:223], v[68:71], v[52:55], v[220:223]
    s_mov_b32 s53, 818176
    buffer_load_dwordx4 v3, s[92:95], s53 offen offset:1024 lds
    s_waitcnt lgkmcnt(8)
    v_mfma_f32_16x16x32_bf16 v[224:227], v[56:59], v[32:35], v[224:227]
    ds_read_b64_tr_b16 v[48:49], v6 offset:16384
    v_mfma_f32_16x16x32_bf16 v[228:231], v[60:63], v[32:35], v[228:231]
    ds_read_b64_tr_b16 v[50:51], v6 offset:17408
    v_mfma_f32_16x16x32_bf16 v[232:235], v[64:67], v[32:35], v[232:235]
    ds_read_b128 v[80:83], v16 offset:4096
    v_mfma_f32_16x16x32_bf16 v[236:239], v[68:71], v[32:35], v[236:239]
    s_waitcnt lgkmcnt(9)
    v_mfma_f32_16x16x32_bf16 v[240:243], v[56:59], v[36:39], v[240:243]
    ds_read_b64_tr_b16 v[52:53], v7 offset:16384
    v_mfma_f32_16x16x32_bf16 v[244:247], v[60:63], v[36:39], v[244:247]
    ds_read_b64_tr_b16 v[54:55], v7 offset:17408
    v_mfma_f32_16x16x32_bf16 v[248:251], v[64:67], v[36:39], v[248:251]
    ds_read_b128 v[84:87], v16 offset:6144
    v_mfma_f32_16x16x32_bf16 v[252:255], v[68:71], v[36:39], v[252:255]
    s_waitcnt lgkmcnt(9)
    v_mfma_f32_16x16x32_bf16 v[128:131], v[72:75], v[40:43], v[128:131]
    ds_read_b64_tr_b16 v[32:33], v8 offset:16384
    s_waitcnt lgkmcnt(7)
    v_mfma_f32_16x16x32_bf16 v[132:135], v[76:79], v[40:43], v[132:135]
    ds_read_b64_tr_b16 v[34:35], v8 offset:17408
    s_waitcnt lgkmcnt(5)
    v_mfma_f32_16x16x32_bf16 v[136:139], v[80:83], v[40:43], v[136:139]
    s_waitcnt lgkmcnt(2)
    v_mfma_f32_16x16x32_bf16 v[140:143], v[84:87], v[40:43], v[140:143]
    v_mfma_f32_16x16x32_bf16 v[144:147], v[72:75], v[44:47], v[144:147]
    ds_read_b64_tr_b16 v[36:37], v9 offset:16384
    v_mfma_f32_16x16x32_bf16 v[148:151], v[76:79], v[44:47], v[148:151]
    ds_read_b64_tr_b16 v[38:39], v9 offset:17408
    v_mfma_f32_16x16x32_bf16 v[152:155], v[80:83], v[44:47], v[152:155]
    v_mfma_f32_16x16x32_bf16 v[156:159], v[84:87], v[44:47], v[156:159]
    v_mfma_f32_16x16x32_bf16 v[160:163], v[72:75], v[48:51], v[160:163]
    ds_read_b64_tr_b16 v[40:41], v10 offset:16384
    v_mfma_f32_16x16x32_bf16 v[164:167], v[76:79], v[48:51], v[164:167]
    ds_read_b64_tr_b16 v[42:43], v10 offset:17408
    v_mfma_f32_16x16x32_bf16 v[168:171], v[80:83], v[48:51], v[168:171]
    v_mfma_f32_16x16x32_bf16 v[172:175], v[84:87], v[48:51], v[172:175]
    v_mfma_f32_16x16x32_bf16 v[176:179], v[72:75], v[52:55], v[176:179]
    ds_read_b64_tr_b16 v[44:45], v11 offset:16384
    v_mfma_f32_16x16x32_bf16 v[180:183], v[76:79], v[52:55], v[180:183]
    ds_read_b64_tr_b16 v[46:47], v11 offset:17408
    v_mfma_f32_16x16x32_bf16 v[184:187], v[80:83], v[52:55], v[184:187]
    v_mfma_f32_16x16x32_bf16 v[188:191], v[84:87], v[52:55], v[188:191]
    s_waitcnt lgkmcnt(6)
    v_mfma_f32_16x16x32_bf16 v[192:195], v[72:75], v[32:35], v[192:195]
    s_cmp_lg_u32 s5, 7
    s_cbranch_scc1 F_P1C
    s_waitcnt vmcnt(4)
    v_and_b32 v26, v26, v25
    v_cmp_ne_u32 vcc, v26, v25
    s_cbranch_vccz P1_OK
    s_mov_b32 s55, 0x40000
P1_SP:
    s_sleep 2
    buffer_load_dword v26, v24, s[48:51], 0 offen sc1
    s_waitcnt vmcnt(0)
    v_and_b32 v26, v26, v25
    v_cmp_ne_u32 vcc, v26, v25
    s_cbranch_vccz P1_OK
    s_sub_u32 s55, s55, 1
    s_cmp_lg_u32 s55, 0
    s_cbranch_scc1 P1_SP
P1_OK:
F_P1C:
    s_barrier
    ds_read_b64_tr_b16 v[48:49], v4 offset:32768
    v_mfma_f32_16x16x32_bf16 v[196:199], v[76:79], v[32:35], v[196:199]
    ds_read_b64_tr_b16 v[50:51], v4 offset:33792
    s_add_u32 m0, s97, 98304
    s_add_u32 s53, s98, 0
    buffer_load_dwordx4 v2, s[44:47], s53 offen sc1 lds
    v_mfma_f32_16x16x32_bf16 v[200:203], v[80:83], v[32:35], v[200:203]
    ds_read_b128 v[56:59], v15 offset:32768
    v_mfma_f32_16x16x32_bf16 v[204:207], v[84:87], v[32:35], v[204:207]
    s_add_u32 m0, s97, 106496
    s_add_u32 s53, s98, 8192
    buffer_load_dwordx4 v2, s[44:47], s53 offen sc1 lds
    s_waitcnt lgkmcnt(7)
    v_mfma_f32_16x16x32_bf16 v[208:211], v[72:75], v[36:39], v[208:211]
    ds_read_b64_tr_b16 v[52:53], v5 offset:32768
    v_mfma_f32_16x16x32_bf16 v[212:215], v[76:79], v[36:39], v[212:215]
    ds_read_b64_tr_b16 v[54:55], v5 offset:33792
    v_mfma_f32_16x16x32_bf16 v[216:219], v[80:83], v[36:39], v[216:219]
    ds_read_b128 v[60:63], v15 offset:34816
    v_mfma_f32_16x16x32_bf16 v[220:223], v[84:87], v[36:39], v[220:223]
    s_waitcnt lgkmcnt(8)
    v_mfma_f32_16x16x32_bf16 v[224:227], v[72:75], v[40:43], v[224:227]
    ds_read_b64_tr_b16 v[32:33], v6 offset:32768
    s_add_u32 s53, s99, 0
    buffer_load_dwordx4 v[88:91], v2, s[44:47], s53 offen sc1
    v_mfma_f32_16x16x32_bf16 v[228:231], v[76:79], v[40:43], v[228:231]
    ds_read_b64_tr_b16 v[34:35], v6 offset:33792
    v_mfma_f32_16x16x32_bf16 v[232:235], v[80:83], v[40:43], v[232:235]
    ds_read_b128 v[64:67], v15 offset:36864
    s_add_u32 s53, s99, 18432
    buffer_load_dwordx4 v[92:95], v2, s[44:47], s53 offen sc1
    v_mfma_f32_16x16x32_bf16 v[236:239], v[84:87], v[40:43], v[236:239]
    s_waitcnt lgkmcnt(9)
    v_mfma_f32_16x16x32_bf16 v[240:243], v[72:75], v[44:47], v[240:243]
    ds_read_b64_tr_b16 v[36:37], v7 offset:32768
    s_add_u32 s53, s99, 1024
    buffer_load_dwordx4 v[96:99], v2, s[44:47], s53 offen sc1
    v_mfma_f32_16x16x32_bf16 v[244:247], v[76:79], v[44:47], v[244:247]
    ds_read_b64_tr_b16 v[38:39], v7 offset:33792
    v_mfma_f32_16x16x32_bf16 v[248:251], v[80:83], v[44:47], v[248:251]
    ds_read_b128 v[68:71], v15 offset:38912
    s_add_u32 s53, s99, 19456
    buffer_load_dwordx4 v[100:103], v2, s[44:47], s53 offen sc1
    v_mfma_f32_16x16x32_bf16 v[252:255], v[84:87], v[44:47], v[252:255]
    s_waitcnt lgkmcnt(9)
    v_mfma_f32_16x16x32_bf16 v[128:131], v[56:59], v[48:51], v[128:131]
    ds_read_b64_tr_b16 v[40:41], v8 offset:32768
    s_add_u32 s53, s99, 2048
    buffer_load_dwordx4 v[104:107], v2, s[44:47], s53 offen sc1
    s_waitcnt lgkmcnt(7)
    v_mfma_f32_16x16x32_bf16 v[132:135], v[60:63], v[48:51], v[132:135]
    ds_read_b64_tr_b16 v[42:43], v8 offset:33792
    s_waitcnt lgkmcnt(5)
    v_mfma_f32_16x16x32_bf16 v[136:139], v[64:67], v[48:51], v[136:139]
    s_add_u32 s53, s99, 20480
    buffer_load_dwordx4 v[108:111], v2, s[44:47], s53 offen sc1
    s_waitcnt lgkmcnt(2)
    v_mfma_f32_16x16x32_bf16 v[140:143], v[68:71], v[48:51], v[140:143]
    v_mfma_f32_16x16x32_bf16 v[144:147], v[56:59], v[52:55], v[144:147]
    ds_read_b64_tr_b16 v[44:45], v9 offset:32768
    s_add_u32 s53, s99, 3072
    buffer_load_dwordx4 v[112:115], v2, s[44:47], s53 offen sc1
    v_mfma_f32_16x16x32_bf16 v[148:151], v[60:63], v[52:55], v[148:151]
    ds_read_b64_tr_b16 v[46:47], v9 offset:33792
    v_mfma_f32_16x16x32_bf16 v[152:155], v[64:67], v[52:55], v[152:155]
    s_add_u32 s53, s99, 21504
    buffer_load_dwordx4 v[116:119], v2, s[44:47], s53 offen sc1
    v_mfma_f32_16x16x32_bf16 v[156:159], v[68:71], v[52:55], v[156:159]
    v_mfma_f32_16x16x32_bf16 v[160:163], v[56:59], v[32:35], v[160:163]
    ds_read_b64_tr_b16 v[48:49], v10 offset:32768
    s_add_u32 s53, s99, 4096
    buffer_load_dwordx4 v[120:123], v2, s[44:47], s53 offen sc1
    v_mfma_f32_16x16x32_bf16 v[164:167], v[60:63], v[32:35], v[164:167]
    ds_read_b64_tr_b16 v[50:51], v10 offset:33792
    v_mfma_f32_16x16x32_bf16 v[168:171], v[64:67], v[32:35], v[168:171]
    s_add_u32 s53, s99, 22528
    buffer_load_dwordx4 v[124:127], v2, s[44:47], s53 offen sc1
    v_mfma_f32_16x16x32_bf16 v[172:175], v[68:71], v[32:35], v[172:175]
    v_mfma_f32_16x16x32_bf16 v[176:179], v[56:59], v[36:39], v[176:179]
    ds_read_b64_tr_b16 v[52:53], v11 offset:32768
    v_mfma_f32_16x16x32_bf16 v[180:183], v[60:63], v[36:39], v[180:183]
    ds_read_b64_tr_b16 v[54:55], v11 offset:33792
    v_mfma_f32_16x16x32_bf16 v[184:187], v[64:67], v[36:39], v[184:187]
    v_mfma_f32_16x16x32_bf16 v[188:191], v[68:71], v[36:39], v[188:191]
    s_waitcnt lgkmcnt(6)
    v_mfma_f32_16x16x32_bf16 v[192:195], v[56:59], v[40:43], v[192:195]
    s_barrier
    ds_read_b64_tr_b16 v[32:33], v4 offset:49152
    v_mfma_f32_16x16x32_bf16 v[196:199], v[60:63], v[40:43], v[196:199]
    ds_read_b64_tr_b16 v[34:35], v4 offset:50176
    s_add_u32 m0, s96, 114688
    s_mov_b32 s53, 1310720
    buffer_load_dwordx4 v3, s[92:95], s53 offen offset:0 lds
    v_mfma_f32_16x16x32_bf16 v[200:203], v[64:67], v[40:43], v[200:203]
    ds_read_b128 v[72:75], v16 offset:32768
    v_mfma_f32_16x16x32_bf16 v[204:207], v[68:71], v[40:43], v[204:207]
    s_mov_b32 s53, 1342464
    buffer_load_dwordx4 v3, s[92:95], s53 offen offset:1024 lds
    s_waitcnt lgkmcnt(7)
    v_mfma_f32_16x16x32_bf16 v[208:211], v[56:59], v[44:47], v[208:211]
    ds_read_b64_tr_b16 v[36:37], v5 offset:49152
    v_mfma_f32_16x16x32_bf16 v[212:215], v[60:63], v[44:47], v[212:215]
    ds_read_b64_tr_b16 v[38:39], v5 offset:50176
    s_add_u32 m0, s96, 16384
    s_mov_b32 s53, 1835008
    buffer_load_dwordx4 v3, s[92:95], s53 offen offset:0 lds
    v_mfma_f32_16x16x32_bf16 v[216:219], v[64:67], v[44:47], v[216:219]
    ds_read_b128 v[76:79], v16 offset:34816
    v_mfma_f32_16x16x32_bf16 v[220:223], v[68:71], v[44:47], v[220:223]
    s_mov_b32 s53, 1866752
    buffer_load_dwordx4 v3, s[92:95], s53 offen offset:1024 lds
    s_waitcnt lgkmcnt(8)
    v_mfma_f32_16x16x32_bf16 v[224:227], v[56:59], v[48:51], v[224:227]
    ds_read_b64_tr_b16 v[40:41], v6 offset:49152
    v_mfma_f32_16x16x32_bf16 v[228:231], v[60:63], v[48:51], v[228:231]
    ds_read_b64_tr_b16 v[42:43], v6 offset:50176
    s_add_u32 m0, s97, 0
    s_add_u32 s53, s98, 16384
    buffer_load_dwordx4 v2, s[44:47], s53 offen sc1 lds
    v_mfma_f32_16x16x32_bf16 v[232:235], v[64:67], v[48:51], v[232:235]
    ds_read_b128 v[80:83], v16 offset:36864
    v_mfma_f32_16x16x32_bf16 v[236:239], v[68:71], v[48:51], v[236:239]
    s_add_u32 m0, s97, 8192
    s_add_u32 s53, s98, 24576
    buffer_load_dwordx4 v2, s[44:47], s53 offen sc1 lds
    s_waitcnt lgkmcnt(9)
    v_mfma_f32_16x16x32_bf16 v[240:243], v[56:59], v[52:55], v[240:243]
    ds_read_b64_tr_b16 v[44:45], v7 offset:49152
    v_mfma_f32_16x16x32_bf16 v[244:247], v[60:63], v[52:55], v[244:247]
    ds_read_b64_tr_b16 v[46:47], v7 offset:50176
    v_mfma_f32_16x16x32_bf16 v[248:251], v[64:67], v[52:55], v[248:251]
    ds_read_b128 v[84:87], v16 offset:38912
    v_mfma_f32_16x16x32_bf16 v[252:255], v[68:71], v[52:55], v[252:255]
    s_waitcnt lgkmcnt(9)
    v_mfma_f32_16x16x32_bf16 v[128:131], v[72:75], v[32:35], v[128:131]
    ds_read_b64_tr_b16 v[48:49], v8 offset:49152
    s_waitcnt lgkmcnt(7)
    v_mfma_f32_16x16x32_bf16 v[132:135], v[76:79], v[32:35], v[132:135]
    ds_read_b64_tr_b16 v[50:51], v8 offset:50176
    s_waitcnt lgkmcnt(5)
    v_mfma_f32_16x16x32_bf16 v[136:139], v[80:83], v[32:35], v[136:139]
    s_waitcnt lgkmcnt(2)
    v_mfma_f32_16x16x32_bf16 v[140:143], v[84:87], v[32:35], v[140:143]
    v_mfma_f32_16x16x32_bf16 v[144:147], v[72:75], v[36:39], v[144:147]
    ds_read_b64_tr_b16 v[52:53], v9 offset:49152
    v_mfma_f32_16x16x32_bf16 v[148:151], v[76:79], v[36:39], v[148:151]
    ds_read_b64_tr_b16 v[54:55], v9 offset:50176
    v_mfma_f32_16x16x32_bf16 v[152:155], v[80:83], v[36:39], v[152:155]
    v_mfma_f32_16x16x32_bf16 v[156:159], v[84:87], v[36:39], v[156:159]
    v_mfma_f32_16x16x32_bf16 v[160:163], v[72:75], v[40:43], v[160:163]
    ds_read_b64_tr_b16 v[32:33], v10 offset:49152
    v_mfma_f32_16x16x32_bf16 v[164:167], v[76:79], v[40:43], v[164:167]
    ds_read_b64_tr_b16 v[34:35], v10 offset:50176
    v_mfma_f32_16x16x32_bf16 v[168:171], v[80:83], v[40:43], v[168:171]
    v_mfma_f32_16x16x32_bf16 v[172:175], v[84:87], v[40:43], v[172:175]
    v_mfma_f32_16x16x32_bf16 v[176:179], v[72:75], v[44:47], v[176:179]
    ds_read_b64_tr_b16 v[36:37], v11 offset:49152
    v_mfma_f32_16x16x32_bf16 v[180:183], v[76:79], v[44:47], v[180:183]
    ds_read_b64_tr_b16 v[38:39], v11 offset:50176
    v_mfma_f32_16x16x32_bf16 v[184:187], v[80:83], v[44:47], v[184:187]
    v_mfma_f32_16x16x32_bf16 v[188:191], v[84:87], v[44:47], v[188:191]
    s_waitcnt lgkmcnt(6)
    v_mfma_f32_16x16x32_bf16 v[192:195], v[72:75], v[48:51], v[192:195]
    v_mfma_f32_16x16x32_bf16 v[196:199], v[76:79], v[48:51], v[196:199]
    v_mfma_f32_16x16x32_bf16 v[200:203], v[80:83], v[48:51], v[200:203]
    v_mfma_f32_16x16x32_bf16 v[204:207], v[84:87], v[48:51], v[204:207]
    s_waitcnt lgkmcnt(4)
    v_mfma_f32_16x16x32_bf16 v[208:211], v[72:75], v[52:55], v[208:211]
    v_mfma_f32_16x16x32_bf16 v[212:215], v[76:79], v[52:55], v[212:215]
    v_mfma_f32_16x16x32_bf16 v[216:219], v[80:83], v[52:55], v[216:219]
    v_mfma_f32_16x16x32_bf16 v[220:223], v[84:87], v[52:55], v[220:223]
    s_waitcnt lgkmcnt(2)
    v_mfma_f32_16x16x32_bf16 v[224:227], v[72:75], v[32:35], v[224:227]
    v_mfma_f32_16x16x32_bf16 v[228:231], v[76:79], v[32:35], v[228:231]
    v_mfma_f32_16x16x32_bf16 v[232:235], v[80:83], v[32:35], v[232:235]
    v_mfma_f32_16x16x32_bf16 v[236:239], v[84:87], v[32:35], v[236:239]
    s_waitcnt lgkmcnt(0)
    v_mfma_f32_16x16x32_bf16 v[240:243], v[72:75], v[36:39], v[240:243]
    v_mfma_f32_16x16x32_bf16 v[244:247], v[76:79], v[36:39], v[244:247]
    v_mfma_f32_16x16x32_bf16 v[248:251], v[80:83], v[36:39], v[248:251]
    v_mfma_f32_16x16x32_bf16 v[252:255], v[84:87], v[36:39], v[252:255]
    v_add_u32 v4, 0xffff6000, v4
    v_add_u32 v5, 0xffff6000, v5
    v_add_u32 v6, 0xffff6000, v6
    v_add_u32 v7, 0xffff6000, v7
    v_add_u32 v8, 0xffff6000, v8
    v_add_u32 v9, 0xffff6000, v9
    v_add_u32 v10, 0xffff6000, v10
    v_add_u32 v11, 0xffff6000, v11
    v_lshrrev_b32 v13, 4, v1
    v_bfe_u32 v14, v1, 2, 2
    v_lshl_add_u32 v15, v13, 3, v14
    v_lshlrev_b32 v15, 7, v15
    v_lshrrev_b32 v14, 1, v14
    v_and_b32 v13, 1, v13
    v_lshl_add_u32 v14, v13, 1, v14
    v_lshl_add_u32 v15, v14, 5, v15
    v_and_b32 v14, 3, v1
    v_lshl_add_u32 v15, v14, 3, v15
    v_add_u32 v12, 98304, v15
    v_xor_b32 v16, 32, v12
    v_xor_b32 v17, 64, v12
    v_xor_b32 v18, 96, v12
    s_waitcnt vmcnt(17)
    s_barrier
    ds_read_b64_tr_b16 v[24:25], v4 offset:0
    ds_read_b64_tr_b16 v[26:27], v4 offset:1024
    ds_read_b64_tr_b16 v[28:29], v5 offset:0
    ds_read_b64_tr_b16 v[30:31], v5 offset:1024
    ds_read_b64_tr_b16 v[32:33], v6 offset:0
    ds_read_b64_tr_b16 v[34:35], v6 offset:1024
    ds_read_b64_tr_b16 v[36:37], v7 offset:0
    ds_read_b64_tr_b16 v[38:39], v7 offset:1024
    ds_read_b64_tr_b16 v[40:41], v8 offset:0
    ds_read_b64_tr_b16 v[42:43], v8 offset:1024
    v_cvt_pk_bf16_f32 v192, v192, v193
    v_cvt_pk_bf16_f32 v193, v194, v195
    v_cvt_pk_bf16_f32 v194, v196, v197
    v_cvt_pk_bf16_f32 v195, v198, v199
    v_cvt_pk_bf16_f32 v200, v200, v201
    v_cvt_pk_bf16_f32 v201, v202, v203
    v_cvt_pk_bf16_f32 v202, v204, v205
    v_cvt_pk_bf16_f32 v203, v206, v207
    v_cvt_pk_bf16_f32 v208, v208, v209
    v_cvt_pk_bf16_f32 v209, v210, v211
    v_cvt_pk_bf16_f32 v210, v212, v213
    v_cvt_pk_bf16_f32 v211, v214, v215
    v_cvt_pk_bf16_f32 v216, v216, v217
    v_cvt_pk_bf16_f32 v217, v218, v219
    v_cvt_pk_bf16_f32 v218, v220, v221
    v_cvt_pk_bf16_f32 v219, v222, v223
    v_cvt_pk_bf16_f32 v224, v224, v225
    v_cvt_pk_bf16_f32 v225, v226, v227
    v_cvt_pk_bf16_f32 v226, v228, v229
    v_cvt_pk_bf16_f32 v227, v230, v231
    v_cvt_pk_bf16_f32 v232, v232, v233
    v_cvt_pk_bf16_f32 v233, v234, v235
    v_cvt_pk_bf16_f32 v234, v236, v237
    v_cvt_pk_bf16_f32 v235, v238, v239
    v_cvt_pk_bf16_f32 v240, v240, v241
    v_cvt_pk_bf16_f32 v241, v242, v243
    v_cvt_pk_bf16_f32 v242, v244, v245
    v_cvt_pk_bf16_f32 v243, v246, v247
    v_cvt_pk_bf16_f32 v248, v248, v249
    v_cvt_pk_bf16_f32 v249, v250, v251
    v_cvt_pk_bf16_f32 v250, v252, v253
    v_cvt_pk_bf16_f32 v251, v254, v255
    v_cvt_pk_bf16_f32 v196, v128, v129
    v_cvt_pk_bf16_f32 v197, v130, v131
    v_cvt_pk_bf16_f32 v198, v132, v133
    v_cvt_pk_bf16_f32 v199, v134, v135
    v_cvt_pk_bf16_f32 v204, v136, v137
    v_cvt_pk_bf16_f32 v205, v138, v139
    v_cvt_pk_bf16_f32 v206, v140, v141
    v_cvt_pk_bf16_f32 v207, v142, v143
    v_cvt_pk_bf16_f32 v212, v144, v145
    v_cvt_pk_bf16_f32 v213, v146, v147
    v_cvt_pk_bf16_f32 v214, v148, v149
    v_cvt_pk_bf16_f32 v215, v150, v151
    v_cvt_pk_bf16_f32 v220, v152, v153
    v_cvt_pk_bf16_f32 v221, v154, v155
    v_cvt_pk_bf16_f32 v222, v156, v157
    v_cvt_pk_bf16_f32 v223, v158, v159
    v_cvt_pk_bf16_f32 v228, v160, v161
    v_cvt_pk_bf16_f32 v229, v162, v163
    v_cvt_pk_bf16_f32 v230, v164, v165
    v_cvt_pk_bf16_f32 v231, v166, v167
    v_cvt_pk_bf16_f32 v236, v168, v169
    v_cvt_pk_bf16_f32 v237, v170, v171
    v_cvt_pk_bf16_f32 v238, v172, v173
    v_cvt_pk_bf16_f32 v239, v174, v175
    v_cvt_pk_bf16_f32 v244, v176, v177
    v_cvt_pk_bf16_f32 v245, v178, v179
    v_cvt_pk_bf16_f32 v246, v180, v181
    v_cvt_pk_bf16_f32 v247, v182, v183
    v_cvt_pk_bf16_f32 v252, v184, v185
    v_cvt_pk_bf16_f32 v253, v186, v187
    v_cvt_pk_bf16_f32 v254, v188, v189
    v_cvt_pk_bf16_f32 v255, v190, v191
    s_waitcnt vmcnt(15) lgkmcnt(8)
    v_mfma_f32_16x16x32_bf16 v[56:59], v[24:27], v[88:91], 0
    ds_read_b64_tr_b16 v[44:45], v9 offset:0
    s_waitcnt vmcnt(14)
    v_mfma_f32_16x16x32_bf16 v[60:63], v[24:27], v[92:95], 0
    ds_read_b64_tr_b16 v[46:47], v9 offset:1024
    s_add_u32 m0, s96, 32768
    s_mov_b32 s53, 2359296
    buffer_load_dwordx4 v3, s[92:95], s53 offen offset:0 lds
    s_waitcnt lgkmcnt(8)
    v_mfma_f32_16x16x32_bf16 v[64:67], v[28:31], v[88:91], 0
    ds_read_b64_tr_b16 v[48:49], v10 offset:0
    s_mov_b32 s53, 2391040
    buffer_load_dwordx4 v3, s[92:95], s53 offen offset:1024 lds
    v_mfma_f32_16x16x32_bf16 v[68:71], v[28:31], v[92:95], 0
    ds_read_b64_tr_b16 v[50:51], v10 offset:1024
    s_add_u32 m0, s97, 131072
    s_add_u32 s53, s98, 32768
    buffer_load_dwordx4 v2, s[44:47], s53 offen sc1 lds
    s_waitcnt lgkmcnt(8)
    v_mfma_f32_16x16x32_bf16 v[72:75], v[32:35], v[88:91], 0
    ds_read_b64_tr_b16 v[52:53], v11 offset:0
    s_add_u32 m0, s96, 49152
    s_mov_b32 s53, 2883584
    buffer_load_dwordx4 v3, s[92:95], s53 offen offset:0 lds
    v_mfma_f32_16x16x32_bf16 v[76:79], v[32:35], v[92:95], 0
    ds_read_b64_tr_b16 v[54:55], v11 offset:1024
    s_mov_b32 s53, 2915328
    buffer_load_dwordx4 v3, s[92:95], s53 offen offset:1024 lds
    s_waitcnt lgkmcnt(8)
    v_mfma_f32_16x16x32_bf16 v[80:83], v[36:39], v[88:91], 0
    ds_read_b64_tr_b16 v[24:25], v12 offset:0
    s_add_u32 m0, s97, 139264
    s_add_u32 s53, s98, 40960
    buffer_load_dwordx4 v2, s[44:47], s53 offen sc1 lds
    v_mfma_f32_16x16x32_bf16 v[84:87], v[36:39], v[92:95], 0
    ds_read_b64_tr_b16 v[26:27], v12 offset:512
    s_mul_i32 s6, s3, 648
    s_add_u32 s56, s32, s6
    s_addc_u32 s57, s33, 0
    s_mov_b32 s58, 648
    s_mov_b32 s59, 0x00020000
    s_lshl_b32 s6, s5, 8
    s_add_u32 m0, s6, 147456
    v_lshrrev_b32 v13, 2, v2
    buffer_load_dword v13, s[56:59], s6 offen lds
    s_waitcnt lgkmcnt(8)
    v_mfma_f32_16x16x32_bf16 v[128:131], v[40:43], v[88:91], 0
    ds_read_b64_tr_b16 v[28:29], v16 offset:0
    s_cmp_ge_u32 s4, 7
    s_cbranch_scc0 KSBE0
    buffer_store_dwordx4 v[192:195], v2, s[44:47], s83 offen offset:0 sc1
KSBE0:
    v_mfma_f32_16x16x32_bf16 v[132:135], v[40:43], v[92:95], 0
    ds_read_b64_tr_b16 v[30:31], v16 offset:512
    s_waitcnt lgkmcnt(8)
    v_mfma_f32_16x16x32_bf16 v[136:139], v[44:47], v[88:91], 0
    ds_read_b64_tr_b16 v[32:33], v17 offset:0
    v_mfma_f32_16x16x32_bf16 v[140:143], v[44:47], v[92:95], 0
    ds_read_b64_tr_b16 v[34:35], v17 offset:512
    s_waitcnt lgkmcnt(8)
    v_mfma_f32_16x16x32_bf16 v[144:147], v[48:51], v[88:91], 0
    ds_read_b64_tr_b16 v[36:37], v18 offset:0
    v_mfma_f32_16x16x32_bf16 v[148:151], v[48:51], v[92:95], 0
    ds_read_b64_tr_b16 v[38:39], v18 offset:512
    s_cmp_ge_u32 s4, 7
    s_cbranch_scc1 KSBL0
    buffer_store_dwordx4 v[192:195], v2, s[44:47], s83 offen offset:0 sc1
KSBL0:
    s_waitcnt lgkmcnt(8)
    v_mfma_f32_16x16x32_bf16 v[152:155], v[52:55], v[88:91], 0
    ds_read_b64_tr_b16 v[40:41], v4 offset:8192
    v_mfma_f32_16x16x32_bf16 v[156:159], v[52:55], v[92:95], 0
    ds_read_b64_tr_b16 v[42:43], v4 offset:9216
    s_waitcnt lgkmcnt(8)
    v_mfma_f32_16x16x32_bf16 v[160:163], v[24:27], v[88:91], 0
    ds_read_b64_tr_b16 v[44:45], v5 offset:8192
    v_mfma_f32_16x16x32_bf16 v[164:167], v[24:27], v[92:95], 0
    ds_read_b64_tr_b16 v[46:47], v5 offset:9216
    s_waitcnt lgkmcnt(8)
    v_mfma_f32_16x16x32_bf16 v[168:171], v[28:31], v[88:91], 0
    ds_read_b64_tr_b16 v[48:49], v6 offset:8192
    s_cmp_ge_u32 s4, 7
    s_cbranch_scc0 KSBE1
    buffer_store_dwordx4 v[196:199], v2, s[44:47], s82 offen offset:0 sc1
KSBE1:
    v_mfma_f32_16x16x32_bf16 v[172:175], v[28:31], v[92:95], 0
    ds_read_b64_tr_b16 v[50:51], v6 offset:9216
    s_waitcnt lgkmcnt(8)
    v_mfma_f32_16x16x32_bf16 v[176:179], v[32:35], v[88:91], 0
    ds_read_b64_tr_b16 v[52:53], v7 offset:8192
    v_mfma_f32_16x16x32_bf16 v[180:183], v[32:35], v[92:95], 0
    ds_read_b64_tr_b16 v[54:55], v7 offset:9216
    s_waitcnt lgkmcnt(8)
    v_mfma_f32_16x16x32_bf16 v[184:187], v[36:39], v[88:91], 0
    ds_read_b64_tr_b16 v[24:25], v8 offset:8192
    v_mfma_f32_16x16x32_bf16 v[188:191], v[36:39], v[92:95], 0
    ds_read_b64_tr_b16 v[26:27], v8 offset:9216
    s_waitcnt vmcnt(20) lgkmcnt(8)
    v_mfma_f32_16x16x32_bf16 v[56:59], v[40:43], v[96:99], v[56:59]
    ds_read_b64_tr_b16 v[28:29], v9 offset:8192
    s_add_u32 s53, s99, 5120
    buffer_load_dwordx4 v[88:91], v2, s[44:47], s53 offen sc1
    s_waitcnt vmcnt(20)
    v_mfma_f32_16x16x32_bf16 v[60:63], v[40:43], v[100:103], v[60:63]
    ds_read_b64_tr_b16 v[30:31], v9 offset:9216
    s_add_u32 s53, s99, 23552
    buffer_load_dwordx4 v[92:95], v2, s[44:47], s53 offen sc1
    s_waitcnt lgkmcnt(8)
    v_mfma_f32_16x16x32_bf16 v[64:67], v[44:47], v[96:99], v[64:67]
    ds_read_b64_tr_b16 v[32:33], v10 offset:8192
    v_mfma_f32_16x16x32_bf16 v[68:71], v[44:47], v[100:103], v[68:71]
    ds_read_b64_tr_b16 v[34:35], v10 offset:9216
    s_waitcnt lgkmcnt(8)
    v_mfma_f32_16x16x32_bf16 v[72:75], v[48:51], v[96:99], v[72:75]
    ds_read_b64_tr_b16 v[36:37], v11 offset:8192
    s_cmp_ge_u32 s4, 7
    s_cbranch_scc0 KSBE2
    buffer_store_dwordx4 v[200:203], v2, s[44:47], s85 offen offset:0 sc1
KSBE2:
    v_mfma_f32_16x16x32_bf16 v[76:79], v[48:51], v[100:103], v[76:79]
    ds_read_b64_tr_b16 v[38:39], v11 offset:9216
    s_waitcnt lgkmcnt(8)
    v_mfma_f32_16x16x32_bf16 v[80:83], v[52:55], v[96:99], v[80:83]
    ds_read_b64_tr_b16 v[40:41], v12 offset:4096
    v_mfma_f32_16x16x32_bf16 v[84:87], v[52:55], v[100:103], v[84:87]
    ds_read_b64_tr_b16 v[42:43], v12 offset:4608
    s_waitcnt lgkmcnt(8)
    v_mfma_f32_16x16x32_bf16 v[128:131], v[24:27], v[96:99], v[128:131]
    ds_read_b64_tr_b16 v[44:45], v16 offset:4096
    v_mfma_f32_16x16x32_bf16 v[132:135], v[24:27], v[100:103], v[132:135]
    ds_read_b64_tr_b16 v[46:47], v16 offset:4608
    s_cmp_ge_u32 s4, 7
    s_cbranch_scc1 KSBL1
    buffer_store_dwordx4 v[196:199], v2, s[44:47], s82 offen offset:0 sc1
KSBL1:
    s_waitcnt lgkmcnt(8)
    v_mfma_f32_16x16x32_bf16 v[136:139], v[28:31], v[96:99], v[136:139]
    ds_read_b64_tr_b16 v[48:49], v17 offset:4096
    v_mfma_f32_16x16x32_bf16 v[140:143], v[28:31], v[100:103], v[140:143]
    ds_read_b64_tr_b16 v[50:51], v17 offset:4608
    s_waitcnt lgkmcnt(8)
    v_mfma_f32_16x16x32_bf16 v[144:147], v[32:35], v[96:99], v[144:147]
    ds_read_b64_tr_b16 v[52:53], v18 offset:4096
    v_mfma_f32_16x16x32_bf16 v[148:151], v[32:35], v[100:103], v[148:151]
    ds_read_b64_tr_b16 v[54:55], v18 offset:4608
    s_waitcnt lgkmcnt(8)
    v_mfma_f32_16x16x32_bf16 v[152:155], v[36:39], v[96:99], v[152:155]
    v_add_u32 v4, 0x4000, v4
    v_add_u32 v5, 0x4000, v5
    v_add_u32 v6, 0x4000, v6
    v_add_u32 v7, 0x4000, v7
    v_add_u32 v8, 0x4000, v8
    v_add_u32 v9, 0x4000, v9
    v_add_u32 v10, 0x4000, v10
    v_add_u32 v11, 0x4000, v11
    v_add_u32 v12, 0x2000, v12
    v_add_u32 v16, 0x2000, v16
    v_add_u32 v17, 0x2000, v17
    v_add_u32 v18, 0x2000, v18
    s_barrier
    ds_read_b64_tr_b16 v[24:25], v4 offset:0
    s_cmp_ge_u32 s4, 7
    s_cbranch_scc0 KSBE3
    buffer_store_dwordx4 v[204:207], v2, s[44:47], s84 offen offset:0 sc1
KSBE3:
    v_mfma_f32_16x16x32_bf16 v[156:159], v[36:39], v[100:103], v[156:159]
    ds_read_b64_tr_b16 v[26:27], v4 offset:1024
    s_waitcnt lgkmcnt(8)
    v_mfma_f32_16x16x32_bf16 v[160:163], v[40:43], v[96:99], v[160:163]
    ds_read_b64_tr_b16 v[28:29], v5 offset:0
    v_mfma_f32_16x16x32_bf16 v[164:167], v[40:43], v[100:103], v[164:167]
    ds_read_b64_tr_b16 v[30:31], v5 offset:1024
    s_waitcnt lgkmcnt(8)
    v_mfma_f32_16x16x32_bf16 v[168:171], v[44:47], v[96:99], v[168:171]
    ds_read_b64_tr_b16 v[32:33], v6 offset:0
    v_mfma_f32_16x16x32_bf16 v[172:175], v[44:47], v[100:103], v[172:175]
    ds_read_b64_tr_b16 v[34:35], v6 offset:1024
    s_waitcnt lgkmcnt(8)
    v_mfma_f32_16x16x32_bf16 v[176:179], v[48:51], v[96:99], v[176:179]
    ds_read_b64_tr_b16 v[36:37], v7 offset:0
    v_mfma_f32_16x16x32_bf16 v[180:183], v[48:51], v[100:103], v[180:183]
    ds_read_b64_tr_b16 v[38:39], v7 offset:1024
    s_waitcnt lgkmcnt(8)
    v_mfma_f32_16x16x32_bf16 v[184:187], v[52:55], v[96:99], v[184:187]
    ds_read_b64_tr_b16 v[40:41], v8 offset:0
    v_mfma_f32_16x16x32_bf16 v[188:191], v[52:55], v[100:103], v[188:191]
    ds_read_b64_tr_b16 v[42:43], v8 offset:1024
    s_waitcnt vmcnt(20) lgkmcnt(8)
    v_mfma_f32_16x16x32_bf16 v[56:59], v[24:27], v[104:107], v[56:59]
    ds_read_b64_tr_b16 v[44:45], v9 offset:0
    s_cmp_ge_u32 s4, 7
    s_cbranch_scc0 KSBE4
    buffer_store_dwordx4 v[208:211], v2, s[44:47], s83 offen offset:1024 sc1
KSBE4:
    s_add_u32 s53, s99, 6144
    buffer_load_dwordx4 v[96:99], v2, s[44:47], s53 offen sc1
    s_waitcnt vmcnt(20)
    v_mfma_f32_16x16x32_bf16 v[60:63], v[24:27], v[108:111], v[60:63]
    ds_read_b64_tr_b16 v[46:47], v9 offset:1024
    s_add_u32 s53, s99, 24576
    buffer_load_dwordx4 v[100:103], v2, s[44:47], s53 offen sc1
    s_waitcnt lgkmcnt(8)
    v_mfma_f32_16x16x32_bf16 v[64:67], v[28:31], v[104:107], v[64:67]
    ds_read_b64_tr_b16 v[48:49], v10 offset:0
    v_mfma_f32_16x16x32_bf16 v[68:71], v[28:31], v[108:111], v[68:71]
    ds_read_b64_tr_b16 v[50:51], v10 offset:1024
    s_waitcnt lgkmcnt(8)
    v_mfma_f32_16x16x32_bf16 v[72:75], v[32:35], v[104:107], v[72:75]
    ds_read_b64_tr_b16 v[52:53], v11 offset:0
    v_mfma_f32_16x16x32_bf16 v[76:79], v[32:35], v[108:111], v[76:79]
    ds_read_b64_tr_b16 v[54:55], v11 offset:1024
    s_cmp_ge_u32 s4, 7
    s_cbranch_scc1 KSBL2
    buffer_store_dwordx4 v[200:203], v2, s[44:47], s85 offen offset:0 sc1
KSBL2:
    s_waitcnt lgkmcnt(8)
    v_mfma_f32_16x16x32_bf16 v[80:83], v[36:39], v[104:107], v[80:83]
    ds_read_b64_tr_b16 v[24:25], v12 offset:0
    v_mfma_f32_16x16x32_bf16 v[84:87], v[36:39], v[108:111], v[84:87]
    ds_read_b64_tr_b16 v[26:27], v12 offset:512
    s_waitcnt lgkmcnt(8)
    v_mfma_f32_16x16x32_bf16 v[128:131], v[40:43], v[104:107], v[128:131]
    ds_read_b64_tr_b16 v[28:29], v16 offset:0
    v_mfma_f32_16x16x32_bf16 v[132:135], v[40:43], v[108:111], v[132:135]
    ds_read_b64_tr_b16 v[30:31], v16 offset:512
    s_waitcnt lgkmcnt(8)
    v_mfma_f32_16x16x32_bf16 v[136:139], v[44:47], v[104:107], v[136:139]
    ds_read_b64_tr_b16 v[32:33], v17 offset:0
    s_cmp_ge_u32 s4, 7
    s_cbranch_scc0 KSBE5
    buffer_store_dwordx4 v[212:215], v2, s[44:47], s82 offen offset:1024 sc1
KSBE5:
    v_mfma_f32_16x16x32_bf16 v[140:143], v[44:47], v[108:111], v[140:143]
    ds_read_b64_tr_b16 v[34:35], v17 offset:512
    s_waitcnt lgkmcnt(8)
    v_mfma_f32_16x16x32_bf16 v[144:147], v[48:51], v[104:107], v[144:147]
    ds_read_b64_tr_b16 v[36:37], v18 offset:0
    v_mfma_f32_16x16x32_bf16 v[148:151], v[48:51], v[108:111], v[148:151]
    ds_read_b64_tr_b16 v[38:39], v18 offset:512
    s_waitcnt lgkmcnt(8)
    v_mfma_f32_16x16x32_bf16 v[152:155], v[52:55], v[104:107], v[152:155]
    ds_read_b64_tr_b16 v[40:41], v4 offset:8192
    v_mfma_f32_16x16x32_bf16 v[156:159], v[52:55], v[108:111], v[156:159]
    ds_read_b64_tr_b16 v[42:43], v4 offset:9216
    s_waitcnt lgkmcnt(8)
    v_mfma_f32_16x16x32_bf16 v[160:163], v[24:27], v[104:107], v[160:163]
    ds_read_b64_tr_b16 v[44:45], v5 offset:8192
    v_mfma_f32_16x16x32_bf16 v[164:167], v[24:27], v[108:111], v[164:167]
    ds_read_b64_tr_b16 v[46:47], v5 offset:9216
    s_waitcnt lgkmcnt(8)
    v_mfma_f32_16x16x32_bf16 v[168:171], v[28:31], v[104:107], v[168:171]
    ds_read_b64_tr_b16 v[48:49], v6 offset:8192
    v_mfma_f32_16x16x32_bf16 v[172:175], v[28:31], v[108:111], v[172:175]
    ds_read_b64_tr_b16 v[50:51], v6 offset:9216
    s_waitcnt lgkmcnt(8)
    v_mfma_f32_16x16x32_bf16 v[176:179], v[32:35], v[104:107], v[176:179]
    ds_read_b64_tr_b16 v[52:53], v7 offset:8192
    s_cmp_ge_u32 s4, 7
    s_cbranch_scc0 KSBE6
    buffer_store_dwordx4 v[216:219], v2, s[44:47], s85 offen offset:1024 sc1
KSBE6:
    v_mfma_f32_16x16x32_bf16 v[180:183], v[32:35], v[108:111], v[180:183]
    ds_read_b64_tr_b16 v[54:55], v7 offset:9216
    s_waitcnt lgkmcnt(8)
    v_mfma_f32_16x16x32_bf16 v[184:187], v[36:39], v[104:107], v[184:187]
    ds_read_b64_tr_b16 v[24:25], v8 offset:8192
    v_mfma_f32_16x16x32_bf16 v[188:191], v[36:39], v[108:111], v[188:191]
    ds_read_b64_tr_b16 v[26:27], v8 offset:9216
    s_waitcnt vmcnt(20) lgkmcnt(8)
    v_mfma_f32_16x16x32_bf16 v[56:59], v[40:43], v[112:115], v[56:59]
    ds_read_b64_tr_b16 v[28:29], v9 offset:8192
    s_add_u32 s53, s99, 7168
    buffer_load_dwordx4 v[104:107], v2, s[44:47], s53 offen sc1
    s_waitcnt vmcnt(20)
    v_mfma_f32_16x16x32_bf16 v[60:63], v[40:43], v[116:119], v[60:63]
    ds_read_b64_tr_b16 v[30:31], v9 offset:9216
    s_cmp_ge_u32 s4, 7
    s_cbranch_scc1 KSBL3
    buffer_store_dwordx4 v[204:207], v2, s[44:47], s84 offen offset:0 sc1
KSBL3:
    s_add_u32 s53, s99, 25600
    buffer_load_dwordx4 v[108:111], v2, s[44:47], s53 offen sc1
    s_waitcnt lgkmcnt(8)
    v_mfma_f32_16x16x32_bf16 v[64:67], v[44:47], v[112:115], v[64:67]
    ds_read_b64_tr_b16 v[32:33], v10 offset:8192
    v_mfma_f32_16x16x32_bf16 v[68:71], v[44:47], v[116:119], v[68:71]
    ds_read_b64_tr_b16 v[34:35], v10 offset:9216
    s_waitcnt lgkmcnt(8)
    v_mfma_f32_16x16x32_bf16 v[72:75], v[48:51], v[112:115], v[72:75]
    ds_read_b64_tr_b16 v[36:37], v11 offset:8192
    v_mfma_f32_16x16x32_bf16 v[76:79], v[48:51], v[116:119], v[76:79]
    ds_read_b64_tr_b16 v[38:39], v11 offset:9216
    s_waitcnt lgkmcnt(8)
    v_mfma_f32_16x16x32_bf16 v[80:83], v[52:55], v[112:115], v[80:83]
    ds_read_b64_tr_b16 v[40:41], v12 offset:4096
    s_cmp_ge_u32 s4, 7
    s_cbranch_scc0 KSBE7
    buffer_store_dwordx4 v[220:223], v2, s[44:47], s84 offen offset:1024 sc1
KSBE7:
    v_mfma_f32_16x16x32_bf16 v[84:87], v[52:55], v[116:119], v[84:87]
    ds_read_b64_tr_b16 v[42:43], v12 offset:4608
    s_waitcnt lgkmcnt(8)
    v_mfma_f32_16x16x32_bf16 v[128:131], v[24:27], v[112:115], v[128:131]
    ds_read_b64_tr_b16 v[44:45], v16 offset:4096
    v_mfma_f32_16x16x32_bf16 v[132:135], v[24:27], v[116:119], v[132:135]
    ds_read_b64_tr_b16 v[46:47], v16 offset:4608
    s_waitcnt lgkmcnt(8)
    v_mfma_f32_16x16x32_bf16 v[136:139], v[28:31], v[112:115], v[136:139]
    ds_read_b64_tr_b16 v[48:49], v17 offset:4096
    v_mfma_f32_16x16x32_bf16 v[140:143], v[28:31], v[116:119], v[140:143]
    ds_read_b64_tr_b16 v[50:51], v17 offset:4608
    s_waitcnt lgkmcnt(8)
    v_mfma_f32_16x16x32_bf16 v[144:147], v[32:35], v[112:115], v[144:147]
    ds_read_b64_tr_b16 v[52:53], v18 offset:4096
    v_mfma_f32_16x16x32_bf16 v[148:151], v[32:35], v[116:119], v[148:151]
    ds_read_b64_tr_b16 v[54:55], v18 offset:4608
    s_waitcnt lgkmcnt(8)
    v_mfma_f32_16x16x32_bf16 v[152:155], v[36:39], v[112:115], v[152:155]
    v_add_u32 v4, 0x8000, v4
    v_add_u32 v5, 0x8000, v5
    v_add_u32 v6, 0x8000, v6
    v_add_u32 v7, 0x8000, v7
    v_add_u32 v8, 0x8000, v8
    v_add_u32 v9, 0x8000, v9
    v_add_u32 v10, 0x8000, v10
    v_add_u32 v11, 0x8000, v11
    v_add_u32 v12, 0xfffe6000, v12
    v_add_u32 v16, 0xfffe6000, v16
    v_add_u32 v17, 0xfffe6000, v17
    v_add_u32 v18, 0xfffe6000, v18
    s_waitcnt vmcnt(14)
    s_barrier
    ds_read_b64_tr_b16 v[24:25], v4 offset:0
    v_mfma_f32_16x16x32_bf16 v[156:159], v[36:39], v[116:119], v[156:159]
    ds_read_b64_tr_b16 v[26:27], v4 offset:1024
    s_waitcnt lgkmcnt(8)
    v_mfma_f32_16x16x32_bf16 v[160:163], v[40:43], v[112:115], v[160:163]
    ds_read_b64_tr_b16 v[28:29], v5 offset:0
    s_add_u32 m0, s96, 65536
    s_mov_b32 s53, 3407872
    buffer_load_dwordx4 v3, s[92:95], s53 offen offset:0 lds
    s_cmp_ge_u32 s4, 7
    s_cbranch_scc0 KSBE8
    buffer_store_dwordx4 v[224:227], v2, s[44:47], s83 offen offset:2048 sc1
KSBE8:
    v_mfma_f32_16x16x32_bf16 v[164:167], v[40:43], v[116:119], v[164:167]
    ds_read_b64_tr_b16 v[30:31], v5 offset:1024
    s_mov_b32 s53, 3439616
    buffer_load_dwordx4 v3, s[92:95], s53 offen offset:1024 lds
    s_waitcnt lgkmcnt(8)
    v_mfma_f32_16x16x32_bf16 v[168:171], v[44:47], v[112:115], v[168:171]
    ds_read_b64_tr_b16 v[32:33], v6 offset:0
    s_add_u32 m0, s97, 155648
    s_add_u32 s53, s98, 65536
    buffer_load_dwordx4 v2, s[44:47], s53 offen sc1 lds
    v_mfma_f32_16x16x32_bf16 v[172:175], v[44:47], v[116:119], v[172:175]
    ds_read_b64_tr_b16 v[34:35], v6 offset:1024
    s_waitcnt lgkmcnt(8)
    v_mfma_f32_16x16x32_bf16 v[176:179], v[48:51], v[112:115], v[176:179]
    ds_read_b64_tr_b16 v[36:37], v7 offset:0
    v_mfma_f32_16x16x32_bf16 v[180:183], v[48:51], v[116:119], v[180:183]
    ds_read_b64_tr_b16 v[38:39], v7 offset:1024
    s_cmp_ge_u32 s4, 7
    s_cbranch_scc1 KSBL4
    buffer_store_dwordx4 v[208:211], v2, s[44:47], s83 offen offset:1024 sc1
KSBL4:
    s_waitcnt lgkmcnt(8)
    v_mfma_f32_16x16x32_bf16 v[184:187], v[52:55], v[112:115], v[184:187]
    ds_read_b64_tr_b16 v[40:41], v8 offset:0
    v_mfma_f32_16x16x32_bf16 v[188:191], v[52:55], v[116:119], v[188:191]
    ds_read_b64_tr_b16 v[42:43], v8 offset:1024
    s_waitcnt lgkmcnt(8)
    v_mfma_f32_16x16x32_bf16 v[56:59], v[24:27], v[120:123], v[56:59]
    ds_read_b64_tr_b16 v[44:45], v9 offset:0
    s_add_u32 s53, s99, 8192
    buffer_load_dwordx4 v[112:115], v2, s[44:47], s53 offen sc1
    v_mfma_f32_16x16x32_bf16 v[60:63], v[24:27], v[124:127], v[60:63]
    ds_read_b64_tr_b16 v[46:47], v9 offset:1024
    s_add_u32 s53, s99, 26624
    buffer_load_dwordx4 v[116:119], v2, s[44:47], s53 offen sc1
    s_waitcnt lgkmcnt(8)
    v_mfma_f32_16x16x32_bf16 v[64:67], v[28:31], v[120:123], v[64:67]
    ds_read_b64_tr_b16 v[48:49], v10 offset:0
    s_cmp_ge_u32 s4, 7
    s_cbranch_scc0 KSBE9
    buffer_store_dwordx4 v[228:231], v2, s[44:47], s82 offen offset:2048 sc1
KSBE9:
    v_mfma_f32_16x16x32_bf16 v[68:71], v[28:31], v[124:127], v[68:71]
    ds_read_b64_tr_b16 v[50:51], v10 offset:1024
    s_waitcnt lgkmcnt(8)
    v_mfma_f32_16x16x32_bf16 v[72:75], v[32:35], v[120:123], v[72:75]
    ds_read_b64_tr_b16 v[52:53], v11 offset:0
    v_mfma_f32_16x16x32_bf16 v[76:79], v[32:35], v[124:127], v[76:79]
    ds_read_b64_tr_b16 v[54:55], v11 offset:1024
    s_waitcnt lgkmcnt(8)
    v_mfma_f32_16x16x32_bf16 v[80:83], v[36:39], v[120:123], v[80:83]
    ds_read_b64_tr_b16 v[24:25], v12 offset:0
    v_mfma_f32_16x16x32_bf16 v[84:87], v[36:39], v[124:127], v[84:87]
    ds_read_b64_tr_b16 v[26:27], v12 offset:512
    s_waitcnt lgkmcnt(8)
    v_mfma_f32_16x16x32_bf16 v[128:131], v[40:43], v[120:123], v[128:131]
    ds_read_b64_tr_b16 v[28:29], v16 offset:0
    v_mfma_f32_16x16x32_bf16 v[132:135], v[40:43], v[124:127], v[132:135]
    ds_read_b64_tr_b16 v[30:31], v16 offset:512
    s_waitcnt lgkmcnt(8)
    v_mfma_f32_16x16x32_bf16 v[136:139], v[44:47], v[120:123], v[136:139]
    ds_read_b64_tr_b16 v[32:33], v17 offset:0
    v_mfma_f32_16x16x32_bf16 v[140:143], v[44:47], v[124:127], v[140:143]
    ds_read_b64_tr_b16 v[34:35], v17 offset:512
    s_waitcnt lgkmcnt(8)
    v_mfma_f32_16x16x32_bf16 v[144:147], v[48:51], v[120:123], v[144:147]
    ds_read_b64_tr_b16 v[36:37], v18 offset:0
    s_cmp_ge_u32 s4, 7
    s_cbranch_scc0 KSBE10
    buffer_store_dwordx4 v[232:235], v2, s[44:47], s85 offen offset:2048 sc1
KSBE10:
    v_mfma_f32_16x16x32_bf16 v[148:151], v[48:51], v[124:127], v[148:151]
    ds_read_b64_tr_b16 v[38:39], v18 offset:512
    s_waitcnt lgkmcnt(8)
    v_mfma_f32_16x16x32_bf16 v[152:155], v[52:55], v[120:123], v[152:155]
    ds_read_b64_tr_b16 v[40:41], v4 offset:8192
    v_mfma_f32_16x16x32_bf16 v[156:159], v[52:55], v[124:127], v[156:159]
    ds_read_b64_tr_b16 v[42:43], v4 offset:9216
    s_waitcnt lgkmcnt(8)
    v_mfma_f32_16x16x32_bf16 v[160:163], v[24:27], v[120:123], v[160:163]
    ds_read_b64_tr_b16 v[44:45], v5 offset:8192
    v_mfma_f32_16x16x32_bf16 v[164:167], v[24:27], v[124:127], v[164:167]
    ds_read_b64_tr_b16 v[46:47], v5 offset:9216
    s_cmp_ge_u32 s4, 7
    s_cbranch_scc1 KSBL5
    buffer_store_dwordx4 v[212:215], v2, s[44:47], s82 offen offset:1024 sc1
KSBL5:
    s_waitcnt lgkmcnt(8)
    v_mfma_f32_16x16x32_bf16 v[168:171], v[28:31], v[120:123], v[168:171]
    ds_read_b64_tr_b16 v[48:49], v6 offset:8192
    v_mfma_f32_16x16x32_bf16 v[172:175], v[28:31], v[124:127], v[172:175]
    ds_read_b64_tr_b16 v[50:51], v6 offset:9216
    s_waitcnt lgkmcnt(8)
    v_mfma_f32_16x16x32_bf16 v[176:179], v[32:35], v[120:123], v[176:179]
    ds_read_b64_tr_b16 v[52:53], v7 offset:8192
    v_mfma_f32_16x16x32_bf16 v[180:183], v[32:35], v[124:127], v[180:183]
    ds_read_b64_tr_b16 v[54:55], v7 offset:9216
    s_waitcnt lgkmcnt(8)
    v_mfma_f32_16x16x32_bf16 v[184:187], v[36:39], v[120:123], v[184:187]
    ds_read_b64_tr_b16 v[24:25], v8 offset:8192
    s_cmp_ge_u32 s4, 7
    s_cbranch_scc0 KSBE11
    buffer_store_dwordx4 v[236:239], v2, s[44:47], s84 offen offset:2048 sc1
KSBE11:
    v_mfma_f32_16x16x32_bf16 v[188:191], v[36:39], v[124:127], v[188:191]
    ds_read_b64_tr_b16 v[26:27], v8 offset:9216
    s_waitcnt vmcnt(10) lgkmcnt(8)
    v_mfma_f32_16x16x32_bf16 v[56:59], v[40:43], v[88:91], v[56:59]
    ds_read_b64_tr_b16 v[28:29], v9 offset:8192
    s_add_u32 s53, s99, 9216
    buffer_load_dwordx4 v[120:123], v2, s[44:47], s53 offen sc1
    s_waitcnt vmcnt(10)
    v_mfma_f32_16x16x32_bf16 v[60:63], v[40:43], v[92:95], v[60:63]
    ds_read_b64_tr_b16 v[30:31], v9 offset:9216
    s_add_u32 s53, s99, 27648
    buffer_load_dwordx4 v[124:127], v2, s[44:47], s53 offen sc1
    s_waitcnt lgkmcnt(8)
    v_mfma_f32_16x16x32_bf16 v[64:67], v[44:47], v[88:91], v[64:67]
    ds_read_b64_tr_b16 v[32:33], v10 offset:8192
    v_mfma_f32_16x16x32_bf16 v[68:71], v[44:47], v[92:95], v[68:71]
    ds_read_b64_tr_b16 v[34:35], v10 offset:9216
    s_waitcnt lgkmcnt(8)
    v_mfma_f32_16x16x32_bf16 v[72:75], v[48:51], v[88:91], v[72:75]
    ds_read_b64_tr_b16 v[36:37], v11 offset:8192
    v_mfma_f32_16x16x32_bf16 v[76:79], v[48:51], v[92:95], v[76:79]
    ds_read_b64_tr_b16 v[38:39], v11 offset:9216
    s_waitcnt lgkmcnt(8)
    v_mfma_f32_16x16x32_bf16 v[80:83], v[52:55], v[88:91], v[80:83]
    ds_read_b64_tr_b16 v[40:41], v12 offset:4096
    v_mfma_f32_16x16x32_bf16 v[84:87], v[52:55], v[92:95], v[84:87]
    ds_read_b64_tr_b16 v[42:43], v12 offset:4608
    s_waitcnt lgkmcnt(8)
    v_mfma_f32_16x16x32_bf16 v[128:131], v[24:27], v[88:91], v[128:131]
    ds_read_b64_tr_b16 v[44:45], v16 offset:4096
    s_cmp_ge_u32 s4, 7
    s_cbranch_scc0 KSBE12
    buffer_store_dwordx4 v[240:243], v2, s[44:47], s83 offen offset:3072 sc1
KSBE12:
    v_mfma_f32_16x16x32_bf16 v[132:135], v[24:27], v[92:95], v[132:135]
    ds_read_b64_tr_b16 v[46:47], v16 offset:4608
    s_waitcnt lgkmcnt(8)
    v_mfma_f32_16x16x32_bf16 v[136:139], v[28:31], v[88:91], v[136:139]
    ds_read_b64_tr_b16 v[48:49], v17 offset:4096
    v_mfma_f32_16x16x32_bf16 v[140:143], v[28:31], v[92:95], v[140:143]
    ds_read_b64_tr_b16 v[50:51], v17 offset:4608
    s_waitcnt lgkmcnt(8)
    v_mfma_f32_16x16x32_bf16 v[144:147], v[32:35], v[88:91], v[144:147]
    ds_read_b64_tr_b16 v[52:53], v18 offset:4096
    v_mfma_f32_16x16x32_bf16 v[148:151], v[32:35], v[92:95], v[148:151]
    ds_read_b64_tr_b16 v[54:55], v18 offset:4608
    s_cmp_ge_u32 s4, 7
    s_cbranch_scc1 KSBL6
    buffer_store_dwordx4 v[216:219], v2, s[44:47], s85 offen offset:1024 sc1
KSBL6:
    s_waitcnt lgkmcnt(8)
    v_mfma_f32_16x16x32_bf16 v[152:155], v[36:39], v[88:91], v[152:155]
    v_add_u32 v4, 0xfffe8000, v4
    v_add_u32 v5, 0xfffe8000, v5
    v_add_u32 v6, 0xfffe8000, v6
    v_add_u32 v7, 0xfffe8000, v7
    v_add_u32 v8, 0xfffe8000, v8
    v_add_u32 v9, 0xfffe8000, v9
    v_add_u32 v10, 0xfffe8000, v10
    v_add_u32 v11, 0xfffe8000, v11
    v_add_u32 v12, 0x2000, v12
    v_add_u32 v16, 0x2000, v16
    v_add_u32 v17, 0x2000, v17
    v_add_u32 v18, 0x2000, v18
    s_barrier
    ds_read_b64_tr_b16 v[24:25], v4 offset:0
    v_mfma_f32_16x16x32_bf16 v[156:159], v[36:39], v[92:95], v[156:159]
    ds_read_b64_tr_b16 v[26:27], v4 offset:1024
    s_waitcnt lgkmcnt(8)
    v_mfma_f32_16x16x32_bf16 v[160:163], v[40:43], v[88:91], v[160:163]
    ds_read_b64_tr_b16 v[28:29], v5 offset:0
    s_add_u32 m0, s96, 81920
    s_mov_b32 s53, 3932160
    buffer_load_dwordx4 v3, s[92:95], s53 offen offset:0 lds
    v_mfma_f32_16x16x32_bf16 v[164:167], v[40:43], v[92:95], v[164:167]
    ds_read_b64_tr_b16 v[30:31], v5 offset:1024
    s_mov_b32 s53, 3963904
    buffer_load_dwordx4 v3, s[92:95], s53 offen offset:1024 lds
    s_waitcnt lgkmcnt(8)
    v_mfma_f32_16x16x32_bf16 v[168:171], v[44:47], v[88:91], v[168:171]
    ds_read_b64_tr_b16 v[32:33], v6 offset:0
    s_add_u32 m0, s97, 98304
    s_add_u32 s53, s98, 49152
    buffer_load_dwordx4 v2, s[44:47], s53 offen sc1 lds
    s_cmp_ge_u32 s4, 7
    s_cbranch_scc0 KSBE13
    buffer_store_dwordx4 v[244:247], v2, s[44:47], s82 offen offset:3072 sc1
KSBE13:
    v_mfma_f32_16x16x32_bf16 v[172:175], v[44:47], v[92:95], v[172:175]
    ds_read_b64_tr_b16 v[34:35], v6 offset:1024
    s_add_u32 m0, s97, 106496
    s_add_u32 s53, s98, 57344
    buffer_load_dwordx4 v2, s[44:47], s53 offen sc1 lds
    s_waitcnt lgkmcnt(8)
    v_mfma_f32_16x16x32_bf16 v[176:179], v[48:51], v[88:91], v[176:179]
    ds_read_b64_tr_b16 v[36:37], v7 offset:0
    v_mfma_f32_16x16x32_bf16 v[180:183], v[48:51], v[92:95], v[180:183]
    ds_read_b64_tr_b16 v[38:39], v7 offset:1024
    s_waitcnt lgkmcnt(8)
    v_mfma_f32_16x16x32_bf16 v[184:187], v[52:55], v[88:91], v[184:187]
    ds_read_b64_tr_b16 v[40:41], v8 offset:0
    v_mfma_f32_16x16x32_bf16 v[188:191], v[52:55], v[92:95], v[188:191]
    ds_read_b64_tr_b16 v[42:43], v8 offset:1024
    s_waitcnt vmcnt(14) lgkmcnt(8)
    v_mfma_f32_16x16x32_bf16 v[56:59], v[24:27], v[96:99], v[56:59]
    ds_read_b64_tr_b16 v[44:45], v9 offset:0
    s_add_u32 s53, s99, 10240
    buffer_load_dwordx4 v[88:91], v2, s[44:47], s53 offen sc1
    s_waitcnt vmcnt(14)
    v_mfma_f32_16x16x32_bf16 v[60:63], v[24:27], v[100:103], v[60:63]
    ds_read_b64_tr_b16 v[46:47], v9 offset:1024
    s_add_u32 s53, s99, 28672
    buffer_load_dwordx4 v[92:95], v2, s[44:47], s53 offen sc1
    s_waitcnt lgkmcnt(8)
    v_mfma_f32_16x16x32_bf16 v[64:67], v[28:31], v[96:99], v[64:67]
    ds_read_b64_tr_b16 v[48:49], v10 offset:0
    v_mfma_f32_16x16x32_bf16 v[68:71], v[28:31], v[100:103], v[68:71]
    ds_read_b64_tr_b16 v[50:51], v10 offset:1024
    s_waitcnt lgkmcnt(8)
    v_mfma_f32_16x16x32_bf16 v[72:75], v[32:35], v[96:99], v[72:75]
    ds_read_b64_tr_b16 v[52:53], v11 offset:0
    s_cmp_ge_u32 s4, 7
    s_cbranch_scc0 KSBE14
    buffer_store_dwordx4 v[248:251], v2, s[44:47], s85 offen offset:3072 sc1
KSBE14:
    v_mfma_f32_16x16x32_bf16 v[76:79], v[32:35], v[100:103], v[76:79]
    ds_read_b64_tr_b16 v[54:55], v11 offset:1024
    s_waitcnt lgkmcnt(8)
    v_mfma_f32_16x16x32_bf16 v[80:83], v[36:39], v[96:99], v[80:83]
    ds_read_b64_tr_b16 v[24:25], v12 offset:0
    v_mfma_f32_16x16x32_bf16 v[84:87], v[36:39], v[100:103], v[84:87]
    ds_read_b64_tr_b16 v[26:27], v12 offset:512
    s_waitcnt lgkmcnt(8)
    v_mfma_f32_16x16x32_bf16 v[128:131], v[40:43], v[96:99], v[128:131]
    ds_read_b64_tr_b16 v[28:29], v16 offset:0
    v_mfma_f32_16x16x32_bf16 v[132:135], v[40:43], v[100:103], v[132:135]
    ds_read_b64_tr_b16 v[30:31], v16 offset:512
    s_cmp_ge_u32 s4, 7
    s_cbranch_scc1 KSBL7
    buffer_store_dwordx4 v[220:223], v2, s[44:47], s84 offen offset:1024 sc1
KSBL7:
    s_waitcnt lgkmcnt(8)
    v_mfma_f32_16x16x32_bf16 v[136:139], v[44:47], v[96:99], v[136:139]
    ds_read_b64_tr_b16 v[32:33], v17 offset:0
    v_mfma_f32_16x16x32_bf16 v[140:143], v[44:47], v[100:103], v[140:143]
    ds_read_b64_tr_b16 v[34:35], v17 offset:512
    s_waitcnt lgkmcnt(8)
    v_mfma_f32_16x16x32_bf16 v[144:147], v[48:51], v[96:99], v[144:147]
    ds_read_b64_tr_b16 v[36:37], v18 offset:0
    v_mfma_f32_16x16x32_bf16 v[148:151], v[48:51], v[100:103], v[148:151]
    ds_read_b64_tr_b16 v[38:39], v18 offset:512
    s_waitcnt lgkmcnt(8)
    v_mfma_f32_16x16x32_bf16 v[152:155], v[52:55], v[96:99], v[152:155]
    ds_read_b64_tr_b16 v[40:41], v4 offset:8192
    s_cmp_ge_u32 s4, 7
    s_cbranch_scc0 KSBE15
    buffer_store_dwordx4 v[252:255], v2, s[44:47], s84 offen offset:3072 sc1
KSBE15:
    v_mfma_f32_16x16x32_bf16 v[156:159], v[52:55], v[100:103], v[156:159]
    ds_read_b64_tr_b16 v[42:43], v4 offset:9216
    s_waitcnt lgkmcnt(8)
    v_mfma_f32_16x16x32_bf16 v[160:163], v[24:27], v[96:99], v[160:163]
    ds_read_b64_tr_b16 v[44:45], v5 offset:8192
    v_mfma_f32_16x16x32_bf16 v[164:167], v[24:27], v[100:103], v[164:167]
    ds_read_b64_tr_b16 v[46:47], v5 offset:9216
    s_waitcnt lgkmcnt(8)
    v_mfma_f32_16x16x32_bf16 v[168:171], v[28:31], v[96:99], v[168:171]
    ds_read_b64_tr_b16 v[48:49], v6 offset:8192
    v_mfma_f32_16x16x32_bf16 v[172:175], v[28:31], v[100:103], v[172:175]
    ds_read_b64_tr_b16 v[50:51], v6 offset:9216
    s_waitcnt lgkmcnt(8)
    v_mfma_f32_16x16x32_bf16 v[176:179], v[32:35], v[96:99], v[176:179]
    ds_read_b64_tr_b16 v[52:53], v7 offset:8192
    v_mfma_f32_16x16x32_bf16 v[180:183], v[32:35], v[100:103], v[180:183]
    ds_read_b64_tr_b16 v[54:55], v7 offset:9216
    s_waitcnt lgkmcnt(8)
    v_mfma_f32_16x16x32_bf16 v[184:187], v[36:39], v[96:99], v[184:187]
    ds_read_b64_tr_b16 v[24:25], v8 offset:8192
    v_mfma_f32_16x16x32_bf16 v[188:191], v[36:39], v[100:103], v[188:191]
    ds_read_b64_tr_b16 v[26:27], v8 offset:9216
    s_waitcnt vmcnt(14) lgkmcnt(8)
    v_mfma_f32_16x16x32_bf16 v[56:59], v[40:43], v[104:107], v[56:59]
    ds_read_b64_tr_b16 v[28:29], v9 offset:8192
    s_add_u32 s53, s99, 11264
    buffer_load_dwordx4 v[96:99], v2, s[44:47], s53 offen sc1
    s_waitcnt vmcnt(14)
    v_mfma_f32_16x16x32_bf16 v[60:63], v[40:43], v[108:111], v[60:63]
    ds_read_b64_tr_b16 v[30:31], v9 offset:9216
    s_add_u32 s53, s99, 29696
    buffer_load_dwordx4 v[100:103], v2, s[44:47], s53 offen sc1
    s_waitcnt lgkmcnt(8)
    v_mfma_f32_16x16x32_bf16 v[64:67], v[44:47], v[104:107], v[64:67]
    ds_read_b64_tr_b16 v[32:33], v10 offset:8192
    v_mfma_f32_16x16x32_bf16 v[68:71], v[44:47], v[108:111], v[68:71]
    ds_read_b64_tr_b16 v[34:35], v10 offset:9216
    s_waitcnt lgkmcnt(8)
    v_mfma_f32_16x16x32_bf16 v[72:75], v[48:51], v[104:107], v[72:75]
    ds_read_b64_tr_b16 v[36:37], v11 offset:8192
    v_mfma_f32_16x16x32_bf16 v[76:79], v[48:51], v[108:111], v[76:79]
    ds_read_b64_tr_b16 v[38:39], v11 offset:9216
    s_cmp_ge_u32 s4, 7
    s_cbranch_scc1 KSBL8
    buffer_store_dwordx4 v[224:227], v2, s[44:47], s83 offen offset:2048 sc1
KSBL8:
    s_waitcnt lgkmcnt(8)
    v_mfma_f32_16x16x32_bf16 v[80:83], v[52:55], v[104:107], v[80:83]
    ds_read_b64_tr_b16 v[40:41], v12 offset:4096
    v_mfma_f32_16x16x32_bf16 v[84:87], v[52:55], v[108:111], v[84:87]
    ds_read_b64_tr_b16 v[42:43], v12 offset:4608
    s_waitcnt lgkmcnt(8)
    v_mfma_f32_16x16x32_bf16 v[128:131], v[24:27], v[104:107], v[128:131]
    ds_read_b64_tr_b16 v[44:45], v16 offset:4096
    v_mfma_f32_16x16x32_bf16 v[132:135], v[24:27], v[108:111], v[132:135]
    ds_read_b64_tr_b16 v[46:47], v16 offset:4608
    s_waitcnt lgkmcnt(8)
    v_mfma_f32_16x16x32_bf16 v[136:139], v[28:31], v[104:107], v[136:139]
    ds_read_b64_tr_b16 v[48:49], v17 offset:4096
    v_mfma_f32_16x16x32_bf16 v[140:143], v[28:31], v[108:111], v[140:143]
    ds_read_b64_tr_b16 v[50:51], v17 offset:4608
    s_waitcnt lgkmcnt(8)
    v_mfma_f32_16x16x32_bf16 v[144:147], v[32:35], v[104:107], v[144:147]
    ds_read_b64_tr_b16 v[52:53], v18 offset:4096
    v_mfma_f32_16x16x32_bf16 v[148:151], v[32:35], v[108:111], v[148:151]
    ds_read_b64_tr_b16 v[54:55], v18 offset:4608
    s_waitcnt lgkmcnt(8)
    v_mfma_f32_16x16x32_bf16 v[152:155], v[36:39], v[104:107], v[152:155]
    v_add_u32 v4, 0x4000, v4
    v_add_u32 v5, 0x4000, v5
    v_add_u32 v6, 0x4000, v6
    v_add_u32 v7, 0x4000, v7
    v_add_u32 v8, 0x4000, v8
    v_add_u32 v9, 0x4000, v9
    v_add_u32 v10, 0x4000, v10
    v_add_u32 v11, 0x4000, v11
    v_add_u32 v12, 0x1e000, v12
    v_add_u32 v16, 0x1e000, v16
    v_add_u32 v17, 0x1e000, v17
    v_add_u32 v18, 0x1e000, v18
    s_barrier
    ds_read_b64_tr_b16 v[24:25], v4 offset:0
    v_mfma_f32_16x16x32_bf16 v[156:159], v[36:39], v[108:111], v[156:159]
    ds_read_b64_tr_b16 v[26:27], v4 offset:1024
    s_waitcnt lgkmcnt(8)
    v_mfma_f32_16x16x32_bf16 v[160:163], v[40:43], v[104:107], v[160:163]
    ds_read_b64_tr_b16 v[28:29], v5 offset:0
    s_add_u32 m0, s96, 114688
    s_mov_b32 s53, 4456448
    buffer_load_dwordx4 v3, s[92:95], s53 offen offset:0 lds
    v_mfma_f32_16x16x32_bf16 v[164:167], v[40:43], v[108:111], v[164:167]
    ds_read_b64_tr_b16 v[30:31], v5 offset:1024
    s_mov_b32 s53, 4488192
    buffer_load_dwordx4 v3, s[92:95], s53 offen offset:1024 lds
    s_waitcnt lgkmcnt(8)
    v_mfma_f32_16x16x32_bf16 v[168:171], v[44:47], v[104:107], v[168:171]
    ds_read_b64_tr_b16 v[32:33], v6 offset:0
    v_mfma_f32_16x16x32_bf16 v[172:175], v[44:47], v[108:111], v[172:175]
    ds_read_b64_tr_b16 v[34:35], v6 offset:1024
    s_waitcnt lgkmcnt(8)
    v_mfma_f32_16x16x32_bf16 v[176:179], v[48:51], v[104:107], v[176:179]
    ds_read_b64_tr_b16 v[36:37], v7 offset:0
    v_mfma_f32_16x16x32_bf16 v[180:183], v[48:51], v[108:111], v[180:183]
    ds_read_b64_tr_b16 v[38:39], v7 offset:1024
    s_waitcnt lgkmcnt(8)
    v_mfma_f32_16x16x32_bf16 v[184:187], v[52:55], v[104:107], v[184:187]
    ds_read_b64_tr_b16 v[40:41], v8 offset:0
    v_mfma_f32_16x16x32_bf16 v[188:191], v[52:55], v[108:111], v[188:191]
    ds_read_b64_tr_b16 v[42:43], v8 offset:1024
    s_waitcnt vmcnt(13) lgkmcnt(8)
    v_mfma_f32_16x16x32_bf16 v[56:59], v[24:27], v[112:115], v[56:59]
    ds_read_b64_tr_b16 v[44:45], v9 offset:0
    s_add_u32 s53, s99, 12288
    buffer_load_dwordx4 v[104:107], v2, s[44:47], s53 offen sc1
    s_waitcnt vmcnt(13)
    v_mfma_f32_16x16x32_bf16 v[60:63], v[24:27], v[116:119], v[60:63]
    ds_read_b64_tr_b16 v[46:47], v9 offset:1024
    s_cmp_ge_u32 s4, 7
    s_cbranch_scc1 KSBL9
    buffer_store_dwordx4 v[228:231], v2, s[44:47], s82 offen offset:2048 sc1
KSBL9:
    s_add_u32 s53, s99, 30720
    buffer_load_dwordx4 v[108:111], v2, s[44:47], s53 offen sc1
    s_waitcnt lgkmcnt(8)
    v_mfma_f32_16x16x32_bf16 v[64:67], v[28:31], v[112:115], v[64:67]
    ds_read_b64_tr_b16 v[48:49], v10 offset:0
    v_mfma_f32_16x16x32_bf16 v[68:71], v[28:31], v[116:119], v[68:71]
    ds_read_b64_tr_b16 v[50:51], v10 offset:1024
    s_waitcnt lgkmcnt(8)
    v_mfma_f32_16x16x32_bf16 v[72:75], v[32:35], v[112:115], v[72:75]
    ds_read_b64_tr_b16 v[52:53], v11 offset:0
    v_mfma_f32_16x16x32_bf16 v[76:79], v[32:35], v[116:119], v[76:79]
    ds_read_b64_tr_b16 v[54:55], v11 offset:1024
    s_waitcnt lgkmcnt(8)
    v_mfma_f32_16x16x32_bf16 v[80:83], v[36:39], v[112:115], v[80:83]
    ds_read_b64_tr_b16 v[24:25], v12 offset:0
    v_mfma_f32_16x16x32_bf16 v[84:87], v[36:39], v[116:119], v[84:87]
    ds_read_b64_tr_b16 v[26:27], v12 offset:512
    s_waitcnt lgkmcnt(8)
    v_mfma_f32_16x16x32_bf16 v[128:131], v[40:43], v[112:115], v[128:131]
    ds_read_b64_tr_b16 v[28:29], v16 offset:0
    s_lshl_b32 s6, s3, 19
    v_mfma_f32_16x16x32_bf16 v[132:135], v[40:43], v[116:119], v[132:135]
    ds_read_b64_tr_b16 v[30:31], v16 offset:512
    s_add_u32 s60, s6, s80
    s_waitcnt lgkmcnt(8)
    v_mfma_f32_16x16x32_bf16 v[136:139], v[44:47], v[112:115], v[136:139]
    ds_read_b64_tr_b16 v[32:33], v17 offset:0
    s_add_u32 s61, s60, 16777216
    v_mfma_f32_16x16x32_bf16 v[140:143], v[44:47], v[116:119], v[140:143]
    ds_read_b64_tr_b16 v[34:35], v17 offset:512
    s_lshr_b32 s66, s7, 6
    s_waitcnt lgkmcnt(8)
    v_mfma_f32_16x16x32_bf16 v[144:147], v[48:51], v[112:115], v[144:147]
    ds_read_b64_tr_b16 v[36:37], v18 offset:0
    s_lshl_b32 s6, s4, 1
    v_mfma_f32_16x16x32_bf16 v[148:151], v[48:51], v[116:119], v[148:151]
    ds_read_b64_tr_b16 v[38:39], v18 offset:512
    s_sub_u32 s67, 31, s6
    s_waitcnt lgkmcnt(8)
    v_mfma_f32_16x16x32_bf16 v[152:155], v[52:55], v[112:115], v[152:155]
    ds_read_b64_tr_b16 v[40:41], v4 offset:8192
    s_mov_b32 s70, 0x3e0293ee
    v_mfma_f32_16x16x32_bf16 v[156:159], v[52:55], v[116:119], v[156:159]
    ds_read_b64_tr_b16 v[42:43], v4 offset:9216
    s_mov_b32 s71, 0x3e0293ee
    s_waitcnt lgkmcnt(8)
    v_mfma_f32_16x16x32_bf16 v[160:163], v[24:27], v[112:115], v[160:163]
    ds_read_b64_tr_b16 v[44:45], v5 offset:8192
    s_mov_b32 s68, 0x3fb8aa3b
    v_mfma_f32_16x16x32_bf16 v[164:167], v[24:27], v[116:119], v[164:167]
    ds_read_b64_tr_b16 v[46:47], v5 offset:9216
    s_mul_i32 s6, s66, 598016
    s_waitcnt lgkmcnt(8)
    v_mfma_f32_16x16x32_bf16 v[168:171], v[28:31], v[112:115], v[168:171]
    ds_read_b64_tr_b16 v[48:49], v6 offset:8192
    s_lshr_b32 s8, s7, 4
    v_mfma_f32_16x16x32_bf16 v[172:175], v[28:31], v[116:119], v[172:175]
    ds_read_b64_tr_b16 v[50:51], v6 offset:9216
    s_and_b32 s8, s8, 3
    s_waitcnt lgkmcnt(8)
    v_mfma_f32_16x16x32_bf16 v[176:179], v[32:35], v[112:115], v[176:179]
    ds_read_b64_tr_b16 v[52:53], v7 offset:8192
    s_lshl_b32 s8, s8, 10
    v_mfma_f32_16x16x32_bf16 v[180:183], v[32:35], v[116:119], v[180:183]
    ds_read_b64_tr_b16 v[54:55], v7 offset:9216
    s_cmp_ge_u32 s4, 7
    s_cbranch_scc1 KSBL10
    buffer_store_dwordx4 v[232:235], v2, s[44:47], s85 offen offset:2048 sc1
KSBL10:
    s_add_u32 s6, s6, s8
    s_waitcnt lgkmcnt(8)
    v_mfma_f32_16x16x32_bf16 v[184:187], v[36:39], v[112:115], v[184:187]
    ds_read_b64_tr_b16 v[24:25], v8 offset:8192
    s_add_u32 s69, s6, 33554432
    v_mfma_f32_16x16x32_bf16 v[188:191], v[36:39], v[116:119], v[188:191]
    ds_read_b64_tr_b16 v[26:27], v8 offset:9216
    v_lshrrev_b32 v22, 4, v1
    s_waitcnt vmcnt(13) lgkmcnt(8)
    v_mfma_f32_16x16x32_bf16 v[56:59], v[40:43], v[120:123], v[56:59]
    ds_read_b64_tr_b16 v[28:29], v9 offset:8192
    s_add_u32 s53, s99, 13312
    buffer_load_dwordx4 v[112:115], v2, s[44:47], s53 offen sc1
    v_cmp_gt_u32 vcc, 2, v22
    s_waitcnt vmcnt(13)
    v_mfma_f32_16x16x32_bf16 v[60:63], v[40:43], v[124:127], v[60:63]
    ds_read_b64_tr_b16 v[30:31], v9 offset:9216
    s_add_u32 s53, s99, 31744
    buffer_load_dwordx4 v[116:119], v2, s[44:47], s53 offen sc1
    v_cndmask_b32 v23, 0, 1.0, vcc
    s_waitcnt lgkmcnt(8)
    v_mfma_f32_16x16x32_bf16 v[64:67], v[44:47], v[120:123], v[64:67]
    ds_read_b64_tr_b16 v[32:33], v10 offset:8192
    v_mov_b32 v22, 0xff800000
    v_mfma_f32_16x16x32_bf16 v[68:71], v[44:47], v[124:127], v[68:71]
    ds_read_b64_tr_b16 v[34:35], v10 offset:9216
    s_waitcnt lgkmcnt(8)
    v_mfma_f32_16x16x32_bf16 v[72:75], v[48:51], v[120:123], v[72:75]
    ds_read_b64_tr_b16 v[36:37], v11 offset:8192
    v_mfma_f32_16x16x32_bf16 v[76:79], v[48:51], v[124:127], v[76:79]
    ds_read_b64_tr_b16 v[38:39], v11 offset:9216
    s_waitcnt lgkmcnt(8)
    v_mfma_f32_16x16x32_bf16 v[80:83], v[52:55], v[120:123], v[80:83]
    ds_read_b64_tr_b16 v[40:41], v12 offset:4096
    v_mfma_f32_16x16x32_bf16 v[84:87], v[52:55], v[124:127], v[84:87]
    ds_read_b64_tr_b16 v[42:43], v12 offset:4608
    s_waitcnt lgkmcnt(8)
    v_mfma_f32_16x16x32_bf16 v[128:131], v[24:27], v[120:123], v[128:131]
    ds_read_b64_tr_b16 v[44:45], v16 offset:4096
    v_mfma_f32_16x16x32_bf16 v[132:135], v[24:27], v[124:127], v[132:135]
    ds_read_b64_tr_b16 v[46:47], v16 offset:4608
    s_waitcnt lgkmcnt(8)
    v_mfma_f32_16x16x32_bf16 v[136:139], v[28:31], v[120:123], v[136:139]
    ds_read_b64_tr_b16 v[48:49], v17 offset:4096
    v_mfma_f32_16x16x32_bf16 v[140:143], v[28:31], v[124:127], v[140:143]
    ds_read_b64_tr_b16 v[50:51], v17 offset:4608
    s_waitcnt lgkmcnt(8)
    v_mfma_f32_16x16x32_bf16 v[144:147], v[32:35], v[120:123], v[144:147]
    ds_read_b64_tr_b16 v[52:53], v18 offset:4096
    v_mfma_f32_16x16x32_bf16 v[148:151], v[32:35], v[124:127], v[148:151]
    ds_read_b64_tr_b16 v[54:55], v18 offset:4608
    s_waitcnt lgkmcnt(8)
    v_mfma_f32_16x16x32_bf16 v[152:155], v[36:39], v[120:123], v[152:155]
    v_add_u32 v4, 0x4000, v4
    v_add_u32 v5, 0x4000, v5
    v_add_u32 v6, 0x4000, v6
    v_add_u32 v7, 0x4000, v7
    v_add_u32 v8, 0x4000, v8
    v_add_u32 v9, 0x4000, v9
    v_add_u32 v10, 0x4000, v10
    v_add_u32 v11, 0x4000, v11
    v_add_u32 v12, 0x2000, v12
    v_add_u32 v16, 0x2000, v16
    v_add_u32 v17, 0x2000, v17
    v_add_u32 v18, 0x2000, v18
    s_waitcnt vmcnt(6)
    s_barrier
    ds_read_b64_tr_b16 v[24:25], v4 offset:0
    v_mfma_f32_16x16x32_bf16 v[156:159], v[36:39], v[124:127], v[156:159]
    ds_read_b64_tr_b16 v[26:27], v4 offset:1024
    s_waitcnt lgkmcnt(8)
    v_mfma_f32_16x16x32_bf16 v[160:163], v[40:43], v[120:123], v[160:163]
    ds_read_b64_tr_b16 v[28:29], v5 offset:0
    s_cmp_lg_u32 s5, 7
    s_cbranch_scc1 F_FKV
    s_lshl_b32 s6, s3, 7
    s_lshl_b32 s8, s4, 2
    s_add_u32 s6, s6, s8
    s_add_u32 s6, s6, 83886080
    s_cmp_ge_u32 s4, 7
    s_cselect_b32 s6, s6, s52
    v_mov_b32 v13, 1
    s_mov_b64 exec, 1
    buffer_store_dword v13, off, s[44:47], s6 sc1
    s_mov_b64 exec, -1
F_FKV:
    v_mfma_f32_16x16x32_bf16 v[164:167], v[40:43], v[124:127], v[164:167]
    ds_read_b64_tr_b16 v[30:31], v5 offset:1024
    s_cmp_ge_u32 s4, 7
    s_cbranch_scc1 KSBL11
    buffer_store_dwordx4 v[236:239], v2, s[44:47], s84 offen offset:2048 sc1
KSBL11:
    s_waitcnt lgkmcnt(8)
    v_mfma_f32_16x16x32_bf16 v[168:171], v[44:47], v[120:123], v[168:171]
    ds_read_b64_tr_b16 v[32:33], v6 offset:0
    v_mfma_f32_16x16x32_bf16 v[172:175], v[44:47], v[124:127], v[172:175]
    ds_read_b64_tr_b16 v[34:35], v6 offset:1024
    s_waitcnt lgkmcnt(8)
    v_mfma_f32_16x16x32_bf16 v[176:179], v[48:51], v[120:123], v[176:179]
    ds_read_b64_tr_b16 v[36:37], v7 offset:0
    v_mfma_f32_16x16x32_bf16 v[180:183], v[48:51], v[124:127], v[180:183]
    ds_read_b64_tr_b16 v[38:39], v7 offset:1024
    s_waitcnt lgkmcnt(8)
    v_mfma_f32_16x16x32_bf16 v[184:187], v[52:55], v[120:123], v[184:187]
    ds_read_b64_tr_b16 v[40:41], v8 offset:0
    v_mfma_f32_16x16x32_bf16 v[188:191], v[52:55], v[124:127], v[188:191]
    ds_read_b64_tr_b16 v[42:43], v8 offset:1024
    s_waitcnt lgkmcnt(8)
    v_mfma_f32_16x16x32_bf16 v[56:59], v[24:27], v[88:91], v[56:59]
    ds_read_b64_tr_b16 v[44:45], v9 offset:0
    s_add_u32 s53, s99, 14336
    buffer_load_dwordx4 v[120:123], v2, s[44:47], s53 offen sc1
    v_mfma_f32_16x16x32_bf16 v[60:63], v[24:27], v[92:95], v[60:63]
    ds_read_b64_tr_b16 v[46:47], v9 offset:1024
    s_add_u32 s53, s99, 32768
    buffer_load_dwordx4 v[124:127], v2, s[44:47], s53 offen sc1
    s_waitcnt lgkmcnt(8)
    v_mfma_f32_16x16x32_bf16 v[64:67], v[28:31], v[88:91], v[64:67]
    ds_read_b64_tr_b16 v[48:49], v10 offset:0
    v_mfma_f32_16x16x32_bf16 v[68:71], v[28:31], v[92:95], v[68:71]
    ds_read_b64_tr_b16 v[50:51], v10 offset:1024
    s_waitcnt lgkmcnt(8)
    v_mfma_f32_16x16x32_bf16 v[72:75], v[32:35], v[88:91], v[72:75]
    ds_read_b64_tr_b16 v[52:53], v11 offset:0
    v_mfma_f32_16x16x32_bf16 v[76:79], v[32:35], v[92:95], v[76:79]
    ds_read_b64_tr_b16 v[54:55], v11 offset:1024
    s_waitcnt lgkmcnt(8)
    v_mfma_f32_16x16x32_bf16 v[80:83], v[36:39], v[88:91], v[80:83]
    ds_read_b64_tr_b16 v[24:25], v12 offset:0
    v_mfma_f32_16x16x32_bf16 v[84:87], v[36:39], v[92:95], v[84:87]
    ds_read_b64_tr_b16 v[26:27], v12 offset:512
    s_waitcnt lgkmcnt(8)
    v_mfma_f32_16x16x32_bf16 v[128:131], v[40:43], v[88:91], v[128:131]
    ds_read_b64_tr_b16 v[28:29], v16 offset:0
    v_mfma_f32_16x16x32_bf16 v[132:135], v[40:43], v[92:95], v[132:135]
    ds_read_b64_tr_b16 v[30:31], v16 offset:512
    s_waitcnt lgkmcnt(8)
    v_mfma_f32_16x16x32_bf16 v[136:139], v[44:47], v[88:91], v[136:139]
    ds_read_b64_tr_b16 v[32:33], v17 offset:0
    v_mfma_f32_16x16x32_bf16 v[140:143], v[44:47], v[92:95], v[140:143]
    ds_read_b64_tr_b16 v[34:35], v17 offset:512
    s_waitcnt lgkmcnt(8)
    v_mfma_f32_16x16x32_bf16 v[144:147], v[48:51], v[88:91], v[144:147]
    ds_read_b64_tr_b16 v[36:37], v18 offset:0
    v_mfma_f32_16x16x32_bf16 v[148:151], v[48:51], v[92:95], v[148:151]
    ds_read_b64_tr_b16 v[38:39], v18 offset:512
    s_cmp_ge_u32 s4, 7
    s_cbranch_scc1 KSBL12
    buffer_store_dwordx4 v[240:243], v2, s[44:47], s83 offen offset:3072 sc1
KSBL12:
    s_waitcnt lgkmcnt(8)
    v_mfma_f32_16x16x32_bf16 v[152:155], v[52:55], v[88:91], v[152:155]
    ds_read_b64_tr_b16 v[40:41], v4 offset:8192
    v_mfma_f32_16x16x32_bf16 v[156:159], v[52:55], v[92:95], v[156:159]
    ds_read_b64_tr_b16 v[42:43], v4 offset:9216
    s_waitcnt lgkmcnt(8)
    v_mfma_f32_16x16x32_bf16 v[160:163], v[24:27], v[88:91], v[160:163]
    ds_read_b64_tr_b16 v[44:45], v5 offset:8192
    v_mfma_f32_16x16x32_bf16 v[164:167], v[24:27], v[92:95], v[164:167]
    ds_read_b64_tr_b16 v[46:47], v5 offset:9216
    s_waitcnt lgkmcnt(8)
    v_mfma_f32_16x16x32_bf16 v[168:171], v[28:31], v[88:91], v[168:171]
    ds_read_b64_tr_b16 v[48:49], v6 offset:8192
    v_mfma_f32_16x16x32_bf16 v[172:175], v[28:31], v[92:95], v[172:175]
    ds_read_b64_tr_b16 v[50:51], v6 offset:9216
    s_waitcnt lgkmcnt(8)
    v_mfma_f32_16x16x32_bf16 v[176:179], v[32:35], v[88:91], v[176:179]
    ds_read_b64_tr_b16 v[52:53], v7 offset:8192
    v_mfma_f32_16x16x32_bf16 v[180:183], v[32:35], v[92:95], v[180:183]
    ds_read_b64_tr_b16 v[54:55], v7 offset:9216
    s_waitcnt lgkmcnt(8)
    v_mfma_f32_16x16x32_bf16 v[184:187], v[36:39], v[88:91], v[184:187]
    ds_read_b64_tr_b16 v[24:25], v8 offset:8192
    v_mfma_f32_16x16x32_bf16 v[188:191], v[36:39], v[92:95], v[188:191]
    ds_read_b64_tr_b16 v[26:27], v8 offset:9216
    s_waitcnt lgkmcnt(8)
    v_mfma_f32_16x16x32_bf16 v[56:59], v[40:43], v[96:99], v[56:59]
    ds_read_b64_tr_b16 v[28:29], v9 offset:8192
    s_add_u32 s53, s99, 15360
    buffer_load_dwordx4 v[88:91], v2, s[44:47], s53 offen sc1
    v_mfma_f32_16x16x32_bf16 v[60:63], v[40:43], v[100:103], v[60:63]
    ds_read_b64_tr_b16 v[30:31], v9 offset:9216
    s_add_u32 s53, s99, 33792
    buffer_load_dwordx4 v[92:95], v2, s[44:47], s53 offen sc1
    s_waitcnt lgkmcnt(8)
    v_mfma_f32_16x16x32_bf16 v[64:67], v[44:47], v[96:99], v[64:67]
    ds_read_b64_tr_b16 v[32:33], v10 offset:8192
    v_mfma_f32_16x16x32_bf16 v[68:71], v[44:47], v[100:103], v[68:71]
    ds_read_b64_tr_b16 v[34:35], v10 offset:9216
    s_waitcnt lgkmcnt(8)
    v_mfma_f32_16x16x32_bf16 v[72:75], v[48:51], v[96:99], v[72:75]
    ds_read_b64_tr_b16 v[36:37], v11 offset:8192
    v_mfma_f32_16x16x32_bf16 v[76:79], v[48:51], v[100:103], v[76:79]
    ds_read_b64_tr_b16 v[38:39], v11 offset:9216
    s_waitcnt lgkmcnt(8)
    v_mfma_f32_16x16x32_bf16 v[80:83], v[52:55], v[96:99], v[80:83]
    ds_read_b64_tr_b16 v[40:41], v12 offset:4096
    v_mfma_f32_16x16x32_bf16 v[84:87], v[52:55], v[100:103], v[84:87]
    ds_read_b64_tr_b16 v[42:43], v12 offset:4608
    s_waitcnt lgkmcnt(8)
    v_mfma_f32_16x16x32_bf16 v[128:131], v[24:27], v[96:99], v[128:131]
    ds_read_b64_tr_b16 v[44:45], v16 offset:4096
    v_mfma_f32_16x16x32_bf16 v[132:135], v[24:27], v[100:103], v[132:135]
    ds_read_b64_tr_b16 v[46:47], v16 offset:4608
    s_cmp_ge_u32 s4, 7
    s_cbranch_scc1 KSBL13
    buffer_store_dwordx4 v[244:247], v2, s[44:47], s82 offen offset:3072 sc1
KSBL13:
    s_waitcnt lgkmcnt(8)
    v_mfma_f32_16x16x32_bf16 v[136:139], v[28:31], v[96:99], v[136:139]
    ds_read_b64_tr_b16 v[48:49], v17 offset:4096
    v_mfma_f32_16x16x32_bf16 v[140:143], v[28:31], v[100:103], v[140:143]
    ds_read_b64_tr_b16 v[50:51], v17 offset:4608
    s_waitcnt lgkmcnt(8)
    v_mfma_f32_16x16x32_bf16 v[144:147], v[32:35], v[96:99], v[144:147]
    ds_read_b64_tr_b16 v[52:53], v18 offset:4096
    v_mfma_f32_16x16x32_bf16 v[148:151], v[32:35], v[100:103], v[148:151]
    ds_read_b64_tr_b16 v[54:55], v18 offset:4608
    s_waitcnt lgkmcnt(8)
    v_mfma_f32_16x16x32_bf16 v[152:155], v[36:39], v[96:99], v[152:155]
    v_add_u32 v4, 0x4000, v4
    v_add_u32 v5, 0x4000, v5
    v_add_u32 v6, 0x4000, v6
    v_add_u32 v7, 0x4000, v7
    v_add_u32 v8, 0x4000, v8
    v_add_u32 v9, 0x4000, v9
    v_add_u32 v10, 0x4000, v10
    v_add_u32 v11, 0x4000, v11
    v_add_u32 v12, 0xffff6000, v12
    v_add_u32 v16, 0xffff6000, v16
    v_add_u32 v17, 0xffff6000, v17
    v_add_u32 v18, 0xffff6000, v18
    s_barrier
    ds_read_b64_tr_b16 v[24:25], v4 offset:0
    v_mfma_f32_16x16x32_bf16 v[156:159], v[36:39], v[100:103], v[156:159]
    ds_read_b64_tr_b16 v[26:27], v4 offset:1024
    s_waitcnt lgkmcnt(8)
    v_mfma_f32_16x16x32_bf16 v[160:163], v[40:43], v[96:99], v[160:163]
    ds_read_b64_tr_b16 v[28:29], v5 offset:0
    v_mfma_f32_16x16x32_bf16 v[164:167], v[40:43], v[100:103], v[164:167]
    ds_read_b64_tr_b16 v[30:31], v5 offset:1024
    s_waitcnt lgkmcnt(8)
    v_mfma_f32_16x16x32_bf16 v[168:171], v[44:47], v[96:99], v[168:171]
    ds_read_b64_tr_b16 v[32:33], v6 offset:0
    v_mfma_f32_16x16x32_bf16 v[172:175], v[44:47], v[100:103], v[172:175]
    ds_read_b64_tr_b16 v[34:35], v6 offset:1024
    s_waitcnt lgkmcnt(8)
    v_mfma_f32_16x16x32_bf16 v[176:179], v[48:51], v[96:99], v[176:179]
    ds_read_b64_tr_b16 v[36:37], v7 offset:0
    v_mfma_f32_16x16x32_bf16 v[180:183], v[48:51], v[100:103], v[180:183]
    ds_read_b64_tr_b16 v[38:39], v7 offset:1024
    s_waitcnt lgkmcnt(8)
    v_mfma_f32_16x16x32_bf16 v[184:187], v[52:55], v[96:99], v[184:187]
    ds_read_b64_tr_b16 v[40:41], v8 offset:0
    v_mfma_f32_16x16x32_bf16 v[188:191], v[52:55], v[100:103], v[188:191]
    ds_read_b64_tr_b16 v[42:43], v8 offset:1024
    s_waitcnt vmcnt(7) lgkmcnt(8)
    v_mfma_f32_16x16x32_bf16 v[56:59], v[24:27], v[104:107], v[56:59]
    ds_read_b64_tr_b16 v[44:45], v9 offset:0
    s_add_u32 s53, s99, 16384
    buffer_load_dwordx4 v[96:99], v2, s[44:47], s53 offen sc1
    s_waitcnt vmcnt(7)
    v_mfma_f32_16x16x32_bf16 v[60:63], v[24:27], v[108:111], v[60:63]
    ds_read_b64_tr_b16 v[46:47], v9 offset:1024
    s_add_u32 s53, s99, 34816
    buffer_load_dwordx4 v[100:103], v2, s[44:47], s53 offen sc1
    s_waitcnt lgkmcnt(8)
    v_mfma_f32_16x16x32_bf16 v[64:67], v[28:31], v[104:107], v[64:67]
    ds_read_b64_tr_b16 v[48:49], v10 offset:0
    v_mfma_f32_16x16x32_bf16 v[68:71], v[28:31], v[108:111], v[68:71]
    ds_read_b64_tr_b16 v[50:51], v10 offset:1024
    s_waitcnt lgkmcnt(8)
    v_mfma_f32_16x16x32_bf16 v[72:75], v[32:35], v[104:107], v[72:75]
    ds_read_b64_tr_b16 v[52:53], v11 offset:0
    v_mfma_f32_16x16x32_bf16 v[76:79], v[32:35], v[108:111], v[76:79]
    ds_read_b64_tr_b16 v[54:55], v11 offset:1024
    s_cmp_ge_u32 s4, 7
    s_cbranch_scc1 KSBL14
    buffer_store_dwordx4 v[248:251], v2, s[44:47], s85 offen offset:3072 sc1
KSBL14:
    s_waitcnt lgkmcnt(8)
    v_mfma_f32_16x16x32_bf16 v[80:83], v[36:39], v[104:107], v[80:83]
    ds_read_b64_tr_b16 v[24:25], v12 offset:0
    v_mfma_f32_16x16x32_bf16 v[84:87], v[36:39], v[108:111], v[84:87]
    ds_read_b64_tr_b16 v[26:27], v12 offset:512
    s_waitcnt lgkmcnt(8)
    v_mfma_f32_16x16x32_bf16 v[128:131], v[40:43], v[104:107], v[128:131]
    ds_read_b64_tr_b16 v[28:29], v16 offset:0
    v_mfma_f32_16x16x32_bf16 v[132:135], v[40:43], v[108:111], v[132:135]
    ds_read_b64_tr_b16 v[30:31], v16 offset:512
    s_waitcnt lgkmcnt(8)
    v_mfma_f32_16x16x32_bf16 v[136:139], v[44:47], v[104:107], v[136:139]
    ds_read_b64_tr_b16 v[32:33], v17 offset:0
    v_mfma_f32_16x16x32_bf16 v[140:143], v[44:47], v[108:111], v[140:143]
    ds_read_b64_tr_b16 v[34:35], v17 offset:512
    s_waitcnt lgkmcnt(8)
    v_mfma_f32_16x16x32_bf16 v[144:147], v[48:51], v[104:107], v[144:147]
    ds_read_b64_tr_b16 v[36:37], v18 offset:0
    v_mfma_f32_16x16x32_bf16 v[148:151], v[48:51], v[108:111], v[148:151]
    ds_read_b64_tr_b16 v[38:39], v18 offset:512
    s_waitcnt lgkmcnt(8)
    v_mfma_f32_16x16x32_bf16 v[152:155], v[52:55], v[104:107], v[152:155]
    ds_read_b64_tr_b16 v[40:41], v4 offset:8192
    v_mfma_f32_16x16x32_bf16 v[156:159], v[52:55], v[108:111], v[156:159]
    ds_read_b64_tr_b16 v[42:43], v4 offset:9216
    s_waitcnt lgkmcnt(8)
    v_mfma_f32_16x16x32_bf16 v[160:163], v[24:27], v[104:107], v[160:163]
    ds_read_b64_tr_b16 v[44:45], v5 offset:8192
    v_mfma_f32_16x16x32_bf16 v[164:167], v[24:27], v[108:111], v[164:167]
    ds_read_b64_tr_b16 v[46:47], v5 offset:9216
    s_waitcnt lgkmcnt(8)
    v_mfma_f32_16x16x32_bf16 v[168:171], v[28:31], v[104:107], v[168:171]
    ds_read_b64_tr_b16 v[48:49], v6 offset:8192
    v_mfma_f32_16x16x32_bf16 v[172:175], v[28:31], v[108:111], v[172:175]
    ds_read_b64_tr_b16 v[50:51], v6 offset:9216
    s_waitcnt lgkmcnt(8)
    v_mfma_f32_16x16x32_bf16 v[176:179], v[32:35], v[104:107], v[176:179]
    ds_read_b64_tr_b16 v[52:53], v7 offset:8192
    v_mfma_f32_16x16x32_bf16 v[180:183], v[32:35], v[108:111], v[180:183]
    ds_read_b64_tr_b16 v[54:55], v7 offset:9216
    s_waitcnt lgkmcnt(8)
    v_mfma_f32_16x16x32_bf16 v[184:187], v[36:39], v[104:107], v[184:187]
    ds_read_b64_tr_b16 v[24:25], v8 offset:8192
    v_mfma_f32_16x16x32_bf16 v[188:191], v[36:39], v[108:111], v[188:191]
    ds_read_b64_tr_b16 v[26:27], v8 offset:9216
    s_waitcnt vmcnt(7) lgkmcnt(8)
    v_mfma_f32_16x16x32_bf16 v[56:59], v[40:43], v[112:115], v[56:59]
    ds_read_b64_tr_b16 v[28:29], v9 offset:8192
    s_add_u32 s53, s99, 17408
    buffer_load_dwordx4 v[104:107], v2, s[44:47], s53 offen sc1
    s_waitcnt vmcnt(7)
    v_mfma_f32_16x16x32_bf16 v[60:63], v[40:43], v[116:119], v[60:63]
    ds_read_b64_tr_b16 v[30:31], v9 offset:9216
    s_cmp_ge_u32 s4, 7
    s_cbranch_scc1 KSBL15
    buffer_store_dwordx4 v[252:255], v2, s[44:47], s84 offen offset:3072 sc1
KSBL15:
    s_add_u32 s53, s99, 35840
    buffer_load_dwordx4 v[108:111], v2, s[44:47], s53 offen sc1
    s_waitcnt lgkmcnt(8)
    v_mfma_f32_16x16x32_bf16 v[64:67], v[44:47], v[112:115], v[64:67]
    ds_read_b64_tr_b16 v[32:33], v10 offset:8192
    v_mfma_f32_16x16x32_bf16 v[68:71], v[44:47], v[116:119], v[68:71]
    ds_read_b64_tr_b16 v[34:35], v10 offset:9216
    s_waitcnt lgkmcnt(8)
    v_mfma_f32_16x16x32_bf16 v[72:75], v[48:51], v[112:115], v[72:75]
    ds_read_b64_tr_b16 v[36:37], v11 offset:8192
    v_mfma_f32_16x16x32_bf16 v[76:79], v[48:51], v[116:119], v[76:79]
    ds_read_b64_tr_b16 v[38:39], v11 offset:9216
    s_waitcnt lgkmcnt(8)
    v_mfma_f32_16x16x32_bf16 v[80:83], v[52:55], v[112:115], v[80:83]
    ds_read_b64_tr_b16 v[40:41], v12 offset:4096
    v_mfma_f32_16x16x32_bf16 v[84:87], v[52:55], v[116:119], v[84:87]
    ds_read_b64_tr_b16 v[42:43], v12 offset:4608
    s_waitcnt lgkmcnt(8)
    v_mfma_f32_16x16x32_bf16 v[128:131], v[24:27], v[112:115], v[128:131]
    ds_read_b64_tr_b16 v[44:45], v16 offset:4096
    v_mfma_f32_16x16x32_bf16 v[132:135], v[24:27], v[116:119], v[132:135]
    ds_read_b64_tr_b16 v[46:47], v16 offset:4608
    s_waitcnt lgkmcnt(8)
    v_mfma_f32_16x16x32_bf16 v[136:139], v[28:31], v[112:115], v[136:139]
    ds_read_b64_tr_b16 v[48:49], v17 offset:4096
    v_mfma_f32_16x16x32_bf16 v[140:143], v[28:31], v[116:119], v[140:143]
    ds_read_b64_tr_b16 v[50:51], v17 offset:4608
    s_waitcnt lgkmcnt(8)
    v_mfma_f32_16x16x32_bf16 v[144:147], v[32:35], v[112:115], v[144:147]
    ds_read_b64_tr_b16 v[52:53], v18 offset:4096
    v_mfma_f32_16x16x32_bf16 v[148:151], v[32:35], v[116:119], v[148:151]
    ds_read_b64_tr_b16 v[54:55], v18 offset:4608
    s_waitcnt lgkmcnt(8)
    v_mfma_f32_16x16x32_bf16 v[152:155], v[36:39], v[112:115], v[152:155]
    v_add_u32 v4, 0x4000, v4
    v_add_u32 v5, 0x4000, v5
    v_add_u32 v6, 0x4000, v6
    v_add_u32 v7, 0x4000, v7
    v_add_u32 v8, 0x4000, v8
    v_add_u32 v9, 0x4000, v9
    v_add_u32 v10, 0x4000, v10
    v_add_u32 v11, 0x4000, v11
    v_add_u32 v12, 0x2000, v12
    v_add_u32 v16, 0x2000, v16
    v_add_u32 v17, 0x2000, v17
    v_add_u32 v18, 0x2000, v18
    s_barrier
    ds_read_b64_tr_b16 v[24:25], v4 offset:0
    v_mfma_f32_16x16x32_bf16 v[156:159], v[36:39], v[116:119], v[156:159]
    ds_read_b64_tr_b16 v[26:27], v4 offset:1024
    s_waitcnt lgkmcnt(8)
    v_mfma_f32_16x16x32_bf16 v[160:163], v[40:43], v[112:115], v[160:163]
    ds_read_b64_tr_b16 v[28:29], v5 offset:0
    v_mfma_f32_16x16x32_bf16 v[164:167], v[40:43], v[116:119], v[164:167]
    ds_read_b64_tr_b16 v[30:31], v5 offset:1024
    s_waitcnt lgkmcnt(8)
    v_mfma_f32_16x16x32_bf16 v[168:171], v[44:47], v[112:115], v[168:171]
    ds_read_b64_tr_b16 v[32:33], v6 offset:0
    v_mfma_f32_16x16x32_bf16 v[172:175], v[44:47], v[116:119], v[172:175]
    ds_read_b64_tr_b16 v[34:35], v6 offset:1024
    s_waitcnt lgkmcnt(8)
    v_mfma_f32_16x16x32_bf16 v[176:179], v[48:51], v[112:115], v[176:179]
    ds_read_b64_tr_b16 v[36:37], v7 offset:0
    v_mfma_f32_16x16x32_bf16 v[180:183], v[48:51], v[116:119], v[180:183]
    ds_read_b64_tr_b16 v[38:39], v7 offset:1024
    s_waitcnt lgkmcnt(8)
    v_mfma_f32_16x16x32_bf16 v[184:187], v[52:55], v[112:115], v[184:187]
    ds_read_b64_tr_b16 v[40:41], v8 offset:0
    v_mfma_f32_16x16x32_bf16 v[188:191], v[52:55], v[116:119], v[188:191]
    ds_read_b64_tr_b16 v[42:43], v8 offset:1024
    s_waitcnt vmcnt(7) lgkmcnt(8)
    v_mfma_f32_16x16x32_bf16 v[56:59], v[24:27], v[120:123], v[56:59]
    ds_read_b64_tr_b16 v[44:45], v9 offset:0
    s_waitcnt vmcnt(6)
    v_mfma_f32_16x16x32_bf16 v[60:63], v[24:27], v[124:127], v[60:63]
    ds_read_b64_tr_b16 v[46:47], v9 offset:1024
    s_waitcnt lgkmcnt(8)
    v_mfma_f32_16x16x32_bf16 v[64:67], v[28:31], v[120:123], v[64:67]
    ds_read_b64_tr_b16 v[48:49], v10 offset:0
    v_mfma_f32_16x16x32_bf16 v[68:71], v[28:31], v[124:127], v[68:71]
    ds_read_b64_tr_b16 v[50:51], v10 offset:1024
    s_waitcnt lgkmcnt(8)
    v_mfma_f32_16x16x32_bf16 v[72:75], v[32:35], v[120:123], v[72:75]
    ds_read_b64_tr_b16 v[52:53], v11 offset:0
    v_and_b32 v204, 15, v1
    v_mfma_f32_16x16x32_bf16 v[76:79], v[32:35], v[124:127], v[76:79]
    ds_read_b64_tr_b16 v[54:55], v11 offset:1024
    v_lshrrev_b32 v205, 4, v1
    s_waitcnt lgkmcnt(8)
    v_mfma_f32_16x16x32_bf16 v[80:83], v[36:39], v[120:123], v[80:83]
    ds_read_b64_tr_b16 v[24:25], v12 offset:0
    v_mul_u32_u24 v192, 144, v205
    v_mfma_f32_16x16x32_bf16 v[84:87], v[36:39], v[124:127], v[84:87]
    ds_read_b64_tr_b16 v[26:27], v12 offset:512
    v_add_u32 v192, 147456, v192
    s_waitcnt lgkmcnt(8)
    v_mfma_f32_16x16x32_bf16 v[128:131], v[40:43], v[120:123], v[128:131]
    ds_read_b64_tr_b16 v[28:29], v16 offset:0
    v_mov_b32 v205, 512
    v_mfma_f32_16x16x32_bf16 v[132:135], v[40:43], v[124:127], v[132:135]
    ds_read_b64_tr_b16 v[30:31], v16 offset:512
    v_cmp_eq_u32 vcc, 0, v204
    s_waitcnt lgkmcnt(8)
    v_mfma_f32_16x16x32_bf16 v[136:139], v[44:47], v[120:123], v[136:139]
    ds_read_b64_tr_b16 v[32:33], v17 offset:0
    v_cndmask_b32 v205, v205, 16, vcc
    v_mfma_f32_16x16x32_bf16 v[140:143], v[44:47], v[124:127], v[140:143]
    ds_read_b64_tr_b16 v[34:35], v17 offset:512
    v_cmp_eq_u32 vcc, 4, v204
    s_waitcnt lgkmcnt(8)
    v_mfma_f32_16x16x32_bf16 v[144:147], v[48:51], v[120:123], v[144:147]
    ds_read_b64_tr_b16 v[36:37], v18 offset:0
    v_cndmask_b32 v205, v205, 17, vcc
    v_mfma_f32_16x16x32_bf16 v[148:151], v[48:51], v[124:127], v[148:151]
    ds_read_b64_tr_b16 v[38:39], v18 offset:512
    v_cmp_eq_u32 vcc, 8, v204
    s_waitcnt lgkmcnt(8)
    v_mfma_f32_16x16x32_bf16 v[152:155], v[52:55], v[120:123], v[152:155]
    ds_read_b64_tr_b16 v[40:41], v4 offset:8192
    v_cndmask_b32 v205, v205, 8, vcc
    v_mfma_f32_16x16x32_bf16 v[156:159], v[52:55], v[124:127], v[156:159]
    ds_read_b64_tr_b16 v[42:43], v4 offset:9216
    v_cmp_eq_u32 vcc, 12, v204
    s_waitcnt lgkmcnt(8)
    v_mfma_f32_16x16x32_bf16 v[160:163], v[24:27], v[120:123], v[160:163]
    ds_read_b64_tr_b16 v[44:45], v5 offset:8192
    v_cndmask_b32 v205, v205, 12, vcc
    v_mfma_f32_16x16x32_bf16 v[164:167], v[24:27], v[124:127], v[164:167]
    ds_read_b64_tr_b16 v[46:47], v5 offset:9216
    v_lshl_add_u32 v205, v205, 1, v192
    s_waitcnt lgkmcnt(8)
    v_mfma_f32_16x16x32_bf16 v[168:171], v[28:31], v[120:123], v[168:171]
    ds_read_b64_tr_b16 v[48:49], v6 offset:8192
    v_lshl_add_u32 v204, v204, 1, v192
    v_mfma_f32_16x16x32_bf16 v[172:175], v[28:31], v[124:127], v[172:175]
    ds_read_b64_tr_b16 v[50:51], v6 offset:9216
    ds_read_u16 v192, v204 offset:0
    s_waitcnt lgkmcnt(9)
    v_mfma_f32_16x16x32_bf16 v[176:179], v[32:35], v[120:123], v[176:179]
    ds_read_b64_tr_b16 v[52:53], v7 offset:8192
    ds_read_u16 v193, v204 offset:36
    v_mfma_f32_16x16x32_bf16 v[180:183], v[32:35], v[124:127], v[180:183]
    ds_read_b64_tr_b16 v[54:55], v7 offset:9216
    ds_read_u16 v194, v204 offset:72
    s_waitcnt lgkmcnt(11)
    v_mfma_f32_16x16x32_bf16 v[184:187], v[36:39], v[120:123], v[184:187]
    ds_read_b64_tr_b16 v[24:25], v8 offset:8192
    ds_read_u16 v195, v204 offset:108
    v_mfma_f32_16x16x32_bf16 v[188:191], v[36:39], v[124:127], v[188:191]
    ds_read_b64_tr_b16 v[26:27], v8 offset:9216
    ds_read_u16 v196, v204 offset:576
    s_waitcnt vmcnt(5) lgkmcnt(13)
    v_mfma_f32_16x16x32_bf16 v[56:59], v[40:43], v[88:91], v[56:59]
    ds_read_b64_tr_b16 v[28:29], v9 offset:8192
    ds_read_u16 v197, v204 offset:612
    s_waitcnt vmcnt(4)
    v_mfma_f32_16x16x32_bf16 v[60:63], v[40:43], v[92:95], v[60:63]
    ds_read_b64_tr_b16 v[30:31], v9 offset:9216
    ds_read_u16 v198, v205 offset:0
    s_waitcnt lgkmcnt(15)
    v_mfma_f32_16x16x32_bf16 v[64:67], v[44:47], v[88:91], v[64:67]
    ds_read_b64_tr_b16 v[32:33], v10 offset:8192
    ds_read_u16 v199, v205 offset:36
    v_mfma_f32_16x16x32_bf16 v[68:71], v[44:47], v[92:95], v[68:71]
    ds_read_b64_tr_b16 v[34:35], v10 offset:9216
    ds_read_u16 v200, v205 offset:72
    s_waitcnt lgkmcnt(15)
    v_mfma_f32_16x16x32_bf16 v[72:75], v[48:51], v[88:91], v[72:75]
    ds_read_b64_tr_b16 v[36:37], v11 offset:8192
    ds_read_u16 v201, v205 offset:108
    v_mfma_f32_16x16x32_bf16 v[76:79], v[48:51], v[92:95], v[76:79]
    ds_read_b64_tr_b16 v[38:39], v11 offset:9216
    ds_read_u16 v202, v205 offset:576
    s_waitcnt lgkmcnt(15)
    v_mfma_f32_16x16x32_bf16 v[80:83], v[52:55], v[88:91], v[80:83]
    ds_read_b64_tr_b16 v[40:41], v12 offset:4096
    ds_read_u16 v203, v205 offset:612
    v_mfma_f32_16x16x32_bf16 v[84:87], v[52:55], v[92:95], v[84:87]
    ds_read_b64_tr_b16 v[42:43], v12 offset:4608
    s_waitcnt lgkmcnt(15)
    v_mfma_f32_16x16x32_bf16 v[128:131], v[24:27], v[88:91], v[128:131]
    ds_read_b64_tr_b16 v[44:45], v16 offset:4096
    v_mfma_f32_16x16x32_bf16 v[132:135], v[24:27], v[92:95], v[132:135]
    ds_read_b64_tr_b16 v[46:47], v16 offset:4608
    s_waitcnt lgkmcnt(14)
    v_mfma_f32_16x16x32_bf16 v[136:139], v[28:31], v[88:91], v[136:139]
    ds_read_b64_tr_b16 v[48:49], v17 offset:4096
    v_mfma_f32_16x16x32_bf16 v[140:143], v[28:31], v[92:95], v[140:143]
    ds_read_b64_tr_b16 v[50:51], v17 offset:4608
    s_waitcnt lgkmcnt(12)
    v_mfma_f32_16x16x32_bf16 v[144:147], v[32:35], v[88:91], v[144:147]
    ds_read_b64_tr_b16 v[52:53], v18 offset:4096
    v_mfma_f32_16x16x32_bf16 v[148:151], v[32:35], v[92:95], v[148:151]
    ds_read_b64_tr_b16 v[54:55], v18 offset:4608
    s_waitcnt lgkmcnt(10)
    v_mfma_f32_16x16x32_bf16 v[152:155], v[36:39], v[88:91], v[152:155]
    v_add_u32 v4, 0x8000, v4
    v_add_u32 v5, 0x8000, v5
    v_add_u32 v6, 0x8000, v6
    v_add_u32 v7, 0x8000, v7
    v_add_u32 v8, 0x8000, v8
    v_add_u32 v9, 0x8000, v9
    v_add_u32 v10, 0x8000, v10
    v_add_u32 v11, 0x8000, v11
    v_add_u32 v12, 0xc000, v12
    v_add_u32 v16, 0xc000, v16
    v_add_u32 v17, 0xc000, v17
    v_add_u32 v18, 0xc000, v18
    s_barrier
    ds_read_b64_tr_b16 v[24:25], v12 offset:0
    v_mfma_f32_16x16x32_bf16 v[156:159], v[36:39], v[92:95], v[156:159]
    ds_read_b64_tr_b16 v[26:27], v12 offset:512
    s_waitcnt lgkmcnt(8)
    v_mfma_f32_16x16x32_bf16 v[160:163], v[40:43], v[88:91], v[160:163]
    ds_read_b64_tr_b16 v[28:29], v16 offset:0
    v_mfma_f32_16x16x32_bf16 v[164:167], v[40:43], v[92:95], v[164:167]
    ds_read_b64_tr_b16 v[30:31], v16 offset:512
    s_waitcnt lgkmcnt(8)
    v_mfma_f32_16x16x32_bf16 v[168:171], v[44:47], v[88:91], v[168:171]
    ds_read_b64_tr_b16 v[32:33], v17 offset:0
    v_mfma_f32_16x16x32_bf16 v[172:175], v[44:47], v[92:95], v[172:175]
    ds_read_b64_tr_b16 v[34:35], v17 offset:512
    s_waitcnt lgkmcnt(8)
    v_mfma_f32_16x16x32_bf16 v[176:179], v[48:51], v[88:91], v[176:179]
    ds_read_b64_tr_b16 v[36:37], v18 offset:0
    v_mfma_f32_16x16x32_bf16 v[180:183], v[48:51], v[92:95], v[180:183]
    ds_read_b64_tr_b16 v[38:39], v18 offset:512
    s_waitcnt lgkmcnt(8)
    v_mfma_f32_16x16x32_bf16 v[184:187], v[52:55], v[88:91], v[184:187]
    ds_read_b64_tr_b16 v[40:41], v12 offset:4096
    v_mfma_f32_16x16x32_bf16 v[188:191], v[52:55], v[92:95], v[188:191]
    ds_read_b64_tr_b16 v[42:43], v12 offset:4608
    s_waitcnt vmcnt(3) lgkmcnt(8)
    v_mfma_f32_16x16x32_bf16 v[160:163], v[24:27], v[96:99], v[160:163]
    ds_read_b64_tr_b16 v[44:45], v16 offset:4096
    s_waitcnt vmcnt(2)
    v_mfma_f32_16x16x32_bf16 v[164:167], v[24:27], v[100:103], v[164:167]
    ds_read_b64_tr_b16 v[46:47], v16 offset:4608
    s_waitcnt lgkmcnt(8)
    v_mfma_f32_16x16x32_bf16 v[168:171], v[28:31], v[96:99], v[168:171]
    ds_read_b64_tr_b16 v[48:49], v17 offset:4096
    v_mfma_f32_16x16x32_bf16 v[172:175], v[28:31], v[100:103], v[172:175]
    ds_read_b64_tr_b16 v[50:51], v17 offset:4608
    s_waitcnt lgkmcnt(8)
    v_mfma_f32_16x16x32_bf16 v[176:179], v[32:35], v[96:99], v[176:179]
    ds_read_b64_tr_b16 v[52:53], v18 offset:4096
    v_mfma_f32_16x16x32_bf16 v[180:183], v[32:35], v[100:103], v[180:183]
    ds_read_b64_tr_b16 v[54:55], v18 offset:4608
    s_waitcnt lgkmcnt(8)
    v_mfma_f32_16x16x32_bf16 v[184:187], v[36:39], v[96:99], v[184:187]
    ds_read_b64_tr_b16 v[24:25], v4 offset:0
    v_mfma_f32_16x16x32_bf16 v[188:191], v[36:39], v[100:103], v[188:191]
    ds_read_b64_tr_b16 v[26:27], v4 offset:1024
    s_waitcnt vmcnt(1) lgkmcnt(8)
    v_mfma_f32_16x16x32_bf16 v[160:163], v[40:43], v[104:107], v[160:163]
    ds_read_b64_tr_b16 v[28:29], v5 offset:0
    s_waitcnt vmcnt(0)
    v_mfma_f32_16x16x32_bf16 v[164:167], v[40:43], v[108:111], v[164:167]
    ds_read_b64_tr_b16 v[30:31], v5 offset:1024
    s_waitcnt lgkmcnt(8)
    v_mfma_f32_16x16x32_bf16 v[168:171], v[44:47], v[104:107], v[168:171]
    ds_read_b64_tr_b16 v[32:33], v6 offset:0
    v_mfma_f32_16x16x32_bf16 v[172:175], v[44:47], v[108:111], v[172:175]
    ds_read_b64_tr_b16 v[34:35], v6 offset:1024
    s_waitcnt lgkmcnt(8)
    v_mfma_f32_16x16x32_bf16 v[176:179], v[48:51], v[104:107], v[176:179]
    ds_read_b64_tr_b16 v[36:37], v7 offset:0
    v_mfma_f32_16x16x32_bf16 v[180:183], v[48:51], v[108:111], v[180:183]
    ds_read_b64_tr_b16 v[38:39], v7 offset:1024
    s_waitcnt lgkmcnt(8)
    v_mfma_f32_16x16x32_bf16 v[184:187], v[52:55], v[104:107], v[184:187]
    ds_read_b64_tr_b16 v[40:41], v8 offset:0
    v_mfma_f32_16x16x32_bf16 v[188:191], v[52:55], v[108:111], v[188:191]
    ds_read_b64_tr_b16 v[42:43], v8 offset:1024
    s_waitcnt lgkmcnt(8)
    v_mfma_f32_16x16x32_bf16 v[56:59], v[24:27], v[96:99], v[56:59]
    ds_read_b64_tr_b16 v[44:45], v9 offset:0
    v_mfma_f32_16x16x32_bf16 v[60:63], v[24:27], v[100:103], v[60:63]
    ds_read_b64_tr_b16 v[46:47], v9 offset:1024
    s_waitcnt lgkmcnt(8)
    v_mfma_f32_16x16x32_bf16 v[64:67], v[28:31], v[96:99], v[64:67]
    ds_read_b64_tr_b16 v[48:49], v10 offset:0
    v_lshl_or_b32 v208, v193, 16, v192
    v_lshl_or_b32 v209, v195, 16, v194
    v_lshl_or_b32 v210, v197, 16, v196
    v_mov_b32 v211, 0
    v_lshl_or_b32 v212, v199, 16, v198
    v_lshl_or_b32 v213, v201, 16, v200
    v_lshl_or_b32 v214, v203, 16, v202
    v_mfma_f32_16x16x32_bf16 v[68:71], v[28:31], v[100:103], v[68:71]
    ds_read_b64_tr_b16 v[50:51], v10 offset:1024
    v_mov_b32 v215, 0
    v_and_b32 v120, 15, v1
    v_lshlrev_b32 v120, 2, v120
    v_add_u32 v120, 64, v120
    v_cvt_pk_bf16_f32 v88, v176, v177
    v_cvt_pk_bf16_f32 v89, v178, v179
    s_waitcnt lgkmcnt(8)
    v_mfma_f32_16x16x32_bf16 v[72:75], v[32:35], v[96:99], v[72:75]
    ds_read_b64_tr_b16 v[52:53], v11 offset:0
    v_cvt_pk_bf16_f32 v250, v184, v185
    v_cvt_pk_bf16_f32 v251, v186, v187
    v_mov_b32 v90, v251
    v_mov_b32 v91, v250
    v_cvt_pk_bf16_f32 v92, v180, v181
    v_cvt_pk_bf16_f32 v93, v182, v183
    v_mfma_f32_16x16x32_bf16 v[76:79], v[32:35], v[100:103], v[76:79]
    ds_read_b64_tr_b16 v[54:55], v11 offset:1024
    v_cvt_pk_bf16_f32 v254, v188, v189
    v_cvt_pk_bf16_f32 v255, v190, v191
    v_mov_b32 v94, v255
    v_mov_b32 v95, v254
    ds_bpermute_b32 v3, v120, v186
    ds_bpermute_b32 v12, v120, v190
    s_waitcnt lgkmcnt(10)
    v_mfma_f32_16x16x32_bf16 v[80:83], v[36:39], v[96:99], v[80:83]
    ds_read_b64_tr_b16 v[24:25], v4 offset:8192
    v_mfma_f32_16x16x32_bf16 v[216:219], v[208:211], v[88:91], 0
    v_mfma_f32_16x16x32_bf16 v[220:223], v[208:211], v[92:95], 0
    v_mfma_f32_16x16x32_bf16 v[224:227], v[212:215], v[88:91], 0
    v_mfma_f32_16x16x32_bf16 v[228:231], v[212:215], v[92:95], 0
    v_cvt_pk_bf16_f32 v248, v160, v161
    v_cvt_pk_bf16_f32 v249, v162, v163
    v_mfma_f32_16x16x32_bf16 v[84:87], v[36:39], v[100:103], v[84:87]
    ds_read_b64_tr_b16 v[26:27], v4 offset:9216
    v_cvt_pk_bf16_f32 v112, v168, v169
    v_cvt_pk_bf16_f32 v113, v170, v171
    v_mov_b32 v114, v250
    v_mov_b32 v115, 0x3f80
    v_cvt_pk_bf16_f32 v252, v164, v165
    v_cvt_pk_bf16_f32 v253, v166, v167
    s_waitcnt lgkmcnt(10)
    v_mfma_f32_16x16x32_bf16 v[128:131], v[40:43], v[96:99], v[128:131]
    ds_read_b64_tr_b16 v[28:29], v5 offset:8192
    v_cvt_pk_bf16_f32 v116, v172, v173
    v_cvt_pk_bf16_f32 v117, v174, v175
    v_mov_b32 v118, v254
    v_mov_b32 v119, 0x3f80
    s_waitcnt lgkmcnt(4)
    v_mul_f32 v3, s68, v3
    v_exp_f32 v3, -v3
    v_mfma_f32_16x16x32_bf16 v[132:135], v[40:43], v[100:103], v[132:135]
    ds_read_b64_tr_b16 v[30:31], v5 offset:9216
    v_add_f32 v3, 1.0, v3
    v_rcp_f32 v3, v3
    s_waitcnt lgkmcnt(4)
    v_mul_f32 v12, s68, v12
    v_exp_f32 v12, -v12
    s_nop 0
    v_add_f32 v12, 1.0, v12
    v_rcp_f32 v12, v12
    v_mfma_f32_16x16x32_bf16 v[136:139], v[44:47], v[96:99], v[136:139]
    ds_read_b64_tr_b16 v[32:33], v6 offset:8192
    v_max3_f32 v120, v216, v217, v218
    v_max3_f32 v121, -v216, -v217, -v218
    v_max3_f32 v120, v120, v219, v224
    v_max3_f32 v121, v121, -v219, -v224
    v_max3_f32 v122, v220, v221, v222
    v_max3_f32 v123, -v220, -v221, -v222
    v_mfma_f32_16x16x32_bf16 v[140:143], v[44:47], v[100:103], v[140:143]
    ds_read_b64_tr_b16 v[34:35], v6 offset:9216
    v_max3_f32 v122, v122, v223, v228
    v_max3_f32 v123, v123, -v223, -v228
    v_permlane16_swap_b32 v120, v121
    s_nop 0
    v_permlane16_swap_b32 v122, v123
    v_max_f32 v120, v120, v121
    v_max_f32 v122, v122, v123
    v_mfma_f32_16x16x32_bf16 v[144:147], v[48:51], v[96:99], v[144:147]
    ds_read_b64_tr_b16 v[36:37], v7 offset:8192
    v_permlane32_swap_b32 v120, v122
    v_max_f32 v120, v120, v122
    v_mov_b32 v122, v120
    s_nop 1
    v_permlane32_swap_b32 v120, v122
    v_mov_b32 v121, v120
    v_mov_b32 v123, v122
    v_mfma_f32_16x16x32_bf16 v[148:151], v[48:51], v[100:103], v[148:151]
    ds_read_b64_tr_b16 v[38:39], v7 offset:9216
    v_permlane16_swap_b32 v120, v121
    v_permlane16_swap_b32 v122, v123
    v_mul_f32 v120, s68, v120
    v_mul_f32 v121, s68, v121
    v_mul_f32 v122, s68, v122
    v_mul_f32 v123, s68, v123
    v_mfma_f32_16x16x32_bf16 v[152:155], v[52:55], v[96:99], v[152:155]
    ds_read_b64_tr_b16 v[40:41], v8 offset:8192
    v_fma_f32 v160, v216, s68, -v120
    v_fma_f32 v165, -v216, s68, -v121
    v_fma_f32 v161, v217, s68, -v120
    v_fma_f32 v166, -v217, s68, -v121
    v_fma_f32 v162, v218, s68, -v120
    v_fma_f32 v167, -v218, s68, -v121
    v_mfma_f32_16x16x32_bf16 v[156:159], v[52:55], v[100:103], v[156:159]
    ds_read_b64_tr_b16 v[42:43], v8 offset:9216
    v_fma_f32 v163, v219, s68, -v120
    v_fma_f32 v168, -v219, s68, -v121
    v_fma_f32 v164, v224, s68, -v120
    v_fma_f32 v169, -v224, s68, -v121
    v_fma_f32 v170, v220, s68, -v122
    v_fma_f32 v175, -v220, s68, -v123
    s_waitcnt lgkmcnt(8)
    v_mfma_f32_16x16x32_bf16 v[56:59], v[24:27], v[104:107], v[56:59]
    ds_read_b64_tr_b16 v[44:45], v9 offset:8192
    v_fma_f32 v171, v221, s68, -v122
    v_fma_f32 v176, -v221, s68, -v123
    v_fma_f32 v172, v222, s68, -v122
    v_fma_f32 v177, -v222, s68, -v123
    v_fma_f32 v173, v223, s68, -v122
    v_fma_f32 v178, -v223, s68, -v123
    v_mfma_f32_16x16x32_bf16 v[60:63], v[24:27], v[108:111], v[60:63]
    ds_read_b64_tr_b16 v[46:47], v9 offset:9216
    v_fma_f32 v174, v228, s68, -v122
    v_fma_f32 v179, -v228, s68, -v123
    v_exp_f32 v160, v160
    v_exp_f32 v161, v161
    v_exp_f32 v162, v162
    v_exp_f32 v163, v163
    s_waitcnt lgkmcnt(8)
    v_mfma_f32_16x16x32_bf16 v[64:67], v[28:31], v[104:107], v[64:67]
    ds_read_b64_tr_b16 v[48:49], v10 offset:8192
    v_exp_f32 v164, v164
    v_exp_f32 v165, v165
    v_exp_f32 v166, v166
    v_exp_f32 v167, v167
    v_exp_f32 v168, v168
    v_exp_f32 v169, v169
    v_mfma_f32_16x16x32_bf16 v[68:71], v[28:31], v[108:111], v[68:71]
    ds_read_b64_tr_b16 v[50:51], v10 offset:9216
    v_exp_f32 v170, v170
    v_exp_f32 v171, v171
    v_exp_f32 v172, v172
    v_exp_f32 v173, v173
    v_exp_f32 v174, v174
    v_exp_f32 v175, v175
    s_waitcnt lgkmcnt(8)
    v_mfma_f32_16x16x32_bf16 v[72:75], v[32:35], v[104:107], v[72:75]
    ds_read_b64_tr_b16 v[52:53], v11 offset:8192
    v_exp_f32 v176, v176
    v_exp_f32 v177, v177
    v_exp_f32 v178, v178
    v_exp_f32 v179, v179
    v_mul_f32 v164, v164, v23
    v_mul_f32 v169, v169, v23
    v_mfma_f32_16x16x32_bf16 v[76:79], v[32:35], v[108:111], v[76:79]
    ds_read_b64_tr_b16 v[54:55], v11 offset:9216
    v_mul_f32 v174, v174, v23
    v_mul_f32 v179, v179, v23
    v_add_f32 v120, v160, v161
    v_add_f32 v121, v165, v166
    v_add_f32 v122, v170, v171
    v_add_f32 v123, v175, v176
    s_waitcnt lgkmcnt(8)
    v_mfma_f32_16x16x32_bf16 v[80:83], v[36:39], v[104:107], v[80:83]
    v_add_f32 v120, v120, v162
    v_add_f32 v121, v121, v167
    v_add_f32 v122, v122, v172
    v_add_f32 v123, v123, v177
    v_add_f32 v120, v120, v163
    v_add_f32 v121, v121, v168
    v_mfma_f32_16x16x32_bf16 v[84:87], v[36:39], v[108:111], v[84:87]
    v_add_f32 v122, v122, v173
    v_add_f32 v123, v123, v178
    v_add_f32 v120, v120, v164
    v_add_f32 v121, v121, v169
    v_add_f32 v122, v122, v174
    v_add_f32 v123, v123, v179
    s_waitcnt lgkmcnt(6)
    v_mfma_f32_16x16x32_bf16 v[128:131], v[40:43], v[104:107], v[128:131]
    v_permlane16_swap_b32 v120, v121
    v_permlane16_swap_b32 v122, v123
    v_add_f32 v120, v120, v121
    v_add_f32 v122, v122, v123
    s_nop 1
    v_permlane32_swap_b32 v120, v122
    v_add_f32 v120, v120, v122
    v_mfma_f32_16x16x32_bf16 v[132:135], v[40:43], v[108:111], v[132:135]
    v_mov_b32 v122, v120
    s_nop 1
    v_permlane32_swap_b32 v120, v122
    v_mov_b32 v121, v120
    v_mov_b32 v123, v122
    s_nop 0
    v_permlane16_swap_b32 v120, v121
    v_permlane16_swap_b32 v122, v123
    s_waitcnt lgkmcnt(4)
    v_mfma_f32_16x16x32_bf16 v[136:139], v[44:47], v[104:107], v[136:139]
    v_rcp_f32 v120, v120
    v_rcp_f32 v121, v121
    v_rcp_f32 v122, v122
    v_rcp_f32 v123, v123
    v_mul_f32 v160, v160, v120
    v_mul_f32 v161, v161, v120
    v_mfma_f32_16x16x32_bf16 v[140:143], v[44:47], v[108:111], v[140:143]
    v_mul_f32 v162, v162, v120
    v_mul_f32 v163, v163, v120
    v_mul_f32 v164, v164, v120
    v_mul_f32 v165, v165, v121
    v_mul_f32 v166, v166, v121
    v_mul_f32 v167, v167, v121
    s_waitcnt lgkmcnt(2)
    v_mfma_f32_16x16x32_bf16 v[144:147], v[48:51], v[104:107], v[144:147]
    v_mul_f32 v168, v168, v121
    v_mul_f32 v169, v169, v121
    v_mul_f32 v170, v170, v122
    v_mul_f32 v171, v171, v122
    v_mul_f32 v172, v172, v122
    v_mul_f32 v173, v173, v122
    v_mfma_f32_16x16x32_bf16 v[148:151], v[48:51], v[108:111], v[148:151]
    v_mul_f32 v174, v174, v122
    v_mul_f32 v175, v175, v123
    v_mul_f32 v176, v176, v123
    v_mul_f32 v177, v177, v123
    v_mul_f32 v178, v178, v123
    v_mul_f32 v179, v179, v123
    s_waitcnt lgkmcnt(0)
    v_mfma_f32_16x16x32_bf16 v[152:155], v[52:55], v[104:107], v[152:155]
    v_cvt_pk_bf16_f32 v192, v160, v161
    v_cvt_pk_bf16_f32 v193, v162, v163
    v_cvt_pk_bf16_f32 v194, v165, v166
    v_cvt_pk_bf16_f32 v195, v167, v168
    v_cvt_pk_bf16_f32 v196, v164, v169
    v_mov_b32 v197, 0
    v_mfma_f32_16x16x32_bf16 v[156:159], v[52:55], v[108:111], v[156:159]
    v_cvt_pk_bf16_f32 v200, v170, v171
    v_cvt_pk_bf16_f32 v201, v172, v173
    v_cvt_pk_bf16_f32 v202, v175, v176
    v_cvt_pk_bf16_f32 v203, v177, v178
    v_cvt_pk_bf16_f32 v204, v174, v179
    v_mov_b32 v205, 0
    v_and_b32 v6, 15, v1
    v_lshrrev_b32 v7, 4, v1
    s_mul_i32 s6, s5, 5376
    s_add_u32 s6, s6, 98304
    v_mul_u32_u24 v8, 168, v6
    v_lshl_add_u32 v8, v7, 3, v8
    v_add_u32 v4, s6, v8
    v_mov_b32 v13, v2
    s_waitcnt vmcnt(0)
    s_barrier
    ds_write_b64 v4, v[192:193] offset:0
    ds_write_b64 v4, v[194:195] offset:32
    ds_write_b64 v4, v[196:197] offset:64
    ds_write_b64 v4, v[112:113] offset:96
    ds_write_b64 v4, v[114:115] offset:128
    ds_write_b64 v4, v[200:201] offset:2688
    ds_write_b64 v4, v[202:203] offset:2720
    ds_write_b64 v4, v[204:205] offset:2752
    ds_write_b64 v4, v[116:117] offset:2784
    ds_write_b64 v4, v[118:119] offset:2816
    s_cmp_lg_u32 s5, 7
    s_cbranch_scc1 F_FKV2
    s_lshl_b32 s6, s3, 7
    s_lshl_b32 s8, s4, 2
    s_add_u32 s6, s6, s8
    s_add_u32 s6, s6, 83886080
    v_mov_b32 v8, 1
    s_mov_b64 exec, 1
    buffer_store_dword v8, off, s[44:47], s6 sc1
    s_mov_b64 exec, -1
F_FKV2:
    ds_read_b128 v[24:27], v13 offset:0
    ds_read_b128 v[28:31], v13 offset:1024
    ds_read_b128 v[32:35], v13 offset:2048
    ds_read_b128 v[36:39], v13 offset:3072
    ds_read_b128 v[40:43], v13 offset:4096
    ds_read_b128 v[44:47], v13 offset:5120
    ds_read_b128 v[48:51], v13 offset:6144
    ds_read_b128 v[52:55], v13 offset:7168
    v_pk_mul_f32 v[56:57], v[56:57], s[70:71]
    v_pk_mul_f32 v[58:59], v[58:59], s[70:71]
    v_cvt_pk_bf16_f32 v216, v56, v57
    v_cvt_pk_bf16_f32 v217, v58, v59
    v_pk_mul_f32 v[64:65], v[64:65], s[70:71]
    v_pk_mul_f32 v[66:67], v[66:67], s[70:71]
    v_cvt_pk_bf16_f32 v218, v64, v65
    v_cvt_pk_bf16_f32 v219, v66, v67
    v_pk_mul_f32 v[72:73], v[72:73], s[70:71]
    v_pk_mul_f32 v[74:75], v[74:75], s[70:71]
    v_cvt_pk_bf16_f32 v220, v72, v73
    v_cvt_pk_bf16_f32 v221, v74, v75
    v_pk_mul_f32 v[80:81], v[80:81], s[70:71]
    v_pk_mul_f32 v[82:83], v[82:83], s[70:71]
    v_cvt_pk_bf16_f32 v222, v80, v81
    v_cvt_pk_bf16_f32 v223, v82, v83
    v_pk_mul_f32 v[128:129], v[128:129], s[70:71]
    v_pk_mul_f32 v[130:131], v[130:131], s[70:71]
    v_cvt_pk_bf16_f32 v224, v128, v129
    v_cvt_pk_bf16_f32 v225, v130, v131
    v_pk_mul_f32 v[136:137], v[136:137], s[70:71]
    v_pk_mul_f32 v[138:139], v[138:139], s[70:71]
    v_cvt_pk_bf16_f32 v226, v136, v137
    v_cvt_pk_bf16_f32 v227, v138, v139
    v_pk_mul_f32 v[144:145], v[144:145], s[70:71]
    v_pk_mul_f32 v[146:147], v[146:147], s[70:71]
    v_cvt_pk_bf16_f32 v228, v144, v145
    v_cvt_pk_bf16_f32 v229, v146, v147
    v_pk_mul_f32 v[152:153], v[152:153], s[70:71]
    v_pk_mul_f32 v[154:155], v[154:155], s[70:71]
    v_cvt_pk_bf16_f32 v230, v152, v153
    v_cvt_pk_bf16_f32 v231, v154, v155
    v_pk_mul_f32 v[60:61], v[60:61], s[70:71]
    v_pk_mul_f32 v[62:63], v[62:63], s[70:71]
    v_cvt_pk_bf16_f32 v232, v60, v61
    v_cvt_pk_bf16_f32 v233, v62, v63
    v_pk_mul_f32 v[68:69], v[68:69], s[70:71]
    v_pk_mul_f32 v[70:71], v[70:71], s[70:71]
    v_cvt_pk_bf16_f32 v234, v68, v69
    v_cvt_pk_bf16_f32 v235, v70, v71
    v_pk_mul_f32 v[76:77], v[76:77], s[70:71]
    v_pk_mul_f32 v[78:79], v[78:79], s[70:71]
    v_cvt_pk_bf16_f32 v236, v76, v77
    v_cvt_pk_bf16_f32 v237, v78, v79
    v_pk_mul_f32 v[84:85], v[84:85], s[70:71]
    v_pk_mul_f32 v[86:87], v[86:87], s[70:71]
    v_cvt_pk_bf16_f32 v238, v84, v85
    v_cvt_pk_bf16_f32 v239, v86, v87
    v_pk_mul_f32 v[132:133], v[132:133], s[70:71]
    v_pk_mul_f32 v[134:135], v[134:135], s[70:71]
    v_cvt_pk_bf16_f32 v240, v132, v133
    v_cvt_pk_bf16_f32 v241, v134, v135
    v_pk_mul_f32 v[140:141], v[140:141], s[70:71]
    v_pk_mul_f32 v[142:143], v[142:143], s[70:71]
    v_cvt_pk_bf16_f32 v242, v140, v141
    v_cvt_pk_bf16_f32 v243, v142, v143
    v_pk_mul_f32 v[148:149], v[148:149], s[70:71]
    v_pk_mul_f32 v[150:151], v[150:151], s[70:71]
    v_cvt_pk_bf16_f32 v244, v148, v149
    v_cvt_pk_bf16_f32 v245, v150, v151
    v_pk_mul_f32 v[156:157], v[156:157], s[70:71]
    v_pk_mul_f32 v[158:159], v[158:159], s[70:71]
    v_cvt_pk_bf16_f32 v246, v156, v157
    v_cvt_pk_bf16_f32 v247, v158, v159
    v_lshlrev_b32 v8, 2, v7
    v_sub_u32 v8, v6, v8
    v_add_u32 v15, s7, v8
    v_add_u32 v16, 16, v15
    v_mov_b32 v17, 0
    v_mov_b32 v18, 0
    v_mov_b32 v11, 0x44800000
    s_mov_b32 s64, 0xffff
    v_mov_b32 v10, 0x10000
    v_add_u32 v14, 0x10000, v2
    s_mov_b32 s65, 0
    s_cmp_ge_u32 s5, 3
    s_cselect_b32 s6, 1, 0
    s_mul_i32 s8, s6, 3
    s_sub_u32 s8, s5, s8
    v_bfe_u32 v8, v1, 2, 2
    v_lshl_add_u32 v8, v7, 3, v8
    v_and_b32 v9, 3, v1
    v_lshlrev_b32 v9, 3, v9
    v_mul_u32_u24 v21, 168, v8
    v_add_u32 v21, v21, v9
    s_lshl_b32 s9, s8, 5
    s_add_u32 s9, s9, 98304
    v_add_u32 v4, s9, v21
    s_lshl_b32 s9, s6, 5
    s_add_u32 s9, s9, 98400
    v_add_u32 v6, s9, v21
    v_mov_b32 v68, 0
    v_mov_b32 v69, 0
    v_mov_b32 v70, 0
    v_mov_b32 v71, 0
    s_waitcnt lgkmcnt(8)
    s_barrier
    ds_read_b128 v[120:123], v13 offset:8192
    ds_read_b128 v[124:127], v13 offset:9216
    ds_read_b128 v[192:195], v13 offset:10240
    ds_read_b128 v[196:199], v13 offset:11264
    s_waitcnt lgkmcnt(11)
    v_mfma_f32_16x16x32_bf16 v[72:75], v[24:27], v[216:219], 0
    ds_read_b64_tr_b16 v[128:129], v4 offset:0
    ds_read_b64_tr_b16 v[130:131], v4 offset:672
    v_mfma_f32_16x16x32_bf16 v[76:79], v[24:27], v[232:235], 0
    ds_read_b128 v[200:203], v13 offset:12288
    ds_read_b64_tr_b16 v[160:161], v6 offset:0
    ds_read_b64_tr_b16 v[162:163], v6 offset:672
    s_waitcnt lgkmcnt(15)
    v_mfma_f32_16x16x32_bf16 v[72:75], v[28:31], v[220:223], v[72:75]
    ds_read_b64_tr_b16 v[132:133], v4 offset:5376
    ds_read_b64_tr_b16 v[134:135], v4 offset:6048
    v_mfma_f32_16x16x32_bf16 v[76:79], v[28:31], v[236:239], v[76:79]
    ds_read_b128 v[204:207], v13 offset:13312
    ds_read_b64_tr_b16 v[164:165], v6 offset:5376
    ds_read_b64_tr_b16 v[166:167], v6 offset:6048
    s_waitcnt lgkmcnt(15)
    v_mfma_f32_16x16x32_bf16 v[72:75], v[32:35], v[224:227], v[72:75]
    ds_read_b64_tr_b16 v[136:137], v4 offset:10752
    ds_read_b64_tr_b16 v[138:139], v4 offset:11424
    v_mfma_f32_16x16x32_bf16 v[76:79], v[32:35], v[240:243], v[76:79]
    ds_read_b128 v[208:211], v13 offset:14336
    ds_read_b64_tr_b16 v[168:169], v6 offset:10752
    ds_read_b64_tr_b16 v[170:171], v6 offset:11424
    v_mfma_f32_16x16x32_bf16 v[72:75], v[36:39], v[228:231], v[72:75]
    ds_read_b64_tr_b16 v[140:141], v4 offset:16128
    ds_read_b64_tr_b16 v[142:143], v4 offset:16800
    v_mfma_f32_16x16x32_bf16 v[76:79], v[36:39], v[244:247], v[76:79]
    ds_read_b128 v[212:215], v13 offset:15360
    ds_read_b64_tr_b16 v[172:173], v6 offset:16128
    ds_read_b64_tr_b16 v[174:175], v6 offset:16800
    v_mfma_f32_16x16x32_bf16 v[80:83], v[40:43], v[216:219], 0
    ds_read_b64_tr_b16 v[144:145], v4 offset:21504
    ds_read_b64_tr_b16 v[146:147], v4 offset:22176
    v_mfma_f32_16x16x32_bf16 v[84:87], v[40:43], v[232:235], 0
    ds_read_b64_tr_b16 v[176:177], v6 offset:21504
    ds_read_b64_tr_b16 v[178:179], v6 offset:22176
    v_mfma_f32_16x16x32_bf16 v[80:83], v[44:47], v[220:223], v[80:83]
    ds_read_b64_tr_b16 v[148:149], v4 offset:26880
    ds_read_b64_tr_b16 v[150:151], v4 offset:27552
    v_mfma_f32_16x16x32_bf16 v[84:87], v[44:47], v[236:239], v[84:87]
    ds_read_b64_tr_b16 v[180:181], v6 offset:26880
    ds_read_b64_tr_b16 v[182:183], v6 offset:27552
    v_mfma_f32_16x16x32_bf16 v[80:83], v[48:51], v[224:227], v[80:83]
    ds_read_b64_tr_b16 v[152:153], v4 offset:32256
    ds_read_b64_tr_b16 v[154:155], v4 offset:32928
    v_mfma_f32_16x16x32_bf16 v[84:87], v[48:51], v[240:243], v[84:87]
    ds_read_b64_tr_b16 v[184:185], v6 offset:32256
    ds_read_b64_tr_b16 v[186:187], v6 offset:32928
    s_waitcnt lgkmcnt(15)
    v_mfma_f32_16x16x32_bf16 v[80:83], v[52:55], v[228:231], v[80:83]
    ds_read_b64_tr_b16 v[156:157], v4 offset:37632
    ds_read_b64_tr_b16 v[158:159], v4 offset:38304
    v_mfma_f32_16x16x32_bf16 v[84:87], v[52:55], v[244:247], v[84:87]
    ds_read_b64_tr_b16 v[188:189], v6 offset:37632
    ds_read_b64_tr_b16 v[190:191], v6 offset:38304
    v_mfma_f32_16x16x32_bf16 v[64:67], v[128:131], v[160:163], 0
    v_mfma_f32_16x16x32_bf16 v[64:67], v[132:135], v[164:167], v[64:67]
    v_mfma_f32_16x16x32_bf16 v[64:67], v[136:139], v[168:171], v[64:67]
    s_waitcnt lgkmcnt(15)
    v_mfma_f32_16x16x32_bf16 v[64:67], v[140:143], v[172:175], v[64:67]
    s_waitcnt lgkmcnt(12)
    v_mfma_f32_16x16x32_bf16 v[64:67], v[144:147], v[176:179], v[64:67]
    s_waitcnt lgkmcnt(8)
    v_mfma_f32_16x16x32_bf16 v[64:67], v[148:151], v[180:183], v[64:67]
    s_waitcnt lgkmcnt(4)
    v_mfma_f32_16x16x32_bf16 v[64:67], v[152:155], v[184:187], v[64:67]
    s_waitcnt lgkmcnt(0)
    v_mfma_f32_16x16x32_bf16 v[64:67], v[156:159], v[188:191], v[64:67]
    s_cmp_lg_u32 s66, 0
    s_cbranch_scc1 B_NM
    s_nop 4
    v_cmp_gt_i32 s[74:75], 0, v15
    v_cmp_gt_i32 s[76:77], 1, v15
    v_cmp_gt_i32 s[78:79], 2, v15
    v_cmp_gt_i32 s[90:91], 3, v15
    v_cndmask_b32 v72, v72, v22, s[74:75]
    v_cndmask_b32 v73, v73, v22, s[76:77]
    v_cndmask_b32 v74, v74, v22, s[78:79]
    v_cndmask_b32 v75, v75, v22, s[90:91]
    v_cmp_gt_i32 s[74:75], 16, v15
    v_cmp_gt_i32 s[76:77], 17, v15
    v_cmp_gt_i32 s[78:79], 18, v15
    v_cmp_gt_i32 s[90:91], 19, v15
    v_cndmask_b32 v80, v80, v22, s[74:75]
    v_cndmask_b32 v81, v81, v22, s[76:77]
    v_cndmask_b32 v82, v82, v22, s[78:79]
    v_cndmask_b32 v83, v83, v22, s[90:91]
    v_cmp_gt_i32 s[74:75], 0, v16
    v_cmp_gt_i32 s[76:77], 1, v16
    v_cmp_gt_i32 s[78:79], 2, v16
    v_cmp_gt_i32 s[90:91], 3, v16
    v_cndmask_b32 v76, v76, v22, s[74:75]
    v_cndmask_b32 v77, v77, v22, s[76:77]
    v_cndmask_b32 v78, v78, v22, s[78:79]
    v_cndmask_b32 v79, v79, v22, s[90:91]
    v_cmp_gt_i32 s[74:75], 16, v16
    v_cmp_gt_i32 s[76:77], 17, v16
    v_cmp_gt_i32 s[78:79], 18, v16
    v_cmp_gt_i32 s[90:91], 19, v16
    v_cndmask_b32 v84, v84, v22, s[74:75]
    v_cndmask_b32 v85, v85, v22, s[76:77]
    v_cndmask_b32 v86, v86, v22, s[78:79]
    v_cndmask_b32 v87, v87, v22, s[90:91]
B_NM:
    v_max3_f32 v112, v72, v73, v74
    v_max3_f32 v112, v112, v75, v80
    v_max3_f32 v112, v112, v81, v82
    v_max_f32 v112, v83, v112
    v_max3_f32 v113, v76, v77, v78
    v_max3_f32 v113, v113, v79, v84
    v_max3_f32 v113, v113, v85, v86
    v_max_f32 v113, v87, v113
    s_lshl_b32 s9, s3, 3
    s_add_u32 s9, s9, s4
    s_mul_i32 s9, s9, 6144
    s_add_u32 s9, s9, s97
    s_add_u32 s9, s9, 67108864
    s_cmp_ge_u32 s5, 6
    s_cselect_b32 s9, s52, s9
    v_mfma_f32_16x16x32_bf16 v[128:131], v[68:71], v[68:71], 0
    v_permlane16_swap_b32 v112, v113
    v_max_f32 v112, v112, v113
    v_mfma_f32_16x16x32_bf16 v[132:135], v[68:71], v[68:71], 0
    v_mov_b32 v114, v112
    s_nop 1
    v_permlane32_swap_b32 v112, v114
    v_mfma_f32_16x16x32_bf16 v[136:139], v[68:71], v[68:71], 0
    v_max_f32 v112, v112, v114
    v_mov_b32 v113, v112
    v_mfma_f32_16x16x32_bf16 v[140:143], v[68:71], v[68:71], 0
    s_nop 0
    v_permlane16_swap_b32 v112, v113
    buffer_store_dwordx4 v[64:67], v2, s[44:47], s9 offen sc1
    v_mfma_f32_16x16x32_bf16 v[144:147], v[68:71], v[68:71], 0
    v_sub_f32 v104, 0, v112
    v_sub_f32 v105, 0, v112
    v_mfma_f32_16x16x32_bf16 v[148:151], v[68:71], v[68:71], 0
    v_sub_f32 v106, 0, v112
    v_sub_f32 v107, 0, v112
    v_mfma_f32_16x16x32_bf16 v[152:155], v[68:71], v[68:71], 0
    v_sub_f32 v108, 0, v113
    v_sub_f32 v109, 0, v113
    v_mfma_f32_16x16x32_bf16 v[156:159], v[68:71], v[68:71], 0
    v_sub_f32 v110, 0, v113
    v_sub_f32 v111, 0, v113
    v_mfma_f32_16x16x32_bf16 v[160:163], v[68:71], v[68:71], 0
    v_sub_f32 v72, v72, v112
    v_sub_f32 v73, v73, v112
    v_mfma_f32_16x16x32_bf16 v[164:167], v[68:71], v[68:71], 0
    v_sub_f32 v74, v74, v112
    v_sub_f32 v75, v75, v112
    v_mfma_f32_16x16x32_bf16 v[168:171], v[68:71], v[68:71], 0
    v_sub_f32 v80, v80, v112
    v_sub_f32 v81, v81, v112
    v_mfma_f32_16x16x32_bf16 v[172:175], v[68:71], v[68:71], 0
    v_sub_f32 v82, v82, v112
    v_sub_f32 v83, v83, v112
    v_mfma_f32_16x16x32_bf16 v[176:179], v[68:71], v[68:71], 0
    v_sub_f32 v76, v76, v113
    v_sub_f32 v77, v77, v113
    v_mfma_f32_16x16x32_bf16 v[180:183], v[68:71], v[68:71], 0
    v_sub_f32 v78, v78, v113
    v_sub_f32 v79, v79, v113
    v_mfma_f32_16x16x32_bf16 v[184:187], v[68:71], v[68:71], 0
    v_sub_f32 v84, v84, v113
    v_sub_f32 v85, v85, v113
    v_mfma_f32_16x16x32_bf16 v[188:191], v[68:71], v[68:71], 0
    v_sub_f32 v86, v86, v113
    v_sub_f32 v87, v87, v113
    s_lshl_b32 s6, s66, 6
    v_subrev_u32 v15, s6, v15
    v_subrev_u32 v16, s6, v16
    v_mfma_f32_16x16x32_bf16 v[88:91], v[120:123], v[216:219], v[104:107]
    v_exp_f32 v112, v72
    v_exp_f32 v113, v73
    v_mfma_f32_16x16x32_bf16 v[92:95], v[120:123], v[232:235], v[108:111]
    v_add_f32 v19, v112, v113
    v_cvt_pk_bf16_f32 v56, v112, v113
    v_mfma_f32_16x16x32_bf16 v[88:91], v[124:127], v[220:223], v[88:91]
    v_exp_f32 v114, v74
    v_exp_f32 v115, v75
    v_mfma_f32_16x16x32_bf16 v[92:95], v[124:127], v[236:239], v[92:95]
    v_add_f32 v19, v19, v114
    v_add_f32 v19, v19, v115
    v_cvt_pk_bf16_f32 v57, v114, v115
    v_mfma_f32_16x16x32_bf16 v[88:91], v[192:195], v[224:227], v[88:91]
    v_exp_f32 v116, v80
    v_exp_f32 v117, v81
    v_mfma_f32_16x16x32_bf16 v[92:95], v[192:195], v[240:243], v[92:95]
    v_add_f32 v19, v19, v116
    v_add_f32 v19, v19, v117
    v_cvt_pk_bf16_f32 v58, v116, v117
    v_mfma_f32_16x16x32_bf16 v[88:91], v[196:199], v[228:231], v[88:91]
    v_exp_f32 v118, v82
    v_exp_f32 v119, v83
    v_mfma_f32_16x16x32_bf16 v[92:95], v[196:199], v[244:247], v[92:95]
    v_add_f32 v19, v19, v118
    v_add_f32 v19, v19, v119
    v_cvt_pk_bf16_f32 v59, v118, v119
    v_mfma_f32_16x16x32_bf16 v[96:99], v[200:203], v[216:219], v[104:107]
    v_exp_f32 v112, v76
    v_exp_f32 v113, v77
    v_mfma_f32_16x16x32_bf16 v[100:103], v[200:203], v[232:235], v[108:111]
    v_add_f32 v20, v112, v113
    v_cvt_pk_bf16_f32 v60, v112, v113
    v_mfma_f32_16x16x32_bf16 v[96:99], v[204:207], v[220:223], v[96:99]
    v_exp_f32 v114, v78
    v_exp_f32 v115, v79
    v_mfma_f32_16x16x32_bf16 v[100:103], v[204:207], v[236:239], v[100:103]
    v_add_f32 v20, v20, v114
    v_add_f32 v20, v20, v115
    v_cvt_pk_bf16_f32 v61, v114, v115
    v_mfma_f32_16x16x32_bf16 v[96:99], v[208:211], v[224:227], v[96:99]
    v_exp_f32 v116, v84
    v_exp_f32 v117, v85
    v_mfma_f32_16x16x32_bf16 v[100:103], v[208:211], v[240:243], v[100:103]
    v_add_f32 v20, v20, v116
    v_add_f32 v20, v20, v117
    v_cvt_pk_bf16_f32 v62, v116, v117
    v_mfma_f32_16x16x32_bf16 v[96:99], v[212:215], v[228:231], v[96:99]
    v_exp_f32 v118, v86
    v_exp_f32 v119, v87
    v_mfma_f32_16x16x32_bf16 v[100:103], v[212:215], v[244:247], v[100:103]
    v_add_f32 v20, v20, v118
    v_add_f32 v20, v20, v119
    v_cvt_pk_bf16_f32 v63, v118, v119
    s_barrier
    s_cmp_eq_u32 s66, 0
    s_cbranch_scc1 B_PV
    v_add_u32 v13, 0x4000, v13
    v_and_b32 v13, 0xffff, v13
    ds_read_b128 v[24:27], v13 offset:0
    ds_read_b128 v[28:31], v13 offset:1024
    ds_read_b128 v[32:35], v13 offset:2048
    ds_read_b128 v[36:39], v13 offset:3072
    ds_read_b128 v[40:43], v13 offset:4096
    ds_read_b128 v[44:47], v13 offset:5120
    ds_read_b128 v[48:51], v13 offset:6144
    ds_read_b128 v[52:55], v13 offset:7168
    ds_read_b128 v[120:123], v14 offset:0
    ds_read_b128 v[124:127], v14 offset:1024
    ds_read_b128 v[192:195], v14 offset:2048
    ds_read_b128 v[196:199], v14 offset:3072
    s_cmp_le_u32 s66, 1
    s_cbranch_scc1 B_S1
.p2align 6
    s_nop 0
    s_nop 0
    s_nop 0
    s_nop 0
B_LOOP:
    s_waitcnt lgkmcnt(8)
    v_mfma_f32_16x16x32_bf16 v[72:75], v[24:27], v[216:219], v[104:107]
    v_exp_f32 v112, v88
    v_mfma_f32_16x16x32_bf16 v[76:79], v[24:27], v[232:235], v[108:111]
    ds_read_b128 v[200:203], v14 offset:4096
    v_add_f32 v17, v17, v19
    v_mfma_f32_16x16x32_bf16 v[72:75], v[28:31], v[220:223], v[72:75]
    v_exp_f32 v113, v89
    v_mfma_f32_16x16x32_bf16 v[76:79], v[28:31], v[236:239], v[76:79]
    ds_read_b128 v[204:207], v14 offset:5120
    v_add_f32 v19, v112, v113
    v_cvt_pk_bf16_f32 v64, v112, v113
    v_mfma_f32_16x16x32_bf16 v[72:75], v[32:35], v[224:227], v[72:75]
    v_exp_f32 v114, v90
    v_mfma_f32_16x16x32_bf16 v[76:79], v[32:35], v[240:243], v[76:79]
    ds_read_b128 v[208:211], v14 offset:6144
    v_add_f32 v19, v19, v114
    v_mfma_f32_16x16x32_bf16 v[72:75], v[36:39], v[228:231], v[72:75]
    v_exp_f32 v115, v91
    v_mfma_f32_16x16x32_bf16 v[76:79], v[36:39], v[244:247], v[76:79]
    ds_read_b128 v[212:215], v14 offset:7168
    v_add_f32 v19, v19, v115
    v_cvt_pk_bf16_f32 v65, v114, v115
    s_waitcnt lgkmcnt(8)
    v_mfma_f32_16x16x32_bf16 v[80:83], v[40:43], v[216:219], v[104:107]
    v_exp_f32 v116, v96
    v_mfma_f32_16x16x32_bf16 v[84:87], v[40:43], v[232:235], v[108:111]
    ds_read_b128 v[24:27], v13 offset:8192
    v_add_f32 v19, v19, v116
    v_mfma_f32_16x16x32_bf16 v[80:83], v[44:47], v[220:223], v[80:83]
    v_exp_f32 v117, v97
    v_mfma_f32_16x16x32_bf16 v[84:87], v[44:47], v[236:239], v[84:87]
    ds_read_b128 v[28:31], v13 offset:9216
    v_add_f32 v19, v19, v117
    v_cvt_pk_bf16_f32 v66, v116, v117
    v_mfma_f32_16x16x32_bf16 v[80:83], v[48:51], v[224:227], v[80:83]
    v_exp_f32 v118, v98
    v_mfma_f32_16x16x32_bf16 v[84:87], v[48:51], v[240:243], v[84:87]
    ds_read_b128 v[32:35], v13 offset:10240
    v_add_f32 v19, v19, v118
    v_mfma_f32_16x16x32_bf16 v[80:83], v[52:55], v[228:231], v[80:83]
    v_exp_f32 v119, v99
    v_mfma_f32_16x16x32_bf16 v[84:87], v[52:55], v[244:247], v[84:87]
    ds_read_b128 v[36:39], v13 offset:11264
    v_add_f32 v19, v19, v119
    v_cvt_pk_bf16_f32 v67, v118, v119
    s_waitcnt lgkmcnt(8)
    v_mfma_f32_16x16x32_bf16 v[128:131], v[120:123], v[56:59], v[128:131]
    v_exp_f32 v112, v92
    v_mfma_f32_16x16x32_bf16 v[132:135], v[120:123], v[60:63], v[132:135]
    ds_read_b128 v[40:43], v13 offset:12288
    v_add_f32 v18, v18, v20
    v_mfma_f32_16x16x32_bf16 v[136:139], v[124:127], v[56:59], v[136:139]
    v_exp_f32 v113, v93
    v_mfma_f32_16x16x32_bf16 v[140:143], v[124:127], v[60:63], v[140:143]
    ds_read_b128 v[44:47], v13 offset:13312
    v_add_f32 v20, v112, v113
    v_cvt_pk_bf16_f32 v68, v112, v113
    v_mfma_f32_16x16x32_bf16 v[144:147], v[192:195], v[56:59], v[144:147]
    v_exp_f32 v114, v94
    v_mfma_f32_16x16x32_bf16 v[148:151], v[192:195], v[60:63], v[148:151]
    ds_read_b128 v[48:51], v13 offset:14336
    v_add_f32 v20, v20, v114
    v_mfma_f32_16x16x32_bf16 v[152:155], v[196:199], v[56:59], v[152:155]
    v_exp_f32 v115, v95
    v_mfma_f32_16x16x32_bf16 v[156:159], v[196:199], v[60:63], v[156:159]
    ds_read_b128 v[52:55], v13 offset:15360
    v_add_f32 v20, v20, v115
    v_cvt_pk_bf16_f32 v69, v114, v115
    s_waitcnt lgkmcnt(8)
    v_mfma_f32_16x16x32_bf16 v[160:163], v[200:203], v[56:59], v[160:163]
    v_exp_f32 v116, v100
    v_mfma_f32_16x16x32_bf16 v[164:167], v[200:203], v[60:63], v[164:167]
    ds_read_b128 v[120:123], v14 offset:8192
    v_add_f32 v20, v20, v116
    v_mfma_f32_16x16x32_bf16 v[168:171], v[204:207], v[56:59], v[168:171]
    v_exp_f32 v117, v101
    v_mfma_f32_16x16x32_bf16 v[172:175], v[204:207], v[60:63], v[172:175]
    ds_read_b128 v[124:127], v14 offset:9216
    v_add_f32 v20, v20, v117
    v_cvt_pk_bf16_f32 v70, v116, v117
    v_mfma_f32_16x16x32_bf16 v[176:179], v[208:211], v[56:59], v[176:179]
    v_exp_f32 v118, v102
    v_mfma_f32_16x16x32_bf16 v[180:183], v[208:211], v[60:63], v[180:183]
    ds_read_b128 v[192:195], v14 offset:10240
    v_add_f32 v20, v20, v118
    v_mfma_f32_16x16x32_bf16 v[184:187], v[212:215], v[56:59], v[184:187]
    v_exp_f32 v119, v103
    v_mfma_f32_16x16x32_bf16 v[188:191], v[212:215], v[60:63], v[188:191]
    ds_read_b128 v[196:199], v14 offset:11264
    v_add_f32 v20, v20, v119
    v_cvt_pk_bf16_f32 v71, v118, v119
    v_max_f32 v21, v19, v20
    v_cmp_nle_f32 vcc, v21, v11
    s_cbranch_vccnz RBSa
RBSa_R:
    s_waitcnt lgkmcnt(8)
    v_mfma_f32_16x16x32_bf16 v[88:91], v[24:27], v[216:219], v[104:107]
    v_exp_f32 v112, v72
    v_mfma_f32_16x16x32_bf16 v[92:95], v[24:27], v[232:235], v[108:111]
    ds_read_b128 v[200:203], v14 offset:12288
    v_add_f32 v17, v17, v19
    v_mfma_f32_16x16x32_bf16 v[88:91], v[28:31], v[220:223], v[88:91]
    v_exp_f32 v113, v73
    v_mfma_f32_16x16x32_bf16 v[92:95], v[28:31], v[236:239], v[92:95]
    ds_read_b128 v[204:207], v14 offset:13312
    v_add_f32 v19, v112, v113
    v_cvt_pk_bf16_f32 v56, v112, v113
    v_mfma_f32_16x16x32_bf16 v[88:91], v[32:35], v[224:227], v[88:91]
    v_exp_f32 v114, v74
    v_mfma_f32_16x16x32_bf16 v[92:95], v[32:35], v[240:243], v[92:95]
    ds_read_b128 v[208:211], v14 offset:14336
    v_add_u32 v13, 0x4000, v13
    v_and_b32 v13, 0xffff, v13
    v_add_f32 v19, v19, v114
    v_mfma_f32_16x16x32_bf16 v[88:91], v[36:39], v[228:231], v[88:91]
    v_exp_f32 v115, v75
    v_mfma_f32_16x16x32_bf16 v[92:95], v[36:39], v[244:247], v[92:95]
    ds_read_b128 v[212:215], v14 offset:15360
    v_add_f32 v19, v19, v115
    v_cvt_pk_bf16_f32 v57, v114, v115
    s_waitcnt lgkmcnt(8)
    v_mfma_f32_16x16x32_bf16 v[96:99], v[40:43], v[216:219], v[104:107]
    v_exp_f32 v116, v80
    v_mfma_f32_16x16x32_bf16 v[100:103], v[40:43], v[232:235], v[108:111]
    s_waitcnt vmcnt(0)
    s_barrier
    ds_read_b128 v[24:27], v13 offset:0
    v_add_f32 v19, v19, v116
    v_mfma_f32_16x16x32_bf16 v[96:99], v[44:47], v[220:223], v[96:99]
    v_exp_f32 v117, v81
    v_mfma_f32_16x16x32_bf16 v[100:103], v[44:47], v[236:239], v[100:103]
    ds_read_b128 v[28:31], v13 offset:1024
    v_add_f32 v19, v19, v117
    v_cvt_pk_bf16_f32 v58, v116, v117
    v_mfma_f32_16x16x32_bf16 v[96:99], v[48:51], v[224:227], v[96:99]
    v_exp_f32 v118, v82
    v_mfma_f32_16x16x32_bf16 v[100:103], v[48:51], v[240:243], v[100:103]
    ds_read_b128 v[32:35], v13 offset:2048
    v_add_u32 v14, 0x4000, v14
    v_and_or_b32 v14, v14, s64, v10
    v_add_f32 v19, v19, v118
    v_mfma_f32_16x16x32_bf16 v[96:99], v[52:55], v[228:231], v[96:99]
    v_exp_f32 v119, v83
    v_mfma_f32_16x16x32_bf16 v[100:103], v[52:55], v[244:247], v[100:103]
    ds_read_b128 v[36:39], v13 offset:3072
    v_add_f32 v19, v19, v119
    v_cvt_pk_bf16_f32 v59, v118, v119
    s_waitcnt lgkmcnt(8)
    v_mfma_f32_16x16x32_bf16 v[128:131], v[120:123], v[64:67], v[128:131]
    v_exp_f32 v112, v76
    v_mfma_f32_16x16x32_bf16 v[132:135], v[120:123], v[68:71], v[132:135]
    ds_read_b128 v[40:43], v13 offset:4096
    v_add_f32 v18, v18, v20
    v_mfma_f32_16x16x32_bf16 v[136:139], v[124:127], v[64:67], v[136:139]
    v_exp_f32 v113, v77
    v_mfma_f32_16x16x32_bf16 v[140:143], v[124:127], v[68:71], v[140:143]
    ds_read_b128 v[44:47], v13 offset:5120
    v_add_f32 v20, v112, v113
    v_cvt_pk_bf16_f32 v60, v112, v113
    v_mfma_f32_16x16x32_bf16 v[144:147], v[192:195], v[64:67], v[144:147]
    v_exp_f32 v114, v78
    v_mfma_f32_16x16x32_bf16 v[148:151], v[192:195], v[68:71], v[148:151]
    ds_read_b128 v[48:51], v13 offset:6144
    v_add_f32 v20, v20, v114
    v_mfma_f32_16x16x32_bf16 v[152:155], v[196:199], v[64:67], v[152:155]
    v_exp_f32 v115, v79
    v_mfma_f32_16x16x32_bf16 v[156:159], v[196:199], v[68:71], v[156:159]
    ds_read_b128 v[52:55], v13 offset:7168
    v_add_f32 v20, v20, v115
    v_cvt_pk_bf16_f32 v61, v114, v115
    s_waitcnt lgkmcnt(8)
    v_mfma_f32_16x16x32_bf16 v[160:163], v[200:203], v[64:67], v[160:163]
    v_exp_f32 v116, v84
    v_mfma_f32_16x16x32_bf16 v[164:167], v[200:203], v[68:71], v[164:167]
    ds_read_b128 v[120:123], v14 offset:0
    v_add_f32 v20, v20, v116
    v_mfma_f32_16x16x32_bf16 v[168:171], v[204:207], v[64:67], v[168:171]
    v_exp_f32 v117, v85
    v_mfma_f32_16x16x32_bf16 v[172:175], v[204:207], v[68:71], v[172:175]
    ds_read_b128 v[124:127], v14 offset:1024
    v_add_f32 v20, v20, v117
    v_cvt_pk_bf16_f32 v62, v116, v117
    s_add_u32 s65, s65, 1
    s_add_u32 s6, s65, 1
    v_mfma_f32_16x16x32_bf16 v[176:179], v[208:211], v[64:67], v[176:179]
    v_exp_f32 v118, v86
    v_mfma_f32_16x16x32_bf16 v[180:183], v[208:211], v[68:71], v[180:183]
    ds_read_b128 v[192:195], v14 offset:2048
    v_add_f32 v20, v20, v118
    v_mfma_f32_16x16x32_bf16 v[184:187], v[212:215], v[64:67], v[184:187]
    v_exp_f32 v119, v87
    v_mfma_f32_16x16x32_bf16 v[188:191], v[212:215], v[68:71], v[188:191]
    ds_read_b128 v[196:199], v14 offset:3072
    v_add_f32 v20, v20, v119
    v_cvt_pk_bf16_f32 v63, v118, v119
    v_max_f32 v21, v19, v20
    v_cmp_nle_f32 vcc, v21, v11
    s_cbranch_vccnz RBSb
RBSb_R:
    s_cmp_lt_u32 s6, s66
    s_cbranch_scc1 B_LOOP
    s_branch B_S1
B_PV:
    s_bitcmp0_b32 s7, 5
    s_cbranch_scc1 B_PE
    ds_read_b128 v[24:27], v14 offset:0
    ds_read_b128 v[28:31], v14 offset:1024
    ds_read_b128 v[32:35], v14 offset:2048
    ds_read_b128 v[36:39], v14 offset:3072
    ds_read_b128 v[40:43], v14 offset:4096
    ds_read_b128 v[44:47], v14 offset:5120
    ds_read_b128 v[48:51], v14 offset:6144
    ds_read_b128 v[52:55], v14 offset:7168
    ds_read_b128 v[120:123], v14 offset:8192
    ds_read_b128 v[124:127], v14 offset:9216
    ds_read_b128 v[192:195], v14 offset:10240
    ds_read_b128 v[196:199], v14 offset:11264
    s_branch B_S2
B_PE:
    ds_read_b128 v[120:123], v14 offset:0
    ds_read_b128 v[124:127], v14 offset:1024
    ds_read_b128 v[192:195], v14 offset:2048
    ds_read_b128 v[196:199], v14 offset:3072
    ds_read_b128 v[200:203], v14 offset:4096
    ds_read_b128 v[204:207], v14 offset:5120
    ds_read_b128 v[208:211], v14 offset:6144
    ds_read_b128 v[212:215], v14 offset:7168
    s_branch B_E2
B_E1:
    s_waitcnt lgkmcnt(8)
    v_mfma_f32_16x16x32_bf16 v[72:75], v[24:27], v[216:219], v[104:107]
    v_exp_f32 v112, v88
    v_mfma_f32_16x16x32_bf16 v[76:79], v[24:27], v[232:235], v[108:111]
    ds_read_b128 v[200:203], v14 offset:4096
    v_add_f32 v17, v17, v19
    v_mfma_f32_16x16x32_bf16 v[72:75], v[28:31], v[220:223], v[72:75]
    v_exp_f32 v113, v89
    v_mfma_f32_16x16x32_bf16 v[76:79], v[28:31], v[236:239], v[76:79]
    ds_read_b128 v[204:207], v14 offset:5120
    v_add_f32 v19, v112, v113
    v_cvt_pk_bf16_f32 v64, v112, v113
    v_mfma_f32_16x16x32_bf16 v[72:75], v[32:35], v[224:227], v[72:75]
    v_exp_f32 v114, v90
    v_mfma_f32_16x16x32_bf16 v[76:79], v[32:35], v[240:243], v[76:79]
    ds_read_b128 v[208:211], v14 offset:6144
    v_add_f32 v19, v19, v114
    v_mfma_f32_16x16x32_bf16 v[72:75], v[36:39], v[228:231], v[72:75]
    v_exp_f32 v115, v91
    v_mfma_f32_16x16x32_bf16 v[76:79], v[36:39], v[244:247], v[76:79]
    ds_read_b128 v[212:215], v14 offset:7168
    v_add_f32 v19, v19, v115
    v_cvt_pk_bf16_f32 v65, v114, v115
    s_waitcnt lgkmcnt(8)
    v_mfma_f32_16x16x32_bf16 v[80:83], v[40:43], v[216:219], v[104:107]
    v_exp_f32 v116, v96
    v_mfma_f32_16x16x32_bf16 v[84:87], v[40:43], v[232:235], v[108:111]
    ds_read_b128 v[24:27], v14 offset:8192
    v_add_f32 v19, v19, v116
    v_mfma_f32_16x16x32_bf16 v[80:83], v[44:47], v[220:223], v[80:83]
    v_exp_f32 v117, v97
    v_mfma_f32_16x16x32_bf16 v[84:87], v[44:47], v[236:239], v[84:87]
    ds_read_b128 v[28:31], v14 offset:9216
    v_add_f32 v19, v19, v117
    v_cvt_pk_bf16_f32 v66, v116, v117
    v_mfma_f32_16x16x32_bf16 v[80:83], v[48:51], v[224:227], v[80:83]
    v_exp_f32 v118, v98
    v_mfma_f32_16x16x32_bf16 v[84:87], v[48:51], v[240:243], v[84:87]
    ds_read_b128 v[32:35], v14 offset:10240
    v_add_f32 v19, v19, v118
    v_mfma_f32_16x16x32_bf16 v[80:83], v[52:55], v[228:231], v[80:83]
    v_exp_f32 v119, v99
    v_mfma_f32_16x16x32_bf16 v[84:87], v[52:55], v[244:247], v[84:87]
    ds_read_b128 v[36:39], v14 offset:11264
    v_add_f32 v19, v19, v119
    v_cvt_pk_bf16_f32 v67, v118, v119
    s_waitcnt lgkmcnt(8)
    v_mfma_f32_16x16x32_bf16 v[128:131], v[120:123], v[56:59], v[128:131]
    v_exp_f32 v112, v92
    v_mfma_f32_16x16x32_bf16 v[132:135], v[120:123], v[60:63], v[132:135]
    ds_read_b128 v[40:43], v14 offset:12288
    v_add_f32 v18, v18, v20
    v_mfma_f32_16x16x32_bf16 v[136:139], v[124:127], v[56:59], v[136:139]
    v_exp_f32 v113, v93
    v_mfma_f32_16x16x32_bf16 v[140:143], v[124:127], v[60:63], v[140:143]
    ds_read_b128 v[44:47], v14 offset:13312
    v_add_f32 v20, v112, v113
    v_cvt_pk_bf16_f32 v68, v112, v113
    v_mfma_f32_16x16x32_bf16 v[144:147], v[192:195], v[56:59], v[144:147]
    v_exp_f32 v114, v94
    v_mfma_f32_16x16x32_bf16 v[148:151], v[192:195], v[60:63], v[148:151]
    ds_read_b128 v[48:51], v14 offset:14336
    v_add_f32 v20, v20, v114
    v_mfma_f32_16x16x32_bf16 v[152:155], v[196:199], v[56:59], v[152:155]
    v_exp_f32 v115, v95
    v_mfma_f32_16x16x32_bf16 v[156:159], v[196:199], v[60:63], v[156:159]
    ds_read_b128 v[52:55], v14 offset:15360
    v_add_f32 v20, v20, v115
    v_cvt_pk_bf16_f32 v69, v114, v115
    v_add_u32 v14, 0x4000, v14
    v_and_or_b32 v14, v14, s64, v10
    s_waitcnt lgkmcnt(8)
    v_mfma_f32_16x16x32_bf16 v[160:163], v[200:203], v[56:59], v[160:163]
    v_exp_f32 v116, v100
    v_mfma_f32_16x16x32_bf16 v[164:167], v[200:203], v[60:63], v[164:167]
    s_waitcnt vmcnt(0)
    s_barrier
    ds_read_b128 v[120:123], v14 offset:0
    v_add_f32 v20, v20, v116
    v_mfma_f32_16x16x32_bf16 v[168:171], v[204:207], v[56:59], v[168:171]
    v_exp_f32 v117, v101
    v_mfma_f32_16x16x32_bf16 v[172:175], v[204:207], v[60:63], v[172:175]
    ds_read_b128 v[124:127], v14 offset:1024
    v_add_f32 v20, v20, v117
    v_cvt_pk_bf16_f32 v70, v116, v117
    v_mfma_f32_16x16x32_bf16 v[176:179], v[208:211], v[56:59], v[176:179]
    v_exp_f32 v118, v102
    v_mfma_f32_16x16x32_bf16 v[180:183], v[208:211], v[60:63], v[180:183]
    ds_read_b128 v[192:195], v14 offset:2048
    v_add_f32 v20, v20, v118
    v_mfma_f32_16x16x32_bf16 v[184:187], v[212:215], v[56:59], v[184:187]
    v_exp_f32 v119, v103
    v_mfma_f32_16x16x32_bf16 v[188:191], v[212:215], v[60:63], v[188:191]
    ds_read_b128 v[196:199], v14 offset:3072
    v_add_f32 v20, v20, v119
    v_cvt_pk_bf16_f32 v71, v118, v119
    v_max_f32 v21, v19, v20
    v_cmp_nle_f32 vcc, v21, v11
    s_cbranch_vccnz RBE1a
RBE1a_R:
    s_waitcnt lgkmcnt(8)
    v_mfma_f32_16x16x32_bf16 v[128:131], v[24:27], v[64:67], v[128:131]
    v_cmp_gt_i32 s[74:75], 0, v15
    v_cmp_gt_i32 s[76:77], 1, v15
    v_cmp_gt_i32 s[78:79], 2, v15
    v_cmp_gt_i32 s[90:91], 3, v15
    v_cndmask_b32 v72, v72, v22, s[74:75]
    v_cndmask_b32 v73, v73, v22, s[76:77]
    v_cndmask_b32 v74, v74, v22, s[78:79]
    v_cndmask_b32 v75, v75, v22, s[90:91]
    v_exp_f32 v112, v72
    v_exp_f32 v113, v73
    v_mfma_f32_16x16x32_bf16 v[132:135], v[24:27], v[68:71], v[132:135]
    ds_read_b128 v[200:203], v14 offset:4096
    v_add_f32 v17, v17, v19
    v_add_f32 v18, v18, v20
    v_add_f32 v19, v112, v113
    v_cvt_pk_bf16_f32 v56, v112, v113
    v_mfma_f32_16x16x32_bf16 v[136:139], v[28:31], v[64:67], v[136:139]
    v_exp_f32 v114, v74
    v_exp_f32 v115, v75
    v_mfma_f32_16x16x32_bf16 v[140:143], v[28:31], v[68:71], v[140:143]
    ds_read_b128 v[204:207], v14 offset:5120
    v_add_f32 v19, v19, v114
    v_add_f32 v19, v19, v115
    v_cvt_pk_bf16_f32 v57, v114, v115
    v_mfma_f32_16x16x32_bf16 v[144:147], v[32:35], v[64:67], v[144:147]
    v_cmp_gt_i32 s[74:75], 16, v15
    v_cmp_gt_i32 s[76:77], 17, v15
    v_cmp_gt_i32 s[78:79], 18, v15
    v_cmp_gt_i32 s[90:91], 19, v15
    v_cndmask_b32 v80, v80, v22, s[74:75]
    v_cndmask_b32 v81, v81, v22, s[76:77]
    v_cndmask_b32 v82, v82, v22, s[78:79]
    v_cndmask_b32 v83, v83, v22, s[90:91]
    v_exp_f32 v116, v80
    v_exp_f32 v117, v81
    v_mfma_f32_16x16x32_bf16 v[148:151], v[32:35], v[68:71], v[148:151]
    ds_read_b128 v[208:211], v14 offset:6144
    v_add_f32 v19, v19, v116
    v_add_f32 v19, v19, v117
    v_cvt_pk_bf16_f32 v58, v116, v117
    v_mfma_f32_16x16x32_bf16 v[152:155], v[36:39], v[64:67], v[152:155]
    v_exp_f32 v118, v82
    v_exp_f32 v119, v83
    v_mfma_f32_16x16x32_bf16 v[156:159], v[36:39], v[68:71], v[156:159]
    ds_read_b128 v[212:215], v14 offset:7168
    v_add_f32 v19, v19, v118
    v_add_f32 v19, v19, v119
    v_cvt_pk_bf16_f32 v59, v118, v119
    s_waitcnt lgkmcnt(8)
    v_mfma_f32_16x16x32_bf16 v[160:163], v[40:43], v[64:67], v[160:163]
    v_cmp_gt_i32 s[74:75], 0, v16
    v_cmp_gt_i32 s[76:77], 1, v16
    v_cmp_gt_i32 s[78:79], 2, v16
    v_cmp_gt_i32 s[90:91], 3, v16
    v_cndmask_b32 v76, v76, v22, s[74:75]
    v_cndmask_b32 v77, v77, v22, s[76:77]
    v_cndmask_b32 v78, v78, v22, s[78:79]
    v_cndmask_b32 v79, v79, v22, s[90:91]
    v_exp_f32 v112, v76
    v_exp_f32 v113, v77
    v_mfma_f32_16x16x32_bf16 v[164:167], v[40:43], v[68:71], v[164:167]
    v_add_f32 v20, v112, v113
    v_cvt_pk_bf16_f32 v60, v112, v113
    v_mfma_f32_16x16x32_bf16 v[168:171], v[44:47], v[64:67], v[168:171]
    v_exp_f32 v114, v78
    v_exp_f32 v115, v79
    v_mfma_f32_16x16x32_bf16 v[172:175], v[44:47], v[68:71], v[172:175]
    v_add_f32 v20, v20, v114
    v_add_f32 v20, v20, v115
    v_cvt_pk_bf16_f32 v61, v114, v115
    v_mfma_f32_16x16x32_bf16 v[176:179], v[48:51], v[64:67], v[176:179]
    v_cmp_gt_i32 s[74:75], 16, v16
    v_cmp_gt_i32 s[76:77], 17, v16
    v_cmp_gt_i32 s[78:79], 18, v16
    v_cmp_gt_i32 s[90:91], 19, v16
    v_cndmask_b32 v84, v84, v22, s[74:75]
    v_cndmask_b32 v85, v85, v22, s[76:77]
    v_cndmask_b32 v86, v86, v22, s[78:79]
    v_cndmask_b32 v87, v87, v22, s[90:91]
    v_exp_f32 v116, v84
    v_exp_f32 v117, v85
    v_mfma_f32_16x16x32_bf16 v[180:183], v[48:51], v[68:71], v[180:183]
    v_add_f32 v20, v20, v116
    v_add_f32 v20, v20, v117
    v_cvt_pk_bf16_f32 v62, v116, v117
    v_mfma_f32_16x16x32_bf16 v[184:187], v[52:55], v[64:67], v[184:187]
    v_exp_f32 v118, v86
    v_exp_f32 v119, v87
    v_mfma_f32_16x16x32_bf16 v[188:191], v[52:55], v[68:71], v[188:191]
    v_add_f32 v20, v20, v118
    v_add_f32 v20, v20, v119
    v_cvt_pk_bf16_f32 v63, v118, v119
    v_max_f32 v21, v19, v20
    v_cmp_nle_f32 vcc, v21, v11
    s_cbranch_vccnz RBE1b
RBE1b_R:
    s_add_u32 s65, s65, 1
B_E2:
    s_waitcnt lgkmcnt(4)
    v_mfma_f32_16x16x32_bf16 v[128:131], v[120:123], v[56:59], v[128:131]
    v_mfma_f32_16x16x32_bf16 v[132:135], v[120:123], v[60:63], v[132:135]
    v_add_f32 v17, v17, v19
    v_add_f32 v18, v18, v20
    v_mfma_f32_16x16x32_bf16 v[136:139], v[124:127], v[56:59], v[136:139]
    v_mfma_f32_16x16x32_bf16 v[140:143], v[124:127], v[60:63], v[140:143]
    v_mfma_f32_16x16x32_bf16 v[144:147], v[192:195], v[56:59], v[144:147]
    v_mfma_f32_16x16x32_bf16 v[148:151], v[192:195], v[60:63], v[148:151]
    v_mfma_f32_16x16x32_bf16 v[152:155], v[196:199], v[56:59], v[152:155]
    v_mfma_f32_16x16x32_bf16 v[156:159], v[196:199], v[60:63], v[156:159]
    s_waitcnt lgkmcnt(0)
    v_mfma_f32_16x16x32_bf16 v[160:163], v[200:203], v[56:59], v[160:163]
    v_mfma_f32_16x16x32_bf16 v[164:167], v[200:203], v[60:63], v[164:167]
    s_cmp_eq_u32 s65, s67
    s_cbranch_scc1 NB_BE2
    s_waitcnt vmcnt(0)
    s_barrier
NB_BE2:
    v_mfma_f32_16x16x32_bf16 v[168:171], v[204:207], v[56:59], v[168:171]
    v_mfma_f32_16x16x32_bf16 v[172:175], v[204:207], v[60:63], v[172:175]
    v_mfma_f32_16x16x32_bf16 v[176:179], v[208:211], v[56:59], v[176:179]
    v_mfma_f32_16x16x32_bf16 v[180:183], v[208:211], v[60:63], v[180:183]
    v_mfma_f32_16x16x32_bf16 v[184:187], v[212:215], v[56:59], v[184:187]
    v_mfma_f32_16x16x32_bf16 v[188:191], v[212:215], v[60:63], v[188:191]
    s_branch B_EP
B_S1:
    s_bitcmp0_b32 s7, 5
    s_cbranch_scc1 B_E1
    s_waitcnt lgkmcnt(8)
    v_mfma_f32_16x16x32_bf16 v[72:75], v[24:27], v[216:219], v[104:107]
    v_exp_f32 v112, v88
    v_mfma_f32_16x16x32_bf16 v[76:79], v[24:27], v[232:235], v[108:111]
    ds_read_b128 v[200:203], v14 offset:4096
    v_add_f32 v17, v17, v19
    v_mfma_f32_16x16x32_bf16 v[72:75], v[28:31], v[220:223], v[72:75]
    v_exp_f32 v113, v89
    v_mfma_f32_16x16x32_bf16 v[76:79], v[28:31], v[236:239], v[76:79]
    ds_read_b128 v[204:207], v14 offset:5120
    v_add_f32 v19, v112, v113
    v_cvt_pk_bf16_f32 v64, v112, v113
    v_mfma_f32_16x16x32_bf16 v[72:75], v[32:35], v[224:227], v[72:75]
    v_exp_f32 v114, v90
    v_mfma_f32_16x16x32_bf16 v[76:79], v[32:35], v[240:243], v[76:79]
    ds_read_b128 v[208:211], v14 offset:6144
    v_add_f32 v19, v19, v114
    v_mfma_f32_16x16x32_bf16 v[72:75], v[36:39], v[228:231], v[72:75]
    v_exp_f32 v115, v91
    v_mfma_f32_16x16x32_bf16 v[76:79], v[36:39], v[244:247], v[76:79]
    ds_read_b128 v[212:215], v14 offset:7168
    v_add_f32 v19, v19, v115
    v_cvt_pk_bf16_f32 v65, v114, v115
    s_waitcnt lgkmcnt(8)
    v_mfma_f32_16x16x32_bf16 v[80:83], v[40:43], v[216:219], v[104:107]
    v_exp_f32 v116, v96
    v_mfma_f32_16x16x32_bf16 v[84:87], v[40:43], v[232:235], v[108:111]
    ds_read_b128 v[24:27], v13 offset:8192
    v_add_f32 v19, v19, v116
    v_mfma_f32_16x16x32_bf16 v[80:83], v[44:47], v[220:223], v[80:83]
    v_exp_f32 v117, v97
    v_mfma_f32_16x16x32_bf16 v[84:87], v[44:47], v[236:239], v[84:87]
    ds_read_b128 v[28:31], v13 offset:9216
    v_add_f32 v19, v19, v117
    v_cvt_pk_bf16_f32 v66, v116, v117
    v_mfma_f32_16x16x32_bf16 v[80:83], v[48:51], v[224:227], v[80:83]
    v_exp_f32 v118, v98
    v_mfma_f32_16x16x32_bf16 v[84:87], v[48:51], v[240:243], v[84:87]
    ds_read_b128 v[32:35], v13 offset:10240
    v_add_f32 v19, v19, v118
    v_mfma_f32_16x16x32_bf16 v[80:83], v[52:55], v[228:231], v[80:83]
    v_exp_f32 v119, v99
    v_mfma_f32_16x16x32_bf16 v[84:87], v[52:55], v[244:247], v[84:87]
    ds_read_b128 v[36:39], v13 offset:11264
    v_add_f32 v19, v19, v119
    v_cvt_pk_bf16_f32 v67, v118, v119
    s_waitcnt lgkmcnt(8)
    v_mfma_f32_16x16x32_bf16 v[128:131], v[120:123], v[56:59], v[128:131]
    v_exp_f32 v112, v92
    v_mfma_f32_16x16x32_bf16 v[132:135], v[120:123], v[60:63], v[132:135]
    ds_read_b128 v[40:43], v13 offset:12288
    v_add_f32 v18, v18, v20
    v_mfma_f32_16x16x32_bf16 v[136:139], v[124:127], v[56:59], v[136:139]
    v_exp_f32 v113, v93
    v_mfma_f32_16x16x32_bf16 v[140:143], v[124:127], v[60:63], v[140:143]
    ds_read_b128 v[44:47], v13 offset:13312
    v_add_f32 v20, v112, v113
    v_cvt_pk_bf16_f32 v68, v112, v113
    v_mfma_f32_16x16x32_bf16 v[144:147], v[192:195], v[56:59], v[144:147]
    v_exp_f32 v114, v94
    v_mfma_f32_16x16x32_bf16 v[148:151], v[192:195], v[60:63], v[148:151]
    ds_read_b128 v[48:51], v13 offset:14336
    v_add_f32 v20, v20, v114
    v_mfma_f32_16x16x32_bf16 v[152:155], v[196:199], v[56:59], v[152:155]
    v_exp_f32 v115, v95
    v_mfma_f32_16x16x32_bf16 v[156:159], v[196:199], v[60:63], v[156:159]
    ds_read_b128 v[52:55], v13 offset:15360
    v_add_f32 v20, v20, v115
    v_cvt_pk_bf16_f32 v69, v114, v115
    s_waitcnt lgkmcnt(8)
    v_mfma_f32_16x16x32_bf16 v[160:163], v[200:203], v[56:59], v[160:163]
    v_exp_f32 v116, v100
    v_mfma_f32_16x16x32_bf16 v[164:167], v[200:203], v[60:63], v[164:167]
    ds_read_b128 v[120:123], v14 offset:8192
    v_add_f32 v20, v20, v116
    v_mfma_f32_16x16x32_bf16 v[168:171], v[204:207], v[56:59], v[168:171]
    v_exp_f32 v117, v101
    v_mfma_f32_16x16x32_bf16 v[172:175], v[204:207], v[60:63], v[172:175]
    ds_read_b128 v[124:127], v14 offset:9216
    v_add_f32 v20, v20, v117
    v_cvt_pk_bf16_f32 v70, v116, v117
    v_mfma_f32_16x16x32_bf16 v[176:179], v[208:211], v[56:59], v[176:179]
    v_exp_f32 v118, v102
    v_mfma_f32_16x16x32_bf16 v[180:183], v[208:211], v[60:63], v[180:183]
    ds_read_b128 v[192:195], v14 offset:10240
    v_add_f32 v20, v20, v118
    v_mfma_f32_16x16x32_bf16 v[184:187], v[212:215], v[56:59], v[184:187]
    v_exp_f32 v119, v103
    v_mfma_f32_16x16x32_bf16 v[188:191], v[212:215], v[60:63], v[188:191]
    ds_read_b128 v[196:199], v14 offset:11264
    v_add_f32 v20, v20, v119
    v_cvt_pk_bf16_f32 v71, v118, v119
    v_max_f32 v21, v19, v20
    v_cmp_nle_f32 vcc, v21, v11
    s_cbranch_vccnz RBS1a
RBS1a_R:
    s_waitcnt lgkmcnt(8)
    v_mfma_f32_16x16x32_bf16 v[88:91], v[24:27], v[216:219], v[104:107]
    v_cmp_gt_i32 s[74:75], 0, v15
    v_cmp_gt_i32 s[76:77], 1, v15
    v_cmp_gt_i32 s[78:79], 2, v15
    v_cmp_gt_i32 s[90:91], 3, v15
    v_cndmask_b32 v72, v72, v22, s[74:75]
    v_cndmask_b32 v73, v73, v22, s[76:77]
    v_cndmask_b32 v74, v74, v22, s[78:79]
    v_cndmask_b32 v75, v75, v22, s[90:91]
    v_exp_f32 v112, v72
    v_mfma_f32_16x16x32_bf16 v[92:95], v[24:27], v[232:235], v[108:111]
    ds_read_b128 v[200:203], v14 offset:12288
    v_add_f32 v17, v17, v19
    v_mfma_f32_16x16x32_bf16 v[88:91], v[28:31], v[220:223], v[88:91]
    v_exp_f32 v113, v73
    v_mfma_f32_16x16x32_bf16 v[92:95], v[28:31], v[236:239], v[92:95]
    ds_read_b128 v[204:207], v14 offset:13312
    v_add_f32 v19, v112, v113
    v_cvt_pk_bf16_f32 v56, v112, v113
    v_mfma_f32_16x16x32_bf16 v[88:91], v[32:35], v[224:227], v[88:91]
    v_exp_f32 v114, v74
    v_mfma_f32_16x16x32_bf16 v[92:95], v[32:35], v[240:243], v[92:95]
    ds_read_b128 v[208:211], v14 offset:14336
    v_add_f32 v19, v19, v114
    v_mfma_f32_16x16x32_bf16 v[88:91], v[36:39], v[228:231], v[88:91]
    v_exp_f32 v115, v75
    v_mfma_f32_16x16x32_bf16 v[92:95], v[36:39], v[244:247], v[92:95]
    ds_read_b128 v[212:215], v14 offset:15360
    v_add_f32 v19, v19, v115
    v_cvt_pk_bf16_f32 v57, v114, v115
    v_add_u32 v14, 0x4000, v14
    v_and_or_b32 v14, v14, s64, v10
    s_waitcnt lgkmcnt(8)
    v_mfma_f32_16x16x32_bf16 v[96:99], v[40:43], v[216:219], v[104:107]
    v_cmp_gt_i32 s[74:75], 16, v15
    v_cmp_gt_i32 s[76:77], 17, v15
    v_cmp_gt_i32 s[78:79], 18, v15
    v_cmp_gt_i32 s[90:91], 19, v15
    v_cndmask_b32 v80, v80, v22, s[74:75]
    v_cndmask_b32 v81, v81, v22, s[76:77]
    v_cndmask_b32 v82, v82, v22, s[78:79]
    v_cndmask_b32 v83, v83, v22, s[90:91]
    v_exp_f32 v116, v80
    v_mfma_f32_16x16x32_bf16 v[100:103], v[40:43], v[232:235], v[108:111]
    s_waitcnt vmcnt(0)
    s_barrier
    ds_read_b128 v[24:27], v14 offset:0
    v_add_f32 v19, v19, v116
    v_mfma_f32_16x16x32_bf16 v[96:99], v[44:47], v[220:223], v[96:99]
    v_exp_f32 v117, v81
    v_mfma_f32_16x16x32_bf16 v[100:103], v[44:47], v[236:239], v[100:103]
    ds_read_b128 v[28:31], v14 offset:1024
    v_add_f32 v19, v19, v117
    v_cvt_pk_bf16_f32 v58, v116, v117
    v_mfma_f32_16x16x32_bf16 v[96:99], v[48:51], v[224:227], v[96:99]
    v_exp_f32 v118, v82
    v_mfma_f32_16x16x32_bf16 v[100:103], v[48:51], v[240:243], v[100:103]
    ds_read_b128 v[32:35], v14 offset:2048
    v_add_f32 v19, v19, v118
    v_mfma_f32_16x16x32_bf16 v[96:99], v[52:55], v[228:231], v[96:99]
    v_exp_f32 v119, v83
    v_mfma_f32_16x16x32_bf16 v[100:103], v[52:55], v[244:247], v[100:103]
    ds_read_b128 v[36:39], v14 offset:3072
    v_add_f32 v19, v19, v119
    v_cvt_pk_bf16_f32 v59, v118, v119
    s_waitcnt lgkmcnt(8)
    v_mfma_f32_16x16x32_bf16 v[128:131], v[120:123], v[64:67], v[128:131]
    v_cmp_gt_i32 s[74:75], 0, v16
    v_cmp_gt_i32 s[76:77], 1, v16
    v_cmp_gt_i32 s[78:79], 2, v16
    v_cmp_gt_i32 s[90:91], 3, v16
    v_cndmask_b32 v76, v76, v22, s[74:75]
    v_cndmask_b32 v77, v77, v22, s[76:77]
    v_cndmask_b32 v78, v78, v22, s[78:79]
    v_cndmask_b32 v79, v79, v22, s[90:91]
    v_exp_f32 v112, v76
    v_mfma_f32_16x16x32_bf16 v[132:135], v[120:123], v[68:71], v[132:135]
    ds_read_b128 v[40:43], v14 offset:4096
    v_add_f32 v18, v18, v20
    v_mfma_f32_16x16x32_bf16 v[136:139], v[124:127], v[64:67], v[136:139]
    v_exp_f32 v113, v77
    v_mfma_f32_16x16x32_bf16 v[140:143], v[124:127], v[68:71], v[140:143]
    ds_read_b128 v[44:47], v14 offset:5120
    v_add_f32 v20, v112, v113
    v_cvt_pk_bf16_f32 v60, v112, v113
    v_mfma_f32_16x16x32_bf16 v[144:147], v[192:195], v[64:67], v[144:147]
    v_exp_f32 v114, v78
    v_mfma_f32_16x16x32_bf16 v[148:151], v[192:195], v[68:71], v[148:151]
    ds_read_b128 v[48:51], v14 offset:6144
    v_add_f32 v20, v20, v114
    v_mfma_f32_16x16x32_bf16 v[152:155], v[196:199], v[64:67], v[152:155]
    v_exp_f32 v115, v79
    v_mfma_f32_16x16x32_bf16 v[156:159], v[196:199], v[68:71], v[156:159]
    ds_read_b128 v[52:55], v14 offset:7168
    v_add_f32 v20, v20, v115
    v_cvt_pk_bf16_f32 v61, v114, v115
    s_waitcnt lgkmcnt(8)
    v_mfma_f32_16x16x32_bf16 v[160:163], v[200:203], v[64:67], v[160:163]
    v_cmp_gt_i32 s[74:75], 16, v16
    v_cmp_gt_i32 s[76:77], 17, v16
    v_cmp_gt_i32 s[78:79], 18, v16
    v_cmp_gt_i32 s[90:91], 19, v16
    v_cndmask_b32 v84, v84, v22, s[74:75]
    v_cndmask_b32 v85, v85, v22, s[76:77]
    v_cndmask_b32 v86, v86, v22, s[78:79]
    v_cndmask_b32 v87, v87, v22, s[90:91]
    v_exp_f32 v116, v84
    v_mfma_f32_16x16x32_bf16 v[164:167], v[200:203], v[68:71], v[164:167]
    ds_read_b128 v[120:123], v14 offset:8192
    v_add_f32 v20, v20, v116
    v_mfma_f32_16x16x32_bf16 v[168:171], v[204:207], v[64:67], v[168:171]
    v_exp_f32 v117, v85
    v_mfma_f32_16x16x32_bf16 v[172:175], v[204:207], v[68:71], v[172:175]
    ds_read_b128 v[124:127], v14 offset:9216
    v_add_f32 v20, v20, v117
    v_cvt_pk_bf16_f32 v62, v116, v117
    v_mfma_f32_16x16x32_bf16 v[176:179], v[208:211], v[64:67], v[176:179]
    v_exp_f32 v118, v86
    v_mfma_f32_16x16x32_bf16 v[180:183], v[208:211], v[68:71], v[180:183]
    ds_read_b128 v[192:195], v14 offset:10240
    v_add_f32 v20, v20, v118
    v_mfma_f32_16x16x32_bf16 v[184:187], v[212:215], v[64:67], v[184:187]
    v_exp_f32 v119, v87
    v_mfma_f32_16x16x32_bf16 v[188:191], v[212:215], v[68:71], v[188:191]
    ds_read_b128 v[196:199], v14 offset:11264
    v_add_f32 v20, v20, v119
    v_cvt_pk_bf16_f32 v63, v118, v119
    v_max_f32 v21, v19, v20
    v_cmp_nle_f32 vcc, v21, v11
    s_cbranch_vccnz RBS1b
RBS1b_R:
    s_add_u32 s65, s65, 1
B_S2:
    s_waitcnt lgkmcnt(8)
    v_mfma_f32_16x16x32_bf16 v[128:131], v[24:27], v[56:59], v[128:131]
    v_cmp_gt_i32 s[74:75], 32, v15
    v_cmp_gt_i32 s[76:77], 33, v15
    v_cmp_gt_i32 s[78:79], 34, v15
    v_cmp_gt_i32 s[90:91], 35, v15
    v_cndmask_b32 v88, v88, v22, s[74:75]
    v_cndmask_b32 v89, v89, v22, s[76:77]
    v_cndmask_b32 v90, v90, v22, s[78:79]
    v_cndmask_b32 v91, v91, v22, s[90:91]
    v_exp_f32 v112, v88
    v_exp_f32 v113, v89
    v_mfma_f32_16x16x32_bf16 v[132:135], v[24:27], v[60:63], v[132:135]
    ds_read_b128 v[200:203], v14 offset:12288
    v_add_f32 v17, v17, v19
    v_add_f32 v18, v18, v20
    v_add_f32 v19, v112, v113
    v_cvt_pk_bf16_f32 v64, v112, v113
    v_mfma_f32_16x16x32_bf16 v[136:139], v[28:31], v[56:59], v[136:139]
    v_exp_f32 v114, v90
    v_exp_f32 v115, v91
    v_mfma_f32_16x16x32_bf16 v[140:143], v[28:31], v[60:63], v[140:143]
    ds_read_b128 v[204:207], v14 offset:13312
    v_add_f32 v19, v19, v114
    v_add_f32 v19, v19, v115
    v_cvt_pk_bf16_f32 v65, v114, v115
    v_mfma_f32_16x16x32_bf16 v[144:147], v[32:35], v[56:59], v[144:147]
    v_cmp_gt_i32 s[74:75], 48, v15
    v_cmp_gt_i32 s[76:77], 49, v15
    v_cmp_gt_i32 s[78:79], 50, v15
    v_cmp_gt_i32 s[90:91], 51, v15
    v_cndmask_b32 v96, v96, v22, s[74:75]
    v_cndmask_b32 v97, v97, v22, s[76:77]
    v_cndmask_b32 v98, v98, v22, s[78:79]
    v_cndmask_b32 v99, v99, v22, s[90:91]
    v_exp_f32 v116, v96
    v_exp_f32 v117, v97
    v_mfma_f32_16x16x32_bf16 v[148:151], v[32:35], v[60:63], v[148:151]
    ds_read_b128 v[208:211], v14 offset:14336
    v_add_f32 v19, v19, v116
    v_add_f32 v19, v19, v117
    v_cvt_pk_bf16_f32 v66, v116, v117
    v_mfma_f32_16x16x32_bf16 v[152:155], v[36:39], v[56:59], v[152:155]
    v_exp_f32 v118, v98
    v_exp_f32 v119, v99
    v_mfma_f32_16x16x32_bf16 v[156:159], v[36:39], v[60:63], v[156:159]
    ds_read_b128 v[212:215], v14 offset:15360
    v_add_f32 v19, v19, v118
    v_add_f32 v19, v19, v119
    v_cvt_pk_bf16_f32 v67, v118, v119
    s_waitcnt lgkmcnt(8)
    v_mfma_f32_16x16x32_bf16 v[160:163], v[40:43], v[56:59], v[160:163]
    v_cmp_gt_i32 s[74:75], 32, v16
    v_cmp_gt_i32 s[76:77], 33, v16
    v_cmp_gt_i32 s[78:79], 34, v16
    v_cmp_gt_i32 s[90:91], 35, v16
    v_cndmask_b32 v92, v92, v22, s[74:75]
    v_cndmask_b32 v93, v93, v22, s[76:77]
    v_cndmask_b32 v94, v94, v22, s[78:79]
    v_cndmask_b32 v95, v95, v22, s[90:91]
    v_exp_f32 v112, v92
    v_exp_f32 v113, v93
    v_mfma_f32_16x16x32_bf16 v[164:167], v[40:43], v[60:63], v[164:167]
    v_add_f32 v20, v112, v113
    v_cvt_pk_bf16_f32 v68, v112, v113
    v_mfma_f32_16x16x32_bf16 v[168:171], v[44:47], v[56:59], v[168:171]
    v_exp_f32 v114, v94
    v_exp_f32 v115, v95
    v_mfma_f32_16x16x32_bf16 v[172:175], v[44:47], v[60:63], v[172:175]
    v_add_f32 v20, v20, v114
    v_add_f32 v20, v20, v115
    v_cvt_pk_bf16_f32 v69, v114, v115
    v_mfma_f32_16x16x32_bf16 v[176:179], v[48:51], v[56:59], v[176:179]
    v_cmp_gt_i32 s[74:75], 48, v16
    v_cmp_gt_i32 s[76:77], 49, v16
    v_cmp_gt_i32 s[78:79], 50, v16
    v_cmp_gt_i32 s[90:91], 51, v16
    v_cndmask_b32 v100, v100, v22, s[74:75]
    v_cndmask_b32 v101, v101, v22, s[76:77]
    v_cndmask_b32 v102, v102, v22, s[78:79]
    v_cndmask_b32 v103, v103, v22, s[90:91]
    v_exp_f32 v116, v100
    v_exp_f32 v117, v101
    v_mfma_f32_16x16x32_bf16 v[180:183], v[48:51], v[60:63], v[180:183]
    v_add_f32 v20, v20, v116
    v_add_f32 v20, v20, v117
    v_cvt_pk_bf16_f32 v70, v116, v117
    v_mfma_f32_16x16x32_bf16 v[184:187], v[52:55], v[56:59], v[184:187]
    v_exp_f32 v118, v102
    v_exp_f32 v119, v103
    v_mfma_f32_16x16x32_bf16 v[188:191], v[52:55], v[60:63], v[188:191]
    v_add_f32 v20, v20, v118
    v_add_f32 v20, v20, v119
    v_cvt_pk_bf16_f32 v71, v118, v119
    v_max_f32 v21, v19, v20
    v_cmp_nle_f32 vcc, v21, v11
    s_cbranch_vccnz RBS2a
RBS2a_R:
    s_waitcnt lgkmcnt(4)
    v_mfma_f32_16x16x32_bf16 v[128:131], v[120:123], v[64:67], v[128:131]
    v_mfma_f32_16x16x32_bf16 v[132:135], v[120:123], v[68:71], v[132:135]
    v_add_f32 v17, v17, v19
    v_add_f32 v18, v18, v20
    v_mfma_f32_16x16x32_bf16 v[136:139], v[124:127], v[64:67], v[136:139]
    v_mfma_f32_16x16x32_bf16 v[140:143], v[124:127], v[68:71], v[140:143]
    s_cmp_eq_u32 s65, s67
    s_cbranch_scc1 NB_BS2
    s_waitcnt vmcnt(0)
    s_barrier
NB_BS2:
    v_mfma_f32_16x16x32_bf16 v[144:147], v[192:195], v[64:67], v[144:147]
    v_mfma_f32_16x16x32_bf16 v[148:151], v[192:195], v[68:71], v[148:151]
    v_mfma_f32_16x16x32_bf16 v[152:155], v[196:199], v[64:67], v[152:155]
    v_mfma_f32_16x16x32_bf16 v[156:159], v[196:199], v[68:71], v[156:159]
    s_waitcnt lgkmcnt(0)
    v_mfma_f32_16x16x32_bf16 v[160:163], v[200:203], v[64:67], v[160:163]
    v_mfma_f32_16x16x32_bf16 v[164:167], v[200:203], v[68:71], v[164:167]
    v_mfma_f32_16x16x32_bf16 v[168:171], v[204:207], v[64:67], v[168:171]
    v_mfma_f32_16x16x32_bf16 v[172:175], v[204:207], v[68:71], v[172:175]
    v_mfma_f32_16x16x32_bf16 v[176:179], v[208:211], v[64:67], v[176:179]
    v_mfma_f32_16x16x32_bf16 v[180:183], v[208:211], v[68:71], v[180:183]
    v_mfma_f32_16x16x32_bf16 v[184:187], v[212:215], v[64:67], v[184:187]
    v_mfma_f32_16x16x32_bf16 v[188:191], v[212:215], v[68:71], v[188:191]
B_EP:
    s_nop 7
    v_permlane16_swap_b32 v17, v18
    v_add_f32 v17, v17, v18
    v_mov_b32 v112, v17
    s_nop 1
    v_permlane32_swap_b32 v17, v112
    v_add_f32 v17, v17, v112
    v_mov_b32 v18, v17
    s_nop 1
    v_permlane16_swap_b32 v17, v18
    v_rcp_f32 v17, v17
    s_nop 0
    v_mul_f32 v112, v17, v3
    v_mov_b32 v113, v112
    v_rcp_f32 v18, v18
    s_nop 0
    v_mul_f32 v114, v18, v12
    v_mov_b32 v115, v114
    s_lshl_b32 s6, s3, 14
    s_add_u32 s6, s6, s69
    v_pk_mul_f32 v[128:129], v[128:129], v[112:113]
    v_pk_mul_f32 v[130:131], v[130:131], v[112:113]
    v_cvt_pk_bf16_f32 v24, v128, v129
    v_cvt_pk_bf16_f32 v25, v130, v131
    v_pk_mul_f32 v[136:137], v[136:137], v[112:113]
    v_pk_mul_f32 v[138:139], v[138:139], v[112:113]
    v_cvt_pk_bf16_f32 v26, v136, v137
    v_cvt_pk_bf16_f32 v27, v138, v139
    buffer_store_dwordx4 v[24:27], v2, s[44:47], s6 offen offset:0 sc1
    v_pk_mul_f32 v[132:133], v[132:133], v[114:115]
    v_pk_mul_f32 v[134:135], v[134:135], v[114:115]
    v_cvt_pk_bf16_f32 v28, v132, v133
    v_cvt_pk_bf16_f32 v29, v134, v135
    v_pk_mul_f32 v[140:141], v[140:141], v[114:115]
    v_pk_mul_f32 v[142:143], v[142:143], v[114:115]
    v_cvt_pk_bf16_f32 v30, v140, v141
    v_cvt_pk_bf16_f32 v31, v142, v143
    buffer_store_dwordx4 v[28:31], v2, s[44:47], s6 offen offset:1024 sc1
    s_add_u32 s6, s6, 4096
    v_pk_mul_f32 v[144:145], v[144:145], v[112:113]
    v_pk_mul_f32 v[146:147], v[146:147], v[112:113]
    v_cvt_pk_bf16_f32 v32, v144, v145
    v_cvt_pk_bf16_f32 v33, v146, v147
    v_pk_mul_f32 v[152:153], v[152:153], v[112:113]
    v_pk_mul_f32 v[154:155], v[154:155], v[112:113]
    v_cvt_pk_bf16_f32 v34, v152, v153
    v_cvt_pk_bf16_f32 v35, v154, v155
    buffer_store_dwordx4 v[32:35], v2, s[44:47], s6 offen offset:0 sc1
    v_pk_mul_f32 v[148:149], v[148:149], v[114:115]
    v_pk_mul_f32 v[150:151], v[150:151], v[114:115]
    v_cvt_pk_bf16_f32 v36, v148, v149
    v_cvt_pk_bf16_f32 v37, v150, v151
    v_pk_mul_f32 v[156:157], v[156:157], v[114:115]
    v_pk_mul_f32 v[158:159], v[158:159], v[114:115]
    v_cvt_pk_bf16_f32 v38, v156, v157
    v_cvt_pk_bf16_f32 v39, v158, v159
    buffer_store_dwordx4 v[36:39], v2, s[44:47], s6 offen offset:1024 sc1
    s_add_u32 s6, s6, 4096
    v_pk_mul_f32 v[160:161], v[160:161], v[112:113]
    v_pk_mul_f32 v[162:163], v[162:163], v[112:113]
    v_cvt_pk_bf16_f32 v40, v160, v161
    v_cvt_pk_bf16_f32 v41, v162, v163
    v_pk_mul_f32 v[168:169], v[168:169], v[112:113]
    v_pk_mul_f32 v[170:171], v[170:171], v[112:113]
    v_cvt_pk_bf16_f32 v42, v168, v169
    v_cvt_pk_bf16_f32 v43, v170, v171
    buffer_store_dwordx4 v[40:43], v2, s[44:47], s6 offen offset:0 sc1
    v_pk_mul_f32 v[164:165], v[164:165], v[114:115]
    v_pk_mul_f32 v[166:167], v[166:167], v[114:115]
    v_cvt_pk_bf16_f32 v44, v164, v165
    v_cvt_pk_bf16_f32 v45, v166, v167
    v_pk_mul_f32 v[172:173], v[172:173], v[114:115]
    v_pk_mul_f32 v[174:175], v[174:175], v[114:115]
    v_cvt_pk_bf16_f32 v46, v172, v173
    v_cvt_pk_bf16_f32 v47, v174, v175
    buffer_store_dwordx4 v[44:47], v2, s[44:47], s6 offen offset:1024 sc1
    s_add_u32 s6, s6, 4096
    v_pk_mul_f32 v[176:177], v[176:177], v[112:113]
    v_pk_mul_f32 v[178:179], v[178:179], v[112:113]
    v_cvt_pk_bf16_f32 v48, v176, v177
    v_cvt_pk_bf16_f32 v49, v178, v179
    v_pk_mul_f32 v[184:185], v[184:185], v[112:113]
    v_pk_mul_f32 v[186:187], v[186:187], v[112:113]
    v_cvt_pk_bf16_f32 v50, v184, v185
    v_cvt_pk_bf16_f32 v51, v186, v187
    buffer_store_dwordx4 v[48:51], v2, s[44:47], s6 offen offset:0 sc1
    v_pk_mul_f32 v[180:181], v[180:181], v[114:115]
    v_pk_mul_f32 v[182:183], v[182:183], v[114:115]
    v_cvt_pk_bf16_f32 v52, v180, v181
    v_cvt_pk_bf16_f32 v53, v182, v183
    v_pk_mul_f32 v[188:189], v[188:189], v[114:115]
    v_pk_mul_f32 v[190:191], v[190:191], v[114:115]
    v_cvt_pk_bf16_f32 v54, v188, v189
    v_cvt_pk_bf16_f32 v55, v190, v191
    buffer_store_dwordx4 v[52:55], v2, s[44:47], s6 offen offset:1024 sc1
F_FIN:
    s_setprio 0
    s_waitcnt lgkmcnt(0)
    v_lshrrev_b32 v4, 2, v2
    buffer_load_dword v5, v4, s[48:51], 0 offen sc1
    v_and_b32 v68, 15, v1
    v_lshrrev_b32 v69, 4, v1
    v_mul_u32_u24 v56, 144, v69
    v_add_u32 v56, 147456, v56
    v_mov_b32 v69, 512
    v_cmp_eq_u32 vcc, 0, v68
    s_nop 1
    v_cndmask_b32 v69, v69, 16, vcc
    v_cmp_eq_u32 vcc, 4, v68
    s_nop 1
    v_cndmask_b32 v69, v69, 17, vcc
    v_cmp_eq_u32 vcc, 8, v68
    s_nop 1
    v_cndmask_b32 v69, v69, 8, vcc
    v_cmp_eq_u32 vcc, 12, v68
    s_nop 1
    v_cndmask_b32 v69, v69, 12, vcc
    v_lshl_add_u32 v69, v69, 1, v56
    v_lshl_add_u32 v68, v68, 1, v56
    ds_read_u16 v56, v68 offset:0
    ds_read_u16 v57, v68 offset:36
    ds_read_u16 v58, v68 offset:72
    ds_read_u16 v59, v68 offset:108
    ds_read_u16 v60, v68 offset:576
    ds_read_u16 v61, v68 offset:612
    ds_read_u16 v62, v69 offset:0
    ds_read_u16 v63, v69 offset:36
    ds_read_u16 v64, v69 offset:72
    ds_read_u16 v65, v69 offset:108
    ds_read_u16 v66, v69 offset:576
    ds_read_u16 v67, v69 offset:612
    v_add_u32 v6, 149504, v2
    ds_read_b128 v[136:139], v6 offset:0
    ds_read_b128 v[140:143], v6 offset:1024
    ds_read_b128 v[144:147], v6 offset:2048
    ds_read_b128 v[148:151], v6 offset:3072
    s_waitcnt lgkmcnt(14)
    v_lshl_or_b32 v72, v57, 16, v56
    s_waitcnt lgkmcnt(12)
    v_lshl_or_b32 v73, v59, 16, v58
    s_waitcnt lgkmcnt(10)
    v_lshl_or_b32 v74, v61, 16, v60
    v_mov_b32 v75, 0
    s_waitcnt lgkmcnt(8)
    v_lshl_or_b32 v76, v63, 16, v62
    s_waitcnt lgkmcnt(6)
    v_lshl_or_b32 v77, v65, 16, v64
    s_waitcnt lgkmcnt(4)
    v_lshl_or_b32 v78, v67, 16, v66
    v_mov_b32 v79, 0
    v_mfma_f32_16x16x32_bf16 v[80:83], v[72:75], v[248:251], 0
    v_mfma_f32_16x16x32_bf16 v[84:87], v[72:75], v[252:255], 0
    v_mfma_f32_16x16x32_bf16 v[88:91], v[76:79], v[248:251], 0
    v_mfma_f32_16x16x32_bf16 v[92:95], v[76:79], v[252:255], 0
    s_nop 4
    v_max3_f32 v116, v80, v81, v82
    v_max3_f32 v117, -v80, -v81, -v82
    v_max3_f32 v116, v116, v83, v88
    v_max3_f32 v117, v117, -v83, -v88
    v_max3_f32 v118, v84, v85, v86
    v_max3_f32 v119, -v84, -v85, -v86
    v_max3_f32 v118, v118, v87, v92
    v_max3_f32 v119, v119, -v87, -v92
    v_permlane16_swap_b32 v116, v117
    s_nop 0
    v_permlane16_swap_b32 v118, v119
    v_max_f32 v116, v116, v117
    v_max_f32 v118, v118, v119
    s_nop 1
    v_permlane32_swap_b32 v116, v118
    v_max_f32 v116, v116, v118
    v_mov_b32 v118, v116
    s_nop 1
    v_permlane32_swap_b32 v116, v118
    v_mov_b32 v117, v116
    v_mov_b32 v119, v118
    s_nop 0
    v_permlane16_swap_b32 v116, v117
    v_permlane16_swap_b32 v118, v119
    v_mul_f32 v116, s68, v116
    v_mul_f32 v117, s68, v117
    v_mul_f32 v118, s68, v118
    v_mul_f32 v119, s68, v119
    v_fma_f32 v96, v80, s68, -v116
    v_fma_f32 v101, -v80, s68, -v117
    v_fma_f32 v97, v81, s68, -v116
    v_fma_f32 v102, -v81, s68, -v117
    v_fma_f32 v98, v82, s68, -v116
    v_fma_f32 v103, -v82, s68, -v117
    v_fma_f32 v99, v83, s68, -v116
    v_fma_f32 v104, -v83, s68, -v117
    v_fma_f32 v100, v88, s68, -v116
    v_fma_f32 v105, -v88, s68, -v117
    v_fma_f32 v106, v84, s68, -v118
    v_fma_f32 v111, -v84, s68, -v119
    v_fma_f32 v107, v85, s68, -v118
    v_fma_f32 v112, -v85, s68, -v119
    v_fma_f32 v108, v86, s68, -v118
    v_fma_f32 v113, -v86, s68, -v119
    v_fma_f32 v109, v87, s68, -v118
    v_fma_f32 v114, -v87, s68, -v119
    v_fma_f32 v110, v92, s68, -v118
    v_fma_f32 v115, -v92, s68, -v119
    v_exp_f32 v96, v96
    v_exp_f32 v97, v97
    v_exp_f32 v98, v98
    v_exp_f32 v99, v99
    v_exp_f32 v100, v100
    v_exp_f32 v101, v101
    v_exp_f32 v102, v102
    v_exp_f32 v103, v103
    v_exp_f32 v104, v104
    v_exp_f32 v105, v105
    v_exp_f32 v106, v106
    v_exp_f32 v107, v107
    v_exp_f32 v108, v108
    v_exp_f32 v109, v109
    v_exp_f32 v110, v110
    v_exp_f32 v111, v111
    v_exp_f32 v112, v112
    v_exp_f32 v113, v113
    v_exp_f32 v114, v114
    v_exp_f32 v115, v115
    v_mul_f32 v100, v100, v23
    v_mul_f32 v105, v105, v23
    v_mul_f32 v110, v110, v23
    v_mul_f32 v115, v115, v23
    v_add_f32 v116, v96, v97
    v_add_f32 v117, v101, v102
    v_add_f32 v118, v106, v107
    v_add_f32 v119, v111, v112
    v_add_f32 v116, v116, v98
    v_add_f32 v117, v117, v103
    v_add_f32 v118, v118, v108
    v_add_f32 v119, v119, v113
    v_add_f32 v116, v116, v99
    v_add_f32 v117, v117, v104
    v_add_f32 v118, v118, v109
    v_add_f32 v119, v119, v114
    v_add_f32 v116, v116, v100
    v_add_f32 v117, v117, v105
    v_add_f32 v118, v118, v110
    v_add_f32 v119, v119, v115
    v_permlane16_swap_b32 v116, v117
    s_nop 0
    v_permlane16_swap_b32 v118, v119
    v_add_f32 v116, v116, v117
    v_add_f32 v118, v118, v119
    s_nop 1
    v_permlane32_swap_b32 v116, v118
    v_add_f32 v116, v116, v118
    v_mov_b32 v118, v116
    s_nop 1
    v_permlane32_swap_b32 v116, v118
    v_mov_b32 v117, v116
    v_mov_b32 v119, v118
    s_nop 0
    v_permlane16_swap_b32 v116, v117
    v_permlane16_swap_b32 v118, v119
    v_rcp_f32 v116, v116
    v_rcp_f32 v117, v117
    v_rcp_f32 v118, v118
    v_rcp_f32 v119, v119
    v_mul_f32 v96, v96, v116
    v_mul_f32 v97, v97, v116
    v_mul_f32 v98, v98, v116
    v_mul_f32 v99, v99, v116
    v_mul_f32 v100, v100, v116
    v_mul_f32 v101, v101, v117
    v_mul_f32 v102, v102, v117
    v_mul_f32 v103, v103, v117
    v_mul_f32 v104, v104, v117
    v_mul_f32 v105, v105, v117
    v_mul_f32 v106, v106, v118
    v_mul_f32 v107, v107, v118
    v_mul_f32 v108, v108, v118
    v_mul_f32 v109, v109, v118
    v_mul_f32 v110, v110, v118
    v_mul_f32 v111, v111, v119
    v_mul_f32 v112, v112, v119
    v_mul_f32 v113, v113, v119
    v_mul_f32 v114, v114, v119
    v_mul_f32 v115, v115, v119
    v_cvt_pk_bf16_f32 v120, v96, v97
    v_cvt_pk_bf16_f32 v121, v98, v99
    v_cvt_pk_bf16_f32 v122, v101, v102
    v_cvt_pk_bf16_f32 v123, v103, v104
    v_cvt_pk_bf16_f32 v124, v100, v105
    v_mov_b32 v125, 0
    v_cvt_pk_bf16_f32 v128, v106, v107
    v_cvt_pk_bf16_f32 v129, v108, v109
    v_cvt_pk_bf16_f32 v130, v111, v112
    v_cvt_pk_bf16_f32 v131, v113, v114
    v_cvt_pk_bf16_f32 v132, v110, v115
    v_mov_b32 v133, 0
    v_mov_b32 v126, 0
    v_mov_b32 v127, 0
    v_mov_b32 v134, 0
    v_mov_b32 v135, 0
    s_waitcnt lgkmcnt(3)
    v_mfma_f32_16x16x32_bf16 v[152:155], v[136:139], v[120:123], 0
    s_waitcnt lgkmcnt(2)
    v_mfma_f32_16x16x32_bf16 v[152:155], v[140:143], v[124:127], v[152:155]
    s_waitcnt lgkmcnt(1)
    v_mfma_f32_16x16x32_bf16 v[156:159], v[144:147], v[120:123], 0
    s_waitcnt lgkmcnt(0)
    v_mfma_f32_16x16x32_bf16 v[156:159], v[148:151], v[124:127], v[156:159]
    v_mfma_f32_16x16x32_bf16 v[160:163], v[136:139], v[128:131], 0
    v_mfma_f32_16x16x32_bf16 v[160:163], v[140:143], v[132:135], v[160:163]
    v_mfma_f32_16x16x32_bf16 v[164:167], v[144:147], v[128:131], 0
    v_mfma_f32_16x16x32_bf16 v[164:167], v[148:151], v[132:135], v[164:167]
    s_lshr_b32 s6, s3, 1
    s_add_u32 s6, s6, 128
    s_lshl_b32 s6, s6, 12
    s_add_u32 s6, s6, s69
    s_and_b32 s8, s3, 1
    s_lshl_b32 s8, s8, 9
    s_add_u32 s6, s6, s8
    s_lshr_b32 s8, s3, 4
    s_add_u32 s8, s8, 144
    s_lshl_b32 s8, s8, 12
    s_add_u32 s8, s8, s69
    s_lshr_b32 s9, s3, 2
    s_and_b32 s9, s9, 3
    s_lshl_b32 s9, s9, 8
    s_add_u32 s8, s8, s9
    s_and_b32 s9, s3, 3
    s_lshl_b32 s9, s9, 2
    s_add_u32 s8, s8, s9
    v_and_b32 v6, 15, v1
    v_lshlrev_b32 v6, 4, v6
    v_lshrrev_b32 v7, 4, v1
    v_lshl_add_u32 v10, v7, 7, v6
    v_and_b32 v9, 1, v7
    v_mov_b32 v8, s52
    v_cmp_ne_u32 vcc, 1, v7
    s_nop 1
    v_cndmask_b32 v6, v6, v8, vcc
    v_cmp_ne_u32 vcc, 0, v9
    s_nop 1
    v_cndmask_b32 v10, v10, v8, vcc
    v_and_b32 v11, 7, v1
    v_cmp_eq_u32 vcc, 0, v11
    v_mov_b32 v11, 0x142020
    s_nop 0
    v_cndmask_b32 v13, 0, v11, vcc
    s_waitcnt vmcnt(0)
    v_and_b32 v5, v5, v13
    v_cmp_ne_u32 vcc, v5, v13
    s_cbranch_vccz P4_OK
    s_mov_b32 s55, 0x40000
P4_SP:
    s_sleep 2
    buffer_load_dword v5, v4, s[48:51], 0 offen sc1
    s_waitcnt vmcnt(0)
    v_and_b32 v5, v5, v13
    v_cmp_ne_u32 vcc, v5, v13
    s_cbranch_vccz P4_OK
    s_sub_u32 s55, s55, 1
    s_cmp_lg_u32 s55, 0
    s_cbranch_scc1 P4_SP
P4_OK:
    s_mov_b32 s9, 0x358637bd
    v_add_f32 v8, s9, v158
    v_rcp_f32 v8, v8
    v_sub_f32 v9, 1.0, v3
    v_mul_f32 v8, v8, v9
    v_mul_f32 v152, v152, v8
    v_mul_f32 v153, v153, v8
    v_mul_f32 v154, v154, v8
    v_mul_f32 v155, v155, v8
    v_mul_f32 v156, v156, v8
    v_mul_f32 v157, v157, v8
    v_cvt_pk_bf16_f32 v152, v152, v153
    v_cvt_pk_bf16_f32 v153, v154, v155
    v_cvt_pk_bf16_f32 v156, v156, v157
    v_mov_b32 v154, v152
    v_mov_b32 v155, v153
    s_nop 0
    v_permlane16_swap_b32 v152, v154
    v_permlane16_swap_b32 v153, v155
    buffer_store_dwordx4 v[152:155], v10, s[44:47], s6 offen offset:0 sc1
    buffer_store_dword v156, v6, s[44:47], s8 offen offset:0 sc1
    v_add_f32 v8, s9, v166
    v_rcp_f32 v8, v8
    v_sub_f32 v9, 1.0, v12
    v_mul_f32 v8, v8, v9
    v_mul_f32 v160, v160, v8
    v_mul_f32 v161, v161, v8
    v_mul_f32 v162, v162, v8
    v_mul_f32 v163, v163, v8
    v_mul_f32 v164, v164, v8
    v_mul_f32 v165, v165, v8
    v_cvt_pk_bf16_f32 v160, v160, v161
    v_cvt_pk_bf16_f32 v161, v162, v163
    v_cvt_pk_bf16_f32 v164, v164, v165
    v_mov_b32 v162, v160
    v_mov_b32 v163, v161
    s_nop 0
    v_permlane16_swap_b32 v160, v162
    v_permlane16_swap_b32 v161, v163
    buffer_store_dwordx4 v[160:163], v10, s[44:47], s6 offen offset:1024 sc1
    buffer_store_dword v164, v6, s[44:47], s8 offen offset:1024 sc1
    s_and_b32 s64, s2, 3
    s_lshl_b32 s8, s4, 1
    s_sub_u32 s9, 30, s8
    s_bitcmp1_b32 s2, 2
    s_cselect_b32 s10, s9, s8
    s_lshr_b32 s6, s5, 2
    s_add_u32 s6, s6, s10
    s_mul_i32 s6, s6, 598016
    s_lshl_b32 s8, s54, 10
    s_add_u32 s6, s6, s8
    s_add_u32 s6, s6, 33554432
    s_lshl_b32 s8, s64, 17
    s_add_u32 s65, s6, s8
    s_lshl_b32 s8, s64, 14
    s_add_u32 s66, s6, s8
    s_add_u32 s66, s66, 524288
    s_lshl_b32 s8, s64, 11
    s_add_u32 s8, s6, s8
    s_add_u32 s8, s8, 589824
    s_bitcmp1_b32 s64, 0
    s_cselect_b32 s67, s52, s8
    s_cselect_b32 s9, 36, 37
    s_cselect_b32 s11, 8, 16
    s_lshr_b32 s6, s2, 6
    s_lshl_b32 s6, s6, 2
    s_add_u32 s6, s6, s64
    s_mul_i32 s6, s6, 359936
    s_add_u32 s6, s6, 54525952
    s_add_u32 s56, s42, s6
    s_addc_u32 s57, s43, 0
    s_mov_b32 s58, 0
    s_mov_b32 s59, 0x00020000
    s_mul_i32 s58, s9, 9728
    s_mov_b32 s60, s38
    s_mov_b32 s61, s39
    s_mov_b32 s62, 2359296
    s_mov_b32 s63, 0x00020000
    s_lshl_b32 s68, s54, 10
    v_add_u32 v18, s97, v2
    v_add_u32 v19, s68, v2
    v_bfe_u32 v10, v1, 2, 2
    v_lshl_add_u32 v10, v7, 3, v10
    v_mul_u32_u24 v10, 288, v10
    v_lshl_add_u32 v10, v7, 7, v10
    v_and_b32 v11, 3, v1
    v_lshl_add_u32 v10, v11, 3, v10
    s_lshr_b32 s6, s5, 2
    s_mul_i32 s6, s6, 160
    s_add_u32 s6, s6, 65536
    v_add_u32 v12, s6, v10
    v_add_u32 v13, 38912, v12
    s_lshl_b32 s6, s54, 11
    v_add_u32 v14, s6, v2
    s_lshl_b32 s6, s64, 3
    v_subrev_u32 v9, s6, v1
    v_cmp_gt_u32 vcc, s11, v9
    v_mov_b32 v6, s52
    s_nop 0
    v_cndmask_b32 v4, v6, v4, vcc
    v_cndmask_b32 v6, 0, 1, vcc
    s_lshl_b32 s11, s4, 7
    s_add_u32 s11, s11, 83894272
    s_lshr_b32 s6, s2, 10
    s_add_u32 s6, s6, 0
    s_and_b32 s6, s6, 3
    s_lshl_b32 s6, s6, 15
    s_add_u32 s88, s65, s6
    s_lshr_b32 s6, s2, 10
    s_add_u32 s6, s6, 1
    s_and_b32 s6, s6, 3
    s_lshl_b32 s6, s6, 15
    s_add_u32 s89, s65, s6
    s_lshr_b32 s6, s2, 10
    s_add_u32 s6, s6, 2
    s_and_b32 s6, s6, 3
    s_lshl_b32 s6, s6, 15
    s_add_u32 s90, s65, s6
    s_lshr_b32 s6, s2, 10
    s_add_u32 s6, s6, 3
    s_and_b32 s6, s6, 3
    s_lshl_b32 s6, s6, 15
    s_add_u32 s91, s65, s6
    s_waitcnt vmcnt(0)
    s_barrier
    s_cmp_lg_u32 s5, 7
    s_cbranch_scc1 F_FAP
    s_lshl_b32 s6, s4, 7
    s_lshl_b32 s8, s3, 2
    s_add_u32 s6, s6, s8
    s_add_u32 s6, s6, 83894272
    v_mov_b32 v10, 1
    s_mov_b64 exec, 1
    buffer_store_dword v10, off, s[44:47], s6 sc1
    s_mov_b64 exec, -1
F_FAP:
    s_add_u32 m0, s97, 65536
    s_mov_b32 s9, 0
    buffer_load_dwordx4 v18, s[56:59], s9 offen sc1 lds
    s_add_u32 m0, s97, 73728
    s_mov_b32 s9, 8192
    buffer_load_dwordx4 v18, s[56:59], s9 offen sc1 lds
    s_add_u32 m0, s97, 81920
    s_mov_b32 s9, 16384
    buffer_load_dwordx4 v18, s[56:59], s9 offen sc1 lds
    s_add_u32 m0, s97, 90112
    s_mov_b32 s9, 24576
    buffer_load_dwordx4 v18, s[56:59], s9 offen sc1 lds
    s_add_u32 m0, s97, 98304
    s_mov_b32 s9, 32768
    buffer_load_dwordx4 v18, s[56:59], s9 offen sc1 lds
    s_add_u32 m0, s97, 106496
    s_mov_b32 s9, 40960
    buffer_load_dwordx4 v18, s[56:59], s9 offen sc1 lds
    s_add_u32 m0, s97, 114688
    s_mov_b32 s9, 49152
    buffer_load_dwordx4 v18, s[56:59], s9 offen sc1 lds
    s_add_u32 m0, s97, 122880
    s_mov_b32 s9, 57344
    buffer_load_dwordx4 v18, s[56:59], s9 offen sc1 lds
    s_add_u32 m0, s97, 131072
    s_mov_b32 s9, 65536
    buffer_load_dwordx4 v18, s[56:59], s9 offen sc1 lds
    v_and_b32 v16, 15, v1
    s_lshl_b32 s6, s10, 6
    s_lshl_b32 s8, s54, 5
    s_add_u32 s6, s6, s8
    v_add_u32 v16, s6, v16
    v_mul_u32_u24 v16, 1152, v16
    v_lshl_add_u32 v16, v7, 3, v16
    s_lshr_b32 s6, s2, 6
    s_mul_i32 s6, s6, 288
    s_lshr_b32 s8, s5, 2
    s_mul_i32 s8, s8, 160
    s_add_u32 s6, s6, s8
    v_add_u32 v10, s6, v16
    s_mov_b32 s76, 18432
    s_lshl_b32 s69, s4, 3
    s_and_b32 s6, s2, 4
    s_add_u32 s69, s69, s6
    s_lshr_b32 s6, s2, 6
    s_add_u32 s69, s69, s6
    s_lshl_b32 s6, s69, 5
    s_add_u32 s6, s6, s5
    s_mul_i32 s6, s6, 5120
    s_add_u32 s10, s6, 100663296
    s_add_u32 s72, s10, 0
    s_add_u32 s73, s10, 40960
    s_add_u32 s74, s10, 81920
    s_add_u32 s75, s10, 122880
    s_cmp_lg_u32 s5, 7
    s_cbranch_scc1 F_P5
    v_mov_b32 v5, 0
    v_and_b32 v5, v5, v6
    v_cmp_ne_u32 vcc, v5, v6
    s_cbranch_vccz P5_OK
    s_mov_b32 s55, 0x40000
P5_SP:
    s_sleep 2
    buffer_load_dword v5, v4, s[44:47], s11 offen sc1
    s_waitcnt vmcnt(0)
    v_and_b32 v5, v5, v6
    v_cmp_ne_u32 vcc, v5, v6
    s_cbranch_vccz P5_OK
    s_sub_u32 s55, s55, 1
    s_cmp_lg_u32 s55, 0
    s_cbranch_scc1 P5_SP
P5_OK:
F_P5:
    s_barrier
    s_add_u32 m0, s97, 0
    s_add_u32 s8, s88, 0
    buffer_load_dwordx4 v2, s[44:47], s8 offen sc1 lds
    s_add_u32 m0, s97, 8192
    s_add_u32 s8, s88, 4096
    buffer_load_dwordx4 v2, s[44:47], s8 offen sc1 lds
    s_add_u32 m0, s97, 16384
    s_add_u32 s8, s88, 8192
    buffer_load_dwordx4 v2, s[44:47], s8 offen sc1 lds
    s_add_u32 m0, s97, 24576
    s_add_u32 s8, s88, 12288
    buffer_load_dwordx4 v2, s[44:47], s8 offen sc1 lds
    s_add_u32 m0, s97, 32768
    s_add_u32 s8, s88, 16384
    buffer_load_dwordx4 v2, s[44:47], s8 offen sc1 lds
    s_add_u32 m0, s97, 40960
    s_add_u32 s8, s88, 20480
    buffer_load_dwordx4 v2, s[44:47], s8 offen sc1 lds
    s_add_u32 m0, s97, 49152
    s_add_u32 s8, s88, 24576
    buffer_load_dwordx4 v2, s[44:47], s8 offen sc1 lds
    s_add_u32 m0, s97, 57344
    s_add_u32 s8, s88, 28672
    buffer_load_dwordx4 v2, s[44:47], s8 offen sc1 lds
    s_waitcnt vmcnt(6)
    s_waitcnt lgkmcnt(0)
    s_barrier
    s_cmp_ge_u32 s5, 4
    s_cbranch_scc1 G_B
    ds_read_b128 v[24:27], v14 offset:0
    ds_read_b128 v[28:31], v14 offset:1024
    ds_read_b64_tr_b16 v[40:41], v12 offset:0
    ds_read_b64_tr_b16 v[42:43], v12 offset:1152
    ds_read_b64_tr_b16 v[44:45], v12 offset:32
    ds_read_b64_tr_b16 v[46:47], v12 offset:1184
    ds_read_b64_tr_b16 v[48:49], v12 offset:64
    ds_read_b64_tr_b16 v[50:51], v12 offset:1216
    ds_read_b64_tr_b16 v[52:53], v12 offset:96
    ds_read_b64_tr_b16 v[54:55], v12 offset:1248
    ds_read_b64_tr_b16 v[56:57], v12 offset:128
    ds_read_b64_tr_b16 v[58:59], v12 offset:1280
    s_waitcnt lgkmcnt(8)
    v_mfma_f32_16x16x32_bf16 v[80:83], v[40:43], v[24:27], 0
    ds_read_b128 v[32:35], v14 offset:8192
    v_mfma_f32_16x16x32_bf16 v[84:87], v[40:43], v[28:31], 0
    ds_read_b128 v[36:39], v14 offset:9216
    ds_read_b64_tr_b16 v[60:61], v12 offset:9728
    s_waitcnt lgkmcnt(9)
    v_mfma_f32_16x16x32_bf16 v[88:91], v[44:47], v[24:27], 0
    ds_read_b64_tr_b16 v[62:63], v12 offset:10880
    v_mfma_f32_16x16x32_bf16 v[92:95], v[44:47], v[28:31], 0
    ds_read_b64_tr_b16 v[64:65], v12 offset:9760
    ds_read_b64_tr_b16 v[66:67], v12 offset:10912
    s_waitcnt lgkmcnt(10)
    v_mfma_f32_16x16x32_bf16 v[96:99], v[48:51], v[24:27], 0
    ds_read_b64_tr_b16 v[68:69], v12 offset:9792
    v_mfma_f32_16x16x32_bf16 v[100:103], v[48:51], v[28:31], 0
    ds_read_b64_tr_b16 v[70:71], v12 offset:10944
    s_waitcnt lgkmcnt(10)
    v_mfma_f32_16x16x32_bf16 v[104:107], v[52:55], v[24:27], 0
    ds_read_b64_tr_b16 v[72:73], v12 offset:9824
    v_mfma_f32_16x16x32_bf16 v[108:111], v[52:55], v[28:31], 0
    ds_read_b64_tr_b16 v[74:75], v12 offset:10976
    s_waitcnt lgkmcnt(10)
    v_mfma_f32_16x16x32_bf16 v[112:115], v[56:59], v[24:27], 0
    ds_read_b64_tr_b16 v[76:77], v12 offset:9856
    v_mfma_f32_16x16x32_bf16 v[116:119], v[56:59], v[28:31], 0
    ds_read_b64_tr_b16 v[78:79], v12 offset:11008
    s_waitcnt lgkmcnt(8)
    v_mfma_f32_16x16x32_bf16 v[80:83], v[60:63], v[32:35], v[80:83]
    s_waitcnt vmcnt(4)
    s_waitcnt lgkmcnt(0)
    s_barrier
    ds_read_b128 v[24:27], v14 offset:16384
    v_mfma_f32_16x16x32_bf16 v[84:87], v[60:63], v[36:39], v[84:87]
    ds_read_b128 v[28:31], v14 offset:17408
    ds_read_b64_tr_b16 v[40:41], v12 offset:19456
    v_mfma_f32_16x16x32_bf16 v[88:91], v[64:67], v[32:35], v[88:91]
    ds_read_b64_tr_b16 v[42:43], v12 offset:20608
    v_mfma_f32_16x16x32_bf16 v[92:95], v[64:67], v[36:39], v[92:95]
    ds_read_b64_tr_b16 v[44:45], v12 offset:19488
    ds_read_b64_tr_b16 v[46:47], v12 offset:20640
    v_mfma_f32_16x16x32_bf16 v[96:99], v[68:71], v[32:35], v[96:99]
    ds_read_b64_tr_b16 v[48:49], v12 offset:19520
    v_mfma_f32_16x16x32_bf16 v[100:103], v[68:71], v[36:39], v[100:103]
    ds_read_b64_tr_b16 v[50:51], v12 offset:20672
    v_mfma_f32_16x16x32_bf16 v[104:107], v[72:75], v[32:35], v[104:107]
    ds_read_b64_tr_b16 v[52:53], v12 offset:19552
    v_mfma_f32_16x16x32_bf16 v[108:111], v[72:75], v[36:39], v[108:111]
    ds_read_b64_tr_b16 v[54:55], v12 offset:20704
    s_add_u32 m0, s97, 0
    s_add_u32 s8, s89, 0
    buffer_load_dwordx4 v2, s[44:47], s8 offen sc1 lds
    v_mfma_f32_16x16x32_bf16 v[112:115], v[76:79], v[32:35], v[112:115]
    ds_read_b64_tr_b16 v[56:57], v12 offset:19584
    s_add_u32 m0, s97, 8192
    s_add_u32 s8, s89, 4096
    buffer_load_dwordx4 v2, s[44:47], s8 offen sc1 lds
    v_mfma_f32_16x16x32_bf16 v[116:119], v[76:79], v[36:39], v[116:119]
    ds_read_b64_tr_b16 v[58:59], v12 offset:20736
    s_waitcnt lgkmcnt(8)
    v_mfma_f32_16x16x32_bf16 v[80:83], v[40:43], v[24:27], v[80:83]
    ds_read_b128 v[32:35], v14 offset:24576
    v_mfma_f32_16x16x32_bf16 v[84:87], v[40:43], v[28:31], v[84:87]
    ds_read_b128 v[36:39], v14 offset:25600
    ds_read_b64_tr_b16 v[60:61], v12 offset:29184
    s_waitcnt lgkmcnt(9)
    v_mfma_f32_16x16x32_bf16 v[88:91], v[44:47], v[24:27], v[88:91]
    ds_read_b64_tr_b16 v[62:63], v12 offset:30336
    v_mfma_f32_16x16x32_bf16 v[92:95], v[44:47], v[28:31], v[92:95]
    ds_read_b64_tr_b16 v[64:65], v12 offset:29216
    ds_read_b64_tr_b16 v[66:67], v12 offset:30368
    s_waitcnt lgkmcnt(10)
    v_mfma_f32_16x16x32_bf16 v[96:99], v[48:51], v[24:27], v[96:99]
    ds_read_b64_tr_b16 v[68:69], v12 offset:29248
    v_mfma_f32_16x16x32_bf16 v[100:103], v[48:51], v[28:31], v[100:103]
    ds_read_b64_tr_b16 v[70:71], v12 offset:30400
    s_waitcnt lgkmcnt(10)
    v_mfma_f32_16x16x32_bf16 v[104:107], v[52:55], v[24:27], v[104:107]
    ds_read_b64_tr_b16 v[72:73], v12 offset:29280
    v_mfma_f32_16x16x32_bf16 v[108:111], v[52:55], v[28:31], v[108:111]
    ds_read_b64_tr_b16 v[74:75], v12 offset:30432
    s_waitcnt lgkmcnt(10)
    v_mfma_f32_16x16x32_bf16 v[112:115], v[56:59], v[24:27], v[112:115]
    ds_read_b64_tr_b16 v[76:77], v12 offset:29312
    v_mfma_f32_16x16x32_bf16 v[116:119], v[56:59], v[28:31], v[116:119]
    ds_read_b64_tr_b16 v[78:79], v12 offset:30464
    s_waitcnt lgkmcnt(8)
    v_mfma_f32_16x16x32_bf16 v[80:83], v[60:63], v[32:35], v[80:83]
    s_waitcnt vmcnt(4)
    s_waitcnt lgkmcnt(0)
    s_barrier
    ds_read_b128 v[24:27], v14 offset:32768
    v_mfma_f32_16x16x32_bf16 v[84:87], v[60:63], v[36:39], v[84:87]
    ds_read_b128 v[28:31], v14 offset:33792
    ds_read_b64_tr_b16 v[40:41], v13 offset:0
    v_mfma_f32_16x16x32_bf16 v[88:91], v[64:67], v[32:35], v[88:91]
    ds_read_b64_tr_b16 v[42:43], v13 offset:1152
    v_mfma_f32_16x16x32_bf16 v[92:95], v[64:67], v[36:39], v[92:95]
    ds_read_b64_tr_b16 v[44:45], v13 offset:32
    ds_read_b64_tr_b16 v[46:47], v13 offset:1184
    v_mfma_f32_16x16x32_bf16 v[96:99], v[68:71], v[32:35], v[96:99]
    ds_read_b64_tr_b16 v[48:49], v13 offset:64
    v_mfma_f32_16x16x32_bf16 v[100:103], v[68:71], v[36:39], v[100:103]
    ds_read_b64_tr_b16 v[50:51], v13 offset:1216
    v_mfma_f32_16x16x32_bf16 v[104:107], v[72:75], v[32:35], v[104:107]
    ds_read_b64_tr_b16 v[52:53], v13 offset:96
    v_mfma_f32_16x16x32_bf16 v[108:111], v[72:75], v[36:39], v[108:111]
    ds_read_b64_tr_b16 v[54:55], v13 offset:1248
    s_add_u32 m0, s97, 16384
    s_add_u32 s8, s89, 8192
    buffer_load_dwordx4 v2, s[44:47], s8 offen sc1 lds
    v_mfma_f32_16x16x32_bf16 v[112:115], v[76:79], v[32:35], v[112:115]
    ds_read_b64_tr_b16 v[56:57], v13 offset:128
    s_add_u32 m0, s97, 24576
    s_add_u32 s8, s89, 12288
    buffer_load_dwordx4 v2, s[44:47], s8 offen sc1 lds
    v_mfma_f32_16x16x32_bf16 v[116:119], v[76:79], v[36:39], v[116:119]
    ds_read_b64_tr_b16 v[58:59], v13 offset:1280
    s_waitcnt lgkmcnt(8)
    v_mfma_f32_16x16x32_bf16 v[80:83], v[40:43], v[24:27], v[80:83]
    ds_read_b128 v[32:35], v14 offset:40960
    v_mfma_f32_16x16x32_bf16 v[84:87], v[40:43], v[28:31], v[84:87]
    ds_read_b128 v[36:39], v14 offset:41984
    ds_read_b64_tr_b16 v[60:61], v13 offset:9728
    s_waitcnt lgkmcnt(9)
    v_mfma_f32_16x16x32_bf16 v[88:91], v[44:47], v[24:27], v[88:91]
    ds_read_b64_tr_b16 v[62:63], v13 offset:10880
    v_mfma_f32_16x16x32_bf16 v[92:95], v[44:47], v[28:31], v[92:95]
    ds_read_b64_tr_b16 v[64:65], v13 offset:9760
    ds_read_b64_tr_b16 v[66:67], v13 offset:10912
    s_waitcnt lgkmcnt(10)
    v_mfma_f32_16x16x32_bf16 v[96:99], v[48:51], v[24:27], v[96:99]
    ds_read_b64_tr_b16 v[68:69], v13 offset:9792
    v_mfma_f32_16x16x32_bf16 v[100:103], v[48:51], v[28:31], v[100:103]
    ds_read_b64_tr_b16 v[70:71], v13 offset:10944
    s_waitcnt lgkmcnt(10)
    v_mfma_f32_16x16x32_bf16 v[104:107], v[52:55], v[24:27], v[104:107]
    ds_read_b64_tr_b16 v[72:73], v13 offset:9824
    v_mfma_f32_16x16x32_bf16 v[108:111], v[52:55], v[28:31], v[108:111]
    ds_read_b64_tr_b16 v[74:75], v13 offset:10976
    s_waitcnt lgkmcnt(10)
    v_mfma_f32_16x16x32_bf16 v[112:115], v[56:59], v[24:27], v[112:115]
    ds_read_b64_tr_b16 v[76:77], v13 offset:9856
    v_mfma_f32_16x16x32_bf16 v[116:119], v[56:59], v[28:31], v[116:119]
    ds_read_b64_tr_b16 v[78:79], v13 offset:11008
    s_waitcnt lgkmcnt(8)
    v_mfma_f32_16x16x32_bf16 v[80:83], v[60:63], v[32:35], v[80:83]
    s_waitcnt vmcnt(4)
    s_waitcnt lgkmcnt(0)
    s_barrier
    ds_read_b128 v[24:27], v14 offset:49152
    v_mfma_f32_16x16x32_bf16 v[84:87], v[60:63], v[36:39], v[84:87]
    ds_read_b128 v[28:31], v14 offset:50176
    ds_read_b64_tr_b16 v[40:41], v13 offset:19456
    v_mfma_f32_16x16x32_bf16 v[88:91], v[64:67], v[32:35], v[88:91]
    ds_read_b64_tr_b16 v[42:43], v13 offset:20608
    v_mfma_f32_16x16x32_bf16 v[92:95], v[64:67], v[36:39], v[92:95]
    ds_read_b64_tr_b16 v[44:45], v13 offset:19488
    ds_read_b64_tr_b16 v[46:47], v13 offset:20640
    v_mfma_f32_16x16x32_bf16 v[96:99], v[68:71], v[32:35], v[96:99]
    ds_read_b64_tr_b16 v[48:49], v13 offset:19520
    v_mfma_f32_16x16x32_bf16 v[100:103], v[68:71], v[36:39], v[100:103]
    ds_read_b64_tr_b16 v[50:51], v13 offset:20672
    v_mfma_f32_16x16x32_bf16 v[104:107], v[72:75], v[32:35], v[104:107]
    ds_read_b64_tr_b16 v[52:53], v13 offset:19552
    v_mfma_f32_16x16x32_bf16 v[108:111], v[72:75], v[36:39], v[108:111]
    ds_read_b64_tr_b16 v[54:55], v13 offset:20704
    s_add_u32 m0, s97, 32768
    s_add_u32 s8, s89, 16384
    buffer_load_dwordx4 v2, s[44:47], s8 offen sc1 lds
    v_mfma_f32_16x16x32_bf16 v[112:115], v[76:79], v[32:35], v[112:115]
    ds_read_b64_tr_b16 v[56:57], v13 offset:19584
    s_add_u32 m0, s97, 40960
    s_add_u32 s8, s89, 20480
    buffer_load_dwordx4 v2, s[44:47], s8 offen sc1 lds
    v_mfma_f32_16x16x32_bf16 v[116:119], v[76:79], v[36:39], v[116:119]
    ds_read_b64_tr_b16 v[58:59], v13 offset:20736
    s_waitcnt lgkmcnt(8)
    v_mfma_f32_16x16x32_bf16 v[80:83], v[40:43], v[24:27], v[80:83]
    ds_read_b128 v[32:35], v14 offset:57344
    v_mfma_f32_16x16x32_bf16 v[84:87], v[40:43], v[28:31], v[84:87]
    ds_read_b128 v[36:39], v14 offset:58368
    ds_read_b64_tr_b16 v[60:61], v13 offset:29184
    s_waitcnt lgkmcnt(9)
    v_mfma_f32_16x16x32_bf16 v[88:91], v[44:47], v[24:27], v[88:91]
    ds_read_b64_tr_b16 v[62:63], v13 offset:30336
    v_mfma_f32_16x16x32_bf16 v[92:95], v[44:47], v[28:31], v[92:95]
    ds_read_b64_tr_b16 v[64:65], v13 offset:29216
    ds_read_b64_tr_b16 v[66:67], v13 offset:30368
    s_waitcnt lgkmcnt(10)
    v_mfma_f32_16x16x32_bf16 v[96:99], v[48:51], v[24:27], v[96:99]
    ds_read_b64_tr_b16 v[68:69], v13 offset:29248
    v_mfma_f32_16x16x32_bf16 v[100:103], v[48:51], v[28:31], v[100:103]
    ds_read_b64_tr_b16 v[70:71], v13 offset:30400
    s_waitcnt lgkmcnt(10)
    v_mfma_f32_16x16x32_bf16 v[104:107], v[52:55], v[24:27], v[104:107]
    ds_read_b64_tr_b16 v[72:73], v13 offset:29280
    v_mfma_f32_16x16x32_bf16 v[108:111], v[52:55], v[28:31], v[108:111]
    ds_read_b64_tr_b16 v[74:75], v13 offset:30432
    s_waitcnt lgkmcnt(10)
    v_mfma_f32_16x16x32_bf16 v[112:115], v[56:59], v[24:27], v[112:115]
    ds_read_b64_tr_b16 v[76:77], v13 offset:29312
    v_mfma_f32_16x16x32_bf16 v[116:119], v[56:59], v[28:31], v[116:119]
    ds_read_b64_tr_b16 v[78:79], v13 offset:30464
    s_waitcnt lgkmcnt(8)
    v_mfma_f32_16x16x32_bf16 v[80:83], v[60:63], v[32:35], v[80:83]
    s_waitcnt vmcnt(4)
    s_waitcnt lgkmcnt(0)
    s_barrier
    ds_read_b128 v[24:27], v14 offset:0
    v_mfma_f32_16x16x32_bf16 v[84:87], v[60:63], v[36:39], v[84:87]
    ds_read_b128 v[28:31], v14 offset:1024
    ds_read_b64_tr_b16 v[40:41], v12 offset:0
    v_mfma_f32_16x16x32_bf16 v[88:91], v[64:67], v[32:35], v[88:91]
    ds_read_b64_tr_b16 v[42:43], v12 offset:1152
    v_mfma_f32_16x16x32_bf16 v[92:95], v[64:67], v[36:39], v[92:95]
    ds_read_b64_tr_b16 v[44:45], v12 offset:32
    ds_read_b64_tr_b16 v[46:47], v12 offset:1184
    v_mfma_f32_16x16x32_bf16 v[96:99], v[68:71], v[32:35], v[96:99]
    ds_read_b64_tr_b16 v[48:49], v12 offset:64
    v_mfma_f32_16x16x32_bf16 v[100:103], v[68:71], v[36:39], v[100:103]
    ds_read_b64_tr_b16 v[50:51], v12 offset:1216
    v_mfma_f32_16x16x32_bf16 v[104:107], v[72:75], v[32:35], v[104:107]
    ds_read_b64_tr_b16 v[52:53], v12 offset:96
    v_mfma_f32_16x16x32_bf16 v[108:111], v[72:75], v[36:39], v[108:111]
    ds_read_b64_tr_b16 v[54:55], v12 offset:1248
    s_add_u32 m0, s97, 49152
    s_add_u32 s8, s89, 24576
    buffer_load_dwordx4 v2, s[44:47], s8 offen sc1 lds
    v_mfma_f32_16x16x32_bf16 v[112:115], v[76:79], v[32:35], v[112:115]
    ds_read_b64_tr_b16 v[56:57], v12 offset:128
    s_add_u32 m0, s97, 57344
    s_add_u32 s8, s89, 28672
    buffer_load_dwordx4 v2, s[44:47], s8 offen sc1 lds
    v_mfma_f32_16x16x32_bf16 v[116:119], v[76:79], v[36:39], v[116:119]
    ds_read_b64_tr_b16 v[58:59], v12 offset:1280
    s_waitcnt lgkmcnt(8)
    v_mfma_f32_16x16x32_bf16 v[80:83], v[40:43], v[24:27], v[80:83]
    ds_read_b128 v[32:35], v14 offset:8192
    v_mfma_f32_16x16x32_bf16 v[84:87], v[40:43], v[28:31], v[84:87]
    ds_read_b128 v[36:39], v14 offset:9216
    ds_read_b64_tr_b16 v[60:61], v12 offset:9728
    s_waitcnt lgkmcnt(9)
    v_mfma_f32_16x16x32_bf16 v[88:91], v[44:47], v[24:27], v[88:91]
    ds_read_b64_tr_b16 v[62:63], v12 offset:10880
    v_mfma_f32_16x16x32_bf16 v[92:95], v[44:47], v[28:31], v[92:95]
    ds_read_b64_tr_b16 v[64:65], v12 offset:9760
    ds_read_b64_tr_b16 v[66:67], v12 offset:10912
    s_waitcnt lgkmcnt(10)
    v_mfma_f32_16x16x32_bf16 v[96:99], v[48:51], v[24:27], v[96:99]
    ds_read_b64_tr_b16 v[68:69], v12 offset:9792
    v_mfma_f32_16x16x32_bf16 v[100:103], v[48:51], v[28:31], v[100:103]
    ds_read_b64_tr_b16 v[70:71], v12 offset:10944
    s_waitcnt lgkmcnt(10)
    v_mfma_f32_16x16x32_bf16 v[104:107], v[52:55], v[24:27], v[104:107]
    ds_read_b64_tr_b16 v[72:73], v12 offset:9824
    v_mfma_f32_16x16x32_bf16 v[108:111], v[52:55], v[28:31], v[108:111]
    ds_read_b64_tr_b16 v[74:75], v12 offset:10976
    s_waitcnt lgkmcnt(10)
    v_mfma_f32_16x16x32_bf16 v[112:115], v[56:59], v[24:27], v[112:115]
    ds_read_b64_tr_b16 v[76:77], v12 offset:9856
    v_mfma_f32_16x16x32_bf16 v[116:119], v[56:59], v[28:31], v[116:119]
    ds_read_b64_tr_b16 v[78:79], v12 offset:11008
    s_waitcnt lgkmcnt(8)
    v_mfma_f32_16x16x32_bf16 v[80:83], v[60:63], v[32:35], v[80:83]
    s_waitcnt vmcnt(4)
    s_waitcnt lgkmcnt(0)
    s_barrier
    ds_read_b128 v[24:27], v14 offset:16384
    v_mfma_f32_16x16x32_bf16 v[84:87], v[60:63], v[36:39], v[84:87]
    ds_read_b128 v[28:31], v14 offset:17408
    ds_read_b64_tr_b16 v[40:41], v12 offset:19456
    v_mfma_f32_16x16x32_bf16 v[88:91], v[64:67], v[32:35], v[88:91]
    ds_read_b64_tr_b16 v[42:43], v12 offset:20608
    v_mfma_f32_16x16x32_bf16 v[92:95], v[64:67], v[36:39], v[92:95]
    ds_read_b64_tr_b16 v[44:45], v12 offset:19488
    ds_read_b64_tr_b16 v[46:47], v12 offset:20640
    v_mfma_f32_16x16x32_bf16 v[96:99], v[68:71], v[32:35], v[96:99]
    ds_read_b64_tr_b16 v[48:49], v12 offset:19520
    v_mfma_f32_16x16x32_bf16 v[100:103], v[68:71], v[36:39], v[100:103]
    ds_read_b64_tr_b16 v[50:51], v12 offset:20672
    v_mfma_f32_16x16x32_bf16 v[104:107], v[72:75], v[32:35], v[104:107]
    ds_read_b64_tr_b16 v[52:53], v12 offset:19552
    v_mfma_f32_16x16x32_bf16 v[108:111], v[72:75], v[36:39], v[108:111]
    ds_read_b64_tr_b16 v[54:55], v12 offset:20704
    s_add_u32 m0, s97, 0
    s_add_u32 s8, s90, 0
    buffer_load_dwordx4 v2, s[44:47], s8 offen sc1 lds
    v_mfma_f32_16x16x32_bf16 v[112:115], v[76:79], v[32:35], v[112:115]
    ds_read_b64_tr_b16 v[56:57], v12 offset:19584
    s_add_u32 m0, s97, 8192
    s_add_u32 s8, s90, 4096
    buffer_load_dwordx4 v2, s[44:47], s8 offen sc1 lds
    v_mfma_f32_16x16x32_bf16 v[116:119], v[76:79], v[36:39], v[116:119]
    ds_read_b64_tr_b16 v[58:59], v12 offset:20736
    s_waitcnt lgkmcnt(8)
    v_mfma_f32_16x16x32_bf16 v[80:83], v[40:43], v[24:27], v[80:83]
    ds_read_b128 v[32:35], v14 offset:24576
    v_mfma_f32_16x16x32_bf16 v[84:87], v[40:43], v[28:31], v[84:87]
    ds_read_b128 v[36:39], v14 offset:25600
    ds_read_b64_tr_b16 v[60:61], v12 offset:29184
    s_waitcnt lgkmcnt(9)
    v_mfma_f32_16x16x32_bf16 v[88:91], v[44:47], v[24:27], v[88:91]
    ds_read_b64_tr_b16 v[62:63], v12 offset:30336
    v_mfma_f32_16x16x32_bf16 v[92:95], v[44:47], v[28:31], v[92:95]
    ds_read_b64_tr_b16 v[64:65], v12 offset:29216
    ds_read_b64_tr_b16 v[66:67], v12 offset:30368
    s_waitcnt lgkmcnt(10)
    v_mfma_f32_16x16x32_bf16 v[96:99], v[48:51], v[24:27], v[96:99]
    ds_read_b64_tr_b16 v[68:69], v12 offset:29248
    v_mfma_f32_16x16x32_bf16 v[100:103], v[48:51], v[28:31], v[100:103]
    ds_read_b64_tr_b16 v[70:71], v12 offset:30400
    s_waitcnt lgkmcnt(10)
    v_mfma_f32_16x16x32_bf16 v[104:107], v[52:55], v[24:27], v[104:107]
    ds_read_b64_tr_b16 v[72:73], v12 offset:29280
    v_mfma_f32_16x16x32_bf16 v[108:111], v[52:55], v[28:31], v[108:111]
    ds_read_b64_tr_b16 v[74:75], v12 offset:30432
    s_waitcnt lgkmcnt(10)
    v_mfma_f32_16x16x32_bf16 v[112:115], v[56:59], v[24:27], v[112:115]
    ds_read_b64_tr_b16 v[76:77], v12 offset:29312
    v_mfma_f32_16x16x32_bf16 v[116:119], v[56:59], v[28:31], v[116:119]
    ds_read_b64_tr_b16 v[78:79], v12 offset:30464
    s_waitcnt lgkmcnt(8)
    v_mfma_f32_16x16x32_bf16 v[80:83], v[60:63], v[32:35], v[80:83]
    s_waitcnt vmcnt(4)
    s_waitcnt lgkmcnt(0)
    s_barrier
    ds_read_b128 v[24:27], v14 offset:32768
    v_mfma_f32_16x16x32_bf16 v[84:87], v[60:63], v[36:39], v[84:87]
    ds_read_b128 v[28:31], v14 offset:33792
    ds_read_b64_tr_b16 v[40:41], v13 offset:0
    v_mfma_f32_16x16x32_bf16 v[88:91], v[64:67], v[32:35], v[88:91]
    ds_read_b64_tr_b16 v[42:43], v13 offset:1152
    v_mfma_f32_16x16x32_bf16 v[92:95], v[64:67], v[36:39], v[92:95]
    ds_read_b64_tr_b16 v[44:45], v13 offset:32
    ds_read_b64_tr_b16 v[46:47], v13 offset:1184
    v_mfma_f32_16x16x32_bf16 v[96:99], v[68:71], v[32:35], v[96:99]
    ds_read_b64_tr_b16 v[48:49], v13 offset:64
    v_mfma_f32_16x16x32_bf16 v[100:103], v[68:71], v[36:39], v[100:103]
    ds_read_b64_tr_b16 v[50:51], v13 offset:1216
    v_mfma_f32_16x16x32_bf16 v[104:107], v[72:75], v[32:35], v[104:107]
    ds_read_b64_tr_b16 v[52:53], v13 offset:96
    v_mfma_f32_16x16x32_bf16 v[108:111], v[72:75], v[36:39], v[108:111]
    ds_read_b64_tr_b16 v[54:55], v13 offset:1248
    s_add_u32 m0, s97, 16384
    s_add_u32 s8, s90, 8192
    buffer_load_dwordx4 v2, s[44:47], s8 offen sc1 lds
    v_mfma_f32_16x16x32_bf16 v[112:115], v[76:79], v[32:35], v[112:115]
    ds_read_b64_tr_b16 v[56:57], v13 offset:128
    s_add_u32 m0, s97, 24576
    s_add_u32 s8, s90, 12288
    buffer_load_dwordx4 v2, s[44:47], s8 offen sc1 lds
    v_mfma_f32_16x16x32_bf16 v[116:119], v[76:79], v[36:39], v[116:119]
    ds_read_b64_tr_b16 v[58:59], v13 offset:1280
    s_waitcnt lgkmcnt(8)
    v_mfma_f32_16x16x32_bf16 v[80:83], v[40:43], v[24:27], v[80:83]
    ds_read_b128 v[32:35], v14 offset:40960
    v_mfma_f32_16x16x32_bf16 v[84:87], v[40:43], v[28:31], v[84:87]
    ds_read_b128 v[36:39], v14 offset:41984
    ds_read_b64_tr_b16 v[60:61], v13 offset:9728
    s_waitcnt lgkmcnt(9)
    v_mfma_f32_16x16x32_bf16 v[88:91], v[44:47], v[24:27], v[88:91]
    ds_read_b64_tr_b16 v[62:63], v13 offset:10880
    v_mfma_f32_16x16x32_bf16 v[92:95], v[44:47], v[28:31], v[92:95]
    ds_read_b64_tr_b16 v[64:65], v13 offset:9760
    ds_read_b64_tr_b16 v[66:67], v13 offset:10912
    s_waitcnt lgkmcnt(10)
    v_mfma_f32_16x16x32_bf16 v[96:99], v[48:51], v[24:27], v[96:99]
    ds_read_b64_tr_b16 v[68:69], v13 offset:9792
    v_mfma_f32_16x16x32_bf16 v[100:103], v[48:51], v[28:31], v[100:103]
    ds_read_b64_tr_b16 v[70:71], v13 offset:10944
    s_waitcnt lgkmcnt(10)
    v_mfma_f32_16x16x32_bf16 v[104:107], v[52:55], v[24:27], v[104:107]
    ds_read_b64_tr_b16 v[72:73], v13 offset:9824
    v_mfma_f32_16x16x32_bf16 v[108:111], v[52:55], v[28:31], v[108:111]
    ds_read_b64_tr_b16 v[74:75], v13 offset:10976
    s_waitcnt lgkmcnt(10)
    v_mfma_f32_16x16x32_bf16 v[112:115], v[56:59], v[24:27], v[112:115]
    ds_read_b64_tr_b16 v[76:77], v13 offset:9856
    v_mfma_f32_16x16x32_bf16 v[116:119], v[56:59], v[28:31], v[116:119]
    ds_read_b64_tr_b16 v[78:79], v13 offset:11008
    s_waitcnt lgkmcnt(8)
    v_mfma_f32_16x16x32_bf16 v[80:83], v[60:63], v[32:35], v[80:83]
    s_waitcnt vmcnt(4)
    s_waitcnt lgkmcnt(0)
    s_barrier
    ds_read_b128 v[24:27], v14 offset:49152
    v_mfma_f32_16x16x32_bf16 v[84:87], v[60:63], v[36:39], v[84:87]
    ds_read_b128 v[28:31], v14 offset:50176
    ds_read_b64_tr_b16 v[40:41], v13 offset:19456
    v_mfma_f32_16x16x32_bf16 v[88:91], v[64:67], v[32:35], v[88:91]
    ds_read_b64_tr_b16 v[42:43], v13 offset:20608
    v_mfma_f32_16x16x32_bf16 v[92:95], v[64:67], v[36:39], v[92:95]
    ds_read_b64_tr_b16 v[44:45], v13 offset:19488
    ds_read_b64_tr_b16 v[46:47], v13 offset:20640
    v_mfma_f32_16x16x32_bf16 v[96:99], v[68:71], v[32:35], v[96:99]
    ds_read_b64_tr_b16 v[48:49], v13 offset:19520
    v_mfma_f32_16x16x32_bf16 v[100:103], v[68:71], v[36:39], v[100:103]
    ds_read_b64_tr_b16 v[50:51], v13 offset:20672
    v_mfma_f32_16x16x32_bf16 v[104:107], v[72:75], v[32:35], v[104:107]
    ds_read_b64_tr_b16 v[52:53], v13 offset:19552
    v_mfma_f32_16x16x32_bf16 v[108:111], v[72:75], v[36:39], v[108:111]
    ds_read_b64_tr_b16 v[54:55], v13 offset:20704
    s_add_u32 m0, s97, 32768
    s_add_u32 s8, s90, 16384
    buffer_load_dwordx4 v2, s[44:47], s8 offen sc1 lds
    v_mfma_f32_16x16x32_bf16 v[112:115], v[76:79], v[32:35], v[112:115]
    ds_read_b64_tr_b16 v[56:57], v13 offset:19584
    s_add_u32 m0, s97, 40960
    s_add_u32 s8, s90, 20480
    buffer_load_dwordx4 v2, s[44:47], s8 offen sc1 lds
    v_mfma_f32_16x16x32_bf16 v[116:119], v[76:79], v[36:39], v[116:119]
    ds_read_b64_tr_b16 v[58:59], v13 offset:20736
    s_waitcnt lgkmcnt(8)
    v_mfma_f32_16x16x32_bf16 v[80:83], v[40:43], v[24:27], v[80:83]
    ds_read_b128 v[32:35], v14 offset:57344
    v_mfma_f32_16x16x32_bf16 v[84:87], v[40:43], v[28:31], v[84:87]
    ds_read_b128 v[36:39], v14 offset:58368
    ds_read_b64_tr_b16 v[60:61], v13 offset:29184
    s_waitcnt lgkmcnt(9)
    v_mfma_f32_16x16x32_bf16 v[88:91], v[44:47], v[24:27], v[88:91]
    ds_read_b64_tr_b16 v[62:63], v13 offset:30336
    v_mfma_f32_16x16x32_bf16 v[92:95], v[44:47], v[28:31], v[92:95]
    ds_read_b64_tr_b16 v[64:65], v13 offset:29216
    ds_read_b64_tr_b16 v[66:67], v13 offset:30368
    s_waitcnt lgkmcnt(10)
    v_mfma_f32_16x16x32_bf16 v[96:99], v[48:51], v[24:27], v[96:99]
    ds_read_b64_tr_b16 v[68:69], v13 offset:29248
    v_mfma_f32_16x16x32_bf16 v[100:103], v[48:51], v[28:31], v[100:103]
    ds_read_b64_tr_b16 v[70:71], v13 offset:30400
    s_waitcnt lgkmcnt(10)
    v_mfma_f32_16x16x32_bf16 v[104:107], v[52:55], v[24:27], v[104:107]
    ds_read_b64_tr_b16 v[72:73], v13 offset:29280
    v_mfma_f32_16x16x32_bf16 v[108:111], v[52:55], v[28:31], v[108:111]
    ds_read_b64_tr_b16 v[74:75], v13 offset:30432
    s_waitcnt lgkmcnt(10)
    v_mfma_f32_16x16x32_bf16 v[112:115], v[56:59], v[24:27], v[112:115]
    ds_read_b64_tr_b16 v[76:77], v13 offset:29312
    v_mfma_f32_16x16x32_bf16 v[116:119], v[56:59], v[28:31], v[116:119]
    ds_read_b64_tr_b16 v[78:79], v13 offset:30464
    s_waitcnt lgkmcnt(8)
    v_mfma_f32_16x16x32_bf16 v[80:83], v[60:63], v[32:35], v[80:83]
    s_waitcnt vmcnt(4)
    s_waitcnt lgkmcnt(0)
    s_barrier
    ds_read_b128 v[24:27], v14 offset:0
    v_mfma_f32_16x16x32_bf16 v[84:87], v[60:63], v[36:39], v[84:87]
    ds_read_b128 v[28:31], v14 offset:1024
    ds_read_b64_tr_b16 v[40:41], v12 offset:0
    v_mfma_f32_16x16x32_bf16 v[88:91], v[64:67], v[32:35], v[88:91]
    ds_read_b64_tr_b16 v[42:43], v12 offset:1152
    v_mfma_f32_16x16x32_bf16 v[92:95], v[64:67], v[36:39], v[92:95]
    ds_read_b64_tr_b16 v[44:45], v12 offset:32
    ds_read_b64_tr_b16 v[46:47], v12 offset:1184
    v_mfma_f32_16x16x32_bf16 v[96:99], v[68:71], v[32:35], v[96:99]
    ds_read_b64_tr_b16 v[48:49], v12 offset:64
    v_mfma_f32_16x16x32_bf16 v[100:103], v[68:71], v[36:39], v[100:103]
    ds_read_b64_tr_b16 v[50:51], v12 offset:1216
    v_mfma_f32_16x16x32_bf16 v[104:107], v[72:75], v[32:35], v[104:107]
    ds_read_b64_tr_b16 v[52:53], v12 offset:96
    v_mfma_f32_16x16x32_bf16 v[108:111], v[72:75], v[36:39], v[108:111]
    ds_read_b64_tr_b16 v[54:55], v12 offset:1248
    s_add_u32 m0, s97, 49152
    s_add_u32 s8, s90, 24576
    buffer_load_dwordx4 v2, s[44:47], s8 offen sc1 lds
    v_mfma_f32_16x16x32_bf16 v[112:115], v[76:79], v[32:35], v[112:115]
    ds_read_b64_tr_b16 v[56:57], v12 offset:128
    s_add_u32 m0, s97, 57344
    s_add_u32 s8, s90, 28672
    buffer_load_dwordx4 v2, s[44:47], s8 offen sc1 lds
    v_mfma_f32_16x16x32_bf16 v[116:119], v[76:79], v[36:39], v[116:119]
    ds_read_b64_tr_b16 v[58:59], v12 offset:1280
    s_waitcnt lgkmcnt(8)
    v_mfma_f32_16x16x32_bf16 v[80:83], v[40:43], v[24:27], v[80:83]
    ds_read_b128 v[32:35], v14 offset:8192
    v_mfma_f32_16x16x32_bf16 v[84:87], v[40:43], v[28:31], v[84:87]
    ds_read_b128 v[36:39], v14 offset:9216
    ds_read_b64_tr_b16 v[60:61], v12 offset:9728
    s_waitcnt lgkmcnt(9)
    v_mfma_f32_16x16x32_bf16 v[88:91], v[44:47], v[24:27], v[88:91]
    ds_read_b64_tr_b16 v[62:63], v12 offset:10880
    v_mfma_f32_16x16x32_bf16 v[92:95], v[44:47], v[28:31], v[92:95]
    ds_read_b64_tr_b16 v[64:65], v12 offset:9760
    ds_read_b64_tr_b16 v[66:67], v12 offset:10912
    s_waitcnt lgkmcnt(10)
    v_mfma_f32_16x16x32_bf16 v[96:99], v[48:51], v[24:27], v[96:99]
    ds_read_b64_tr_b16 v[68:69], v12 offset:9792
    v_mfma_f32_16x16x32_bf16 v[100:103], v[48:51], v[28:31], v[100:103]
    ds_read_b64_tr_b16 v[70:71], v12 offset:10944
    s_waitcnt lgkmcnt(10)
    v_mfma_f32_16x16x32_bf16 v[104:107], v[52:55], v[24:27], v[104:107]
    ds_read_b64_tr_b16 v[72:73], v12 offset:9824
    v_mfma_f32_16x16x32_bf16 v[108:111], v[52:55], v[28:31], v[108:111]
    ds_read_b64_tr_b16 v[74:75], v12 offset:10976
    s_waitcnt lgkmcnt(10)
    v_mfma_f32_16x16x32_bf16 v[112:115], v[56:59], v[24:27], v[112:115]
    ds_read_b64_tr_b16 v[76:77], v12 offset:9856
    v_mfma_f32_16x16x32_bf16 v[116:119], v[56:59], v[28:31], v[116:119]
    ds_read_b64_tr_b16 v[78:79], v12 offset:11008
    s_waitcnt lgkmcnt(8)
    v_mfma_f32_16x16x32_bf16 v[80:83], v[60:63], v[32:35], v[80:83]
    s_waitcnt vmcnt(4)
    s_waitcnt lgkmcnt(0)
    s_barrier
    ds_read_b128 v[24:27], v14 offset:16384
    v_mfma_f32_16x16x32_bf16 v[84:87], v[60:63], v[36:39], v[84:87]
    ds_read_b128 v[28:31], v14 offset:17408
    ds_read_b64_tr_b16 v[40:41], v12 offset:19456
    v_mfma_f32_16x16x32_bf16 v[88:91], v[64:67], v[32:35], v[88:91]
    ds_read_b64_tr_b16 v[42:43], v12 offset:20608
    v_mfma_f32_16x16x32_bf16 v[92:95], v[64:67], v[36:39], v[92:95]
    ds_read_b64_tr_b16 v[44:45], v12 offset:19488
    ds_read_b64_tr_b16 v[46:47], v12 offset:20640
    v_mfma_f32_16x16x32_bf16 v[96:99], v[68:71], v[32:35], v[96:99]
    ds_read_b64_tr_b16 v[48:49], v12 offset:19520
    v_mfma_f32_16x16x32_bf16 v[100:103], v[68:71], v[36:39], v[100:103]
    ds_read_b64_tr_b16 v[50:51], v12 offset:20672
    v_mfma_f32_16x16x32_bf16 v[104:107], v[72:75], v[32:35], v[104:107]
    ds_read_b64_tr_b16 v[52:53], v12 offset:19552
    v_mfma_f32_16x16x32_bf16 v[108:111], v[72:75], v[36:39], v[108:111]
    ds_read_b64_tr_b16 v[54:55], v12 offset:20704
    s_add_u32 m0, s97, 0
    s_add_u32 s8, s91, 0
    buffer_load_dwordx4 v2, s[44:47], s8 offen sc1 lds
    v_mfma_f32_16x16x32_bf16 v[112:115], v[76:79], v[32:35], v[112:115]
    ds_read_b64_tr_b16 v[56:57], v12 offset:19584
    s_add_u32 m0, s97, 8192
    s_add_u32 s8, s91, 4096
    buffer_load_dwordx4 v2, s[44:47], s8 offen sc1 lds
    v_mfma_f32_16x16x32_bf16 v[116:119], v[76:79], v[36:39], v[116:119]
    ds_read_b64_tr_b16 v[58:59], v12 offset:20736
    s_waitcnt lgkmcnt(8)
    v_mfma_f32_16x16x32_bf16 v[80:83], v[40:43], v[24:27], v[80:83]
    ds_read_b128 v[32:35], v14 offset:24576
    v_mfma_f32_16x16x32_bf16 v[84:87], v[40:43], v[28:31], v[84:87]
    ds_read_b128 v[36:39], v14 offset:25600
    ds_read_b64_tr_b16 v[60:61], v12 offset:29184
    s_waitcnt lgkmcnt(9)
    v_mfma_f32_16x16x32_bf16 v[88:91], v[44:47], v[24:27], v[88:91]
    ds_read_b64_tr_b16 v[62:63], v12 offset:30336
    v_mfma_f32_16x16x32_bf16 v[92:95], v[44:47], v[28:31], v[92:95]
    ds_read_b64_tr_b16 v[64:65], v12 offset:29216
    ds_read_b64_tr_b16 v[66:67], v12 offset:30368
    s_waitcnt lgkmcnt(10)
    v_mfma_f32_16x16x32_bf16 v[96:99], v[48:51], v[24:27], v[96:99]
    ds_read_b64_tr_b16 v[68:69], v12 offset:29248
    v_mfma_f32_16x16x32_bf16 v[100:103], v[48:51], v[28:31], v[100:103]
    ds_read_b64_tr_b16 v[70:71], v12 offset:30400
    s_waitcnt lgkmcnt(10)
    v_mfma_f32_16x16x32_bf16 v[104:107], v[52:55], v[24:27], v[104:107]
    ds_read_b64_tr_b16 v[72:73], v12 offset:29280
    v_mfma_f32_16x16x32_bf16 v[108:111], v[52:55], v[28:31], v[108:111]
    ds_read_b64_tr_b16 v[74:75], v12 offset:30432
    s_waitcnt lgkmcnt(10)
    v_mfma_f32_16x16x32_bf16 v[112:115], v[56:59], v[24:27], v[112:115]
    ds_read_b64_tr_b16 v[76:77], v12 offset:29312
    v_mfma_f32_16x16x32_bf16 v[116:119], v[56:59], v[28:31], v[116:119]
    ds_read_b64_tr_b16 v[78:79], v12 offset:30464
    s_waitcnt lgkmcnt(8)
    v_mfma_f32_16x16x32_bf16 v[80:83], v[60:63], v[32:35], v[80:83]
    s_waitcnt vmcnt(4)
    s_waitcnt lgkmcnt(0)
    s_barrier
    ds_read_b128 v[24:27], v14 offset:32768
    v_mfma_f32_16x16x32_bf16 v[84:87], v[60:63], v[36:39], v[84:87]
    ds_read_b128 v[28:31], v14 offset:33792
    ds_read_b64_tr_b16 v[40:41], v13 offset:0
    v_mfma_f32_16x16x32_bf16 v[88:91], v[64:67], v[32:35], v[88:91]
    ds_read_b64_tr_b16 v[42:43], v13 offset:1152
    v_mfma_f32_16x16x32_bf16 v[92:95], v[64:67], v[36:39], v[92:95]
    ds_read_b64_tr_b16 v[44:45], v13 offset:32
    ds_read_b64_tr_b16 v[46:47], v13 offset:1184
    v_mfma_f32_16x16x32_bf16 v[96:99], v[68:71], v[32:35], v[96:99]
    ds_read_b64_tr_b16 v[48:49], v13 offset:64
    v_mfma_f32_16x16x32_bf16 v[100:103], v[68:71], v[36:39], v[100:103]
    ds_read_b64_tr_b16 v[50:51], v13 offset:1216
    v_mfma_f32_16x16x32_bf16 v[104:107], v[72:75], v[32:35], v[104:107]
    ds_read_b64_tr_b16 v[52:53], v13 offset:96
    v_mfma_f32_16x16x32_bf16 v[108:111], v[72:75], v[36:39], v[108:111]
    ds_read_b64_tr_b16 v[54:55], v13 offset:1248
    s_add_u32 m0, s97, 16384
    s_add_u32 s8, s91, 8192
    buffer_load_dwordx4 v2, s[44:47], s8 offen sc1 lds
    v_mfma_f32_16x16x32_bf16 v[112:115], v[76:79], v[32:35], v[112:115]
    ds_read_b64_tr_b16 v[56:57], v13 offset:128
    s_add_u32 m0, s97, 24576
    s_add_u32 s8, s91, 12288
    buffer_load_dwordx4 v2, s[44:47], s8 offen sc1 lds
    v_mfma_f32_16x16x32_bf16 v[116:119], v[76:79], v[36:39], v[116:119]
    ds_read_b64_tr_b16 v[58:59], v13 offset:1280
    s_waitcnt lgkmcnt(8)
    v_mfma_f32_16x16x32_bf16 v[80:83], v[40:43], v[24:27], v[80:83]
    ds_read_b128 v[32:35], v14 offset:40960
    v_mfma_f32_16x16x32_bf16 v[84:87], v[40:43], v[28:31], v[84:87]
    ds_read_b128 v[36:39], v14 offset:41984
    ds_read_b64_tr_b16 v[60:61], v13 offset:9728
    s_waitcnt lgkmcnt(9)
    v_mfma_f32_16x16x32_bf16 v[88:91], v[44:47], v[24:27], v[88:91]
    ds_read_b64_tr_b16 v[62:63], v13 offset:10880
    v_mfma_f32_16x16x32_bf16 v[92:95], v[44:47], v[28:31], v[92:95]
    ds_read_b64_tr_b16 v[64:65], v13 offset:9760
    ds_read_b64_tr_b16 v[66:67], v13 offset:10912
    s_waitcnt lgkmcnt(10)
    v_mfma_f32_16x16x32_bf16 v[96:99], v[48:51], v[24:27], v[96:99]
    ds_read_b64_tr_b16 v[68:69], v13 offset:9792
    v_mfma_f32_16x16x32_bf16 v[100:103], v[48:51], v[28:31], v[100:103]
    ds_read_b64_tr_b16 v[70:71], v13 offset:10944
    s_waitcnt lgkmcnt(10)
    v_mfma_f32_16x16x32_bf16 v[104:107], v[52:55], v[24:27], v[104:107]
    ds_read_b64_tr_b16 v[72:73], v13 offset:9824
    v_mfma_f32_16x16x32_bf16 v[108:111], v[52:55], v[28:31], v[108:111]
    ds_read_b64_tr_b16 v[74:75], v13 offset:10976
    s_waitcnt lgkmcnt(10)
    v_mfma_f32_16x16x32_bf16 v[112:115], v[56:59], v[24:27], v[112:115]
    ds_read_b64_tr_b16 v[76:77], v13 offset:9856
    v_mfma_f32_16x16x32_bf16 v[116:119], v[56:59], v[28:31], v[116:119]
    ds_read_b64_tr_b16 v[78:79], v13 offset:11008
    s_waitcnt lgkmcnt(8)
    v_mfma_f32_16x16x32_bf16 v[80:83], v[60:63], v[32:35], v[80:83]
    s_waitcnt vmcnt(4)
    s_waitcnt lgkmcnt(0)
    s_barrier
    ds_read_b128 v[24:27], v14 offset:49152
    v_mfma_f32_16x16x32_bf16 v[84:87], v[60:63], v[36:39], v[84:87]
    ds_read_b128 v[28:31], v14 offset:50176
    ds_read_b64_tr_b16 v[40:41], v13 offset:19456
    v_mfma_f32_16x16x32_bf16 v[88:91], v[64:67], v[32:35], v[88:91]
    ds_read_b64_tr_b16 v[42:43], v13 offset:20608
    v_mfma_f32_16x16x32_bf16 v[92:95], v[64:67], v[36:39], v[92:95]
    ds_read_b64_tr_b16 v[44:45], v13 offset:19488
    ds_read_b64_tr_b16 v[46:47], v13 offset:20640
    v_mfma_f32_16x16x32_bf16 v[96:99], v[68:71], v[32:35], v[96:99]
    ds_read_b64_tr_b16 v[48:49], v13 offset:19520
    v_mfma_f32_16x16x32_bf16 v[100:103], v[68:71], v[36:39], v[100:103]
    ds_read_b64_tr_b16 v[50:51], v13 offset:20672
    v_mfma_f32_16x16x32_bf16 v[104:107], v[72:75], v[32:35], v[104:107]
    ds_read_b64_tr_b16 v[52:53], v13 offset:19552
    v_mfma_f32_16x16x32_bf16 v[108:111], v[72:75], v[36:39], v[108:111]
    ds_read_b64_tr_b16 v[54:55], v13 offset:20704
    s_add_u32 m0, s97, 32768
    s_add_u32 s8, s91, 16384
    buffer_load_dwordx4 v2, s[44:47], s8 offen sc1 lds
    v_mfma_f32_16x16x32_bf16 v[112:115], v[76:79], v[32:35], v[112:115]
    ds_read_b64_tr_b16 v[56:57], v13 offset:19584
    s_add_u32 m0, s97, 40960
    s_add_u32 s8, s91, 20480
    buffer_load_dwordx4 v2, s[44:47], s8 offen sc1 lds
    v_mfma_f32_16x16x32_bf16 v[116:119], v[76:79], v[36:39], v[116:119]
    ds_read_b64_tr_b16 v[58:59], v13 offset:20736
    s_waitcnt lgkmcnt(8)
    v_mfma_f32_16x16x32_bf16 v[80:83], v[40:43], v[24:27], v[80:83]
    ds_read_b128 v[32:35], v14 offset:57344
    v_mfma_f32_16x16x32_bf16 v[84:87], v[40:43], v[28:31], v[84:87]
    ds_read_b128 v[36:39], v14 offset:58368
    ds_read_b64_tr_b16 v[60:61], v13 offset:29184
    s_waitcnt lgkmcnt(9)
    v_mfma_f32_16x16x32_bf16 v[88:91], v[44:47], v[24:27], v[88:91]
    ds_read_b64_tr_b16 v[62:63], v13 offset:30336
    v_mfma_f32_16x16x32_bf16 v[92:95], v[44:47], v[28:31], v[92:95]
    ds_read_b64_tr_b16 v[64:65], v13 offset:29216
    ds_read_b64_tr_b16 v[66:67], v13 offset:30368
    s_waitcnt lgkmcnt(10)
    v_mfma_f32_16x16x32_bf16 v[96:99], v[48:51], v[24:27], v[96:99]
    ds_read_b64_tr_b16 v[68:69], v13 offset:29248
    v_mfma_f32_16x16x32_bf16 v[100:103], v[48:51], v[28:31], v[100:103]
    ds_read_b64_tr_b16 v[70:71], v13 offset:30400
    s_waitcnt lgkmcnt(10)
    v_mfma_f32_16x16x32_bf16 v[104:107], v[52:55], v[24:27], v[104:107]
    ds_read_b64_tr_b16 v[72:73], v13 offset:29280
    v_mfma_f32_16x16x32_bf16 v[108:111], v[52:55], v[28:31], v[108:111]
    ds_read_b64_tr_b16 v[74:75], v13 offset:30432
    s_waitcnt lgkmcnt(10)
    v_mfma_f32_16x16x32_bf16 v[112:115], v[56:59], v[24:27], v[112:115]
    ds_read_b64_tr_b16 v[76:77], v13 offset:29312
    v_mfma_f32_16x16x32_bf16 v[116:119], v[56:59], v[28:31], v[116:119]
    ds_read_b64_tr_b16 v[78:79], v13 offset:30464
    s_waitcnt lgkmcnt(8)
    v_mfma_f32_16x16x32_bf16 v[80:83], v[60:63], v[32:35], v[80:83]
    s_waitcnt vmcnt(4)
    s_waitcnt lgkmcnt(0)
    s_barrier
    ds_read_b128 v[24:27], v14 offset:0
    v_mfma_f32_16x16x32_bf16 v[84:87], v[60:63], v[36:39], v[84:87]
    ds_read_b128 v[28:31], v14 offset:1024
    ds_read_b64_tr_b16 v[40:41], v12 offset:0
    v_mfma_f32_16x16x32_bf16 v[88:91], v[64:67], v[32:35], v[88:91]
    ds_read_b64_tr_b16 v[42:43], v12 offset:1152
    v_mfma_f32_16x16x32_bf16 v[92:95], v[64:67], v[36:39], v[92:95]
    ds_read_b64_tr_b16 v[44:45], v12 offset:32
    ds_read_b64_tr_b16 v[46:47], v12 offset:1184
    v_mfma_f32_16x16x32_bf16 v[96:99], v[68:71], v[32:35], v[96:99]
    ds_read_b64_tr_b16 v[48:49], v12 offset:64
    v_mfma_f32_16x16x32_bf16 v[100:103], v[68:71], v[36:39], v[100:103]
    ds_read_b64_tr_b16 v[50:51], v12 offset:1216
    v_mfma_f32_16x16x32_bf16 v[104:107], v[72:75], v[32:35], v[104:107]
    ds_read_b64_tr_b16 v[52:53], v12 offset:96
    v_mfma_f32_16x16x32_bf16 v[108:111], v[72:75], v[36:39], v[108:111]
    ds_read_b64_tr_b16 v[54:55], v12 offset:1248
    s_add_u32 m0, s97, 49152
    s_add_u32 s8, s91, 24576
    buffer_load_dwordx4 v2, s[44:47], s8 offen sc1 lds
    v_mfma_f32_16x16x32_bf16 v[112:115], v[76:79], v[32:35], v[112:115]
    ds_read_b64_tr_b16 v[56:57], v12 offset:128
    s_add_u32 m0, s97, 57344
    s_add_u32 s8, s91, 28672
    buffer_load_dwordx4 v2, s[44:47], s8 offen sc1 lds
    v_mfma_f32_16x16x32_bf16 v[116:119], v[76:79], v[36:39], v[116:119]
    ds_read_b64_tr_b16 v[58:59], v12 offset:1280
    s_waitcnt lgkmcnt(8)
    v_mfma_f32_16x16x32_bf16 v[80:83], v[40:43], v[24:27], v[80:83]
    ds_read_b128 v[32:35], v14 offset:8192
    v_mfma_f32_16x16x32_bf16 v[84:87], v[40:43], v[28:31], v[84:87]
    ds_read_b128 v[36:39], v14 offset:9216
    ds_read_b64_tr_b16 v[60:61], v12 offset:9728
    s_waitcnt lgkmcnt(9)
    v_mfma_f32_16x16x32_bf16 v[88:91], v[44:47], v[24:27], v[88:91]
    ds_read_b64_tr_b16 v[62:63], v12 offset:10880
    v_mfma_f32_16x16x32_bf16 v[92:95], v[44:47], v[28:31], v[92:95]
    ds_read_b64_tr_b16 v[64:65], v12 offset:9760
    ds_read_b64_tr_b16 v[66:67], v12 offset:10912
    s_waitcnt lgkmcnt(10)
    v_mfma_f32_16x16x32_bf16 v[96:99], v[48:51], v[24:27], v[96:99]
    ds_read_b64_tr_b16 v[68:69], v12 offset:9792
    v_mfma_f32_16x16x32_bf16 v[100:103], v[48:51], v[28:31], v[100:103]
    ds_read_b64_tr_b16 v[70:71], v12 offset:10944
    s_waitcnt lgkmcnt(10)
    v_mfma_f32_16x16x32_bf16 v[104:107], v[52:55], v[24:27], v[104:107]
    ds_read_b64_tr_b16 v[72:73], v12 offset:9824
    v_mfma_f32_16x16x32_bf16 v[108:111], v[52:55], v[28:31], v[108:111]
    ds_read_b64_tr_b16 v[74:75], v12 offset:10976
    s_waitcnt lgkmcnt(10)
    v_mfma_f32_16x16x32_bf16 v[112:115], v[56:59], v[24:27], v[112:115]
    ds_read_b64_tr_b16 v[76:77], v12 offset:9856
    v_mfma_f32_16x16x32_bf16 v[116:119], v[56:59], v[28:31], v[116:119]
    ds_read_b64_tr_b16 v[78:79], v12 offset:11008
    s_waitcnt lgkmcnt(8)
    v_mfma_f32_16x16x32_bf16 v[80:83], v[60:63], v[32:35], v[80:83]
    s_waitcnt vmcnt(4)
    s_waitcnt lgkmcnt(0)
    s_barrier
    ds_read_b128 v[24:27], v14 offset:16384
    v_mfma_f32_16x16x32_bf16 v[84:87], v[60:63], v[36:39], v[84:87]
    ds_read_b128 v[28:31], v14 offset:17408
    ds_read_b64_tr_b16 v[40:41], v12 offset:19456
    v_mfma_f32_16x16x32_bf16 v[88:91], v[64:67], v[32:35], v[88:91]
    ds_read_b64_tr_b16 v[42:43], v12 offset:20608
    v_mfma_f32_16x16x32_bf16 v[92:95], v[64:67], v[36:39], v[92:95]
    ds_read_b64_tr_b16 v[44:45], v12 offset:19488
    ds_read_b64_tr_b16 v[46:47], v12 offset:20640
    v_mfma_f32_16x16x32_bf16 v[96:99], v[68:71], v[32:35], v[96:99]
    ds_read_b64_tr_b16 v[48:49], v12 offset:19520
    v_mfma_f32_16x16x32_bf16 v[100:103], v[68:71], v[36:39], v[100:103]
    ds_read_b64_tr_b16 v[50:51], v12 offset:20672
    v_mfma_f32_16x16x32_bf16 v[104:107], v[72:75], v[32:35], v[104:107]
    ds_read_b64_tr_b16 v[52:53], v12 offset:19552
    v_mfma_f32_16x16x32_bf16 v[108:111], v[72:75], v[36:39], v[108:111]
    ds_read_b64_tr_b16 v[54:55], v12 offset:20704
    s_add_u32 m0, s97, 0
    s_add_u32 s8, s66, 0
    buffer_load_dwordx4 v2, s[44:47], s8 offen sc1 lds
    v_mfma_f32_16x16x32_bf16 v[112:115], v[76:79], v[32:35], v[112:115]
    ds_read_b64_tr_b16 v[56:57], v12 offset:19584
    s_add_u32 m0, s97, 8192
    s_add_u32 s8, s66, 4096
    buffer_load_dwordx4 v2, s[44:47], s8 offen sc1 lds
    v_mfma_f32_16x16x32_bf16 v[116:119], v[76:79], v[36:39], v[116:119]
    ds_read_b64_tr_b16 v[58:59], v12 offset:20736
    s_waitcnt lgkmcnt(8)
    v_mfma_f32_16x16x32_bf16 v[80:83], v[40:43], v[24:27], v[80:83]
    ds_read_b128 v[32:35], v14 offset:24576
    v_mfma_f32_16x16x32_bf16 v[84:87], v[40:43], v[28:31], v[84:87]
    ds_read_b128 v[36:39], v14 offset:25600
    ds_read_b64_tr_b16 v[60:61], v12 offset:29184
    s_waitcnt lgkmcnt(9)
    v_mfma_f32_16x16x32_bf16 v[88:91], v[44:47], v[24:27], v[88:91]
    ds_read_b64_tr_b16 v[62:63], v12 offset:30336
    v_mfma_f32_16x16x32_bf16 v[92:95], v[44:47], v[28:31], v[92:95]
    ds_read_b64_tr_b16 v[64:65], v12 offset:29216
    ds_read_b64_tr_b16 v[66:67], v12 offset:30368
    s_waitcnt lgkmcnt(10)
    v_mfma_f32_16x16x32_bf16 v[96:99], v[48:51], v[24:27], v[96:99]
    ds_read_b64_tr_b16 v[68:69], v12 offset:29248
    v_mfma_f32_16x16x32_bf16 v[100:103], v[48:51], v[28:31], v[100:103]
    ds_read_b64_tr_b16 v[70:71], v12 offset:30400
    s_waitcnt lgkmcnt(10)
    v_mfma_f32_16x16x32_bf16 v[104:107], v[52:55], v[24:27], v[104:107]
    ds_read_b64_tr_b16 v[72:73], v12 offset:29280
    v_mfma_f32_16x16x32_bf16 v[108:111], v[52:55], v[28:31], v[108:111]
    ds_read_b64_tr_b16 v[74:75], v12 offset:30432
    s_waitcnt lgkmcnt(10)
    v_mfma_f32_16x16x32_bf16 v[112:115], v[56:59], v[24:27], v[112:115]
    ds_read_b64_tr_b16 v[76:77], v12 offset:29312
    v_mfma_f32_16x16x32_bf16 v[116:119], v[56:59], v[28:31], v[116:119]
    ds_read_b64_tr_b16 v[78:79], v12 offset:30464
    s_waitcnt lgkmcnt(8)
    v_mfma_f32_16x16x32_bf16 v[80:83], v[60:63], v[32:35], v[80:83]
    s_waitcnt vmcnt(4)
    s_waitcnt lgkmcnt(0)
    s_barrier
    ds_read_b128 v[24:27], v14 offset:32768
    v_mfma_f32_16x16x32_bf16 v[84:87], v[60:63], v[36:39], v[84:87]
    ds_read_b128 v[28:31], v14 offset:33792
    ds_read_b64_tr_b16 v[40:41], v13 offset:0
    v_mfma_f32_16x16x32_bf16 v[88:91], v[64:67], v[32:35], v[88:91]
    ds_read_b64_tr_b16 v[42:43], v13 offset:1152
    v_mfma_f32_16x16x32_bf16 v[92:95], v[64:67], v[36:39], v[92:95]
    ds_read_b64_tr_b16 v[44:45], v13 offset:32
    ds_read_b64_tr_b16 v[46:47], v13 offset:1184
    v_mfma_f32_16x16x32_bf16 v[96:99], v[68:71], v[32:35], v[96:99]
    ds_read_b64_tr_b16 v[48:49], v13 offset:64
    v_mfma_f32_16x16x32_bf16 v[100:103], v[68:71], v[36:39], v[100:103]
    ds_read_b64_tr_b16 v[50:51], v13 offset:1216
    v_mfma_f32_16x16x32_bf16 v[104:107], v[72:75], v[32:35], v[104:107]
    ds_read_b64_tr_b16 v[52:53], v13 offset:96
    v_mfma_f32_16x16x32_bf16 v[108:111], v[72:75], v[36:39], v[108:111]
    ds_read_b64_tr_b16 v[54:55], v13 offset:1248
    s_add_u32 m0, s97, 16384
    s_add_u32 s8, s66, 8192
    buffer_load_dwordx4 v2, s[44:47], s8 offen sc1 lds
    v_mfma_f32_16x16x32_bf16 v[112:115], v[76:79], v[32:35], v[112:115]
    ds_read_b64_tr_b16 v[56:57], v13 offset:128
    s_add_u32 m0, s97, 24576
    s_add_u32 s8, s66, 12288
    buffer_load_dwordx4 v2, s[44:47], s8 offen sc1 lds
    v_mfma_f32_16x16x32_bf16 v[116:119], v[76:79], v[36:39], v[116:119]
    ds_read_b64_tr_b16 v[58:59], v13 offset:1280
    s_waitcnt lgkmcnt(8)
    v_mfma_f32_16x16x32_bf16 v[80:83], v[40:43], v[24:27], v[80:83]
    ds_read_b128 v[32:35], v14 offset:40960
    v_mfma_f32_16x16x32_bf16 v[84:87], v[40:43], v[28:31], v[84:87]
    ds_read_b128 v[36:39], v14 offset:41984
    ds_read_b64_tr_b16 v[60:61], v13 offset:9728
    s_waitcnt lgkmcnt(9)
    v_mfma_f32_16x16x32_bf16 v[88:91], v[44:47], v[24:27], v[88:91]
    ds_read_b64_tr_b16 v[62:63], v13 offset:10880
    v_mfma_f32_16x16x32_bf16 v[92:95], v[44:47], v[28:31], v[92:95]
    ds_read_b64_tr_b16 v[64:65], v13 offset:9760
    ds_read_b64_tr_b16 v[66:67], v13 offset:10912
    s_waitcnt lgkmcnt(10)
    v_mfma_f32_16x16x32_bf16 v[96:99], v[48:51], v[24:27], v[96:99]
    ds_read_b64_tr_b16 v[68:69], v13 offset:9792
    v_mfma_f32_16x16x32_bf16 v[100:103], v[48:51], v[28:31], v[100:103]
    ds_read_b64_tr_b16 v[70:71], v13 offset:10944
    s_waitcnt lgkmcnt(10)
    v_mfma_f32_16x16x32_bf16 v[104:107], v[52:55], v[24:27], v[104:107]
    ds_read_b64_tr_b16 v[72:73], v13 offset:9824
    v_mfma_f32_16x16x32_bf16 v[108:111], v[52:55], v[28:31], v[108:111]
    ds_read_b64_tr_b16 v[74:75], v13 offset:10976
    s_waitcnt lgkmcnt(10)
    v_mfma_f32_16x16x32_bf16 v[112:115], v[56:59], v[24:27], v[112:115]
    ds_read_b64_tr_b16 v[76:77], v13 offset:9856
    v_mfma_f32_16x16x32_bf16 v[116:119], v[56:59], v[28:31], v[116:119]
    ds_read_b64_tr_b16 v[78:79], v13 offset:11008
    s_waitcnt lgkmcnt(8)
    v_mfma_f32_16x16x32_bf16 v[80:83], v[60:63], v[32:35], v[80:83]
    s_waitcnt vmcnt(4)
    s_waitcnt lgkmcnt(0)
    s_barrier
    ds_read_b128 v[24:27], v14 offset:49152
    v_mfma_f32_16x16x32_bf16 v[84:87], v[60:63], v[36:39], v[84:87]
    ds_read_b128 v[28:31], v14 offset:50176
    ds_read_b64_tr_b16 v[40:41], v13 offset:19456
    v_mfma_f32_16x16x32_bf16 v[88:91], v[64:67], v[32:35], v[88:91]
    ds_read_b64_tr_b16 v[42:43], v13 offset:20608
    v_mfma_f32_16x16x32_bf16 v[92:95], v[64:67], v[36:39], v[92:95]
    ds_read_b64_tr_b16 v[44:45], v13 offset:19488
    ds_read_b64_tr_b16 v[46:47], v13 offset:20640
    v_mfma_f32_16x16x32_bf16 v[96:99], v[68:71], v[32:35], v[96:99]
    ds_read_b64_tr_b16 v[48:49], v13 offset:19520
    v_mfma_f32_16x16x32_bf16 v[100:103], v[68:71], v[36:39], v[100:103]
    ds_read_b64_tr_b16 v[50:51], v13 offset:20672
    v_mfma_f32_16x16x32_bf16 v[104:107], v[72:75], v[32:35], v[104:107]
    ds_read_b64_tr_b16 v[52:53], v13 offset:19552
    v_mfma_f32_16x16x32_bf16 v[108:111], v[72:75], v[36:39], v[108:111]
    ds_read_b64_tr_b16 v[54:55], v13 offset:20704
    s_add_u32 m0, s97, 32768
    s_nop 0
    buffer_load_dwordx4 v2, s[44:47], s67 offen sc1 lds
    v_mfma_f32_16x16x32_bf16 v[112:115], v[76:79], v[32:35], v[112:115]
    ds_read_b64_tr_b16 v[56:57], v13 offset:19584
    v_mfma_f32_16x16x32_bf16 v[116:119], v[76:79], v[36:39], v[116:119]
    ds_read_b64_tr_b16 v[58:59], v13 offset:20736
    s_waitcnt lgkmcnt(8)
    v_mfma_f32_16x16x32_bf16 v[80:83], v[40:43], v[24:27], v[80:83]
    ds_read_b128 v[32:35], v14 offset:57344
    v_mfma_f32_16x16x32_bf16 v[84:87], v[40:43], v[28:31], v[84:87]
    ds_read_b128 v[36:39], v14 offset:58368
    ds_read_b64_tr_b16 v[60:61], v13 offset:29184
    s_waitcnt lgkmcnt(9)
    v_mfma_f32_16x16x32_bf16 v[88:91], v[44:47], v[24:27], v[88:91]
    ds_read_b64_tr_b16 v[62:63], v13 offset:30336
    v_mfma_f32_16x16x32_bf16 v[92:95], v[44:47], v[28:31], v[92:95]
    ds_read_b64_tr_b16 v[64:65], v13 offset:29216
    ds_read_b64_tr_b16 v[66:67], v13 offset:30368
    s_waitcnt lgkmcnt(10)
    v_mfma_f32_16x16x32_bf16 v[96:99], v[48:51], v[24:27], v[96:99]
    ds_read_b64_tr_b16 v[68:69], v13 offset:29248
    v_mfma_f32_16x16x32_bf16 v[100:103], v[48:51], v[28:31], v[100:103]
    ds_read_b64_tr_b16 v[70:71], v13 offset:30400
    s_waitcnt lgkmcnt(10)
    v_mfma_f32_16x16x32_bf16 v[104:107], v[52:55], v[24:27], v[104:107]
    ds_read_b64_tr_b16 v[72:73], v13 offset:29280
    v_mfma_f32_16x16x32_bf16 v[108:111], v[52:55], v[28:31], v[108:111]
    ds_read_b64_tr_b16 v[74:75], v13 offset:30432
    s_waitcnt lgkmcnt(10)
    v_mfma_f32_16x16x32_bf16 v[112:115], v[56:59], v[24:27], v[112:115]
    ds_read_b64_tr_b16 v[76:77], v13 offset:29312
    v_mfma_f32_16x16x32_bf16 v[116:119], v[56:59], v[28:31], v[116:119]
    ds_read_b64_tr_b16 v[78:79], v13 offset:30464
    s_waitcnt lgkmcnt(8)
    v_mfma_f32_16x16x32_bf16 v[80:83], v[60:63], v[32:35], v[80:83]
    s_waitcnt vmcnt(3)
    s_waitcnt lgkmcnt(0)
    s_barrier
    ds_read_b128 v[24:27], v14 offset:0
    v_mfma_f32_16x16x32_bf16 v[84:87], v[60:63], v[36:39], v[84:87]
    ds_read_b128 v[28:31], v14 offset:1024
    ds_read_b64_tr_b16 v[40:41], v12 offset:0
    v_mfma_f32_16x16x32_bf16 v[88:91], v[64:67], v[32:35], v[88:91]
    ds_read_b64_tr_b16 v[42:43], v12 offset:1152
    v_mfma_f32_16x16x32_bf16 v[92:95], v[64:67], v[36:39], v[92:95]
    ds_read_b64_tr_b16 v[44:45], v12 offset:32
    ds_read_b64_tr_b16 v[46:47], v12 offset:1184
    v_mfma_f32_16x16x32_bf16 v[96:99], v[68:71], v[32:35], v[96:99]
    ds_read_b64_tr_b16 v[48:49], v12 offset:64
    v_mfma_f32_16x16x32_bf16 v[100:103], v[68:71], v[36:39], v[100:103]
    ds_read_b64_tr_b16 v[50:51], v12 offset:1216
    v_mfma_f32_16x16x32_bf16 v[104:107], v[72:75], v[32:35], v[104:107]
    ds_read_b64_tr_b16 v[52:53], v12 offset:96
    v_mfma_f32_16x16x32_bf16 v[108:111], v[72:75], v[36:39], v[108:111]
    ds_read_b64_tr_b16 v[54:55], v12 offset:1248
    v_mfma_f32_16x16x32_bf16 v[112:115], v[76:79], v[32:35], v[112:115]
    ds_read_b64_tr_b16 v[56:57], v12 offset:128
    v_mfma_f32_16x16x32_bf16 v[116:119], v[76:79], v[36:39], v[116:119]
    ds_read_b64_tr_b16 v[58:59], v12 offset:1280
    s_waitcnt lgkmcnt(8)
    v_mfma_f32_16x16x32_bf16 v[80:83], v[40:43], v[24:27], v[80:83]
    ds_read_b128 v[32:35], v14 offset:8192
    v_mfma_f32_16x16x32_bf16 v[84:87], v[40:43], v[28:31], v[84:87]
    ds_read_b128 v[36:39], v14 offset:9216
    ds_read_b64_tr_b16 v[60:61], v12 offset:9728
    s_waitcnt lgkmcnt(9)
    v_mfma_f32_16x16x32_bf16 v[88:91], v[44:47], v[24:27], v[88:91]
    ds_read_b64_tr_b16 v[62:63], v12 offset:10880
    v_mfma_f32_16x16x32_bf16 v[92:95], v[44:47], v[28:31], v[92:95]
    ds_read_b64_tr_b16 v[64:65], v12 offset:9760
    ds_read_b64_tr_b16 v[66:67], v12 offset:10912
    s_waitcnt lgkmcnt(10)
    v_mfma_f32_16x16x32_bf16 v[96:99], v[48:51], v[24:27], v[96:99]
    ds_read_b64_tr_b16 v[68:69], v12 offset:9792
    v_mfma_f32_16x16x32_bf16 v[100:103], v[48:51], v[28:31], v[100:103]
    ds_read_b64_tr_b16 v[70:71], v12 offset:10944
    s_waitcnt lgkmcnt(10)
    v_mfma_f32_16x16x32_bf16 v[104:107], v[52:55], v[24:27], v[104:107]
    ds_read_b64_tr_b16 v[72:73], v12 offset:9824
    v_mfma_f32_16x16x32_bf16 v[108:111], v[52:55], v[28:31], v[108:111]
    ds_read_b64_tr_b16 v[74:75], v12 offset:10976
    s_waitcnt lgkmcnt(10)
    v_mfma_f32_16x16x32_bf16 v[112:115], v[56:59], v[24:27], v[112:115]
    ds_read_b64_tr_b16 v[76:77], v12 offset:9856
    v_mfma_f32_16x16x32_bf16 v[116:119], v[56:59], v[28:31], v[116:119]
    ds_read_b64_tr_b16 v[78:79], v12 offset:11008
    s_waitcnt lgkmcnt(8)
    v_mfma_f32_16x16x32_bf16 v[80:83], v[60:63], v[32:35], v[80:83]
    s_waitcnt vmcnt(1)
    s_waitcnt lgkmcnt(0)
    s_barrier
    ds_read_b128 v[24:27], v14 offset:16384
    v_mfma_f32_16x16x32_bf16 v[84:87], v[60:63], v[36:39], v[84:87]
    ds_read_b128 v[28:31], v14 offset:17408
    ds_read_b64_tr_b16 v[40:41], v12 offset:19456
    v_mfma_f32_16x16x32_bf16 v[88:91], v[64:67], v[32:35], v[88:91]
    ds_read_b64_tr_b16 v[42:43], v12 offset:20608
    v_mfma_f32_16x16x32_bf16 v[92:95], v[64:67], v[36:39], v[92:95]
    ds_read_b64_tr_b16 v[44:45], v12 offset:19488
    ds_read_b64_tr_b16 v[46:47], v12 offset:20640
    v_mfma_f32_16x16x32_bf16 v[96:99], v[68:71], v[32:35], v[96:99]
    ds_read_b64_tr_b16 v[48:49], v12 offset:19520
    v_mfma_f32_16x16x32_bf16 v[100:103], v[68:71], v[36:39], v[100:103]
    ds_read_b64_tr_b16 v[50:51], v12 offset:20672
    v_mfma_f32_16x16x32_bf16 v[104:107], v[72:75], v[32:35], v[104:107]
    ds_read_b64_tr_b16 v[52:53], v12 offset:19552
    v_mfma_f32_16x16x32_bf16 v[108:111], v[72:75], v[36:39], v[108:111]
    ds_read_b64_tr_b16 v[54:55], v12 offset:20704
    v_mfma_f32_16x16x32_bf16 v[112:115], v[76:79], v[32:35], v[112:115]
    ds_read_b64_tr_b16 v[56:57], v12 offset:19584
    v_mfma_f32_16x16x32_bf16 v[116:119], v[76:79], v[36:39], v[116:119]
    ds_read_b64_tr_b16 v[58:59], v12 offset:20736
    s_waitcnt lgkmcnt(8)
    v_mfma_f32_16x16x32_bf16 v[80:83], v[40:43], v[24:27], v[80:83]
    ds_read_b128 v[32:35], v14 offset:24576
    v_mfma_f32_16x16x32_bf16 v[84:87], v[40:43], v[28:31], v[84:87]
    ds_read_b128 v[36:39], v14 offset:25600
    ds_read_b64_tr_b16 v[60:61], v12 offset:29184
    s_waitcnt lgkmcnt(9)
    v_mfma_f32_16x16x32_bf16 v[88:91], v[44:47], v[24:27], v[88:91]
    ds_read_b64_tr_b16 v[62:63], v12 offset:30336
    v_mfma_f32_16x16x32_bf16 v[92:95], v[44:47], v[28:31], v[92:95]
    ds_read_b64_tr_b16 v[64:65], v12 offset:29216
    ds_read_b64_tr_b16 v[66:67], v12 offset:30368
    s_waitcnt lgkmcnt(10)
    v_mfma_f32_16x16x32_bf16 v[96:99], v[48:51], v[24:27], v[96:99]
    ds_read_b64_tr_b16 v[68:69], v12 offset:29248
    v_mfma_f32_16x16x32_bf16 v[100:103], v[48:51], v[28:31], v[100:103]
    ds_read_b64_tr_b16 v[70:71], v12 offset:30400
    s_waitcnt lgkmcnt(10)
    v_mfma_f32_16x16x32_bf16 v[104:107], v[52:55], v[24:27], v[104:107]
    ds_read_b64_tr_b16 v[72:73], v12 offset:29280
    v_mfma_f32_16x16x32_bf16 v[108:111], v[52:55], v[28:31], v[108:111]
    ds_read_b64_tr_b16 v[74:75], v12 offset:30432
    s_waitcnt lgkmcnt(10)
    v_mfma_f32_16x16x32_bf16 v[112:115], v[56:59], v[24:27], v[112:115]
    ds_read_b64_tr_b16 v[76:77], v12 offset:29312
    v_mfma_f32_16x16x32_bf16 v[116:119], v[56:59], v[28:31], v[116:119]
    ds_read_b64_tr_b16 v[78:79], v12 offset:30464
    s_waitcnt lgkmcnt(8)
    v_mfma_f32_16x16x32_bf16 v[80:83], v[60:63], v[32:35], v[80:83]
    s_waitcnt vmcnt(0)
    s_waitcnt lgkmcnt(0)
    s_barrier
    ds_read_b128 v[24:27], v14 offset:32768
    v_mfma_f32_16x16x32_bf16 v[84:87], v[60:63], v[36:39], v[84:87]
    ds_read_b128 v[28:31], v14 offset:33792
    ds_read_b64_tr_b16 v[40:41], v13 offset:0
    v_mfma_f32_16x16x32_bf16 v[88:91], v[64:67], v[32:35], v[88:91]
    ds_read_b64_tr_b16 v[42:43], v13 offset:1152
    v_mfma_f32_16x16x32_bf16 v[92:95], v[64:67], v[36:39], v[92:95]
    ds_read_b64_tr_b16 v[44:45], v13 offset:32
    ds_read_b64_tr_b16 v[46:47], v13 offset:1184
    v_mfma_f32_16x16x32_bf16 v[96:99], v[68:71], v[32:35], v[96:99]
    ds_read_b64_tr_b16 v[48:49], v13 offset:64
    v_mfma_f32_16x16x32_bf16 v[100:103], v[68:71], v[36:39], v[100:103]
    ds_read_b64_tr_b16 v[50:51], v13 offset:1216
    v_mfma_f32_16x16x32_bf16 v[104:107], v[72:75], v[32:35], v[104:107]
    ds_read_b64_tr_b16 v[52:53], v13 offset:96
    v_mfma_f32_16x16x32_bf16 v[108:111], v[72:75], v[36:39], v[108:111]
    ds_read_b64_tr_b16 v[54:55], v13 offset:1248
    v_mfma_f32_16x16x32_bf16 v[112:115], v[76:79], v[32:35], v[112:115]
    ds_read_b64_tr_b16 v[56:57], v13 offset:128
    v_mfma_f32_16x16x32_bf16 v[116:119], v[76:79], v[36:39], v[116:119]
    ds_read_b64_tr_b16 v[58:59], v13 offset:1280
    s_waitcnt lgkmcnt(8)
    v_mfma_f32_16x16x32_bf16 v[80:83], v[40:43], v[24:27], v[80:83]
    v_mfma_f32_16x16x32_bf16 v[84:87], v[40:43], v[28:31], v[84:87]
    s_waitcnt lgkmcnt(6)
    v_mfma_f32_16x16x32_bf16 v[88:91], v[44:47], v[24:27], v[88:91]
    v_mfma_f32_16x16x32_bf16 v[92:95], v[44:47], v[28:31], v[92:95]
    s_waitcnt lgkmcnt(4)
    v_mfma_f32_16x16x32_bf16 v[96:99], v[48:51], v[24:27], v[96:99]
    v_mfma_f32_16x16x32_bf16 v[100:103], v[48:51], v[28:31], v[100:103]
    s_waitcnt lgkmcnt(2)
    v_mfma_f32_16x16x32_bf16 v[104:107], v[52:55], v[24:27], v[104:107]
    v_mfma_f32_16x16x32_bf16 v[108:111], v[52:55], v[28:31], v[108:111]
    s_waitcnt lgkmcnt(0)
    v_mfma_f32_16x16x32_bf16 v[112:115], v[56:59], v[24:27], v[112:115]
    v_mfma_f32_16x16x32_bf16 v[116:119], v[56:59], v[28:31], v[116:119]
    s_mul_i32 s6, s64, 40960
    s_add_u32 s84, s6, s10
    s_add_u32 s85, s84, 4096
    v_lshrrev_b32 v16, 1, v2
    v_cvt_pk_bf16_f32 v120, v80, v81
    v_cvt_pk_bf16_f32 v121, v82, v83
    v_cvt_pk_bf16_f32 v124, v84, v85
    v_cvt_pk_bf16_f32 v125, v86, v87
    v_cvt_pk_bf16_f32 v128, v88, v89
    v_cvt_pk_bf16_f32 v129, v90, v91
    v_cvt_pk_bf16_f32 v132, v92, v93
    v_cvt_pk_bf16_f32 v133, v94, v95
    v_cvt_pk_bf16_f32 v122, v96, v97
    v_cvt_pk_bf16_f32 v123, v98, v99
    v_cvt_pk_bf16_f32 v126, v100, v101
    v_cvt_pk_bf16_f32 v127, v102, v103
    v_cvt_pk_bf16_f32 v130, v104, v105
    v_cvt_pk_bf16_f32 v131, v106, v107
    v_cvt_pk_bf16_f32 v134, v108, v109
    v_cvt_pk_bf16_f32 v135, v110, v111
    v_cvt_pk_bf16_f32 v136, v112, v113
    v_cvt_pk_bf16_f32 v137, v114, v115
    v_cvt_pk_bf16_f32 v138, v116, v117
    v_cvt_pk_bf16_f32 v139, v118, v119
    s_cmp_eq_u32 s64, 0
    s_cbranch_scc1 A_XS0
    buffer_store_dwordx4 v[120:123], v2, s[44:47], s84 offen offset:0 sc1
    buffer_store_dwordx2 v[136:137], v16, s[44:47], s85 offen offset:0 sc1
A_XS0:
    s_cmp_eq_u32 s64, 1
    s_cbranch_scc1 A_XS1
    buffer_store_dwordx4 v[124:127], v2, s[44:47], s84 offen offset:1024 sc1
    buffer_store_dwordx2 v[138:139], v16, s[44:47], s85 offen offset:512 sc1
A_XS1:
    s_cmp_eq_u32 s64, 2
    s_cbranch_scc1 A_XS2
    buffer_store_dwordx4 v[128:131], v2, s[44:47], s84 offen offset:2048 sc1
A_XS2:
    s_cmp_eq_u32 s64, 3
    s_cbranch_scc1 A_XS3
    buffer_store_dwordx4 v[132:135], v2, s[44:47], s84 offen offset:3072 sc1
A_XS3:
    s_mov_b32 s55, 4000
    s_mov_b32 s86, 0xffff0000
    s_cmp_lg_u32 s64, 0
    s_cbranch_scc1 A_XL0
A_XR0:
    buffer_load_dwordx4 v[24:27], v2, s[44:47], s73 offen offset:0 sc1
    s_add_u32 s6, s73, 4096
    buffer_load_dwordx2 v[28:29], v16, s[44:47], s6 offen offset:0 sc1
    buffer_load_dwordx4 v[32:35], v2, s[44:47], s74 offen offset:0 sc1
    s_add_u32 s6, s74, 4096
    buffer_load_dwordx2 v[36:37], v16, s[44:47], s6 offen offset:0 sc1
    buffer_load_dwordx4 v[40:43], v2, s[44:47], s75 offen offset:0 sc1
    s_add_u32 s6, s75, 4096
    buffer_load_dwordx2 v[44:45], v16, s[44:47], s6 offen offset:0 sc1
    s_waitcnt vmcnt(5)
    v_lshlrev_b32 v60, 16, v24
    v_and_b32 v61, s86, v24
    v_add_f32 v48, v60, v80
    v_add_f32 v49, v61, v81
    v_lshlrev_b32 v60, 16, v25
    v_and_b32 v61, s86, v25
    v_add_f32 v50, v60, v82
    v_add_f32 v51, v61, v83
    v_lshlrev_b32 v60, 16, v26
    v_and_b32 v61, s86, v26
    v_add_f32 v52, v60, v96
    v_add_f32 v53, v61, v97
    v_lshlrev_b32 v60, 16, v27
    v_and_b32 v61, s86, v27
    v_add_f32 v54, v60, v98
    v_add_f32 v55, v61, v99
    s_waitcnt vmcnt(4)
    v_lshlrev_b32 v60, 16, v28
    v_and_b32 v61, s86, v28
    v_add_f32 v56, v60, v112
    v_add_f32 v57, v61, v113
    v_lshlrev_b32 v60, 16, v29
    v_and_b32 v61, s86, v29
    v_add_f32 v58, v60, v114
    v_add_f32 v59, v61, v115
    s_waitcnt vmcnt(3)
    v_lshlrev_b32 v60, 16, v32
    v_and_b32 v61, s86, v32
    v_add_f32 v48, v60, v48
    v_add_f32 v49, v61, v49
    v_lshlrev_b32 v60, 16, v33
    v_and_b32 v61, s86, v33
    v_add_f32 v50, v60, v50
    v_add_f32 v51, v61, v51
    v_lshlrev_b32 v60, 16, v34
    v_and_b32 v61, s86, v34
    v_add_f32 v52, v60, v52
    v_add_f32 v53, v61, v53
    v_lshlrev_b32 v60, 16, v35
    v_and_b32 v61, s86, v35
    v_add_f32 v54, v60, v54
    v_add_f32 v55, v61, v55
    s_waitcnt vmcnt(2)
    v_lshlrev_b32 v60, 16, v36
    v_and_b32 v61, s86, v36
    v_add_f32 v56, v60, v56
    v_add_f32 v57, v61, v57
    v_lshlrev_b32 v60, 16, v37
    v_and_b32 v61, s86, v37
    v_add_f32 v58, v60, v58
    v_add_f32 v59, v61, v59
    s_waitcnt vmcnt(1)
    v_lshlrev_b32 v60, 16, v40
    v_and_b32 v61, s86, v40
    v_add_f32 v48, v60, v48
    v_add_f32 v49, v61, v49
    v_lshlrev_b32 v60, 16, v41
    v_and_b32 v61, s86, v41
    v_add_f32 v50, v60, v50
    v_add_f32 v51, v61, v51
    v_lshlrev_b32 v60, 16, v42
    v_and_b32 v61, s86, v42
    v_add_f32 v52, v60, v52
    v_add_f32 v53, v61, v53
    v_lshlrev_b32 v60, 16, v43
    v_and_b32 v61, s86, v43
    v_add_f32 v54, v60, v54
    v_add_f32 v55, v61, v55
    s_waitcnt vmcnt(0)
    v_lshlrev_b32 v60, 16, v44
    v_and_b32 v61, s86, v44
    v_add_f32 v56, v60, v56
    v_add_f32 v57, v61, v57
    v_lshlrev_b32 v60, 16, v45
    v_and_b32 v61, s86, v45
    v_add_f32 v58, v60, v58
    v_add_f32 v59, v61, v59
    v_add_f32 v62, v48, v49
    v_add_f32 v62, v62, v50
    v_add_f32 v62, v62, v51
    v_add_f32 v62, v62, v52
    v_add_f32 v62, v62, v53
    v_add_f32 v62, v62, v54
    v_add_f32 v62, v62, v55
    v_add_f32 v62, v62, v56
    v_add_f32 v62, v62, v57
    v_add_f32 v62, v62, v58
    v_add_f32 v62, v62, v59
    v_cmp_u_f32 vcc, v62, v62
    s_cbranch_vccz A_XK0
    s_sleep 4
    s_sub_u32 s55, s55, 1
    s_cmp_lg_u32 s55, 0
    s_cbranch_scc1 A_XR0
A_XK0:
    v_cvt_pk_bf16_f32 v48, v48, v49
    v_cvt_pk_bf16_f32 v49, v50, v51
    buffer_store_dwordx2 v[48:49], v10, s[60:63], 0 offen offset:0
    v_cvt_pk_bf16_f32 v52, v52, v53
    v_cvt_pk_bf16_f32 v53, v54, v55
    buffer_store_dwordx2 v[52:53], v10, s[60:63], 0 offen offset:64
    v_cvt_pk_bf16_f32 v56, v56, v57
    v_cvt_pk_bf16_f32 v57, v58, v59
    buffer_store_dwordx2 v[56:57], v10, s[60:63], 0 offen offset:128
    s_branch F_XLD
A_XL0:
    s_cmp_lg_u32 s64, 1
    s_cbranch_scc1 A_XL1
A_XR1:
    buffer_load_dwordx4 v[24:27], v2, s[44:47], s72 offen offset:1024 sc1
    s_add_u32 s6, s72, 4096
    buffer_load_dwordx2 v[28:29], v16, s[44:47], s6 offen offset:512 sc1
    buffer_load_dwordx4 v[32:35], v2, s[44:47], s74 offen offset:1024 sc1
    s_add_u32 s6, s74, 4096
    buffer_load_dwordx2 v[36:37], v16, s[44:47], s6 offen offset:512 sc1
    buffer_load_dwordx4 v[40:43], v2, s[44:47], s75 offen offset:1024 sc1
    s_add_u32 s6, s75, 4096
    buffer_load_dwordx2 v[44:45], v16, s[44:47], s6 offen offset:512 sc1
    s_waitcnt vmcnt(5)
    v_lshlrev_b32 v60, 16, v24
    v_and_b32 v61, s86, v24
    v_add_f32 v48, v60, v84
    v_add_f32 v49, v61, v85
    v_lshlrev_b32 v60, 16, v25
    v_and_b32 v61, s86, v25
    v_add_f32 v50, v60, v86
    v_add_f32 v51, v61, v87
    v_lshlrev_b32 v60, 16, v26
    v_and_b32 v61, s86, v26
    v_add_f32 v52, v60, v100
    v_add_f32 v53, v61, v101
    v_lshlrev_b32 v60, 16, v27
    v_and_b32 v61, s86, v27
    v_add_f32 v54, v60, v102
    v_add_f32 v55, v61, v103
    s_waitcnt vmcnt(4)
    v_lshlrev_b32 v60, 16, v28
    v_and_b32 v61, s86, v28
    v_add_f32 v56, v60, v116
    v_add_f32 v57, v61, v117
    v_lshlrev_b32 v60, 16, v29
    v_and_b32 v61, s86, v29
    v_add_f32 v58, v60, v118
    v_add_f32 v59, v61, v119
    s_waitcnt vmcnt(3)
    v_lshlrev_b32 v60, 16, v32
    v_and_b32 v61, s86, v32
    v_add_f32 v48, v60, v48
    v_add_f32 v49, v61, v49
    v_lshlrev_b32 v60, 16, v33
    v_and_b32 v61, s86, v33
    v_add_f32 v50, v60, v50
    v_add_f32 v51, v61, v51
    v_lshlrev_b32 v60, 16, v34
    v_and_b32 v61, s86, v34
    v_add_f32 v52, v60, v52
    v_add_f32 v53, v61, v53
    v_lshlrev_b32 v60, 16, v35
    v_and_b32 v61, s86, v35
    v_add_f32 v54, v60, v54
    v_add_f32 v55, v61, v55
    s_waitcnt vmcnt(2)
    v_lshlrev_b32 v60, 16, v36
    v_and_b32 v61, s86, v36
    v_add_f32 v56, v60, v56
    v_add_f32 v57, v61, v57
    v_lshlrev_b32 v60, 16, v37
    v_and_b32 v61, s86, v37
    v_add_f32 v58, v60, v58
    v_add_f32 v59, v61, v59
    s_waitcnt vmcnt(1)
    v_lshlrev_b32 v60, 16, v40
    v_and_b32 v61, s86, v40
    v_add_f32 v48, v60, v48
    v_add_f32 v49, v61, v49
    v_lshlrev_b32 v60, 16, v41
    v_and_b32 v61, s86, v41
    v_add_f32 v50, v60, v50
    v_add_f32 v51, v61, v51
    v_lshlrev_b32 v60, 16, v42
    v_and_b32 v61, s86, v42
    v_add_f32 v52, v60, v52
    v_add_f32 v53, v61, v53
    v_lshlrev_b32 v60, 16, v43
    v_and_b32 v61, s86, v43
    v_add_f32 v54, v60, v54
    v_add_f32 v55, v61, v55
    s_waitcnt vmcnt(0)
    v_lshlrev_b32 v60, 16, v44
    v_and_b32 v61, s86, v44
    v_add_f32 v56, v60, v56
    v_add_f32 v57, v61, v57
    v_lshlrev_b32 v60, 16, v45
    v_and_b32 v61, s86, v45
    v_add_f32 v58, v60, v58
    v_add_f32 v59, v61, v59
    v_add_f32 v62, v48, v49
    v_add_f32 v62, v62, v50
    v_add_f32 v62, v62, v51
    v_add_f32 v62, v62, v52
    v_add_f32 v62, v62, v53
    v_add_f32 v62, v62, v54
    v_add_f32 v62, v62, v55
    v_add_f32 v62, v62, v56
    v_add_f32 v62, v62, v57
    v_add_f32 v62, v62, v58
    v_add_f32 v62, v62, v59
    v_cmp_u_f32 vcc, v62, v62
    s_cbranch_vccz A_XK1
    s_sleep 4
    s_sub_u32 s55, s55, 1
    s_cmp_lg_u32 s55, 0
    s_cbranch_scc1 A_XR1
A_XK1:
    v_cvt_pk_bf16_f32 v48, v48, v49
    v_cvt_pk_bf16_f32 v49, v50, v51
    buffer_store_dwordx2 v[48:49], v10, s[60:63], s76 offen offset:0
    v_cvt_pk_bf16_f32 v52, v52, v53
    v_cvt_pk_bf16_f32 v53, v54, v55
    buffer_store_dwordx2 v[52:53], v10, s[60:63], s76 offen offset:64
    v_cvt_pk_bf16_f32 v56, v56, v57
    v_cvt_pk_bf16_f32 v57, v58, v59
    buffer_store_dwordx2 v[56:57], v10, s[60:63], s76 offen offset:128
    s_branch F_XLD
A_XL1:
    s_cmp_lg_u32 s64, 2
    s_cbranch_scc1 A_XL2
A_XR2:
    buffer_load_dwordx4 v[24:27], v2, s[44:47], s72 offen offset:2048 sc1
    buffer_load_dwordx4 v[32:35], v2, s[44:47], s73 offen offset:2048 sc1
    buffer_load_dwordx4 v[40:43], v2, s[44:47], s75 offen offset:2048 sc1
    s_waitcnt vmcnt(2)
    v_lshlrev_b32 v60, 16, v24
    v_and_b32 v61, s86, v24
    v_add_f32 v48, v60, v88
    v_add_f32 v49, v61, v89
    v_lshlrev_b32 v60, 16, v25
    v_and_b32 v61, s86, v25
    v_add_f32 v50, v60, v90
    v_add_f32 v51, v61, v91
    v_lshlrev_b32 v60, 16, v26
    v_and_b32 v61, s86, v26
    v_add_f32 v52, v60, v104
    v_add_f32 v53, v61, v105
    v_lshlrev_b32 v60, 16, v27
    v_and_b32 v61, s86, v27
    v_add_f32 v54, v60, v106
    v_add_f32 v55, v61, v107
    s_waitcnt vmcnt(1)
    v_lshlrev_b32 v60, 16, v32
    v_and_b32 v61, s86, v32
    v_add_f32 v48, v60, v48
    v_add_f32 v49, v61, v49
    v_lshlrev_b32 v60, 16, v33
    v_and_b32 v61, s86, v33
    v_add_f32 v50, v60, v50
    v_add_f32 v51, v61, v51
    v_lshlrev_b32 v60, 16, v34
    v_and_b32 v61, s86, v34
    v_add_f32 v52, v60, v52
    v_add_f32 v53, v61, v53
    v_lshlrev_b32 v60, 16, v35
    v_and_b32 v61, s86, v35
    v_add_f32 v54, v60, v54
    v_add_f32 v55, v61, v55
    s_waitcnt vmcnt(0)
    v_lshlrev_b32 v60, 16, v40
    v_and_b32 v61, s86, v40
    v_add_f32 v48, v60, v48
    v_add_f32 v49, v61, v49
    v_lshlrev_b32 v60, 16, v41
    v_and_b32 v61, s86, v41
    v_add_f32 v50, v60, v50
    v_add_f32 v51, v61, v51
    v_lshlrev_b32 v60, 16, v42
    v_and_b32 v61, s86, v42
    v_add_f32 v52, v60, v52
    v_add_f32 v53, v61, v53
    v_lshlrev_b32 v60, 16, v43
    v_and_b32 v61, s86, v43
    v_add_f32 v54, v60, v54
    v_add_f32 v55, v61, v55
    v_add_f32 v62, v48, v49
    v_add_f32 v62, v62, v50
    v_add_f32 v62, v62, v51
    v_add_f32 v62, v62, v52
    v_add_f32 v62, v62, v53
    v_add_f32 v62, v62, v54
    v_add_f32 v62, v62, v55
    v_cmp_u_f32 vcc, v62, v62
    s_cbranch_vccz A_XK2
    s_sleep 4
    s_sub_u32 s55, s55, 1
    s_cmp_lg_u32 s55, 0
    s_cbranch_scc1 A_XR2
A_XK2:
    v_cvt_pk_bf16_f32 v48, v48, v49
    v_cvt_pk_bf16_f32 v49, v50, v51
    buffer_store_dwordx2 v[48:49], v10, s[60:63], 0 offen offset:32
    v_cvt_pk_bf16_f32 v52, v52, v53
    v_cvt_pk_bf16_f32 v53, v54, v55
    buffer_store_dwordx2 v[52:53], v10, s[60:63], 0 offen offset:96
    s_branch F_XLD
A_XL2:
A_XR3:
    buffer_load_dwordx4 v[24:27], v2, s[44:47], s72 offen offset:3072 sc1
    buffer_load_dwordx4 v[32:35], v2, s[44:47], s73 offen offset:3072 sc1
    buffer_load_dwordx4 v[40:43], v2, s[44:47], s74 offen offset:3072 sc1
    s_waitcnt vmcnt(2)
    v_lshlrev_b32 v60, 16, v24
    v_and_b32 v61, s86, v24
    v_add_f32 v48, v60, v92
    v_add_f32 v49, v61, v93
    v_lshlrev_b32 v60, 16, v25
    v_and_b32 v61, s86, v25
    v_add_f32 v50, v60, v94
    v_add_f32 v51, v61, v95
    v_lshlrev_b32 v60, 16, v26
    v_and_b32 v61, s86, v26
    v_add_f32 v52, v60, v108
    v_add_f32 v53, v61, v109
    v_lshlrev_b32 v60, 16, v27
    v_and_b32 v61, s86, v27
    v_add_f32 v54, v60, v110
    v_add_f32 v55, v61, v111
    s_waitcnt vmcnt(1)
    v_lshlrev_b32 v60, 16, v32
    v_and_b32 v61, s86, v32
    v_add_f32 v48, v60, v48
    v_add_f32 v49, v61, v49
    v_lshlrev_b32 v60, 16, v33
    v_and_b32 v61, s86, v33
    v_add_f32 v50, v60, v50
    v_add_f32 v51, v61, v51
    v_lshlrev_b32 v60, 16, v34
    v_and_b32 v61, s86, v34
    v_add_f32 v52, v60, v52
    v_add_f32 v53, v61, v53
    v_lshlrev_b32 v60, 16, v35
    v_and_b32 v61, s86, v35
    v_add_f32 v54, v60, v54
    v_add_f32 v55, v61, v55
    s_waitcnt vmcnt(0)
    v_lshlrev_b32 v60, 16, v40
    v_and_b32 v61, s86, v40
    v_add_f32 v48, v60, v48
    v_add_f32 v49, v61, v49
    v_lshlrev_b32 v60, 16, v41
    v_and_b32 v61, s86, v41
    v_add_f32 v50, v60, v50
    v_add_f32 v51, v61, v51
    v_lshlrev_b32 v60, 16, v42
    v_and_b32 v61, s86, v42
    v_add_f32 v52, v60, v52
    v_add_f32 v53, v61, v53
    v_lshlrev_b32 v60, 16, v43
    v_and_b32 v61, s86, v43
    v_add_f32 v54, v60, v54
    v_add_f32 v55, v61, v55
    v_add_f32 v62, v48, v49
    v_add_f32 v62, v62, v50
    v_add_f32 v62, v62, v51
    v_add_f32 v62, v62, v52
    v_add_f32 v62, v62, v53
    v_add_f32 v62, v62, v54
    v_add_f32 v62, v62, v55
    v_cmp_u_f32 vcc, v62, v62
    s_cbranch_vccz A_XK3
    s_sleep 4
    s_sub_u32 s55, s55, 1
    s_cmp_lg_u32 s55, 0
    s_cbranch_scc1 A_XR3
A_XK3:
    v_cvt_pk_bf16_f32 v48, v48, v49
    v_cvt_pk_bf16_f32 v49, v50, v51
    buffer_store_dwordx2 v[48:49], v10, s[60:63], s76 offen offset:32
    v_cvt_pk_bf16_f32 v52, v52, v53
    v_cvt_pk_bf16_f32 v53, v54, v55
    buffer_store_dwordx2 v[52:53], v10, s[60:63], s76 offen offset:96
    s_branch F_XLD
G_B:
    ds_read_b128 v[24:27], v14 offset:0
    ds_read_b128 v[28:31], v14 offset:1024
    ds_read_b64_tr_b16 v[40:41], v12 offset:0
    ds_read_b64_tr_b16 v[42:43], v12 offset:1152
    ds_read_b64_tr_b16 v[44:45], v12 offset:32
    ds_read_b64_tr_b16 v[46:47], v12 offset:1184
    ds_read_b64_tr_b16 v[48:49], v12 offset:64
    ds_read_b64_tr_b16 v[50:51], v12 offset:1216
    ds_read_b64_tr_b16 v[52:53], v12 offset:96
    ds_read_b64_tr_b16 v[54:55], v12 offset:1248
    s_waitcnt lgkmcnt(6)
    v_mfma_f32_16x16x32_bf16 v[80:83], v[40:43], v[24:27], 0
    ds_read_b128 v[32:35], v14 offset:8192
    v_mfma_f32_16x16x32_bf16 v[84:87], v[40:43], v[28:31], 0
    ds_read_b128 v[36:39], v14 offset:9216
    ds_read_b64_tr_b16 v[60:61], v12 offset:9728
    s_waitcnt lgkmcnt(7)
    v_mfma_f32_16x16x32_bf16 v[88:91], v[44:47], v[24:27], 0
    ds_read_b64_tr_b16 v[62:63], v12 offset:10880
    v_mfma_f32_16x16x32_bf16 v[92:95], v[44:47], v[28:31], 0
    ds_read_b64_tr_b16 v[64:65], v12 offset:9760
    ds_read_b64_tr_b16 v[66:67], v12 offset:10912
    s_waitcnt lgkmcnt(8)
    v_mfma_f32_16x16x32_bf16 v[96:99], v[48:51], v[24:27], 0
    ds_read_b64_tr_b16 v[68:69], v12 offset:9792
    v_mfma_f32_16x16x32_bf16 v[100:103], v[48:51], v[28:31], 0
    ds_read_b64_tr_b16 v[70:71], v12 offset:10944
    s_waitcnt lgkmcnt(8)
    v_mfma_f32_16x16x32_bf16 v[104:107], v[52:55], v[24:27], 0
    ds_read_b64_tr_b16 v[72:73], v12 offset:9824
    v_mfma_f32_16x16x32_bf16 v[108:111], v[52:55], v[28:31], 0
    ds_read_b64_tr_b16 v[74:75], v12 offset:10976
    s_waitcnt lgkmcnt(6)
    v_mfma_f32_16x16x32_bf16 v[80:83], v[60:63], v[32:35], v[80:83]
    s_waitcnt vmcnt(4)
    s_waitcnt lgkmcnt(0)
    s_barrier
    ds_read_b128 v[24:27], v14 offset:16384
    v_mfma_f32_16x16x32_bf16 v[84:87], v[60:63], v[36:39], v[84:87]
    ds_read_b128 v[28:31], v14 offset:17408
    ds_read_b64_tr_b16 v[40:41], v12 offset:19456
    v_mfma_f32_16x16x32_bf16 v[88:91], v[64:67], v[32:35], v[88:91]
    ds_read_b64_tr_b16 v[42:43], v12 offset:20608
    v_mfma_f32_16x16x32_bf16 v[92:95], v[64:67], v[36:39], v[92:95]
    ds_read_b64_tr_b16 v[44:45], v12 offset:19488
    ds_read_b64_tr_b16 v[46:47], v12 offset:20640
    v_mfma_f32_16x16x32_bf16 v[96:99], v[68:71], v[32:35], v[96:99]
    ds_read_b64_tr_b16 v[48:49], v12 offset:19520
    v_mfma_f32_16x16x32_bf16 v[100:103], v[68:71], v[36:39], v[100:103]
    ds_read_b64_tr_b16 v[50:51], v12 offset:20672
    s_add_u32 m0, s97, 0
    s_add_u32 s8, s89, 0
    buffer_load_dwordx4 v2, s[44:47], s8 offen sc1 lds
    v_mfma_f32_16x16x32_bf16 v[104:107], v[72:75], v[32:35], v[104:107]
    ds_read_b64_tr_b16 v[52:53], v12 offset:19552
    s_add_u32 m0, s97, 8192
    s_add_u32 s8, s89, 4096
    buffer_load_dwordx4 v2, s[44:47], s8 offen sc1 lds
    v_mfma_f32_16x16x32_bf16 v[108:111], v[72:75], v[36:39], v[108:111]
    ds_read_b64_tr_b16 v[54:55], v12 offset:20704
    s_waitcnt lgkmcnt(6)
    v_mfma_f32_16x16x32_bf16 v[80:83], v[40:43], v[24:27], v[80:83]
    ds_read_b128 v[32:35], v14 offset:24576
    v_mfma_f32_16x16x32_bf16 v[84:87], v[40:43], v[28:31], v[84:87]
    ds_read_b128 v[36:39], v14 offset:25600
    ds_read_b64_tr_b16 v[60:61], v12 offset:29184
    s_waitcnt lgkmcnt(7)
    v_mfma_f32_16x16x32_bf16 v[88:91], v[44:47], v[24:27], v[88:91]
    ds_read_b64_tr_b16 v[62:63], v12 offset:30336
    s_add_u32 m0, s68, 139264
    s_mov_b32 s9, 73728
    buffer_load_dwordx4 v19, s[56:59], s9 offen sc1 lds
    v_mfma_f32_16x16x32_bf16 v[92:95], v[44:47], v[28:31], v[92:95]
    ds_read_b64_tr_b16 v[64:65], v12 offset:29216
    ds_read_b64_tr_b16 v[66:67], v12 offset:30368
    s_add_u32 m0, s68, 65536
    s_mov_b32 s9, 77824
    buffer_load_dwordx4 v19, s[56:59], s9 offen sc1 lds
    s_waitcnt lgkmcnt(8)
    v_mfma_f32_16x16x32_bf16 v[96:99], v[48:51], v[24:27], v[96:99]
    ds_read_b64_tr_b16 v[68:69], v12 offset:29248
    s_add_u32 m0, s68, 69632
    s_mov_b32 s9, 81920
    buffer_load_dwordx4 v19, s[56:59], s9 offen sc1 lds
    v_mfma_f32_16x16x32_bf16 v[100:103], v[48:51], v[28:31], v[100:103]
    ds_read_b64_tr_b16 v[70:71], v12 offset:30400
    s_add_u32 m0, s68, 73728
    s_mov_b32 s9, 86016
    buffer_load_dwordx4 v19, s[56:59], s9 offen sc1 lds
    s_waitcnt lgkmcnt(8)
    v_mfma_f32_16x16x32_bf16 v[104:107], v[52:55], v[24:27], v[104:107]
    ds_read_b64_tr_b16 v[72:73], v12 offset:29280
    s_add_u32 m0, s68, 77824
    s_mov_b32 s9, 90112
    buffer_load_dwordx4 v19, s[56:59], s9 offen sc1 lds
    v_mfma_f32_16x16x32_bf16 v[108:111], v[52:55], v[28:31], v[108:111]
    ds_read_b64_tr_b16 v[74:75], v12 offset:30432
    s_waitcnt lgkmcnt(6)
    v_mfma_f32_16x16x32_bf16 v[80:83], v[60:63], v[32:35], v[80:83]
    s_waitcnt vmcnt(9)
    s_waitcnt lgkmcnt(0)
    s_barrier
    ds_read_b128 v[24:27], v14 offset:32768
    v_mfma_f32_16x16x32_bf16 v[84:87], v[60:63], v[36:39], v[84:87]
    ds_read_b128 v[28:31], v14 offset:33792
    ds_read_b64_tr_b16 v[40:41], v13 offset:0
    v_mfma_f32_16x16x32_bf16 v[88:91], v[64:67], v[32:35], v[88:91]
    ds_read_b64_tr_b16 v[42:43], v13 offset:1152
    v_mfma_f32_16x16x32_bf16 v[92:95], v[64:67], v[36:39], v[92:95]
    ds_read_b64_tr_b16 v[44:45], v13 offset:32
    ds_read_b64_tr_b16 v[46:47], v13 offset:1184
    v_mfma_f32_16x16x32_bf16 v[96:99], v[68:71], v[32:35], v[96:99]
    ds_read_b64_tr_b16 v[48:49], v13 offset:64
    v_mfma_f32_16x16x32_bf16 v[100:103], v[68:71], v[36:39], v[100:103]
    ds_read_b64_tr_b16 v[50:51], v13 offset:1216
    s_add_u32 m0, s97, 16384
    s_add_u32 s8, s89, 8192
    buffer_load_dwordx4 v2, s[44:47], s8 offen sc1 lds
    v_mfma_f32_16x16x32_bf16 v[104:107], v[72:75], v[32:35], v[104:107]
    ds_read_b64_tr_b16 v[52:53], v13 offset:96
    s_add_u32 m0, s97, 24576
    s_add_u32 s8, s89, 12288
    buffer_load_dwordx4 v2, s[44:47], s8 offen sc1 lds
    v_mfma_f32_16x16x32_bf16 v[108:111], v[72:75], v[36:39], v[108:111]
    ds_read_b64_tr_b16 v[54:55], v13 offset:1248
    s_waitcnt lgkmcnt(6)
    v_mfma_f32_16x16x32_bf16 v[80:83], v[40:43], v[24:27], v[80:83]
    ds_read_b128 v[32:35], v14 offset:40960
    v_mfma_f32_16x16x32_bf16 v[84:87], v[40:43], v[28:31], v[84:87]
    ds_read_b128 v[36:39], v14 offset:41984
    ds_read_b64_tr_b16 v[60:61], v13 offset:9728
    s_waitcnt lgkmcnt(7)
    v_mfma_f32_16x16x32_bf16 v[88:91], v[44:47], v[24:27], v[88:91]
    ds_read_b64_tr_b16 v[62:63], v13 offset:10880
    s_add_u32 m0, s68, 81920
    s_mov_b32 s9, 94208
    buffer_load_dwordx4 v19, s[56:59], s9 offen sc1 lds
    v_mfma_f32_16x16x32_bf16 v[92:95], v[44:47], v[28:31], v[92:95]
    ds_read_b64_tr_b16 v[64:65], v13 offset:9760
    ds_read_b64_tr_b16 v[66:67], v13 offset:10912
    s_add_u32 m0, s68, 86016
    s_mov_b32 s9, 98304
    buffer_load_dwordx4 v19, s[56:59], s9 offen sc1 lds
    s_waitcnt lgkmcnt(8)
    v_mfma_f32_16x16x32_bf16 v[96:99], v[48:51], v[24:27], v[96:99]
    ds_read_b64_tr_b16 v[68:69], v13 offset:9792
    s_add_u32 m0, s68, 90112
    s_mov_b32 s9, 102400
    buffer_load_dwordx4 v19, s[56:59], s9 offen sc1 lds
    v_mfma_f32_16x16x32_bf16 v[100:103], v[48:51], v[28:31], v[100:103]
    ds_read_b64_tr_b16 v[70:71], v13 offset:10944
    s_add_u32 m0, s68, 94208
    s_mov_b32 s9, 106496
    buffer_load_dwordx4 v19, s[56:59], s9 offen sc1 lds
    s_waitcnt lgkmcnt(8)
    v_mfma_f32_16x16x32_bf16 v[104:107], v[52:55], v[24:27], v[104:107]
    ds_read_b64_tr_b16 v[72:73], v13 offset:9824
    s_add_u32 m0, s68, 98304
    s_mov_b32 s9, 110592
    buffer_load_dwordx4 v19, s[56:59], s9 offen sc1 lds
    v_mfma_f32_16x16x32_bf16 v[108:111], v[52:55], v[28:31], v[108:111]
    ds_read_b64_tr_b16 v[74:75], v13 offset:10976
    s_waitcnt lgkmcnt(6)
    v_mfma_f32_16x16x32_bf16 v[80:83], v[60:63], v[32:35], v[80:83]
    s_waitcnt vmcnt(11)
    s_waitcnt lgkmcnt(0)
    s_barrier
    ds_read_b128 v[24:27], v14 offset:49152
    v_mfma_f32_16x16x32_bf16 v[84:87], v[60:63], v[36:39], v[84:87]
    ds_read_b128 v[28:31], v14 offset:50176
    ds_read_b64_tr_b16 v[40:41], v13 offset:19456
    v_mfma_f32_16x16x32_bf16 v[88:91], v[64:67], v[32:35], v[88:91]
    ds_read_b64_tr_b16 v[42:43], v13 offset:20608
    v_mfma_f32_16x16x32_bf16 v[92:95], v[64:67], v[36:39], v[92:95]
    ds_read_b64_tr_b16 v[44:45], v13 offset:19488
    ds_read_b64_tr_b16 v[46:47], v13 offset:20640
    v_mfma_f32_16x16x32_bf16 v[96:99], v[68:71], v[32:35], v[96:99]
    ds_read_b64_tr_b16 v[48:49], v13 offset:19520
    v_mfma_f32_16x16x32_bf16 v[100:103], v[68:71], v[36:39], v[100:103]
    ds_read_b64_tr_b16 v[50:51], v13 offset:20672
    s_add_u32 m0, s97, 32768
    s_add_u32 s8, s89, 16384
    buffer_load_dwordx4 v2, s[44:47], s8 offen sc1 lds
    v_mfma_f32_16x16x32_bf16 v[104:107], v[72:75], v[32:35], v[104:107]
    ds_read_b64_tr_b16 v[52:53], v13 offset:19552
    s_add_u32 m0, s97, 40960
    s_add_u32 s8, s89, 20480
    buffer_load_dwordx4 v2, s[44:47], s8 offen sc1 lds
    v_mfma_f32_16x16x32_bf16 v[108:111], v[72:75], v[36:39], v[108:111]
    ds_read_b64_tr_b16 v[54:55], v13 offset:20704
    s_waitcnt lgkmcnt(6)
    v_mfma_f32_16x16x32_bf16 v[80:83], v[40:43], v[24:27], v[80:83]
    ds_read_b128 v[32:35], v14 offset:57344
    v_mfma_f32_16x16x32_bf16 v[84:87], v[40:43], v[28:31], v[84:87]
    ds_read_b128 v[36:39], v14 offset:58368
    ds_read_b64_tr_b16 v[60:61], v13 offset:29184
    s_waitcnt lgkmcnt(7)
    v_mfma_f32_16x16x32_bf16 v[88:91], v[44:47], v[24:27], v[88:91]
    ds_read_b64_tr_b16 v[62:63], v13 offset:30336
    s_add_u32 m0, s68, 102400
    s_mov_b32 s9, 114688
    buffer_load_dwordx4 v19, s[56:59], s9 offen sc1 lds
    v_mfma_f32_16x16x32_bf16 v[92:95], v[44:47], v[28:31], v[92:95]
    ds_read_b64_tr_b16 v[64:65], v13 offset:29216
    ds_read_b64_tr_b16 v[66:67], v13 offset:30368
    s_add_u32 m0, s68, 106496
    s_mov_b32 s9, 118784
    buffer_load_dwordx4 v19, s[56:59], s9 offen sc1 lds
    s_waitcnt lgkmcnt(8)
    v_mfma_f32_16x16x32_bf16 v[96:99], v[48:51], v[24:27], v[96:99]
    ds_read_b64_tr_b16 v[68:69], v13 offset:29248
    s_add_u32 m0, s68, 110592
    s_mov_b32 s9, 122880
    buffer_load_dwordx4 v19, s[56:59], s9 offen sc1 lds
    v_mfma_f32_16x16x32_bf16 v[100:103], v[48:51], v[28:31], v[100:103]
    ds_read_b64_tr_b16 v[70:71], v13 offset:30400
    s_add_u32 m0, s68, 114688
    s_mov_b32 s9, 126976
    buffer_load_dwordx4 v19, s[56:59], s9 offen sc1 lds
    s_waitcnt lgkmcnt(8)
    v_mfma_f32_16x16x32_bf16 v[104:107], v[52:55], v[24:27], v[104:107]
    ds_read_b64_tr_b16 v[72:73], v13 offset:29280
    s_add_u32 m0, s68, 118784
    s_mov_b32 s9, 131072
    buffer_load_dwordx4 v19, s[56:59], s9 offen sc1 lds
    v_mfma_f32_16x16x32_bf16 v[108:111], v[52:55], v[28:31], v[108:111]
    ds_read_b64_tr_b16 v[74:75], v13 offset:30432
    s_waitcnt lgkmcnt(6)
    v_mfma_f32_16x16x32_bf16 v[80:83], v[60:63], v[32:35], v[80:83]
    s_waitcnt vmcnt(11)
    s_waitcnt lgkmcnt(0)
    s_barrier
    ds_read_b128 v[24:27], v14 offset:0
    v_mfma_f32_16x16x32_bf16 v[84:87], v[60:63], v[36:39], v[84:87]
    ds_read_b128 v[28:31], v14 offset:1024
    ds_read_b64_tr_b16 v[40:41], v12 offset:0
    v_mfma_f32_16x16x32_bf16 v[88:91], v[64:67], v[32:35], v[88:91]
    ds_read_b64_tr_b16 v[42:43], v12 offset:1152
    v_mfma_f32_16x16x32_bf16 v[92:95], v[64:67], v[36:39], v[92:95]
    ds_read_b64_tr_b16 v[44:45], v12 offset:32
    ds_read_b64_tr_b16 v[46:47], v12 offset:1184
    v_mfma_f32_16x16x32_bf16 v[96:99], v[68:71], v[32:35], v[96:99]
    ds_read_b64_tr_b16 v[48:49], v12 offset:64
    v_mfma_f32_16x16x32_bf16 v[100:103], v[68:71], v[36:39], v[100:103]
    ds_read_b64_tr_b16 v[50:51], v12 offset:1216
    s_add_u32 m0, s97, 49152
    s_add_u32 s8, s89, 24576
    buffer_load_dwordx4 v2, s[44:47], s8 offen sc1 lds
    v_mfma_f32_16x16x32_bf16 v[104:107], v[72:75], v[32:35], v[104:107]
    ds_read_b64_tr_b16 v[52:53], v12 offset:96
    s_add_u32 m0, s97, 57344
    s_add_u32 s8, s89, 28672
    buffer_load_dwordx4 v2, s[44:47], s8 offen sc1 lds
    v_mfma_f32_16x16x32_bf16 v[108:111], v[72:75], v[36:39], v[108:111]
    ds_read_b64_tr_b16 v[54:55], v12 offset:1248
    s_waitcnt lgkmcnt(6)
    v_mfma_f32_16x16x32_bf16 v[80:83], v[40:43], v[24:27], v[80:83]
    ds_read_b128 v[32:35], v14 offset:8192
    v_mfma_f32_16x16x32_bf16 v[84:87], v[40:43], v[28:31], v[84:87]
    ds_read_b128 v[36:39], v14 offset:9216
    ds_read_b64_tr_b16 v[60:61], v12 offset:9728
    s_waitcnt lgkmcnt(7)
    v_mfma_f32_16x16x32_bf16 v[88:91], v[44:47], v[24:27], v[88:91]
    ds_read_b64_tr_b16 v[62:63], v12 offset:10880
    s_add_u32 m0, s68, 122880
    s_mov_b32 s9, 135168
    buffer_load_dwordx4 v19, s[56:59], s9 offen sc1 lds
    v_mfma_f32_16x16x32_bf16 v[92:95], v[44:47], v[28:31], v[92:95]
    ds_read_b64_tr_b16 v[64:65], v12 offset:9760
    ds_read_b64_tr_b16 v[66:67], v12 offset:10912
    s_add_u32 m0, s68, 126976
    s_mov_b32 s9, 139264
    buffer_load_dwordx4 v19, s[56:59], s9 offen sc1 lds
    s_waitcnt lgkmcnt(8)
    v_mfma_f32_16x16x32_bf16 v[96:99], v[48:51], v[24:27], v[96:99]
    ds_read_b64_tr_b16 v[68:69], v12 offset:9792
    s_add_u32 m0, s68, 131072
    s_mov_b32 s9, 143360
    buffer_load_dwordx4 v19, s[56:59], s9 offen sc1 lds
    v_mfma_f32_16x16x32_bf16 v[100:103], v[48:51], v[28:31], v[100:103]
    ds_read_b64_tr_b16 v[70:71], v12 offset:10944
    s_add_u32 m0, s68, 135168
    s_mov_b32 s9, 147456
    buffer_load_dwordx4 v19, s[56:59], s9 offen sc1 lds
    s_waitcnt lgkmcnt(8)
    v_mfma_f32_16x16x32_bf16 v[104:107], v[52:55], v[24:27], v[104:107]
    ds_read_b64_tr_b16 v[72:73], v12 offset:9824
    s_add_u32 m0, s68, 139264
    s_mov_b32 s9, 151552
    buffer_load_dwordx4 v19, s[56:59], s9 offen sc1 lds
    v_mfma_f32_16x16x32_bf16 v[108:111], v[52:55], v[28:31], v[108:111]
    ds_read_b64_tr_b16 v[74:75], v12 offset:10976
    s_waitcnt lgkmcnt(6)
    v_mfma_f32_16x16x32_bf16 v[80:83], v[60:63], v[32:35], v[80:83]
    s_waitcnt vmcnt(11)
    s_waitcnt lgkmcnt(0)
    s_barrier
    ds_read_b128 v[24:27], v14 offset:16384
    v_mfma_f32_16x16x32_bf16 v[84:87], v[60:63], v[36:39], v[84:87]
    ds_read_b128 v[28:31], v14 offset:17408
    ds_read_b64_tr_b16 v[40:41], v12 offset:19456
    v_mfma_f32_16x16x32_bf16 v[88:91], v[64:67], v[32:35], v[88:91]
    ds_read_b64_tr_b16 v[42:43], v12 offset:20608
    v_mfma_f32_16x16x32_bf16 v[92:95], v[64:67], v[36:39], v[92:95]
    ds_read_b64_tr_b16 v[44:45], v12 offset:19488
    ds_read_b64_tr_b16 v[46:47], v12 offset:20640
    v_mfma_f32_16x16x32_bf16 v[96:99], v[68:71], v[32:35], v[96:99]
    ds_read_b64_tr_b16 v[48:49], v12 offset:19520
    v_mfma_f32_16x16x32_bf16 v[100:103], v[68:71], v[36:39], v[100:103]
    ds_read_b64_tr_b16 v[50:51], v12 offset:20672
    s_add_u32 m0, s97, 0
    s_add_u32 s8, s90, 0
    buffer_load_dwordx4 v2, s[44:47], s8 offen sc1 lds
    v_mfma_f32_16x16x32_bf16 v[104:107], v[72:75], v[32:35], v[104:107]
    ds_read_b64_tr_b16 v[52:53], v12 offset:19552
    s_add_u32 m0, s97, 8192
    s_add_u32 s8, s90, 4096
    buffer_load_dwordx4 v2, s[44:47], s8 offen sc1 lds
    v_mfma_f32_16x16x32_bf16 v[108:111], v[72:75], v[36:39], v[108:111]
    ds_read_b64_tr_b16 v[54:55], v12 offset:20704
    s_waitcnt lgkmcnt(6)
    v_mfma_f32_16x16x32_bf16 v[80:83], v[40:43], v[24:27], v[80:83]
    ds_read_b128 v[32:35], v14 offset:24576
    v_mfma_f32_16x16x32_bf16 v[84:87], v[40:43], v[28:31], v[84:87]
    ds_read_b128 v[36:39], v14 offset:25600
    ds_read_b64_tr_b16 v[60:61], v12 offset:29184
    s_waitcnt lgkmcnt(7)
    v_mfma_f32_16x16x32_bf16 v[88:91], v[44:47], v[24:27], v[88:91]
    ds_read_b64_tr_b16 v[62:63], v12 offset:30336
    s_add_u32 m0, s68, 65536
    s_mov_b32 s9, 155648
    buffer_load_dwordx4 v19, s[56:59], s9 offen sc1 lds
    v_mfma_f32_16x16x32_bf16 v[92:95], v[44:47], v[28:31], v[92:95]
    ds_read_b64_tr_b16 v[64:65], v12 offset:29216
    ds_read_b64_tr_b16 v[66:67], v12 offset:30368
    s_add_u32 m0, s68, 69632
    s_mov_b32 s9, 159744
    buffer_load_dwordx4 v19, s[56:59], s9 offen sc1 lds
    s_waitcnt lgkmcnt(8)
    v_mfma_f32_16x16x32_bf16 v[96:99], v[48:51], v[24:27], v[96:99]
    ds_read_b64_tr_b16 v[68:69], v12 offset:29248
    s_add_u32 m0, s68, 73728
    s_mov_b32 s9, 163840
    buffer_load_dwordx4 v19, s[56:59], s9 offen sc1 lds
    v_mfma_f32_16x16x32_bf16 v[100:103], v[48:51], v[28:31], v[100:103]
    ds_read_b64_tr_b16 v[70:71], v12 offset:30400
    s_add_u32 m0, s68, 77824
    s_mov_b32 s9, 167936
    buffer_load_dwordx4 v19, s[56:59], s9 offen sc1 lds
    s_waitcnt lgkmcnt(8)
    v_mfma_f32_16x16x32_bf16 v[104:107], v[52:55], v[24:27], v[104:107]
    ds_read_b64_tr_b16 v[72:73], v12 offset:29280
    v_mfma_f32_16x16x32_bf16 v[108:111], v[52:55], v[28:31], v[108:111]
    ds_read_b64_tr_b16 v[74:75], v12 offset:30432
    s_waitcnt lgkmcnt(6)
    v_mfma_f32_16x16x32_bf16 v[80:83], v[60:63], v[32:35], v[80:83]
    s_waitcnt vmcnt(10)
    s_waitcnt lgkmcnt(0)
    s_barrier
    ds_read_b128 v[24:27], v14 offset:32768
    v_mfma_f32_16x16x32_bf16 v[84:87], v[60:63], v[36:39], v[84:87]
    ds_read_b128 v[28:31], v14 offset:33792
    ds_read_b64_tr_b16 v[40:41], v13 offset:0
    v_mfma_f32_16x16x32_bf16 v[88:91], v[64:67], v[32:35], v[88:91]
    ds_read_b64_tr_b16 v[42:43], v13 offset:1152
    v_mfma_f32_16x16x32_bf16 v[92:95], v[64:67], v[36:39], v[92:95]
    ds_read_b64_tr_b16 v[44:45], v13 offset:32
    ds_read_b64_tr_b16 v[46:47], v13 offset:1184
    v_mfma_f32_16x16x32_bf16 v[96:99], v[68:71], v[32:35], v[96:99]
    ds_read_b64_tr_b16 v[48:49], v13 offset:64
    v_mfma_f32_16x16x32_bf16 v[100:103], v[68:71], v[36:39], v[100:103]
    ds_read_b64_tr_b16 v[50:51], v13 offset:1216
    s_add_u32 m0, s97, 16384
    s_add_u32 s8, s90, 8192
    buffer_load_dwordx4 v2, s[44:47], s8 offen sc1 lds
    v_mfma_f32_16x16x32_bf16 v[104:107], v[72:75], v[32:35], v[104:107]
    ds_read_b64_tr_b16 v[52:53], v13 offset:96
    s_add_u32 m0, s97, 24576
    s_add_u32 s8, s90, 12288
    buffer_load_dwordx4 v2, s[44:47], s8 offen sc1 lds
    v_mfma_f32_16x16x32_bf16 v[108:111], v[72:75], v[36:39], v[108:111]
    ds_read_b64_tr_b16 v[54:55], v13 offset:1248
    s_waitcnt lgkmcnt(6)
    v_mfma_f32_16x16x32_bf16 v[80:83], v[40:43], v[24:27], v[80:83]
    ds_read_b128 v[32:35], v14 offset:40960
    v_mfma_f32_16x16x32_bf16 v[84:87], v[40:43], v[28:31], v[84:87]
    ds_read_b128 v[36:39], v14 offset:41984
    ds_read_b64_tr_b16 v[60:61], v13 offset:9728
    s_waitcnt lgkmcnt(7)
    v_mfma_f32_16x16x32_bf16 v[88:91], v[44:47], v[24:27], v[88:91]
    ds_read_b64_tr_b16 v[62:63], v13 offset:10880
    s_add_u32 m0, s68, 81920
    s_mov_b32 s9, 172032
    buffer_load_dwordx4 v19, s[56:59], s9 offen sc1 lds
    v_mfma_f32_16x16x32_bf16 v[92:95], v[44:47], v[28:31], v[92:95]
    ds_read_b64_tr_b16 v[64:65], v13 offset:9760
    ds_read_b64_tr_b16 v[66:67], v13 offset:10912
    s_add_u32 m0, s68, 86016
    s_mov_b32 s9, 176128
    buffer_load_dwordx4 v19, s[56:59], s9 offen sc1 lds
    s_waitcnt lgkmcnt(8)
    v_mfma_f32_16x16x32_bf16 v[96:99], v[48:51], v[24:27], v[96:99]
    ds_read_b64_tr_b16 v[68:69], v13 offset:9792
    s_add_u32 m0, s68, 90112
    s_mov_b32 s9, 180224
    buffer_load_dwordx4 v19, s[56:59], s9 offen sc1 lds
    v_mfma_f32_16x16x32_bf16 v[100:103], v[48:51], v[28:31], v[100:103]
    ds_read_b64_tr_b16 v[70:71], v13 offset:10944
    s_add_u32 m0, s68, 94208
    s_mov_b32 s9, 184320
    buffer_load_dwordx4 v19, s[56:59], s9 offen sc1 lds
    s_waitcnt lgkmcnt(8)
    v_mfma_f32_16x16x32_bf16 v[104:107], v[52:55], v[24:27], v[104:107]
    ds_read_b64_tr_b16 v[72:73], v13 offset:9824
    s_add_u32 m0, s68, 98304
    s_mov_b32 s9, 188416
    buffer_load_dwordx4 v19, s[56:59], s9 offen sc1 lds
    v_mfma_f32_16x16x32_bf16 v[108:111], v[52:55], v[28:31], v[108:111]
    ds_read_b64_tr_b16 v[74:75], v13 offset:10976
    s_waitcnt lgkmcnt(6)
    v_mfma_f32_16x16x32_bf16 v[80:83], v[60:63], v[32:35], v[80:83]
    s_waitcnt vmcnt(13)
    s_waitcnt lgkmcnt(0)
    s_barrier
    ds_read_b128 v[24:27], v14 offset:49152
    v_mfma_f32_16x16x32_bf16 v[84:87], v[60:63], v[36:39], v[84:87]
    ds_read_b128 v[28:31], v14 offset:50176
    ds_read_b64_tr_b16 v[40:41], v13 offset:19456
    v_mfma_f32_16x16x32_bf16 v[88:91], v[64:67], v[32:35], v[88:91]
    ds_read_b64_tr_b16 v[42:43], v13 offset:20608
    v_mfma_f32_16x16x32_bf16 v[92:95], v[64:67], v[36:39], v[92:95]
    ds_read_b64_tr_b16 v[44:45], v13 offset:19488
    ds_read_b64_tr_b16 v[46:47], v13 offset:20640
    v_mfma_f32_16x16x32_bf16 v[96:99], v[68:71], v[32:35], v[96:99]
    ds_read_b64_tr_b16 v[48:49], v13 offset:19520
    v_mfma_f32_16x16x32_bf16 v[100:103], v[68:71], v[36:39], v[100:103]
    ds_read_b64_tr_b16 v[50:51], v13 offset:20672
    s_add_u32 m0, s97, 32768
    s_add_u32 s8, s90, 16384
    buffer_load_dwordx4 v2, s[44:47], s8 offen sc1 lds
    v_mfma_f32_16x16x32_bf16 v[104:107], v[72:75], v[32:35], v[104:107]
    ds_read_b64_tr_b16 v[52:53], v13 offset:19552
    s_add_u32 m0, s97, 40960
    s_add_u32 s8, s90, 20480
    buffer_load_dwordx4 v2, s[44:47], s8 offen sc1 lds
    v_mfma_f32_16x16x32_bf16 v[108:111], v[72:75], v[36:39], v[108:111]
    ds_read_b64_tr_b16 v[54:55], v13 offset:20704
    s_waitcnt lgkmcnt(6)
    v_mfma_f32_16x16x32_bf16 v[80:83], v[40:43], v[24:27], v[80:83]
    ds_read_b128 v[32:35], v14 offset:57344
    v_mfma_f32_16x16x32_bf16 v[84:87], v[40:43], v[28:31], v[84:87]
    ds_read_b128 v[36:39], v14 offset:58368
    ds_read_b64_tr_b16 v[60:61], v13 offset:29184
    s_waitcnt lgkmcnt(7)
    v_mfma_f32_16x16x32_bf16 v[88:91], v[44:47], v[24:27], v[88:91]
    ds_read_b64_tr_b16 v[62:63], v13 offset:30336
    s_add_u32 m0, s68, 102400
    s_mov_b32 s9, 192512
    buffer_load_dwordx4 v19, s[56:59], s9 offen sc1 lds
    v_mfma_f32_16x16x32_bf16 v[92:95], v[44:47], v[28:31], v[92:95]
    ds_read_b64_tr_b16 v[64:65], v13 offset:29216
    ds_read_b64_tr_b16 v[66:67], v13 offset:30368
    s_add_u32 m0, s68, 106496
    s_mov_b32 s9, 196608
    buffer_load_dwordx4 v19, s[56:59], s9 offen sc1 lds
    s_waitcnt lgkmcnt(8)
    v_mfma_f32_16x16x32_bf16 v[96:99], v[48:51], v[24:27], v[96:99]
    ds_read_b64_tr_b16 v[68:69], v13 offset:29248
    s_add_u32 m0, s68, 110592
    s_mov_b32 s9, 200704
    buffer_load_dwordx4 v19, s[56:59], s9 offen sc1 lds
    v_mfma_f32_16x16x32_bf16 v[100:103], v[48:51], v[28:31], v[100:103]
    ds_read_b64_tr_b16 v[70:71], v13 offset:30400
    s_add_u32 m0, s68, 114688
    s_mov_b32 s9, 204800
    buffer_load_dwordx4 v19, s[56:59], s9 offen sc1 lds
    s_waitcnt lgkmcnt(8)
    v_mfma_f32_16x16x32_bf16 v[104:107], v[52:55], v[24:27], v[104:107]
    ds_read_b64_tr_b16 v[72:73], v13 offset:29280
    s_add_u32 m0, s68, 118784
    s_mov_b32 s9, 208896
    buffer_load_dwordx4 v19, s[56:59], s9 offen sc1 lds
    v_mfma_f32_16x16x32_bf16 v[108:111], v[52:55], v[28:31], v[108:111]
    ds_read_b64_tr_b16 v[74:75], v13 offset:30432
    s_waitcnt lgkmcnt(6)
    v_mfma_f32_16x16x32_bf16 v[80:83], v[60:63], v[32:35], v[80:83]
    s_waitcnt vmcnt(11)
    s_waitcnt lgkmcnt(0)
    s_barrier
    ds_read_b128 v[24:27], v14 offset:0
    v_mfma_f32_16x16x32_bf16 v[84:87], v[60:63], v[36:39], v[84:87]
    ds_read_b128 v[28:31], v14 offset:1024
    ds_read_b64_tr_b16 v[40:41], v12 offset:0
    v_mfma_f32_16x16x32_bf16 v[88:91], v[64:67], v[32:35], v[88:91]
    ds_read_b64_tr_b16 v[42:43], v12 offset:1152
    v_mfma_f32_16x16x32_bf16 v[92:95], v[64:67], v[36:39], v[92:95]
    ds_read_b64_tr_b16 v[44:45], v12 offset:32
    ds_read_b64_tr_b16 v[46:47], v12 offset:1184
    v_mfma_f32_16x16x32_bf16 v[96:99], v[68:71], v[32:35], v[96:99]
    ds_read_b64_tr_b16 v[48:49], v12 offset:64
    v_mfma_f32_16x16x32_bf16 v[100:103], v[68:71], v[36:39], v[100:103]
    ds_read_b64_tr_b16 v[50:51], v12 offset:1216
    s_add_u32 m0, s97, 49152
    s_add_u32 s8, s90, 24576
    buffer_load_dwordx4 v2, s[44:47], s8 offen sc1 lds
    v_mfma_f32_16x16x32_bf16 v[104:107], v[72:75], v[32:35], v[104:107]
    ds_read_b64_tr_b16 v[52:53], v12 offset:96
    s_add_u32 m0, s97, 57344
    s_add_u32 s8, s90, 28672
    buffer_load_dwordx4 v2, s[44:47], s8 offen sc1 lds
    v_mfma_f32_16x16x32_bf16 v[108:111], v[72:75], v[36:39], v[108:111]
    ds_read_b64_tr_b16 v[54:55], v12 offset:1248
    s_waitcnt lgkmcnt(6)
    v_mfma_f32_16x16x32_bf16 v[80:83], v[40:43], v[24:27], v[80:83]
    ds_read_b128 v[32:35], v14 offset:8192
    v_mfma_f32_16x16x32_bf16 v[84:87], v[40:43], v[28:31], v[84:87]
    ds_read_b128 v[36:39], v14 offset:9216
    ds_read_b64_tr_b16 v[60:61], v12 offset:9728
    s_waitcnt lgkmcnt(7)
    v_mfma_f32_16x16x32_bf16 v[88:91], v[44:47], v[24:27], v[88:91]
    ds_read_b64_tr_b16 v[62:63], v12 offset:10880
    s_add_u32 m0, s68, 122880
    s_mov_b32 s9, 212992
    buffer_load_dwordx4 v19, s[56:59], s9 offen sc1 lds
    v_mfma_f32_16x16x32_bf16 v[92:95], v[44:47], v[28:31], v[92:95]
    ds_read_b64_tr_b16 v[64:65], v12 offset:9760
    ds_read_b64_tr_b16 v[66:67], v12 offset:10912
    s_add_u32 m0, s68, 126976
    s_mov_b32 s9, 217088
    buffer_load_dwordx4 v19, s[56:59], s9 offen sc1 lds
    s_waitcnt lgkmcnt(8)
    v_mfma_f32_16x16x32_bf16 v[96:99], v[48:51], v[24:27], v[96:99]
    ds_read_b64_tr_b16 v[68:69], v12 offset:9792
    s_add_u32 m0, s68, 131072
    s_mov_b32 s9, 221184
    buffer_load_dwordx4 v19, s[56:59], s9 offen sc1 lds
    v_mfma_f32_16x16x32_bf16 v[100:103], v[48:51], v[28:31], v[100:103]
    ds_read_b64_tr_b16 v[70:71], v12 offset:10944
    s_add_u32 m0, s68, 135168
    s_mov_b32 s9, 225280
    buffer_load_dwordx4 v19, s[56:59], s9 offen sc1 lds
    s_waitcnt lgkmcnt(8)
    v_mfma_f32_16x16x32_bf16 v[104:107], v[52:55], v[24:27], v[104:107]
    ds_read_b64_tr_b16 v[72:73], v12 offset:9824
    s_add_u32 m0, s68, 139264
    s_mov_b32 s9, 229376
    buffer_load_dwordx4 v19, s[56:59], s9 offen sc1 lds
    v_mfma_f32_16x16x32_bf16 v[108:111], v[52:55], v[28:31], v[108:111]
    ds_read_b64_tr_b16 v[74:75], v12 offset:10976
    s_waitcnt lgkmcnt(6)
    v_mfma_f32_16x16x32_bf16 v[80:83], v[60:63], v[32:35], v[80:83]
    s_waitcnt vmcnt(11)
    s_waitcnt lgkmcnt(0)
    s_barrier
    ds_read_b128 v[24:27], v14 offset:16384
    v_mfma_f32_16x16x32_bf16 v[84:87], v[60:63], v[36:39], v[84:87]
    ds_read_b128 v[28:31], v14 offset:17408
    ds_read_b64_tr_b16 v[40:41], v12 offset:19456
    v_mfma_f32_16x16x32_bf16 v[88:91], v[64:67], v[32:35], v[88:91]
    ds_read_b64_tr_b16 v[42:43], v12 offset:20608
    v_mfma_f32_16x16x32_bf16 v[92:95], v[64:67], v[36:39], v[92:95]
    ds_read_b64_tr_b16 v[44:45], v12 offset:19488
    ds_read_b64_tr_b16 v[46:47], v12 offset:20640
    v_mfma_f32_16x16x32_bf16 v[96:99], v[68:71], v[32:35], v[96:99]
    ds_read_b64_tr_b16 v[48:49], v12 offset:19520
    v_mfma_f32_16x16x32_bf16 v[100:103], v[68:71], v[36:39], v[100:103]
    ds_read_b64_tr_b16 v[50:51], v12 offset:20672
    s_add_u32 m0, s97, 0
    s_add_u32 s8, s91, 0
    buffer_load_dwordx4 v2, s[44:47], s8 offen sc1 lds
    v_mfma_f32_16x16x32_bf16 v[104:107], v[72:75], v[32:35], v[104:107]
    ds_read_b64_tr_b16 v[52:53], v12 offset:19552
    s_add_u32 m0, s97, 8192
    s_add_u32 s8, s91, 4096
    buffer_load_dwordx4 v2, s[44:47], s8 offen sc1 lds
    v_mfma_f32_16x16x32_bf16 v[108:111], v[72:75], v[36:39], v[108:111]
    ds_read_b64_tr_b16 v[54:55], v12 offset:20704
    s_waitcnt lgkmcnt(6)
    v_mfma_f32_16x16x32_bf16 v[80:83], v[40:43], v[24:27], v[80:83]
    ds_read_b128 v[32:35], v14 offset:24576
    v_mfma_f32_16x16x32_bf16 v[84:87], v[40:43], v[28:31], v[84:87]
    ds_read_b128 v[36:39], v14 offset:25600
    ds_read_b64_tr_b16 v[60:61], v12 offset:29184
    s_waitcnt lgkmcnt(7)
    v_mfma_f32_16x16x32_bf16 v[88:91], v[44:47], v[24:27], v[88:91]
    ds_read_b64_tr_b16 v[62:63], v12 offset:30336
    s_add_u32 m0, s68, 65536
    s_mov_b32 s9, 233472
    buffer_load_dwordx4 v19, s[56:59], s9 offen sc1 lds
    v_mfma_f32_16x16x32_bf16 v[92:95], v[44:47], v[28:31], v[92:95]
    ds_read_b64_tr_b16 v[64:65], v12 offset:29216
    ds_read_b64_tr_b16 v[66:67], v12 offset:30368
    s_add_u32 m0, s68, 69632
    s_mov_b32 s9, 237568
    buffer_load_dwordx4 v19, s[56:59], s9 offen sc1 lds
    s_waitcnt lgkmcnt(8)
    v_mfma_f32_16x16x32_bf16 v[96:99], v[48:51], v[24:27], v[96:99]
    ds_read_b64_tr_b16 v[68:69], v12 offset:29248
    s_add_u32 m0, s68, 73728
    s_mov_b32 s9, 241664
    buffer_load_dwordx4 v19, s[56:59], s9 offen sc1 lds
    v_mfma_f32_16x16x32_bf16 v[100:103], v[48:51], v[28:31], v[100:103]
    ds_read_b64_tr_b16 v[70:71], v12 offset:30400
    s_add_u32 m0, s68, 77824
    s_mov_b32 s9, 245760
    buffer_load_dwordx4 v19, s[56:59], s9 offen sc1 lds
    s_waitcnt lgkmcnt(8)
    v_mfma_f32_16x16x32_bf16 v[104:107], v[52:55], v[24:27], v[104:107]
    ds_read_b64_tr_b16 v[72:73], v12 offset:29280
    v_mfma_f32_16x16x32_bf16 v[108:111], v[52:55], v[28:31], v[108:111]
    ds_read_b64_tr_b16 v[74:75], v12 offset:30432
    s_waitcnt lgkmcnt(6)
    v_mfma_f32_16x16x32_bf16 v[80:83], v[60:63], v[32:35], v[80:83]
    s_waitcnt vmcnt(10)
    s_waitcnt lgkmcnt(0)
    s_barrier
    ds_read_b128 v[24:27], v14 offset:32768
    v_mfma_f32_16x16x32_bf16 v[84:87], v[60:63], v[36:39], v[84:87]
    ds_read_b128 v[28:31], v14 offset:33792
    ds_read_b64_tr_b16 v[40:41], v13 offset:0
    v_mfma_f32_16x16x32_bf16 v[88:91], v[64:67], v[32:35], v[88:91]
    ds_read_b64_tr_b16 v[42:43], v13 offset:1152
    v_mfma_f32_16x16x32_bf16 v[92:95], v[64:67], v[36:39], v[92:95]
    ds_read_b64_tr_b16 v[44:45], v13 offset:32
    ds_read_b64_tr_b16 v[46:47], v13 offset:1184
    v_mfma_f32_16x16x32_bf16 v[96:99], v[68:71], v[32:35], v[96:99]
    ds_read_b64_tr_b16 v[48:49], v13 offset:64
    v_mfma_f32_16x16x32_bf16 v[100:103], v[68:71], v[36:39], v[100:103]
    ds_read_b64_tr_b16 v[50:51], v13 offset:1216
    s_add_u32 m0, s97, 16384
    s_add_u32 s8, s91, 8192
    buffer_load_dwordx4 v2, s[44:47], s8 offen sc1 lds
    v_mfma_f32_16x16x32_bf16 v[104:107], v[72:75], v[32:35], v[104:107]
    ds_read_b64_tr_b16 v[52:53], v13 offset:96
    s_add_u32 m0, s97, 24576
    s_add_u32 s8, s91, 12288
    buffer_load_dwordx4 v2, s[44:47], s8 offen sc1 lds
    v_mfma_f32_16x16x32_bf16 v[108:111], v[72:75], v[36:39], v[108:111]
    ds_read_b64_tr_b16 v[54:55], v13 offset:1248
    s_waitcnt lgkmcnt(6)
    v_mfma_f32_16x16x32_bf16 v[80:83], v[40:43], v[24:27], v[80:83]
    ds_read_b128 v[32:35], v14 offset:40960
    v_mfma_f32_16x16x32_bf16 v[84:87], v[40:43], v[28:31], v[84:87]
    ds_read_b128 v[36:39], v14 offset:41984
    ds_read_b64_tr_b16 v[60:61], v13 offset:9728
    s_waitcnt lgkmcnt(7)
    v_mfma_f32_16x16x32_bf16 v[88:91], v[44:47], v[24:27], v[88:91]
    ds_read_b64_tr_b16 v[62:63], v13 offset:10880
    s_add_u32 m0, s68, 81920
    s_mov_b32 s9, 249856
    buffer_load_dwordx4 v19, s[56:59], s9 offen sc1 lds
    v_mfma_f32_16x16x32_bf16 v[92:95], v[44:47], v[28:31], v[92:95]
    ds_read_b64_tr_b16 v[64:65], v13 offset:9760
    ds_read_b64_tr_b16 v[66:67], v13 offset:10912
    s_add_u32 m0, s68, 86016
    s_mov_b32 s9, 253952
    buffer_load_dwordx4 v19, s[56:59], s9 offen sc1 lds
    s_waitcnt lgkmcnt(8)
    v_mfma_f32_16x16x32_bf16 v[96:99], v[48:51], v[24:27], v[96:99]
    ds_read_b64_tr_b16 v[68:69], v13 offset:9792
    s_add_u32 m0, s68, 90112
    s_mov_b32 s9, 258048
    buffer_load_dwordx4 v19, s[56:59], s9 offen sc1 lds
    v_mfma_f32_16x16x32_bf16 v[100:103], v[48:51], v[28:31], v[100:103]
    ds_read_b64_tr_b16 v[70:71], v13 offset:10944
    s_add_u32 m0, s68, 94208
    s_mov_b32 s9, 262144
    buffer_load_dwordx4 v19, s[56:59], s9 offen sc1 lds
    s_waitcnt lgkmcnt(8)
    v_mfma_f32_16x16x32_bf16 v[104:107], v[52:55], v[24:27], v[104:107]
    ds_read_b64_tr_b16 v[72:73], v13 offset:9824
    s_add_u32 m0, s68, 98304
    s_mov_b32 s9, 266240
    buffer_load_dwordx4 v19, s[56:59], s9 offen sc1 lds
    v_mfma_f32_16x16x32_bf16 v[108:111], v[52:55], v[28:31], v[108:111]
    ds_read_b64_tr_b16 v[74:75], v13 offset:10976
    s_waitcnt lgkmcnt(6)
    v_mfma_f32_16x16x32_bf16 v[80:83], v[60:63], v[32:35], v[80:83]
    s_waitcnt vmcnt(13)
    s_waitcnt lgkmcnt(0)
    s_barrier
    ds_read_b128 v[24:27], v14 offset:49152
    v_mfma_f32_16x16x32_bf16 v[84:87], v[60:63], v[36:39], v[84:87]
    ds_read_b128 v[28:31], v14 offset:50176
    ds_read_b64_tr_b16 v[40:41], v13 offset:19456
    v_mfma_f32_16x16x32_bf16 v[88:91], v[64:67], v[32:35], v[88:91]
    ds_read_b64_tr_b16 v[42:43], v13 offset:20608
    v_mfma_f32_16x16x32_bf16 v[92:95], v[64:67], v[36:39], v[92:95]
    ds_read_b64_tr_b16 v[44:45], v13 offset:19488
    ds_read_b64_tr_b16 v[46:47], v13 offset:20640
    v_mfma_f32_16x16x32_bf16 v[96:99], v[68:71], v[32:35], v[96:99]
    ds_read_b64_tr_b16 v[48:49], v13 offset:19520
    v_mfma_f32_16x16x32_bf16 v[100:103], v[68:71], v[36:39], v[100:103]
    ds_read_b64_tr_b16 v[50:51], v13 offset:20672
    s_add_u32 m0, s97, 32768
    s_add_u32 s8, s91, 16384
    buffer_load_dwordx4 v2, s[44:47], s8 offen sc1 lds
    v_mfma_f32_16x16x32_bf16 v[104:107], v[72:75], v[32:35], v[104:107]
    ds_read_b64_tr_b16 v[52:53], v13 offset:19552
    s_add_u32 m0, s97, 40960
    s_add_u32 s8, s91, 20480
    buffer_load_dwordx4 v2, s[44:47], s8 offen sc1 lds
    v_mfma_f32_16x16x32_bf16 v[108:111], v[72:75], v[36:39], v[108:111]
    ds_read_b64_tr_b16 v[54:55], v13 offset:20704
    s_waitcnt lgkmcnt(6)
    v_mfma_f32_16x16x32_bf16 v[80:83], v[40:43], v[24:27], v[80:83]
    ds_read_b128 v[32:35], v14 offset:57344
    v_mfma_f32_16x16x32_bf16 v[84:87], v[40:43], v[28:31], v[84:87]
    ds_read_b128 v[36:39], v14 offset:58368
    ds_read_b64_tr_b16 v[60:61], v13 offset:29184
    s_waitcnt lgkmcnt(7)
    v_mfma_f32_16x16x32_bf16 v[88:91], v[44:47], v[24:27], v[88:91]
    ds_read_b64_tr_b16 v[62:63], v13 offset:30336
    s_add_u32 m0, s68, 102400
    s_mov_b32 s9, 270336
    buffer_load_dwordx4 v19, s[56:59], s9 offen sc1 lds
    v_mfma_f32_16x16x32_bf16 v[92:95], v[44:47], v[28:31], v[92:95]
    ds_read_b64_tr_b16 v[64:65], v13 offset:29216
    ds_read_b64_tr_b16 v[66:67], v13 offset:30368
    s_add_u32 m0, s68, 106496
    s_mov_b32 s9, 274432
    buffer_load_dwordx4 v19, s[56:59], s9 offen sc1 lds
    s_waitcnt lgkmcnt(8)
    v_mfma_f32_16x16x32_bf16 v[96:99], v[48:51], v[24:27], v[96:99]
    ds_read_b64_tr_b16 v[68:69], v13 offset:29248
    s_add_u32 m0, s68, 110592
    s_mov_b32 s9, 278528
    buffer_load_dwordx4 v19, s[56:59], s9 offen sc1 lds
    v_mfma_f32_16x16x32_bf16 v[100:103], v[48:51], v[28:31], v[100:103]
    ds_read_b64_tr_b16 v[70:71], v13 offset:30400
    s_add_u32 m0, s68, 114688
    s_mov_b32 s9, 282624
    buffer_load_dwordx4 v19, s[56:59], s9 offen sc1 lds
    s_waitcnt lgkmcnt(8)
    v_mfma_f32_16x16x32_bf16 v[104:107], v[52:55], v[24:27], v[104:107]
    ds_read_b64_tr_b16 v[72:73], v13 offset:29280
    s_add_u32 m0, s68, 118784
    s_mov_b32 s9, 286720
    buffer_load_dwordx4 v19, s[56:59], s9 offen sc1 lds
    v_mfma_f32_16x16x32_bf16 v[108:111], v[52:55], v[28:31], v[108:111]
    ds_read_b64_tr_b16 v[74:75], v13 offset:30432
    s_waitcnt lgkmcnt(6)
    v_mfma_f32_16x16x32_bf16 v[80:83], v[60:63], v[32:35], v[80:83]
    s_waitcnt vmcnt(11)
    s_waitcnt lgkmcnt(0)
    s_barrier
    ds_read_b128 v[24:27], v14 offset:0
    v_mfma_f32_16x16x32_bf16 v[84:87], v[60:63], v[36:39], v[84:87]
    ds_read_b128 v[28:31], v14 offset:1024
    ds_read_b64_tr_b16 v[40:41], v12 offset:0
    v_mfma_f32_16x16x32_bf16 v[88:91], v[64:67], v[32:35], v[88:91]
    ds_read_b64_tr_b16 v[42:43], v12 offset:1152
    v_mfma_f32_16x16x32_bf16 v[92:95], v[64:67], v[36:39], v[92:95]
    ds_read_b64_tr_b16 v[44:45], v12 offset:32
    ds_read_b64_tr_b16 v[46:47], v12 offset:1184
    v_mfma_f32_16x16x32_bf16 v[96:99], v[68:71], v[32:35], v[96:99]
    ds_read_b64_tr_b16 v[48:49], v12 offset:64
    v_mfma_f32_16x16x32_bf16 v[100:103], v[68:71], v[36:39], v[100:103]
    ds_read_b64_tr_b16 v[50:51], v12 offset:1216
    s_add_u32 m0, s97, 49152
    s_add_u32 s8, s91, 24576
    buffer_load_dwordx4 v2, s[44:47], s8 offen sc1 lds
    v_mfma_f32_16x16x32_bf16 v[104:107], v[72:75], v[32:35], v[104:107]
    ds_read_b64_tr_b16 v[52:53], v12 offset:96
    s_add_u32 m0, s97, 57344
    s_add_u32 s8, s91, 28672
    buffer_load_dwordx4 v2, s[44:47], s8 offen sc1 lds
    v_mfma_f32_16x16x32_bf16 v[108:111], v[72:75], v[36:39], v[108:111]
    ds_read_b64_tr_b16 v[54:55], v12 offset:1248
    s_waitcnt lgkmcnt(6)
    v_mfma_f32_16x16x32_bf16 v[80:83], v[40:43], v[24:27], v[80:83]
    ds_read_b128 v[32:35], v14 offset:8192
    v_mfma_f32_16x16x32_bf16 v[84:87], v[40:43], v[28:31], v[84:87]
    ds_read_b128 v[36:39], v14 offset:9216
    ds_read_b64_tr_b16 v[60:61], v12 offset:9728
    s_waitcnt lgkmcnt(7)
    v_mfma_f32_16x16x32_bf16 v[88:91], v[44:47], v[24:27], v[88:91]
    ds_read_b64_tr_b16 v[62:63], v12 offset:10880
    s_add_u32 m0, s68, 122880
    s_mov_b32 s9, 290816
    buffer_load_dwordx4 v19, s[56:59], s9 offen sc1 lds
    v_mfma_f32_16x16x32_bf16 v[92:95], v[44:47], v[28:31], v[92:95]
    ds_read_b64_tr_b16 v[64:65], v12 offset:9760
    ds_read_b64_tr_b16 v[66:67], v12 offset:10912
    s_add_u32 m0, s68, 126976
    s_mov_b32 s9, 294912
    buffer_load_dwordx4 v19, s[56:59], s9 offen sc1 lds
    s_waitcnt lgkmcnt(8)
    v_mfma_f32_16x16x32_bf16 v[96:99], v[48:51], v[24:27], v[96:99]
    ds_read_b64_tr_b16 v[68:69], v12 offset:9792
    s_add_u32 m0, s68, 131072
    s_mov_b32 s9, 299008
    buffer_load_dwordx4 v19, s[56:59], s9 offen sc1 lds
    v_mfma_f32_16x16x32_bf16 v[100:103], v[48:51], v[28:31], v[100:103]
    ds_read_b64_tr_b16 v[70:71], v12 offset:10944
    s_add_u32 m0, s68, 135168
    s_mov_b32 s9, 303104
    buffer_load_dwordx4 v19, s[56:59], s9 offen sc1 lds
    s_waitcnt lgkmcnt(8)
    v_mfma_f32_16x16x32_bf16 v[104:107], v[52:55], v[24:27], v[104:107]
    ds_read_b64_tr_b16 v[72:73], v12 offset:9824
    s_add_u32 m0, s68, 139264
    s_mov_b32 s9, 307200
    buffer_load_dwordx4 v19, s[56:59], s9 offen sc1 lds
    v_mfma_f32_16x16x32_bf16 v[108:111], v[52:55], v[28:31], v[108:111]
    ds_read_b64_tr_b16 v[74:75], v12 offset:10976
    s_waitcnt lgkmcnt(6)
    v_mfma_f32_16x16x32_bf16 v[80:83], v[60:63], v[32:35], v[80:83]
    s_waitcnt vmcnt(11)
    s_waitcnt lgkmcnt(0)
    s_barrier
    ds_read_b128 v[24:27], v14 offset:16384
    v_mfma_f32_16x16x32_bf16 v[84:87], v[60:63], v[36:39], v[84:87]
    ds_read_b128 v[28:31], v14 offset:17408
    ds_read_b64_tr_b16 v[40:41], v12 offset:19456
    v_mfma_f32_16x16x32_bf16 v[88:91], v[64:67], v[32:35], v[88:91]
    ds_read_b64_tr_b16 v[42:43], v12 offset:20608
    v_mfma_f32_16x16x32_bf16 v[92:95], v[64:67], v[36:39], v[92:95]
    ds_read_b64_tr_b16 v[44:45], v12 offset:19488
    ds_read_b64_tr_b16 v[46:47], v12 offset:20640
    v_mfma_f32_16x16x32_bf16 v[96:99], v[68:71], v[32:35], v[96:99]
    ds_read_b64_tr_b16 v[48:49], v12 offset:19520
    v_mfma_f32_16x16x32_bf16 v[100:103], v[68:71], v[36:39], v[100:103]
    ds_read_b64_tr_b16 v[50:51], v12 offset:20672
    s_add_u32 m0, s97, 0
    s_add_u32 s8, s66, 0
    buffer_load_dwordx4 v2, s[44:47], s8 offen sc1 lds
    v_mfma_f32_16x16x32_bf16 v[104:107], v[72:75], v[32:35], v[104:107]
    ds_read_b64_tr_b16 v[52:53], v12 offset:19552
    s_add_u32 m0, s97, 8192
    s_add_u32 s8, s66, 4096
    buffer_load_dwordx4 v2, s[44:47], s8 offen sc1 lds
    v_mfma_f32_16x16x32_bf16 v[108:111], v[72:75], v[36:39], v[108:111]
    ds_read_b64_tr_b16 v[54:55], v12 offset:20704
    s_waitcnt lgkmcnt(6)
    v_mfma_f32_16x16x32_bf16 v[80:83], v[40:43], v[24:27], v[80:83]
    ds_read_b128 v[32:35], v14 offset:24576
    v_mfma_f32_16x16x32_bf16 v[84:87], v[40:43], v[28:31], v[84:87]
    ds_read_b128 v[36:39], v14 offset:25600
    ds_read_b64_tr_b16 v[60:61], v12 offset:29184
    s_waitcnt lgkmcnt(7)
    v_mfma_f32_16x16x32_bf16 v[88:91], v[44:47], v[24:27], v[88:91]
    ds_read_b64_tr_b16 v[62:63], v12 offset:30336
    s_add_u32 m0, s68, 65536
    s_mov_b32 s9, 311296
    buffer_load_dwordx4 v19, s[56:59], s9 offen sc1 lds
    v_mfma_f32_16x16x32_bf16 v[92:95], v[44:47], v[28:31], v[92:95]
    ds_read_b64_tr_b16 v[64:65], v12 offset:29216
    ds_read_b64_tr_b16 v[66:67], v12 offset:30368
    s_add_u32 m0, s68, 69632
    s_mov_b32 s9, 315392
    buffer_load_dwordx4 v19, s[56:59], s9 offen sc1 lds
    s_waitcnt lgkmcnt(8)
    v_mfma_f32_16x16x32_bf16 v[96:99], v[48:51], v[24:27], v[96:99]
    ds_read_b64_tr_b16 v[68:69], v12 offset:29248
    s_add_u32 m0, s68, 73728
    s_mov_b32 s9, 319488
    buffer_load_dwordx4 v19, s[56:59], s9 offen sc1 lds
    v_mfma_f32_16x16x32_bf16 v[100:103], v[48:51], v[28:31], v[100:103]
    ds_read_b64_tr_b16 v[70:71], v12 offset:30400
    s_add_u32 m0, s68, 77824
    s_mov_b32 s9, 323584
    buffer_load_dwordx4 v19, s[56:59], s9 offen sc1 lds
    s_waitcnt lgkmcnt(8)
    v_mfma_f32_16x16x32_bf16 v[104:107], v[52:55], v[24:27], v[104:107]
    ds_read_b64_tr_b16 v[72:73], v12 offset:29280
    v_mfma_f32_16x16x32_bf16 v[108:111], v[52:55], v[28:31], v[108:111]
    ds_read_b64_tr_b16 v[74:75], v12 offset:30432
    s_waitcnt lgkmcnt(6)
    v_mfma_f32_16x16x32_bf16 v[80:83], v[60:63], v[32:35], v[80:83]
    s_waitcnt vmcnt(10)
    s_waitcnt lgkmcnt(0)
    s_barrier
    ds_read_b128 v[24:27], v14 offset:32768
    v_mfma_f32_16x16x32_bf16 v[84:87], v[60:63], v[36:39], v[84:87]
    ds_read_b128 v[28:31], v14 offset:33792
    ds_read_b64_tr_b16 v[40:41], v13 offset:0
    v_mfma_f32_16x16x32_bf16 v[88:91], v[64:67], v[32:35], v[88:91]
    ds_read_b64_tr_b16 v[42:43], v13 offset:1152
    v_mfma_f32_16x16x32_bf16 v[92:95], v[64:67], v[36:39], v[92:95]
    ds_read_b64_tr_b16 v[44:45], v13 offset:32
    ds_read_b64_tr_b16 v[46:47], v13 offset:1184
    v_mfma_f32_16x16x32_bf16 v[96:99], v[68:71], v[32:35], v[96:99]
    ds_read_b64_tr_b16 v[48:49], v13 offset:64
    v_mfma_f32_16x16x32_bf16 v[100:103], v[68:71], v[36:39], v[100:103]
    ds_read_b64_tr_b16 v[50:51], v13 offset:1216
    s_add_u32 m0, s97, 16384
    s_add_u32 s8, s66, 8192
    buffer_load_dwordx4 v2, s[44:47], s8 offen sc1 lds
    v_mfma_f32_16x16x32_bf16 v[104:107], v[72:75], v[32:35], v[104:107]
    ds_read_b64_tr_b16 v[52:53], v13 offset:96
    s_add_u32 m0, s97, 24576
    s_add_u32 s8, s66, 12288
    buffer_load_dwordx4 v2, s[44:47], s8 offen sc1 lds
    v_mfma_f32_16x16x32_bf16 v[108:111], v[72:75], v[36:39], v[108:111]
    ds_read_b64_tr_b16 v[54:55], v13 offset:1248
    s_waitcnt lgkmcnt(6)
    v_mfma_f32_16x16x32_bf16 v[80:83], v[40:43], v[24:27], v[80:83]
    ds_read_b128 v[32:35], v14 offset:40960
    v_mfma_f32_16x16x32_bf16 v[84:87], v[40:43], v[28:31], v[84:87]
    ds_read_b128 v[36:39], v14 offset:41984
    ds_read_b64_tr_b16 v[60:61], v13 offset:9728
    s_waitcnt lgkmcnt(7)
    v_mfma_f32_16x16x32_bf16 v[88:91], v[44:47], v[24:27], v[88:91]
    ds_read_b64_tr_b16 v[62:63], v13 offset:10880
    s_add_u32 m0, s68, 81920
    s_mov_b32 s9, 327680
    buffer_load_dwordx4 v19, s[56:59], s9 offen sc1 lds
    v_mfma_f32_16x16x32_bf16 v[92:95], v[44:47], v[28:31], v[92:95]
    ds_read_b64_tr_b16 v[64:65], v13 offset:9760
    ds_read_b64_tr_b16 v[66:67], v13 offset:10912
    s_add_u32 m0, s68, 86016
    s_mov_b32 s9, 331776
    buffer_load_dwordx4 v19, s[56:59], s9 offen sc1 lds
    s_waitcnt lgkmcnt(8)
    v_mfma_f32_16x16x32_bf16 v[96:99], v[48:51], v[24:27], v[96:99]
    ds_read_b64_tr_b16 v[68:69], v13 offset:9792
    s_add_u32 m0, s68, 90112
    s_mov_b32 s9, 335872
    buffer_load_dwordx4 v19, s[56:59], s9 offen sc1 lds
    v_mfma_f32_16x16x32_bf16 v[100:103], v[48:51], v[28:31], v[100:103]
    ds_read_b64_tr_b16 v[70:71], v13 offset:10944
    s_add_u32 m0, s68, 94208
    s_mov_b32 s9, 339968
    buffer_load_dwordx4 v19, s[56:59], s9 offen sc1 lds
    s_waitcnt lgkmcnt(8)
    v_mfma_f32_16x16x32_bf16 v[104:107], v[52:55], v[24:27], v[104:107]
    ds_read_b64_tr_b16 v[72:73], v13 offset:9824
    s_add_u32 m0, s68, 98304
    s_mov_b32 s9, 344064
    buffer_load_dwordx4 v19, s[56:59], s9 offen sc1 lds
    v_mfma_f32_16x16x32_bf16 v[108:111], v[52:55], v[28:31], v[108:111]
    ds_read_b64_tr_b16 v[74:75], v13 offset:10976
    s_waitcnt lgkmcnt(6)
    v_mfma_f32_16x16x32_bf16 v[80:83], v[60:63], v[32:35], v[80:83]
    s_waitcnt vmcnt(13)
    s_waitcnt lgkmcnt(0)
    s_barrier
    ds_read_b128 v[24:27], v14 offset:49152
    v_mfma_f32_16x16x32_bf16 v[84:87], v[60:63], v[36:39], v[84:87]
    ds_read_b128 v[28:31], v14 offset:50176
    ds_read_b64_tr_b16 v[40:41], v13 offset:19456
    v_mfma_f32_16x16x32_bf16 v[88:91], v[64:67], v[32:35], v[88:91]
    ds_read_b64_tr_b16 v[42:43], v13 offset:20608
    v_mfma_f32_16x16x32_bf16 v[92:95], v[64:67], v[36:39], v[92:95]
    ds_read_b64_tr_b16 v[44:45], v13 offset:19488
    ds_read_b64_tr_b16 v[46:47], v13 offset:20640
    v_mfma_f32_16x16x32_bf16 v[96:99], v[68:71], v[32:35], v[96:99]
    ds_read_b64_tr_b16 v[48:49], v13 offset:19520
    v_mfma_f32_16x16x32_bf16 v[100:103], v[68:71], v[36:39], v[100:103]
    ds_read_b64_tr_b16 v[50:51], v13 offset:20672
    s_add_u32 m0, s97, 32768
    s_nop 0
    buffer_load_dwordx4 v2, s[44:47], s67 offen sc1 lds
    v_mfma_f32_16x16x32_bf16 v[104:107], v[72:75], v[32:35], v[104:107]
    ds_read_b64_tr_b16 v[52:53], v13 offset:19552
    v_mfma_f32_16x16x32_bf16 v[108:111], v[72:75], v[36:39], v[108:111]
    ds_read_b64_tr_b16 v[54:55], v13 offset:20704
    s_waitcnt lgkmcnt(6)
    v_mfma_f32_16x16x32_bf16 v[80:83], v[40:43], v[24:27], v[80:83]
    ds_read_b128 v[32:35], v14 offset:57344
    v_mfma_f32_16x16x32_bf16 v[84:87], v[40:43], v[28:31], v[84:87]
    ds_read_b128 v[36:39], v14 offset:58368
    ds_read_b64_tr_b16 v[60:61], v13 offset:29184
    s_waitcnt lgkmcnt(7)
    v_mfma_f32_16x16x32_bf16 v[88:91], v[44:47], v[24:27], v[88:91]
    ds_read_b64_tr_b16 v[62:63], v13 offset:30336
    s_add_u32 m0, s68, 102400
    s_mov_b32 s9, 348160
    buffer_load_dwordx4 v19, s[56:59], s9 offen sc1 lds
    v_mfma_f32_16x16x32_bf16 v[92:95], v[44:47], v[28:31], v[92:95]
    ds_read_b64_tr_b16 v[64:65], v13 offset:29216
    ds_read_b64_tr_b16 v[66:67], v13 offset:30368
    s_add_u32 m0, s68, 106496
    s_mov_b32 s9, 352256
    buffer_load_dwordx4 v19, s[56:59], s9 offen sc1 lds
    s_waitcnt lgkmcnt(8)
    v_mfma_f32_16x16x32_bf16 v[96:99], v[48:51], v[24:27], v[96:99]
    ds_read_b64_tr_b16 v[68:69], v13 offset:29248
    s_add_u32 m0, s68, 110592
    s_mov_b32 s9, 356352
    buffer_load_dwordx4 v19, s[56:59], s9 offen sc1 lds
    v_mfma_f32_16x16x32_bf16 v[100:103], v[48:51], v[28:31], v[100:103]
    ds_read_b64_tr_b16 v[70:71], v13 offset:30400
    s_waitcnt lgkmcnt(8)
    v_mfma_f32_16x16x32_bf16 v[104:107], v[52:55], v[24:27], v[104:107]
    ds_read_b64_tr_b16 v[72:73], v13 offset:29280
    v_mfma_f32_16x16x32_bf16 v[108:111], v[52:55], v[28:31], v[108:111]
    ds_read_b64_tr_b16 v[74:75], v13 offset:30432
    s_waitcnt lgkmcnt(6)
    v_mfma_f32_16x16x32_bf16 v[80:83], v[60:63], v[32:35], v[80:83]
    s_waitcnt vmcnt(8)
    s_waitcnt lgkmcnt(0)
    s_barrier
    ds_read_b128 v[24:27], v14 offset:0
    v_mfma_f32_16x16x32_bf16 v[84:87], v[60:63], v[36:39], v[84:87]
    ds_read_b128 v[28:31], v14 offset:1024
    ds_read_b64_tr_b16 v[40:41], v12 offset:0
    v_mfma_f32_16x16x32_bf16 v[88:91], v[64:67], v[32:35], v[88:91]
    ds_read_b64_tr_b16 v[42:43], v12 offset:1152
    v_mfma_f32_16x16x32_bf16 v[92:95], v[64:67], v[36:39], v[92:95]
    ds_read_b64_tr_b16 v[44:45], v12 offset:32
    ds_read_b64_tr_b16 v[46:47], v12 offset:1184
    v_mfma_f32_16x16x32_bf16 v[96:99], v[68:71], v[32:35], v[96:99]
    ds_read_b64_tr_b16 v[48:49], v12 offset:64
    v_mfma_f32_16x16x32_bf16 v[100:103], v[68:71], v[36:39], v[100:103]
    ds_read_b64_tr_b16 v[50:51], v12 offset:1216
    v_mfma_f32_16x16x32_bf16 v[104:107], v[72:75], v[32:35], v[104:107]
    ds_read_b64_tr_b16 v[52:53], v12 offset:96
    v_mfma_f32_16x16x32_bf16 v[108:111], v[72:75], v[36:39], v[108:111]
    ds_read_b64_tr_b16 v[54:55], v12 offset:1248
    s_waitcnt lgkmcnt(6)
    v_mfma_f32_16x16x32_bf16 v[80:83], v[40:43], v[24:27], v[80:83]
    ds_read_b128 v[32:35], v14 offset:8192
    v_mfma_f32_16x16x32_bf16 v[84:87], v[40:43], v[28:31], v[84:87]
    ds_read_b128 v[36:39], v14 offset:9216
    ds_read_b64_tr_b16 v[60:61], v12 offset:9728
    s_waitcnt lgkmcnt(7)
    v_mfma_f32_16x16x32_bf16 v[88:91], v[44:47], v[24:27], v[88:91]
    ds_read_b64_tr_b16 v[62:63], v12 offset:10880
    v_mfma_f32_16x16x32_bf16 v[92:95], v[44:47], v[28:31], v[92:95]
    ds_read_b64_tr_b16 v[64:65], v12 offset:9760
    ds_read_b64_tr_b16 v[66:67], v12 offset:10912
    s_waitcnt lgkmcnt(8)
    v_mfma_f32_16x16x32_bf16 v[96:99], v[48:51], v[24:27], v[96:99]
    ds_read_b64_tr_b16 v[68:69], v12 offset:9792
    v_mfma_f32_16x16x32_bf16 v[100:103], v[48:51], v[28:31], v[100:103]
    ds_read_b64_tr_b16 v[70:71], v12 offset:10944
    s_waitcnt lgkmcnt(8)
    v_mfma_f32_16x16x32_bf16 v[104:107], v[52:55], v[24:27], v[104:107]
    ds_read_b64_tr_b16 v[72:73], v12 offset:9824
    v_mfma_f32_16x16x32_bf16 v[108:111], v[52:55], v[28:31], v[108:111]
    ds_read_b64_tr_b16 v[74:75], v12 offset:10976
    s_waitcnt lgkmcnt(6)
    v_mfma_f32_16x16x32_bf16 v[80:83], v[60:63], v[32:35], v[80:83]
    s_waitcnt vmcnt(2)
    s_waitcnt lgkmcnt(0)
    s_barrier
    ds_read_b128 v[24:27], v14 offset:16384
    v_mfma_f32_16x16x32_bf16 v[84:87], v[60:63], v[36:39], v[84:87]
    ds_read_b128 v[28:31], v14 offset:17408
    ds_read_b64_tr_b16 v[40:41], v12 offset:19456
    v_mfma_f32_16x16x32_bf16 v[88:91], v[64:67], v[32:35], v[88:91]
    ds_read_b64_tr_b16 v[42:43], v12 offset:20608
    v_mfma_f32_16x16x32_bf16 v[92:95], v[64:67], v[36:39], v[92:95]
    ds_read_b64_tr_b16 v[44:45], v12 offset:19488
    ds_read_b64_tr_b16 v[46:47], v12 offset:20640
    v_mfma_f32_16x16x32_bf16 v[96:99], v[68:71], v[32:35], v[96:99]
    ds_read_b64_tr_b16 v[48:49], v12 offset:19520
    v_mfma_f32_16x16x32_bf16 v[100:103], v[68:71], v[36:39], v[100:103]
    ds_read_b64_tr_b16 v[50:51], v12 offset:20672
    v_mfma_f32_16x16x32_bf16 v[104:107], v[72:75], v[32:35], v[104:107]
    ds_read_b64_tr_b16 v[52:53], v12 offset:19552
    v_mfma_f32_16x16x32_bf16 v[108:111], v[72:75], v[36:39], v[108:111]
    ds_read_b64_tr_b16 v[54:55], v12 offset:20704
    s_waitcnt lgkmcnt(6)
    v_mfma_f32_16x16x32_bf16 v[80:83], v[40:43], v[24:27], v[80:83]
    ds_read_b128 v[32:35], v14 offset:24576
    v_mfma_f32_16x16x32_bf16 v[84:87], v[40:43], v[28:31], v[84:87]
    ds_read_b128 v[36:39], v14 offset:25600
    ds_read_b64_tr_b16 v[60:61], v12 offset:29184
    s_waitcnt lgkmcnt(7)
    v_mfma_f32_16x16x32_bf16 v[88:91], v[44:47], v[24:27], v[88:91]
    ds_read_b64_tr_b16 v[62:63], v12 offset:30336
    v_mfma_f32_16x16x32_bf16 v[92:95], v[44:47], v[28:31], v[92:95]
    ds_read_b64_tr_b16 v[64:65], v12 offset:29216
    ds_read_b64_tr_b16 v[66:67], v12 offset:30368
    s_waitcnt lgkmcnt(8)
    v_mfma_f32_16x16x32_bf16 v[96:99], v[48:51], v[24:27], v[96:99]
    ds_read_b64_tr_b16 v[68:69], v12 offset:29248
    v_mfma_f32_16x16x32_bf16 v[100:103], v[48:51], v[28:31], v[100:103]
    ds_read_b64_tr_b16 v[70:71], v12 offset:30400
    s_waitcnt lgkmcnt(8)
    v_mfma_f32_16x16x32_bf16 v[104:107], v[52:55], v[24:27], v[104:107]
    ds_read_b64_tr_b16 v[72:73], v12 offset:29280
    v_mfma_f32_16x16x32_bf16 v[108:111], v[52:55], v[28:31], v[108:111]
    ds_read_b64_tr_b16 v[74:75], v12 offset:30432
    s_waitcnt lgkmcnt(6)
    v_mfma_f32_16x16x32_bf16 v[80:83], v[60:63], v[32:35], v[80:83]
    s_waitcnt vmcnt(0)
    s_waitcnt lgkmcnt(0)
    s_barrier
    ds_read_b128 v[24:27], v14 offset:32768
    v_mfma_f32_16x16x32_bf16 v[84:87], v[60:63], v[36:39], v[84:87]
    ds_read_b128 v[28:31], v14 offset:33792
    ds_read_b64_tr_b16 v[40:41], v13 offset:0
    v_mfma_f32_16x16x32_bf16 v[88:91], v[64:67], v[32:35], v[88:91]
    ds_read_b64_tr_b16 v[42:43], v13 offset:1152
    v_mfma_f32_16x16x32_bf16 v[92:95], v[64:67], v[36:39], v[92:95]
    ds_read_b64_tr_b16 v[44:45], v13 offset:32
    ds_read_b64_tr_b16 v[46:47], v13 offset:1184
    v_mfma_f32_16x16x32_bf16 v[96:99], v[68:71], v[32:35], v[96:99]
    ds_read_b64_tr_b16 v[48:49], v13 offset:64
    v_mfma_f32_16x16x32_bf16 v[100:103], v[68:71], v[36:39], v[100:103]
    ds_read_b64_tr_b16 v[50:51], v13 offset:1216
    v_mfma_f32_16x16x32_bf16 v[104:107], v[72:75], v[32:35], v[104:107]
    ds_read_b64_tr_b16 v[52:53], v13 offset:96
    v_mfma_f32_16x16x32_bf16 v[108:111], v[72:75], v[36:39], v[108:111]
    ds_read_b64_tr_b16 v[54:55], v13 offset:1248
    s_waitcnt lgkmcnt(6)
    v_mfma_f32_16x16x32_bf16 v[80:83], v[40:43], v[24:27], v[80:83]
    v_mfma_f32_16x16x32_bf16 v[84:87], v[40:43], v[28:31], v[84:87]
    s_waitcnt lgkmcnt(4)
    v_mfma_f32_16x16x32_bf16 v[88:91], v[44:47], v[24:27], v[88:91]
    v_mfma_f32_16x16x32_bf16 v[92:95], v[44:47], v[28:31], v[92:95]
    s_waitcnt lgkmcnt(2)
    v_mfma_f32_16x16x32_bf16 v[96:99], v[48:51], v[24:27], v[96:99]
    v_mfma_f32_16x16x32_bf16 v[100:103], v[48:51], v[28:31], v[100:103]
    s_waitcnt lgkmcnt(0)
    v_mfma_f32_16x16x32_bf16 v[104:107], v[52:55], v[24:27], v[104:107]
    v_mfma_f32_16x16x32_bf16 v[108:111], v[52:55], v[28:31], v[108:111]
    s_mul_i32 s6, s64, 40960
    s_add_u32 s84, s6, s10
    s_add_u32 s85, s84, 4096
    v_lshrrev_b32 v16, 1, v2
    v_cvt_pk_bf16_f32 v120, v80, v81
    v_cvt_pk_bf16_f32 v121, v82, v83
    v_cvt_pk_bf16_f32 v124, v84, v85
    v_cvt_pk_bf16_f32 v125, v86, v87
    v_cvt_pk_bf16_f32 v128, v88, v89
    v_cvt_pk_bf16_f32 v129, v90, v91
    v_cvt_pk_bf16_f32 v132, v92, v93
    v_cvt_pk_bf16_f32 v133, v94, v95
    v_cvt_pk_bf16_f32 v122, v96, v97
    v_cvt_pk_bf16_f32 v123, v98, v99
    v_cvt_pk_bf16_f32 v126, v100, v101
    v_cvt_pk_bf16_f32 v127, v102, v103
    v_cvt_pk_bf16_f32 v130, v104, v105
    v_cvt_pk_bf16_f32 v131, v106, v107
    v_cvt_pk_bf16_f32 v134, v108, v109
    v_cvt_pk_bf16_f32 v135, v110, v111
    s_cmp_eq_u32 s64, 0
    s_cbranch_scc1 B_XS0
    buffer_store_dwordx4 v[120:123], v2, s[44:47], s84 offen offset:0 sc1
B_XS0:
    s_cmp_eq_u32 s64, 1
    s_cbranch_scc1 B_XS1
    buffer_store_dwordx4 v[124:127], v2, s[44:47], s84 offen offset:1024 sc1
B_XS1:
    s_cmp_eq_u32 s64, 2
    s_cbranch_scc1 B_XS2
    buffer_store_dwordx4 v[128:131], v2, s[44:47], s84 offen offset:2048 sc1
B_XS2:
    s_cmp_eq_u32 s64, 3
    s_cbranch_scc1 B_XS3
    buffer_store_dwordx4 v[132:135], v2, s[44:47], s84 offen offset:3072 sc1
B_XS3:
    s_mov_b32 s55, 4000
    s_mov_b32 s86, 0xffff0000
    s_cmp_lg_u32 s64, 0
    s_cbranch_scc1 B_XL0
B_XR0:
    buffer_load_dwordx4 v[24:27], v2, s[44:47], s73 offen offset:0 sc1
    buffer_load_dwordx4 v[32:35], v2, s[44:47], s74 offen offset:0 sc1
    buffer_load_dwordx4 v[40:43], v2, s[44:47], s75 offen offset:0 sc1
    s_waitcnt vmcnt(2)
    v_lshlrev_b32 v60, 16, v24
    v_and_b32 v61, s86, v24
    v_add_f32 v48, v60, v80
    v_add_f32 v49, v61, v81
    v_lshlrev_b32 v60, 16, v25
    v_and_b32 v61, s86, v25
    v_add_f32 v50, v60, v82
    v_add_f32 v51, v61, v83
    v_lshlrev_b32 v60, 16, v26
    v_and_b32 v61, s86, v26
    v_add_f32 v52, v60, v96
    v_add_f32 v53, v61, v97
    v_lshlrev_b32 v60, 16, v27
    v_and_b32 v61, s86, v27
    v_add_f32 v54, v60, v98
    v_add_f32 v55, v61, v99
    s_waitcnt vmcnt(1)
    v_lshlrev_b32 v60, 16, v32
    v_and_b32 v61, s86, v32
    v_add_f32 v48, v60, v48
    v_add_f32 v49, v61, v49
    v_lshlrev_b32 v60, 16, v33
    v_and_b32 v61, s86, v33
    v_add_f32 v50, v60, v50
    v_add_f32 v51, v61, v51
    v_lshlrev_b32 v60, 16, v34
    v_and_b32 v61, s86, v34
    v_add_f32 v52, v60, v52
    v_add_f32 v53, v61, v53
    v_lshlrev_b32 v60, 16, v35
    v_and_b32 v61, s86, v35
    v_add_f32 v54, v60, v54
    v_add_f32 v55, v61, v55
    s_waitcnt vmcnt(0)
    v_lshlrev_b32 v60, 16, v40
    v_and_b32 v61, s86, v40
    v_add_f32 v48, v60, v48
    v_add_f32 v49, v61, v49
    v_lshlrev_b32 v60, 16, v41
    v_and_b32 v61, s86, v41
    v_add_f32 v50, v60, v50
    v_add_f32 v51, v61, v51
    v_lshlrev_b32 v60, 16, v42
    v_and_b32 v61, s86, v42
    v_add_f32 v52, v60, v52
    v_add_f32 v53, v61, v53
    v_lshlrev_b32 v60, 16, v43
    v_and_b32 v61, s86, v43
    v_add_f32 v54, v60, v54
    v_add_f32 v55, v61, v55
    v_add_f32 v62, v48, v49
    v_add_f32 v62, v62, v50
    v_add_f32 v62, v62, v51
    v_add_f32 v62, v62, v52
    v_add_f32 v62, v62, v53
    v_add_f32 v62, v62, v54
    v_add_f32 v62, v62, v55
    v_cmp_u_f32 vcc, v62, v62
    s_cbranch_vccz B_XK0
    s_sleep 4
    s_sub_u32 s55, s55, 1
    s_cmp_lg_u32 s55, 0
    s_cbranch_scc1 B_XR0
B_XK0:
    v_cvt_pk_bf16_f32 v48, v48, v49
    v_cvt_pk_bf16_f32 v49, v50, v51
    buffer_store_dwordx2 v[48:49], v10, s[60:63], 0 offen offset:0
    v_cvt_pk_bf16_f32 v52, v52, v53
    v_cvt_pk_bf16_f32 v53, v54, v55
    buffer_store_dwordx2 v[52:53], v10, s[60:63], 0 offen offset:64
    s_branch F_XLD
B_XL0:
    s_cmp_lg_u32 s64, 1
    s_cbranch_scc1 B_XL1
B_XR1:
    buffer_load_dwordx4 v[24:27], v2, s[44:47], s72 offen offset:1024 sc1
    buffer_load_dwordx4 v[32:35], v2, s[44:47], s74 offen offset:1024 sc1
    buffer_load_dwordx4 v[40:43], v2, s[44:47], s75 offen offset:1024 sc1
    s_waitcnt vmcnt(2)
    v_lshlrev_b32 v60, 16, v24
    v_and_b32 v61, s86, v24
    v_add_f32 v48, v60, v84
    v_add_f32 v49, v61, v85
    v_lshlrev_b32 v60, 16, v25
    v_and_b32 v61, s86, v25
    v_add_f32 v50, v60, v86
    v_add_f32 v51, v61, v87
    v_lshlrev_b32 v60, 16, v26
    v_and_b32 v61, s86, v26
    v_add_f32 v52, v60, v100
    v_add_f32 v53, v61, v101
    v_lshlrev_b32 v60, 16, v27
    v_and_b32 v61, s86, v27
    v_add_f32 v54, v60, v102
    v_add_f32 v55, v61, v103
    s_waitcnt vmcnt(1)
    v_lshlrev_b32 v60, 16, v32
    v_and_b32 v61, s86, v32
    v_add_f32 v48, v60, v48
    v_add_f32 v49, v61, v49
    v_lshlrev_b32 v60, 16, v33
    v_and_b32 v61, s86, v33
    v_add_f32 v50, v60, v50
    v_add_f32 v51, v61, v51
    v_lshlrev_b32 v60, 16, v34
    v_and_b32 v61, s86, v34
    v_add_f32 v52, v60, v52
    v_add_f32 v53, v61, v53
    v_lshlrev_b32 v60, 16, v35
    v_and_b32 v61, s86, v35
    v_add_f32 v54, v60, v54
    v_add_f32 v55, v61, v55
    s_waitcnt vmcnt(0)
    v_lshlrev_b32 v60, 16, v40
    v_and_b32 v61, s86, v40
    v_add_f32 v48, v60, v48
    v_add_f32 v49, v61, v49
    v_lshlrev_b32 v60, 16, v41
    v_and_b32 v61, s86, v41
    v_add_f32 v50, v60, v50
    v_add_f32 v51, v61, v51
    v_lshlrev_b32 v60, 16, v42
    v_and_b32 v61, s86, v42
    v_add_f32 v52, v60, v52
    v_add_f32 v53, v61, v53
    v_lshlrev_b32 v60, 16, v43
    v_and_b32 v61, s86, v43
    v_add_f32 v54, v60, v54
    v_add_f32 v55, v61, v55
    v_add_f32 v62, v48, v49
    v_add_f32 v62, v62, v50
    v_add_f32 v62, v62, v51
    v_add_f32 v62, v62, v52
    v_add_f32 v62, v62, v53
    v_add_f32 v62, v62, v54
    v_add_f32 v62, v62, v55
    v_cmp_u_f32 vcc, v62, v62
    s_cbranch_vccz B_XK1
    s_sleep 4
    s_sub_u32 s55, s55, 1
    s_cmp_lg_u32 s55, 0
    s_cbranch_scc1 B_XR1
B_XK1:
    v_cvt_pk_bf16_f32 v48, v48, v49
    v_cvt_pk_bf16_f32 v49, v50, v51
    buffer_store_dwordx2 v[48:49], v10, s[60:63], s76 offen offset:0
    v_cvt_pk_bf16_f32 v52, v52, v53
    v_cvt_pk_bf16_f32 v53, v54, v55
    buffer_store_dwordx2 v[52:53], v10, s[60:63], s76 offen offset:64
    s_branch F_XLD
B_XL1:
    s_cmp_lg_u32 s64, 2
    s_cbranch_scc1 B_XL2
B_XR2:
    buffer_load_dwordx4 v[24:27], v2, s[44:47], s72 offen offset:2048 sc1
    buffer_load_dwordx4 v[32:35], v2, s[44:47], s73 offen offset:2048 sc1
    buffer_load_dwordx4 v[40:43], v2, s[44:47], s75 offen offset:2048 sc1
    s_waitcnt vmcnt(2)
    v_lshlrev_b32 v60, 16, v24
    v_and_b32 v61, s86, v24
    v_add_f32 v48, v60, v88
    v_add_f32 v49, v61, v89
    v_lshlrev_b32 v60, 16, v25
    v_and_b32 v61, s86, v25
    v_add_f32 v50, v60, v90
    v_add_f32 v51, v61, v91
    v_lshlrev_b32 v60, 16, v26
    v_and_b32 v61, s86, v26
    v_add_f32 v52, v60, v104
    v_add_f32 v53, v61, v105
    v_lshlrev_b32 v60, 16, v27
    v_and_b32 v61, s86, v27
    v_add_f32 v54, v60, v106
    v_add_f32 v55, v61, v107
    s_waitcnt vmcnt(1)
    v_lshlrev_b32 v60, 16, v32
    v_and_b32 v61, s86, v32
    v_add_f32 v48, v60, v48
    v_add_f32 v49, v61, v49
    v_lshlrev_b32 v60, 16, v33
    v_and_b32 v61, s86, v33
    v_add_f32 v50, v60, v50
    v_add_f32 v51, v61, v51
    v_lshlrev_b32 v60, 16, v34
    v_and_b32 v61, s86, v34
    v_add_f32 v52, v60, v52
    v_add_f32 v53, v61, v53
    v_lshlrev_b32 v60, 16, v35
    v_and_b32 v61, s86, v35
    v_add_f32 v54, v60, v54
    v_add_f32 v55, v61, v55
    s_waitcnt vmcnt(0)
    v_lshlrev_b32 v60, 16, v40
    v_and_b32 v61, s86, v40
    v_add_f32 v48, v60, v48
    v_add_f32 v49, v61, v49
    v_lshlrev_b32 v60, 16, v41
    v_and_b32 v61, s86, v41
    v_add_f32 v50, v60, v50
    v_add_f32 v51, v61, v51
    v_lshlrev_b32 v60, 16, v42
    v_and_b32 v61, s86, v42
    v_add_f32 v52, v60, v52
    v_add_f32 v53, v61, v53
    v_lshlrev_b32 v60, 16, v43
    v_and_b32 v61, s86, v43
    v_add_f32 v54, v60, v54
    v_add_f32 v55, v61, v55
    v_add_f32 v62, v48, v49
    v_add_f32 v62, v62, v50
    v_add_f32 v62, v62, v51
    v_add_f32 v62, v62, v52
    v_add_f32 v62, v62, v53
    v_add_f32 v62, v62, v54
    v_add_f32 v62, v62, v55
    v_cmp_u_f32 vcc, v62, v62
    s_cbranch_vccz B_XK2
    s_sleep 4
    s_sub_u32 s55, s55, 1
    s_cmp_lg_u32 s55, 0
    s_cbranch_scc1 B_XR2
B_XK2:
    v_cvt_pk_bf16_f32 v48, v48, v49
    v_cvt_pk_bf16_f32 v49, v50, v51
    buffer_store_dwordx2 v[48:49], v10, s[60:63], 0 offen offset:32
    v_cvt_pk_bf16_f32 v52, v52, v53
    v_cvt_pk_bf16_f32 v53, v54, v55
    buffer_store_dwordx2 v[52:53], v10, s[60:63], 0 offen offset:96
    s_branch F_XLD
B_XL2:
B_XR3:
    buffer_load_dwordx4 v[24:27], v2, s[44:47], s72 offen offset:3072 sc1
    buffer_load_dwordx4 v[32:35], v2, s[44:47], s73 offen offset:3072 sc1
    buffer_load_dwordx4 v[40:43], v2, s[44:47], s74 offen offset:3072 sc1
    s_waitcnt vmcnt(2)
    v_lshlrev_b32 v60, 16, v24
    v_and_b32 v61, s86, v24
    v_add_f32 v48, v60, v92
    v_add_f32 v49, v61, v93
    v_lshlrev_b32 v60, 16, v25
    v_and_b32 v61, s86, v25
    v_add_f32 v50, v60, v94
    v_add_f32 v51, v61, v95
    v_lshlrev_b32 v60, 16, v26
    v_and_b32 v61, s86, v26
    v_add_f32 v52, v60, v108
    v_add_f32 v53, v61, v109
    v_lshlrev_b32 v60, 16, v27
    v_and_b32 v61, s86, v27
    v_add_f32 v54, v60, v110
    v_add_f32 v55, v61, v111
    s_waitcnt vmcnt(1)
    v_lshlrev_b32 v60, 16, v32
    v_and_b32 v61, s86, v32
    v_add_f32 v48, v60, v48
    v_add_f32 v49, v61, v49
    v_lshlrev_b32 v60, 16, v33
    v_and_b32 v61, s86, v33
    v_add_f32 v50, v60, v50
    v_add_f32 v51, v61, v51
    v_lshlrev_b32 v60, 16, v34
    v_and_b32 v61, s86, v34
    v_add_f32 v52, v60, v52
    v_add_f32 v53, v61, v53
    v_lshlrev_b32 v60, 16, v35
    v_and_b32 v61, s86, v35
    v_add_f32 v54, v60, v54
    v_add_f32 v55, v61, v55
    s_waitcnt vmcnt(0)
    v_lshlrev_b32 v60, 16, v40
    v_and_b32 v61, s86, v40
    v_add_f32 v48, v60, v48
    v_add_f32 v49, v61, v49
    v_lshlrev_b32 v60, 16, v41
    v_and_b32 v61, s86, v41
    v_add_f32 v50, v60, v50
    v_add_f32 v51, v61, v51
    v_lshlrev_b32 v60, 16, v42
    v_and_b32 v61, s86, v42
    v_add_f32 v52, v60, v52
    v_add_f32 v53, v61, v53
    v_lshlrev_b32 v60, 16, v43
    v_and_b32 v61, s86, v43
    v_add_f32 v54, v60, v54
    v_add_f32 v55, v61, v55
    v_add_f32 v62, v48, v49
    v_add_f32 v62, v62, v50
    v_add_f32 v62, v62, v51
    v_add_f32 v62, v62, v52
    v_add_f32 v62, v62, v53
    v_add_f32 v62, v62, v54
    v_add_f32 v62, v62, v55
    v_cmp_u_f32 vcc, v62, v62
    s_cbranch_vccz B_XK3
    s_sleep 4
    s_sub_u32 s55, s55, 1
    s_cmp_lg_u32 s55, 0
    s_cbranch_scc1 B_XR3
B_XK3:
    v_cvt_pk_bf16_f32 v48, v48, v49
    v_cvt_pk_bf16_f32 v49, v50, v51
    buffer_store_dwordx2 v[48:49], v10, s[60:63], s76 offen offset:32
    v_cvt_pk_bf16_f32 v52, v52, v53
    v_cvt_pk_bf16_f32 v53, v54, v55
    buffer_store_dwordx2 v[52:53], v10, s[60:63], s76 offen offset:96
F_XLD:
F_END:
    s_endpgm
F_COLD:
RASa:
    s_nop 12
    v_max3_f32 v112, v88, v89, v90
    v_max3_f32 v112, v112, v91, v96
    v_max3_f32 v112, v112, v97, v98
    v_max3_f32 v112, v112, v99, 0
    v_max3_f32 v113, v92, v93, v94
    v_max3_f32 v113, v113, v95, v100
    v_max3_f32 v113, v113, v101, v102
    v_max3_f32 v113, v113, v103, 0
    s_nop 1
    v_permlane16_swap_b32 v112, v113
    v_max_f32 v112, v112, v113
    v_mov_b32 v114, v112
    s_nop 1
    v_permlane32_swap_b32 v112, v114
    v_max_f32 v112, v112, v114
    v_mov_b32 v113, v112
    s_nop 1
    v_permlane16_swap_b32 v112, v113
    v_exp_f32 v116, -v112
    v_sub_f32 v88, v88, v112
    v_sub_f32 v72, v72, v112
    v_sub_f32 v89, v89, v112
    v_sub_f32 v73, v73, v112
    v_sub_f32 v90, v90, v112
    v_sub_f32 v74, v74, v112
    v_sub_f32 v91, v91, v112
    v_sub_f32 v75, v75, v112
    v_sub_f32 v96, v96, v112
    v_sub_f32 v80, v80, v112
    v_sub_f32 v97, v97, v112
    v_sub_f32 v81, v81, v112
    v_sub_f32 v98, v98, v112
    v_sub_f32 v82, v82, v112
    v_sub_f32 v99, v99, v112
    v_sub_f32 v83, v83, v112
    v_sub_f32 v104, v104, v112
    v_sub_f32 v105, v105, v112
    v_sub_f32 v106, v106, v112
    v_sub_f32 v107, v107, v112
    v_mul_f32 v17, v17, v116
    v_mul_f32 v128, v128, v116
    v_mul_f32 v129, v129, v116
    v_mul_f32 v130, v130, v116
    v_mul_f32 v131, v131, v116
    v_mul_f32 v136, v136, v116
    v_mul_f32 v137, v137, v116
    v_mul_f32 v138, v138, v116
    v_mul_f32 v139, v139, v116
    v_mul_f32 v144, v144, v116
    v_mul_f32 v145, v145, v116
    v_mul_f32 v146, v146, v116
    v_mul_f32 v147, v147, v116
    v_mul_f32 v152, v152, v116
    v_mul_f32 v153, v153, v116
    v_mul_f32 v154, v154, v116
    v_mul_f32 v155, v155, v116
    v_mul_f32 v160, v160, v116
    v_mul_f32 v161, v161, v116
    v_mul_f32 v162, v162, v116
    v_mul_f32 v163, v163, v116
    v_mul_f32 v168, v168, v116
    v_mul_f32 v169, v169, v116
    v_mul_f32 v170, v170, v116
    v_mul_f32 v171, v171, v116
    v_mul_f32 v176, v176, v116
    v_mul_f32 v177, v177, v116
    v_mul_f32 v178, v178, v116
    v_mul_f32 v179, v179, v116
    v_mul_f32 v184, v184, v116
    v_mul_f32 v185, v185, v116
    v_mul_f32 v186, v186, v116
    v_mul_f32 v187, v187, v116
    v_exp_f32 v117, -v113
    v_sub_f32 v92, v92, v113
    v_sub_f32 v76, v76, v113
    v_sub_f32 v93, v93, v113
    v_sub_f32 v77, v77, v113
    v_sub_f32 v94, v94, v113
    v_sub_f32 v78, v78, v113
    v_sub_f32 v95, v95, v113
    v_sub_f32 v79, v79, v113
    v_sub_f32 v100, v100, v113
    v_sub_f32 v84, v84, v113
    v_sub_f32 v101, v101, v113
    v_sub_f32 v85, v85, v113
    v_sub_f32 v102, v102, v113
    v_sub_f32 v86, v86, v113
    v_sub_f32 v103, v103, v113
    v_sub_f32 v87, v87, v113
    v_sub_f32 v108, v108, v113
    v_sub_f32 v109, v109, v113
    v_sub_f32 v110, v110, v113
    v_sub_f32 v111, v111, v113
    v_mul_f32 v18, v18, v117
    v_mul_f32 v132, v132, v117
    v_mul_f32 v133, v133, v117
    v_mul_f32 v134, v134, v117
    v_mul_f32 v135, v135, v117
    v_mul_f32 v140, v140, v117
    v_mul_f32 v141, v141, v117
    v_mul_f32 v142, v142, v117
    v_mul_f32 v143, v143, v117
    v_mul_f32 v148, v148, v117
    v_mul_f32 v149, v149, v117
    v_mul_f32 v150, v150, v117
    v_mul_f32 v151, v151, v117
    v_mul_f32 v156, v156, v117
    v_mul_f32 v157, v157, v117
    v_mul_f32 v158, v158, v117
    v_mul_f32 v159, v159, v117
    v_mul_f32 v164, v164, v117
    v_mul_f32 v165, v165, v117
    v_mul_f32 v166, v166, v117
    v_mul_f32 v167, v167, v117
    v_mul_f32 v172, v172, v117
    v_mul_f32 v173, v173, v117
    v_mul_f32 v174, v174, v117
    v_mul_f32 v175, v175, v117
    v_mul_f32 v180, v180, v117
    v_mul_f32 v181, v181, v117
    v_mul_f32 v182, v182, v117
    v_mul_f32 v183, v183, v117
    v_mul_f32 v188, v188, v117
    v_mul_f32 v189, v189, v117
    v_mul_f32 v190, v190, v117
    v_mul_f32 v191, v191, v117
    v_exp_f32 v112, v88
    s_nop 0
    v_exp_f32 v113, v89
    s_nop 0
    v_add_f32 v19, v112, v113
    v_cvt_pk_bf16_f32 v64, v112, v113
    v_exp_f32 v114, v90
    s_nop 0
    v_add_f32 v19, v19, v114
    v_exp_f32 v115, v91
    s_nop 0
    v_add_f32 v19, v19, v115
    v_cvt_pk_bf16_f32 v65, v114, v115
    v_exp_f32 v116, v96
    s_nop 0
    v_add_f32 v19, v19, v116
    v_exp_f32 v117, v97
    s_nop 0
    v_add_f32 v19, v19, v117
    v_cvt_pk_bf16_f32 v66, v116, v117
    v_exp_f32 v118, v98
    s_nop 0
    v_add_f32 v19, v19, v118
    v_exp_f32 v119, v99
    s_nop 0
    v_add_f32 v19, v19, v119
    v_cvt_pk_bf16_f32 v67, v118, v119
    v_exp_f32 v112, v92
    s_nop 0
    v_exp_f32 v113, v93
    s_nop 0
    v_add_f32 v20, v112, v113
    v_cvt_pk_bf16_f32 v68, v112, v113
    v_exp_f32 v114, v94
    s_nop 0
    v_add_f32 v20, v20, v114
    v_exp_f32 v115, v95
    s_nop 0
    v_add_f32 v20, v20, v115
    v_cvt_pk_bf16_f32 v69, v114, v115
    v_exp_f32 v116, v100
    s_nop 0
    v_add_f32 v20, v20, v116
    v_exp_f32 v117, v101
    s_nop 0
    v_add_f32 v20, v20, v117
    v_cvt_pk_bf16_f32 v70, v116, v117
    v_exp_f32 v118, v102
    s_nop 0
    v_add_f32 v20, v20, v118
    v_exp_f32 v119, v103
    s_nop 0
    v_add_f32 v20, v20, v119
    v_cvt_pk_bf16_f32 v71, v118, v119
    s_nop 1
    s_branch RASa_R
RASb:
    s_nop 12
    v_max3_f32 v112, v72, v73, v74
    v_max3_f32 v112, v112, v75, v80
    v_max3_f32 v112, v112, v81, v82
    v_max3_f32 v112, v112, v83, 0
    v_max3_f32 v113, v76, v77, v78
    v_max3_f32 v113, v113, v79, v84
    v_max3_f32 v113, v113, v85, v86
    v_max3_f32 v113, v113, v87, 0
    s_nop 1
    v_permlane16_swap_b32 v112, v113
    v_max_f32 v112, v112, v113
    v_mov_b32 v114, v112
    s_nop 1
    v_permlane32_swap_b32 v112, v114
    v_max_f32 v112, v112, v114
    v_mov_b32 v113, v112
    s_nop 1
    v_permlane16_swap_b32 v112, v113
    v_exp_f32 v116, -v112
    v_sub_f32 v72, v72, v112
    v_sub_f32 v88, v88, v112
    v_sub_f32 v73, v73, v112
    v_sub_f32 v89, v89, v112
    v_sub_f32 v74, v74, v112
    v_sub_f32 v90, v90, v112
    v_sub_f32 v75, v75, v112
    v_sub_f32 v91, v91, v112
    v_sub_f32 v80, v80, v112
    v_sub_f32 v96, v96, v112
    v_sub_f32 v81, v81, v112
    v_sub_f32 v97, v97, v112
    v_sub_f32 v82, v82, v112
    v_sub_f32 v98, v98, v112
    v_sub_f32 v83, v83, v112
    v_sub_f32 v99, v99, v112
    v_sub_f32 v104, v104, v112
    v_sub_f32 v105, v105, v112
    v_sub_f32 v106, v106, v112
    v_sub_f32 v107, v107, v112
    v_mul_f32 v17, v17, v116
    v_mul_f32 v128, v128, v116
    v_mul_f32 v129, v129, v116
    v_mul_f32 v130, v130, v116
    v_mul_f32 v131, v131, v116
    v_mul_f32 v136, v136, v116
    v_mul_f32 v137, v137, v116
    v_mul_f32 v138, v138, v116
    v_mul_f32 v139, v139, v116
    v_mul_f32 v144, v144, v116
    v_mul_f32 v145, v145, v116
    v_mul_f32 v146, v146, v116
    v_mul_f32 v147, v147, v116
    v_mul_f32 v152, v152, v116
    v_mul_f32 v153, v153, v116
    v_mul_f32 v154, v154, v116
    v_mul_f32 v155, v155, v116
    v_mul_f32 v160, v160, v116
    v_mul_f32 v161, v161, v116
    v_mul_f32 v162, v162, v116
    v_mul_f32 v163, v163, v116
    v_mul_f32 v168, v168, v116
    v_mul_f32 v169, v169, v116
    v_mul_f32 v170, v170, v116
    v_mul_f32 v171, v171, v116
    v_mul_f32 v176, v176, v116
    v_mul_f32 v177, v177, v116
    v_mul_f32 v178, v178, v116
    v_mul_f32 v179, v179, v116
    v_mul_f32 v184, v184, v116
    v_mul_f32 v185, v185, v116
    v_mul_f32 v186, v186, v116
    v_mul_f32 v187, v187, v116
    v_exp_f32 v117, -v113
    v_sub_f32 v76, v76, v113
    v_sub_f32 v92, v92, v113
    v_sub_f32 v77, v77, v113
    v_sub_f32 v93, v93, v113
    v_sub_f32 v78, v78, v113
    v_sub_f32 v94, v94, v113
    v_sub_f32 v79, v79, v113
    v_sub_f32 v95, v95, v113
    v_sub_f32 v84, v84, v113
    v_sub_f32 v100, v100, v113
    v_sub_f32 v85, v85, v113
    v_sub_f32 v101, v101, v113
    v_sub_f32 v86, v86, v113
    v_sub_f32 v102, v102, v113
    v_sub_f32 v87, v87, v113
    v_sub_f32 v103, v103, v113
    v_sub_f32 v108, v108, v113
    v_sub_f32 v109, v109, v113
    v_sub_f32 v110, v110, v113
    v_sub_f32 v111, v111, v113
    v_mul_f32 v18, v18, v117
    v_mul_f32 v132, v132, v117
    v_mul_f32 v133, v133, v117
    v_mul_f32 v134, v134, v117
    v_mul_f32 v135, v135, v117
    v_mul_f32 v140, v140, v117
    v_mul_f32 v141, v141, v117
    v_mul_f32 v142, v142, v117
    v_mul_f32 v143, v143, v117
    v_mul_f32 v148, v148, v117
    v_mul_f32 v149, v149, v117
    v_mul_f32 v150, v150, v117
    v_mul_f32 v151, v151, v117
    v_mul_f32 v156, v156, v117
    v_mul_f32 v157, v157, v117
    v_mul_f32 v158, v158, v117
    v_mul_f32 v159, v159, v117
    v_mul_f32 v164, v164, v117
    v_mul_f32 v165, v165, v117
    v_mul_f32 v166, v166, v117
    v_mul_f32 v167, v167, v117
    v_mul_f32 v172, v172, v117
    v_mul_f32 v173, v173, v117
    v_mul_f32 v174, v174, v117
    v_mul_f32 v175, v175, v117
    v_mul_f32 v180, v180, v117
    v_mul_f32 v181, v181, v117
    v_mul_f32 v182, v182, v117
    v_mul_f32 v183, v183, v117
    v_mul_f32 v188, v188, v117
    v_mul_f32 v189, v189, v117
    v_mul_f32 v190, v190, v117
    v_mul_f32 v191, v191, v117
    v_exp_f32 v112, v72
    s_nop 0
    v_exp_f32 v113, v73
    s_nop 0
    v_add_f32 v19, v112, v113
    v_cvt_pk_bf16_f32 v56, v112, v113
    v_exp_f32 v114, v74
    s_nop 0
    v_add_f32 v19, v19, v114
    v_exp_f32 v115, v75
    s_nop 0
    v_add_f32 v19, v19, v115
    v_cvt_pk_bf16_f32 v57, v114, v115
    v_exp_f32 v116, v80
    s_nop 0
    v_add_f32 v19, v19, v116
    v_exp_f32 v117, v81
    s_nop 0
    v_add_f32 v19, v19, v117
    v_cvt_pk_bf16_f32 v58, v116, v117
    v_exp_f32 v118, v82
    s_nop 0
    v_add_f32 v19, v19, v118
    v_exp_f32 v119, v83
    s_nop 0
    v_add_f32 v19, v19, v119
    v_cvt_pk_bf16_f32 v59, v118, v119
    v_exp_f32 v112, v76
    s_nop 0
    v_exp_f32 v113, v77
    s_nop 0
    v_add_f32 v20, v112, v113
    v_cvt_pk_bf16_f32 v60, v112, v113
    v_exp_f32 v114, v78
    s_nop 0
    v_add_f32 v20, v20, v114
    v_exp_f32 v115, v79
    s_nop 0
    v_add_f32 v20, v20, v115
    v_cvt_pk_bf16_f32 v61, v114, v115
    v_exp_f32 v116, v84
    s_nop 0
    v_add_f32 v20, v20, v116
    v_exp_f32 v117, v85
    s_nop 0
    v_add_f32 v20, v20, v117
    v_cvt_pk_bf16_f32 v62, v116, v117
    v_exp_f32 v118, v86
    s_nop 0
    v_add_f32 v20, v20, v118
    v_exp_f32 v119, v87
    s_nop 0
    v_add_f32 v20, v20, v119
    v_cvt_pk_bf16_f32 v63, v118, v119
    s_nop 1
    s_branch RASb_R
RAE1a:
    s_nop 12
    v_max3_f32 v112, v88, v89, v90
    v_max3_f32 v112, v112, v91, v96
    v_max3_f32 v112, v112, v97, v98
    v_max3_f32 v112, v112, v99, 0
    v_max3_f32 v113, v92, v93, v94
    v_max3_f32 v113, v113, v95, v100
    v_max3_f32 v113, v113, v101, v102
    v_max3_f32 v113, v113, v103, 0
    s_nop 1
    v_permlane16_swap_b32 v112, v113
    v_max_f32 v112, v112, v113
    v_mov_b32 v114, v112
    s_nop 1
    v_permlane32_swap_b32 v112, v114
    v_max_f32 v112, v112, v114
    v_mov_b32 v113, v112
    s_nop 1
    v_permlane16_swap_b32 v112, v113
    v_exp_f32 v116, -v112
    v_sub_f32 v88, v88, v112
    v_sub_f32 v72, v72, v112
    v_sub_f32 v89, v89, v112
    v_sub_f32 v73, v73, v112
    v_sub_f32 v90, v90, v112
    v_sub_f32 v74, v74, v112
    v_sub_f32 v91, v91, v112
    v_sub_f32 v75, v75, v112
    v_sub_f32 v96, v96, v112
    v_sub_f32 v80, v80, v112
    v_sub_f32 v97, v97, v112
    v_sub_f32 v81, v81, v112
    v_sub_f32 v98, v98, v112
    v_sub_f32 v82, v82, v112
    v_sub_f32 v99, v99, v112
    v_sub_f32 v83, v83, v112
    v_sub_f32 v104, v104, v112
    v_sub_f32 v105, v105, v112
    v_sub_f32 v106, v106, v112
    v_sub_f32 v107, v107, v112
    v_mul_f32 v17, v17, v116
    v_mul_f32 v128, v128, v116
    v_mul_f32 v129, v129, v116
    v_mul_f32 v130, v130, v116
    v_mul_f32 v131, v131, v116
    v_mul_f32 v136, v136, v116
    v_mul_f32 v137, v137, v116
    v_mul_f32 v138, v138, v116
    v_mul_f32 v139, v139, v116
    v_mul_f32 v144, v144, v116
    v_mul_f32 v145, v145, v116
    v_mul_f32 v146, v146, v116
    v_mul_f32 v147, v147, v116
    v_mul_f32 v152, v152, v116
    v_mul_f32 v153, v153, v116
    v_mul_f32 v154, v154, v116
    v_mul_f32 v155, v155, v116
    v_mul_f32 v160, v160, v116
    v_mul_f32 v161, v161, v116
    v_mul_f32 v162, v162, v116
    v_mul_f32 v163, v163, v116
    v_mul_f32 v168, v168, v116
    v_mul_f32 v169, v169, v116
    v_mul_f32 v170, v170, v116
    v_mul_f32 v171, v171, v116
    v_mul_f32 v176, v176, v116
    v_mul_f32 v177, v177, v116
    v_mul_f32 v178, v178, v116
    v_mul_f32 v179, v179, v116
    v_mul_f32 v184, v184, v116
    v_mul_f32 v185, v185, v116
    v_mul_f32 v186, v186, v116
    v_mul_f32 v187, v187, v116
    v_exp_f32 v117, -v113
    v_sub_f32 v92, v92, v113
    v_sub_f32 v76, v76, v113
    v_sub_f32 v93, v93, v113
    v_sub_f32 v77, v77, v113
    v_sub_f32 v94, v94, v113
    v_sub_f32 v78, v78, v113
    v_sub_f32 v95, v95, v113
    v_sub_f32 v79, v79, v113
    v_sub_f32 v100, v100, v113
    v_sub_f32 v84, v84, v113
    v_sub_f32 v101, v101, v113
    v_sub_f32 v85, v85, v113
    v_sub_f32 v102, v102, v113
    v_sub_f32 v86, v86, v113
    v_sub_f32 v103, v103, v113
    v_sub_f32 v87, v87, v113
    v_sub_f32 v108, v108, v113
    v_sub_f32 v109, v109, v113
    v_sub_f32 v110, v110, v113
    v_sub_f32 v111, v111, v113
    v_mul_f32 v18, v18, v117
    v_mul_f32 v132, v132, v117
    v_mul_f32 v133, v133, v117
    v_mul_f32 v134, v134, v117
    v_mul_f32 v135, v135, v117
    v_mul_f32 v140, v140, v117
    v_mul_f32 v141, v141, v117
    v_mul_f32 v142, v142, v117
    v_mul_f32 v143, v143, v117
    v_mul_f32 v148, v148, v117
    v_mul_f32 v149, v149, v117
    v_mul_f32 v150, v150, v117
    v_mul_f32 v151, v151, v117
    v_mul_f32 v156, v156, v117
    v_mul_f32 v157, v157, v117
    v_mul_f32 v158, v158, v117
    v_mul_f32 v159, v159, v117
    v_mul_f32 v164, v164, v117
    v_mul_f32 v165, v165, v117
    v_mul_f32 v166, v166, v117
    v_mul_f32 v167, v167, v117
    v_mul_f32 v172, v172, v117
    v_mul_f32 v173, v173, v117
    v_mul_f32 v174, v174, v117
    v_mul_f32 v175, v175, v117
    v_mul_f32 v180, v180, v117
    v_mul_f32 v181, v181, v117
    v_mul_f32 v182, v182, v117
    v_mul_f32 v183, v183, v117
    v_mul_f32 v188, v188, v117
    v_mul_f32 v189, v189, v117
    v_mul_f32 v190, v190, v117
    v_mul_f32 v191, v191, v117
    v_exp_f32 v112, v88
    s_nop 0
    v_exp_f32 v113, v89
    s_nop 0
    v_add_f32 v19, v112, v113
    v_cvt_pk_bf16_f32 v64, v112, v113
    v_exp_f32 v114, v90
    s_nop 0
    v_add_f32 v19, v19, v114
    v_exp_f32 v115, v91
    s_nop 0
    v_add_f32 v19, v19, v115
    v_cvt_pk_bf16_f32 v65, v114, v115
    v_exp_f32 v116, v96
    s_nop 0
    v_add_f32 v19, v19, v116
    v_exp_f32 v117, v97
    s_nop 0
    v_add_f32 v19, v19, v117
    v_cvt_pk_bf16_f32 v66, v116, v117
    v_exp_f32 v118, v98
    s_nop 0
    v_add_f32 v19, v19, v118
    v_exp_f32 v119, v99
    s_nop 0
    v_add_f32 v19, v19, v119
    v_cvt_pk_bf16_f32 v67, v118, v119
    v_exp_f32 v112, v92
    s_nop 0
    v_exp_f32 v113, v93
    s_nop 0
    v_add_f32 v20, v112, v113
    v_cvt_pk_bf16_f32 v68, v112, v113
    v_exp_f32 v114, v94
    s_nop 0
    v_add_f32 v20, v20, v114
    v_exp_f32 v115, v95
    s_nop 0
    v_add_f32 v20, v20, v115
    v_cvt_pk_bf16_f32 v69, v114, v115
    v_exp_f32 v116, v100
    s_nop 0
    v_add_f32 v20, v20, v116
    v_exp_f32 v117, v101
    s_nop 0
    v_add_f32 v20, v20, v117
    v_cvt_pk_bf16_f32 v70, v116, v117
    v_exp_f32 v118, v102
    s_nop 0
    v_add_f32 v20, v20, v118
    v_exp_f32 v119, v103
    s_nop 0
    v_add_f32 v20, v20, v119
    v_cvt_pk_bf16_f32 v71, v118, v119
    s_nop 1
    s_branch RAE1a_R
RAE1b:
    s_nop 12
    v_max3_f32 v112, v72, v73, v74
    v_max3_f32 v112, v112, v75, v80
    v_max3_f32 v112, v112, v81, v82
    v_max3_f32 v112, v112, v83, 0
    v_max3_f32 v113, v76, v77, v78
    v_max3_f32 v113, v113, v79, v84
    v_max3_f32 v113, v113, v85, v86
    v_max3_f32 v113, v113, v87, 0
    s_nop 1
    v_permlane16_swap_b32 v112, v113
    v_max_f32 v112, v112, v113
    v_mov_b32 v114, v112
    s_nop 1
    v_permlane32_swap_b32 v112, v114
    v_max_f32 v112, v112, v114
    v_mov_b32 v113, v112
    s_nop 1
    v_permlane16_swap_b32 v112, v113
    v_exp_f32 v116, -v112
    v_sub_f32 v72, v72, v112
    v_sub_f32 v88, v88, v112
    v_sub_f32 v73, v73, v112
    v_sub_f32 v89, v89, v112
    v_sub_f32 v74, v74, v112
    v_sub_f32 v90, v90, v112
    v_sub_f32 v75, v75, v112
    v_sub_f32 v91, v91, v112
    v_sub_f32 v80, v80, v112
    v_sub_f32 v96, v96, v112
    v_sub_f32 v81, v81, v112
    v_sub_f32 v97, v97, v112
    v_sub_f32 v82, v82, v112
    v_sub_f32 v98, v98, v112
    v_sub_f32 v83, v83, v112
    v_sub_f32 v99, v99, v112
    v_sub_f32 v104, v104, v112
    v_sub_f32 v105, v105, v112
    v_sub_f32 v106, v106, v112
    v_sub_f32 v107, v107, v112
    v_mul_f32 v17, v17, v116
    v_mul_f32 v128, v128, v116
    v_mul_f32 v129, v129, v116
    v_mul_f32 v130, v130, v116
    v_mul_f32 v131, v131, v116
    v_mul_f32 v136, v136, v116
    v_mul_f32 v137, v137, v116
    v_mul_f32 v138, v138, v116
    v_mul_f32 v139, v139, v116
    v_mul_f32 v144, v144, v116
    v_mul_f32 v145, v145, v116
    v_mul_f32 v146, v146, v116
    v_mul_f32 v147, v147, v116
    v_mul_f32 v152, v152, v116
    v_mul_f32 v153, v153, v116
    v_mul_f32 v154, v154, v116
    v_mul_f32 v155, v155, v116
    v_mul_f32 v160, v160, v116
    v_mul_f32 v161, v161, v116
    v_mul_f32 v162, v162, v116
    v_mul_f32 v163, v163, v116
    v_mul_f32 v168, v168, v116
    v_mul_f32 v169, v169, v116
    v_mul_f32 v170, v170, v116
    v_mul_f32 v171, v171, v116
    v_mul_f32 v176, v176, v116
    v_mul_f32 v177, v177, v116
    v_mul_f32 v178, v178, v116
    v_mul_f32 v179, v179, v116
    v_mul_f32 v184, v184, v116
    v_mul_f32 v185, v185, v116
    v_mul_f32 v186, v186, v116
    v_mul_f32 v187, v187, v116
    v_exp_f32 v117, -v113
    v_sub_f32 v76, v76, v113
    v_sub_f32 v92, v92, v113
    v_sub_f32 v77, v77, v113
    v_sub_f32 v93, v93, v113
    v_sub_f32 v78, v78, v113
    v_sub_f32 v94, v94, v113
    v_sub_f32 v79, v79, v113
    v_sub_f32 v95, v95, v113
    v_sub_f32 v84, v84, v113
    v_sub_f32 v100, v100, v113
    v_sub_f32 v85, v85, v113
    v_sub_f32 v101, v101, v113
    v_sub_f32 v86, v86, v113
    v_sub_f32 v102, v102, v113
    v_sub_f32 v87, v87, v113
    v_sub_f32 v103, v103, v113
    v_sub_f32 v108, v108, v113
    v_sub_f32 v109, v109, v113
    v_sub_f32 v110, v110, v113
    v_sub_f32 v111, v111, v113
    v_mul_f32 v18, v18, v117
    v_mul_f32 v132, v132, v117
    v_mul_f32 v133, v133, v117
    v_mul_f32 v134, v134, v117
    v_mul_f32 v135, v135, v117
    v_mul_f32 v140, v140, v117
    v_mul_f32 v141, v141, v117
    v_mul_f32 v142, v142, v117
    v_mul_f32 v143, v143, v117
    v_mul_f32 v148, v148, v117
    v_mul_f32 v149, v149, v117
    v_mul_f32 v150, v150, v117
    v_mul_f32 v151, v151, v117
    v_mul_f32 v156, v156, v117
    v_mul_f32 v157, v157, v117
    v_mul_f32 v158, v158, v117
    v_mul_f32 v159, v159, v117
    v_mul_f32 v164, v164, v117
    v_mul_f32 v165, v165, v117
    v_mul_f32 v166, v166, v117
    v_mul_f32 v167, v167, v117
    v_mul_f32 v172, v172, v117
    v_mul_f32 v173, v173, v117
    v_mul_f32 v174, v174, v117
    v_mul_f32 v175, v175, v117
    v_mul_f32 v180, v180, v117
    v_mul_f32 v181, v181, v117
    v_mul_f32 v182, v182, v117
    v_mul_f32 v183, v183, v117
    v_mul_f32 v188, v188, v117
    v_mul_f32 v189, v189, v117
    v_mul_f32 v190, v190, v117
    v_mul_f32 v191, v191, v117
    v_exp_f32 v112, v72
    s_nop 0
    v_exp_f32 v113, v73
    s_nop 0
    v_add_f32 v19, v112, v113
    v_cvt_pk_bf16_f32 v56, v112, v113
    v_exp_f32 v114, v74
    s_nop 0
    v_add_f32 v19, v19, v114
    v_exp_f32 v115, v75
    s_nop 0
    v_add_f32 v19, v19, v115
    v_cvt_pk_bf16_f32 v57, v114, v115
    v_exp_f32 v116, v80
    s_nop 0
    v_add_f32 v19, v19, v116
    v_exp_f32 v117, v81
    s_nop 0
    v_add_f32 v19, v19, v117
    v_cvt_pk_bf16_f32 v58, v116, v117
    v_exp_f32 v118, v82
    s_nop 0
    v_add_f32 v19, v19, v118
    v_exp_f32 v119, v83
    s_nop 0
    v_add_f32 v19, v19, v119
    v_cvt_pk_bf16_f32 v59, v118, v119
    v_exp_f32 v112, v76
    s_nop 0
    v_exp_f32 v113, v77
    s_nop 0
    v_add_f32 v20, v112, v113
    v_cvt_pk_bf16_f32 v60, v112, v113
    v_exp_f32 v114, v78
    s_nop 0
    v_add_f32 v20, v20, v114
    v_exp_f32 v115, v79
    s_nop 0
    v_add_f32 v20, v20, v115
    v_cvt_pk_bf16_f32 v61, v114, v115
    v_exp_f32 v116, v84
    s_nop 0
    v_add_f32 v20, v20, v116
    v_exp_f32 v117, v85
    s_nop 0
    v_add_f32 v20, v20, v117
    v_cvt_pk_bf16_f32 v62, v116, v117
    v_exp_f32 v118, v86
    s_nop 0
    v_add_f32 v20, v20, v118
    v_exp_f32 v119, v87
    s_nop 0
    v_add_f32 v20, v20, v119
    v_cvt_pk_bf16_f32 v63, v118, v119
    s_nop 1
    s_branch RAE1b_R
RAS1a:
    s_nop 12
    v_max3_f32 v112, v88, v89, v90
    v_max3_f32 v112, v112, v91, v96
    v_max3_f32 v112, v112, v97, v98
    v_max3_f32 v112, v112, v99, 0
    v_max3_f32 v113, v92, v93, v94
    v_max3_f32 v113, v113, v95, v100
    v_max3_f32 v113, v113, v101, v102
    v_max3_f32 v113, v113, v103, 0
    s_nop 1
    v_permlane16_swap_b32 v112, v113
    v_max_f32 v112, v112, v113
    v_mov_b32 v114, v112
    s_nop 1
    v_permlane32_swap_b32 v112, v114
    v_max_f32 v112, v112, v114
    v_mov_b32 v113, v112
    s_nop 1
    v_permlane16_swap_b32 v112, v113
    v_exp_f32 v116, -v112
    v_sub_f32 v88, v88, v112
    v_sub_f32 v72, v72, v112
    v_sub_f32 v89, v89, v112
    v_sub_f32 v73, v73, v112
    v_sub_f32 v90, v90, v112
    v_sub_f32 v74, v74, v112
    v_sub_f32 v91, v91, v112
    v_sub_f32 v75, v75, v112
    v_sub_f32 v96, v96, v112
    v_sub_f32 v80, v80, v112
    v_sub_f32 v97, v97, v112
    v_sub_f32 v81, v81, v112
    v_sub_f32 v98, v98, v112
    v_sub_f32 v82, v82, v112
    v_sub_f32 v99, v99, v112
    v_sub_f32 v83, v83, v112
    v_sub_f32 v104, v104, v112
    v_sub_f32 v105, v105, v112
    v_sub_f32 v106, v106, v112
    v_sub_f32 v107, v107, v112
    v_mul_f32 v17, v17, v116
    v_mul_f32 v128, v128, v116
    v_mul_f32 v129, v129, v116
    v_mul_f32 v130, v130, v116
    v_mul_f32 v131, v131, v116
    v_mul_f32 v136, v136, v116
    v_mul_f32 v137, v137, v116
    v_mul_f32 v138, v138, v116
    v_mul_f32 v139, v139, v116
    v_mul_f32 v144, v144, v116
    v_mul_f32 v145, v145, v116
    v_mul_f32 v146, v146, v116
    v_mul_f32 v147, v147, v116
    v_mul_f32 v152, v152, v116
    v_mul_f32 v153, v153, v116
    v_mul_f32 v154, v154, v116
    v_mul_f32 v155, v155, v116
    v_mul_f32 v160, v160, v116
    v_mul_f32 v161, v161, v116
    v_mul_f32 v162, v162, v116
    v_mul_f32 v163, v163, v116
    v_mul_f32 v168, v168, v116
    v_mul_f32 v169, v169, v116
    v_mul_f32 v170, v170, v116
    v_mul_f32 v171, v171, v116
    v_mul_f32 v176, v176, v116
    v_mul_f32 v177, v177, v116
    v_mul_f32 v178, v178, v116
    v_mul_f32 v179, v179, v116
    v_mul_f32 v184, v184, v116
    v_mul_f32 v185, v185, v116
    v_mul_f32 v186, v186, v116
    v_mul_f32 v187, v187, v116
    v_exp_f32 v117, -v113
    v_sub_f32 v92, v92, v113
    v_sub_f32 v76, v76, v113
    v_sub_f32 v93, v93, v113
    v_sub_f32 v77, v77, v113
    v_sub_f32 v94, v94, v113
    v_sub_f32 v78, v78, v113
    v_sub_f32 v95, v95, v113
    v_sub_f32 v79, v79, v113
    v_sub_f32 v100, v100, v113
    v_sub_f32 v84, v84, v113
    v_sub_f32 v101, v101, v113
    v_sub_f32 v85, v85, v113
    v_sub_f32 v102, v102, v113
    v_sub_f32 v86, v86, v113
    v_sub_f32 v103, v103, v113
    v_sub_f32 v87, v87, v113
    v_sub_f32 v108, v108, v113
    v_sub_f32 v109, v109, v113
    v_sub_f32 v110, v110, v113
    v_sub_f32 v111, v111, v113
    v_mul_f32 v18, v18, v117
    v_mul_f32 v132, v132, v117
    v_mul_f32 v133, v133, v117
    v_mul_f32 v134, v134, v117
    v_mul_f32 v135, v135, v117
    v_mul_f32 v140, v140, v117
    v_mul_f32 v141, v141, v117
    v_mul_f32 v142, v142, v117
    v_mul_f32 v143, v143, v117
    v_mul_f32 v148, v148, v117
    v_mul_f32 v149, v149, v117
    v_mul_f32 v150, v150, v117
    v_mul_f32 v151, v151, v117
    v_mul_f32 v156, v156, v117
    v_mul_f32 v157, v157, v117
    v_mul_f32 v158, v158, v117
    v_mul_f32 v159, v159, v117
    v_mul_f32 v164, v164, v117
    v_mul_f32 v165, v165, v117
    v_mul_f32 v166, v166, v117
    v_mul_f32 v167, v167, v117
    v_mul_f32 v172, v172, v117
    v_mul_f32 v173, v173, v117
    v_mul_f32 v174, v174, v117
    v_mul_f32 v175, v175, v117
    v_mul_f32 v180, v180, v117
    v_mul_f32 v181, v181, v117
    v_mul_f32 v182, v182, v117
    v_mul_f32 v183, v183, v117
    v_mul_f32 v188, v188, v117
    v_mul_f32 v189, v189, v117
    v_mul_f32 v190, v190, v117
    v_mul_f32 v191, v191, v117
    v_exp_f32 v112, v88
    s_nop 0
    v_exp_f32 v113, v89
    s_nop 0
    v_add_f32 v19, v112, v113
    v_cvt_pk_bf16_f32 v64, v112, v113
    v_exp_f32 v114, v90
    s_nop 0
    v_add_f32 v19, v19, v114
    v_exp_f32 v115, v91
    s_nop 0
    v_add_f32 v19, v19, v115
    v_cvt_pk_bf16_f32 v65, v114, v115
    v_exp_f32 v116, v96
    s_nop 0
    v_add_f32 v19, v19, v116
    v_exp_f32 v117, v97
    s_nop 0
    v_add_f32 v19, v19, v117
    v_cvt_pk_bf16_f32 v66, v116, v117
    v_exp_f32 v118, v98
    s_nop 0
    v_add_f32 v19, v19, v118
    v_exp_f32 v119, v99
    s_nop 0
    v_add_f32 v19, v19, v119
    v_cvt_pk_bf16_f32 v67, v118, v119
    v_exp_f32 v112, v92
    s_nop 0
    v_exp_f32 v113, v93
    s_nop 0
    v_add_f32 v20, v112, v113
    v_cvt_pk_bf16_f32 v68, v112, v113
    v_exp_f32 v114, v94
    s_nop 0
    v_add_f32 v20, v20, v114
    v_exp_f32 v115, v95
    s_nop 0
    v_add_f32 v20, v20, v115
    v_cvt_pk_bf16_f32 v69, v114, v115
    v_exp_f32 v116, v100
    s_nop 0
    v_add_f32 v20, v20, v116
    v_exp_f32 v117, v101
    s_nop 0
    v_add_f32 v20, v20, v117
    v_cvt_pk_bf16_f32 v70, v116, v117
    v_exp_f32 v118, v102
    s_nop 0
    v_add_f32 v20, v20, v118
    v_exp_f32 v119, v103
    s_nop 0
    v_add_f32 v20, v20, v119
    v_cvt_pk_bf16_f32 v71, v118, v119
    s_nop 1
    s_branch RAS1a_R
RAS1b:
    s_nop 12
    v_max3_f32 v112, v72, v73, v74
    v_max3_f32 v112, v112, v75, v80
    v_max3_f32 v112, v112, v81, v82
    v_max3_f32 v112, v112, v83, 0
    v_max3_f32 v113, v76, v77, v78
    v_max3_f32 v113, v113, v79, v84
    v_max3_f32 v113, v113, v85, v86
    v_max3_f32 v113, v113, v87, 0
    s_nop 1
    v_permlane16_swap_b32 v112, v113
    v_max_f32 v112, v112, v113
    v_mov_b32 v114, v112
    s_nop 1
    v_permlane32_swap_b32 v112, v114
    v_max_f32 v112, v112, v114
    v_mov_b32 v113, v112
    s_nop 1
    v_permlane16_swap_b32 v112, v113
    v_exp_f32 v116, -v112
    v_sub_f32 v72, v72, v112
    v_sub_f32 v88, v88, v112
    v_sub_f32 v73, v73, v112
    v_sub_f32 v89, v89, v112
    v_sub_f32 v74, v74, v112
    v_sub_f32 v90, v90, v112
    v_sub_f32 v75, v75, v112
    v_sub_f32 v91, v91, v112
    v_sub_f32 v80, v80, v112
    v_sub_f32 v96, v96, v112
    v_sub_f32 v81, v81, v112
    v_sub_f32 v97, v97, v112
    v_sub_f32 v82, v82, v112
    v_sub_f32 v98, v98, v112
    v_sub_f32 v83, v83, v112
    v_sub_f32 v99, v99, v112
    v_sub_f32 v104, v104, v112
    v_sub_f32 v105, v105, v112
    v_sub_f32 v106, v106, v112
    v_sub_f32 v107, v107, v112
    v_mul_f32 v17, v17, v116
    v_mul_f32 v128, v128, v116
    v_mul_f32 v129, v129, v116
    v_mul_f32 v130, v130, v116
    v_mul_f32 v131, v131, v116
    v_mul_f32 v136, v136, v116
    v_mul_f32 v137, v137, v116
    v_mul_f32 v138, v138, v116
    v_mul_f32 v139, v139, v116
    v_mul_f32 v144, v144, v116
    v_mul_f32 v145, v145, v116
    v_mul_f32 v146, v146, v116
    v_mul_f32 v147, v147, v116
    v_mul_f32 v152, v152, v116
    v_mul_f32 v153, v153, v116
    v_mul_f32 v154, v154, v116
    v_mul_f32 v155, v155, v116
    v_mul_f32 v160, v160, v116
    v_mul_f32 v161, v161, v116
    v_mul_f32 v162, v162, v116
    v_mul_f32 v163, v163, v116
    v_mul_f32 v168, v168, v116
    v_mul_f32 v169, v169, v116
    v_mul_f32 v170, v170, v116
    v_mul_f32 v171, v171, v116
    v_mul_f32 v176, v176, v116
    v_mul_f32 v177, v177, v116
    v_mul_f32 v178, v178, v116
    v_mul_f32 v179, v179, v116
    v_mul_f32 v184, v184, v116
    v_mul_f32 v185, v185, v116
    v_mul_f32 v186, v186, v116
    v_mul_f32 v187, v187, v116
    v_exp_f32 v117, -v113
    v_sub_f32 v76, v76, v113
    v_sub_f32 v92, v92, v113
    v_sub_f32 v77, v77, v113
    v_sub_f32 v93, v93, v113
    v_sub_f32 v78, v78, v113
    v_sub_f32 v94, v94, v113
    v_sub_f32 v79, v79, v113
    v_sub_f32 v95, v95, v113
    v_sub_f32 v84, v84, v113
    v_sub_f32 v100, v100, v113
    v_sub_f32 v85, v85, v113
    v_sub_f32 v101, v101, v113
    v_sub_f32 v86, v86, v113
    v_sub_f32 v102, v102, v113
    v_sub_f32 v87, v87, v113
    v_sub_f32 v103, v103, v113
    v_sub_f32 v108, v108, v113
    v_sub_f32 v109, v109, v113
    v_sub_f32 v110, v110, v113
    v_sub_f32 v111, v111, v113
    v_mul_f32 v18, v18, v117
    v_mul_f32 v132, v132, v117
    v_mul_f32 v133, v133, v117
    v_mul_f32 v134, v134, v117
    v_mul_f32 v135, v135, v117
    v_mul_f32 v140, v140, v117
    v_mul_f32 v141, v141, v117
    v_mul_f32 v142, v142, v117
    v_mul_f32 v143, v143, v117
    v_mul_f32 v148, v148, v117
    v_mul_f32 v149, v149, v117
    v_mul_f32 v150, v150, v117
    v_mul_f32 v151, v151, v117
    v_mul_f32 v156, v156, v117
    v_mul_f32 v157, v157, v117
    v_mul_f32 v158, v158, v117
    v_mul_f32 v159, v159, v117
    v_mul_f32 v164, v164, v117
    v_mul_f32 v165, v165, v117
    v_mul_f32 v166, v166, v117
    v_mul_f32 v167, v167, v117
    v_mul_f32 v172, v172, v117
    v_mul_f32 v173, v173, v117
    v_mul_f32 v174, v174, v117
    v_mul_f32 v175, v175, v117
    v_mul_f32 v180, v180, v117
    v_mul_f32 v181, v181, v117
    v_mul_f32 v182, v182, v117
    v_mul_f32 v183, v183, v117
    v_mul_f32 v188, v188, v117
    v_mul_f32 v189, v189, v117
    v_mul_f32 v190, v190, v117
    v_mul_f32 v191, v191, v117
    v_exp_f32 v112, v72
    s_nop 0
    v_exp_f32 v113, v73
    s_nop 0
    v_add_f32 v19, v112, v113
    v_cvt_pk_bf16_f32 v56, v112, v113
    v_exp_f32 v114, v74
    s_nop 0
    v_add_f32 v19, v19, v114
    v_exp_f32 v115, v75
    s_nop 0
    v_add_f32 v19, v19, v115
    v_cvt_pk_bf16_f32 v57, v114, v115
    v_exp_f32 v116, v80
    s_nop 0
    v_add_f32 v19, v19, v116
    v_exp_f32 v117, v81
    s_nop 0
    v_add_f32 v19, v19, v117
    v_cvt_pk_bf16_f32 v58, v116, v117
    v_exp_f32 v118, v82
    s_nop 0
    v_add_f32 v19, v19, v118
    v_exp_f32 v119, v83
    s_nop 0
    v_add_f32 v19, v19, v119
    v_cvt_pk_bf16_f32 v59, v118, v119
    v_exp_f32 v112, v76
    s_nop 0
    v_exp_f32 v113, v77
    s_nop 0
    v_add_f32 v20, v112, v113
    v_cvt_pk_bf16_f32 v60, v112, v113
    v_exp_f32 v114, v78
    s_nop 0
    v_add_f32 v20, v20, v114
    v_exp_f32 v115, v79
    s_nop 0
    v_add_f32 v20, v20, v115
    v_cvt_pk_bf16_f32 v61, v114, v115
    v_exp_f32 v116, v84
    s_nop 0
    v_add_f32 v20, v20, v116
    v_exp_f32 v117, v85
    s_nop 0
    v_add_f32 v20, v20, v117
    v_cvt_pk_bf16_f32 v62, v116, v117
    v_exp_f32 v118, v86
    s_nop 0
    v_add_f32 v20, v20, v118
    v_exp_f32 v119, v87
    s_nop 0
    v_add_f32 v20, v20, v119
    v_cvt_pk_bf16_f32 v63, v118, v119
    s_nop 1
    s_branch RAS1b_R
RAS2a:
    s_nop 12
    v_max3_f32 v112, v88, v89, v90
    v_max3_f32 v112, v112, v91, v96
    v_max3_f32 v112, v112, v97, v98
    v_max3_f32 v112, v112, v99, 0
    v_max3_f32 v113, v92, v93, v94
    v_max3_f32 v113, v113, v95, v100
    v_max3_f32 v113, v113, v101, v102
    v_max3_f32 v113, v113, v103, 0
    s_nop 1
    v_permlane16_swap_b32 v112, v113
    v_max_f32 v112, v112, v113
    v_mov_b32 v114, v112
    s_nop 1
    v_permlane32_swap_b32 v112, v114
    v_max_f32 v112, v112, v114
    v_mov_b32 v113, v112
    s_nop 1
    v_permlane16_swap_b32 v112, v113
    v_exp_f32 v116, -v112
    v_sub_f32 v88, v88, v112
    v_sub_f32 v72, v72, v112
    v_sub_f32 v89, v89, v112
    v_sub_f32 v73, v73, v112
    v_sub_f32 v90, v90, v112
    v_sub_f32 v74, v74, v112
    v_sub_f32 v91, v91, v112
    v_sub_f32 v75, v75, v112
    v_sub_f32 v96, v96, v112
    v_sub_f32 v80, v80, v112
    v_sub_f32 v97, v97, v112
    v_sub_f32 v81, v81, v112
    v_sub_f32 v98, v98, v112
    v_sub_f32 v82, v82, v112
    v_sub_f32 v99, v99, v112
    v_sub_f32 v83, v83, v112
    v_sub_f32 v104, v104, v112
    v_sub_f32 v105, v105, v112
    v_sub_f32 v106, v106, v112
    v_sub_f32 v107, v107, v112
    v_mul_f32 v17, v17, v116
    v_mul_f32 v128, v128, v116
    v_mul_f32 v129, v129, v116
    v_mul_f32 v130, v130, v116
    v_mul_f32 v131, v131, v116
    v_mul_f32 v136, v136, v116
    v_mul_f32 v137, v137, v116
    v_mul_f32 v138, v138, v116
    v_mul_f32 v139, v139, v116
    v_mul_f32 v144, v144, v116
    v_mul_f32 v145, v145, v116
    v_mul_f32 v146, v146, v116
    v_mul_f32 v147, v147, v116
    v_mul_f32 v152, v152, v116
    v_mul_f32 v153, v153, v116
    v_mul_f32 v154, v154, v116
    v_mul_f32 v155, v155, v116
    v_mul_f32 v160, v160, v116
    v_mul_f32 v161, v161, v116
    v_mul_f32 v162, v162, v116
    v_mul_f32 v163, v163, v116
    v_mul_f32 v168, v168, v116
    v_mul_f32 v169, v169, v116
    v_mul_f32 v170, v170, v116
    v_mul_f32 v171, v171, v116
    v_mul_f32 v176, v176, v116
    v_mul_f32 v177, v177, v116
    v_mul_f32 v178, v178, v116
    v_mul_f32 v179, v179, v116
    v_mul_f32 v184, v184, v116
    v_mul_f32 v185, v185, v116
    v_mul_f32 v186, v186, v116
    v_mul_f32 v187, v187, v116
    v_exp_f32 v117, -v113
    v_sub_f32 v92, v92, v113
    v_sub_f32 v76, v76, v113
    v_sub_f32 v93, v93, v113
    v_sub_f32 v77, v77, v113
    v_sub_f32 v94, v94, v113
    v_sub_f32 v78, v78, v113
    v_sub_f32 v95, v95, v113
    v_sub_f32 v79, v79, v113
    v_sub_f32 v100, v100, v113
    v_sub_f32 v84, v84, v113
    v_sub_f32 v101, v101, v113
    v_sub_f32 v85, v85, v113
    v_sub_f32 v102, v102, v113
    v_sub_f32 v86, v86, v113
    v_sub_f32 v103, v103, v113
    v_sub_f32 v87, v87, v113
    v_sub_f32 v108, v108, v113
    v_sub_f32 v109, v109, v113
    v_sub_f32 v110, v110, v113
    v_sub_f32 v111, v111, v113
    v_mul_f32 v18, v18, v117
    v_mul_f32 v132, v132, v117
    v_mul_f32 v133, v133, v117
    v_mul_f32 v134, v134, v117
    v_mul_f32 v135, v135, v117
    v_mul_f32 v140, v140, v117
    v_mul_f32 v141, v141, v117
    v_mul_f32 v142, v142, v117
    v_mul_f32 v143, v143, v117
    v_mul_f32 v148, v148, v117
    v_mul_f32 v149, v149, v117
    v_mul_f32 v150, v150, v117
    v_mul_f32 v151, v151, v117
    v_mul_f32 v156, v156, v117
    v_mul_f32 v157, v157, v117
    v_mul_f32 v158, v158, v117
    v_mul_f32 v159, v159, v117
    v_mul_f32 v164, v164, v117
    v_mul_f32 v165, v165, v117
    v_mul_f32 v166, v166, v117
    v_mul_f32 v167, v167, v117
    v_mul_f32 v172, v172, v117
    v_mul_f32 v173, v173, v117
    v_mul_f32 v174, v174, v117
    v_mul_f32 v175, v175, v117
    v_mul_f32 v180, v180, v117
    v_mul_f32 v181, v181, v117
    v_mul_f32 v182, v182, v117
    v_mul_f32 v183, v183, v117
    v_mul_f32 v188, v188, v117
    v_mul_f32 v189, v189, v117
    v_mul_f32 v190, v190, v117
    v_mul_f32 v191, v191, v117
    v_exp_f32 v112, v88
    s_nop 0
    v_exp_f32 v113, v89
    s_nop 0
    v_add_f32 v19, v112, v113
    v_cvt_pk_bf16_f32 v64, v112, v113
    v_exp_f32 v114, v90
    s_nop 0
    v_add_f32 v19, v19, v114
    v_exp_f32 v115, v91
    s_nop 0
    v_add_f32 v19, v19, v115
    v_cvt_pk_bf16_f32 v65, v114, v115
    v_exp_f32 v116, v96
    s_nop 0
    v_add_f32 v19, v19, v116
    v_exp_f32 v117, v97
    s_nop 0
    v_add_f32 v19, v19, v117
    v_cvt_pk_bf16_f32 v66, v116, v117
    v_exp_f32 v118, v98
    s_nop 0
    v_add_f32 v19, v19, v118
    v_exp_f32 v119, v99
    s_nop 0
    v_add_f32 v19, v19, v119
    v_cvt_pk_bf16_f32 v67, v118, v119
    v_exp_f32 v112, v92
    s_nop 0
    v_exp_f32 v113, v93
    s_nop 0
    v_add_f32 v20, v112, v113
    v_cvt_pk_bf16_f32 v68, v112, v113
    v_exp_f32 v114, v94
    s_nop 0
    v_add_f32 v20, v20, v114
    v_exp_f32 v115, v95
    s_nop 0
    v_add_f32 v20, v20, v115
    v_cvt_pk_bf16_f32 v69, v114, v115
    v_exp_f32 v116, v100
    s_nop 0
    v_add_f32 v20, v20, v116
    v_exp_f32 v117, v101
    s_nop 0
    v_add_f32 v20, v20, v117
    v_cvt_pk_bf16_f32 v70, v116, v117
    v_exp_f32 v118, v102
    s_nop 0
    v_add_f32 v20, v20, v118
    v_exp_f32 v119, v103
    s_nop 0
    v_add_f32 v20, v20, v119
    v_cvt_pk_bf16_f32 v71, v118, v119
    s_nop 1
    s_branch RAS2a_R
RBSa:
    s_nop 12
    v_max3_f32 v112, v88, v89, v90
    v_max3_f32 v112, v112, v91, v96
    v_max3_f32 v112, v112, v97, v98
    v_max3_f32 v112, v112, v99, 0
    v_max3_f32 v113, v92, v93, v94
    v_max3_f32 v113, v113, v95, v100
    v_max3_f32 v113, v113, v101, v102
    v_max3_f32 v113, v113, v103, 0
    s_nop 1
    v_permlane16_swap_b32 v112, v113
    v_max_f32 v112, v112, v113
    v_mov_b32 v114, v112
    s_nop 1
    v_permlane32_swap_b32 v112, v114
    v_max_f32 v112, v112, v114
    v_mov_b32 v113, v112
    s_nop 1
    v_permlane16_swap_b32 v112, v113
    v_exp_f32 v116, -v112
    v_sub_f32 v88, v88, v112
    v_sub_f32 v72, v72, v112
    v_sub_f32 v89, v89, v112
    v_sub_f32 v73, v73, v112
    v_sub_f32 v90, v90, v112
    v_sub_f32 v74, v74, v112
    v_sub_f32 v91, v91, v112
    v_sub_f32 v75, v75, v112
    v_sub_f32 v96, v96, v112
    v_sub_f32 v80, v80, v112
    v_sub_f32 v97, v97, v112
    v_sub_f32 v81, v81, v112
    v_sub_f32 v98, v98, v112
    v_sub_f32 v82, v82, v112
    v_sub_f32 v99, v99, v112
    v_sub_f32 v83, v83, v112
    v_sub_f32 v104, v104, v112
    v_sub_f32 v105, v105, v112
    v_sub_f32 v106, v106, v112
    v_sub_f32 v107, v107, v112
    v_mul_f32 v17, v17, v116
    v_mul_f32 v128, v128, v116
    v_mul_f32 v129, v129, v116
    v_mul_f32 v130, v130, v116
    v_mul_f32 v131, v131, v116
    v_mul_f32 v136, v136, v116
    v_mul_f32 v137, v137, v116
    v_mul_f32 v138, v138, v116
    v_mul_f32 v139, v139, v116
    v_mul_f32 v144, v144, v116
    v_mul_f32 v145, v145, v116
    v_mul_f32 v146, v146, v116
    v_mul_f32 v147, v147, v116
    v_mul_f32 v152, v152, v116
    v_mul_f32 v153, v153, v116
    v_mul_f32 v154, v154, v116
    v_mul_f32 v155, v155, v116
    v_mul_f32 v160, v160, v116
    v_mul_f32 v161, v161, v116
    v_mul_f32 v162, v162, v116
    v_mul_f32 v163, v163, v116
    v_mul_f32 v168, v168, v116
    v_mul_f32 v169, v169, v116
    v_mul_f32 v170, v170, v116
    v_mul_f32 v171, v171, v116
    v_mul_f32 v176, v176, v116
    v_mul_f32 v177, v177, v116
    v_mul_f32 v178, v178, v116
    v_mul_f32 v179, v179, v116
    v_mul_f32 v184, v184, v116
    v_mul_f32 v185, v185, v116
    v_mul_f32 v186, v186, v116
    v_mul_f32 v187, v187, v116
    v_exp_f32 v117, -v113
    v_sub_f32 v92, v92, v113
    v_sub_f32 v76, v76, v113
    v_sub_f32 v93, v93, v113
    v_sub_f32 v77, v77, v113
    v_sub_f32 v94, v94, v113
    v_sub_f32 v78, v78, v113
    v_sub_f32 v95, v95, v113
    v_sub_f32 v79, v79, v113
    v_sub_f32 v100, v100, v113
    v_sub_f32 v84, v84, v113
    v_sub_f32 v101, v101, v113
    v_sub_f32 v85, v85, v113
    v_sub_f32 v102, v102, v113
    v_sub_f32 v86, v86, v113
    v_sub_f32 v103, v103, v113
    v_sub_f32 v87, v87, v113
    v_sub_f32 v108, v108, v113
    v_sub_f32 v109, v109, v113
    v_sub_f32 v110, v110, v113
    v_sub_f32 v111, v111, v113
    v_mul_f32 v18, v18, v117
    v_mul_f32 v132, v132, v117
    v_mul_f32 v133, v133, v117
    v_mul_f32 v134, v134, v117
    v_mul_f32 v135, v135, v117
    v_mul_f32 v140, v140, v117
    v_mul_f32 v141, v141, v117
    v_mul_f32 v142, v142, v117
    v_mul_f32 v143, v143, v117
    v_mul_f32 v148, v148, v117
    v_mul_f32 v149, v149, v117
    v_mul_f32 v150, v150, v117
    v_mul_f32 v151, v151, v117
    v_mul_f32 v156, v156, v117
    v_mul_f32 v157, v157, v117
    v_mul_f32 v158, v158, v117
    v_mul_f32 v159, v159, v117
    v_mul_f32 v164, v164, v117
    v_mul_f32 v165, v165, v117
    v_mul_f32 v166, v166, v117
    v_mul_f32 v167, v167, v117
    v_mul_f32 v172, v172, v117
    v_mul_f32 v173, v173, v117
    v_mul_f32 v174, v174, v117
    v_mul_f32 v175, v175, v117
    v_mul_f32 v180, v180, v117
    v_mul_f32 v181, v181, v117
    v_mul_f32 v182, v182, v117
    v_mul_f32 v183, v183, v117
    v_mul_f32 v188, v188, v117
    v_mul_f32 v189, v189, v117
    v_mul_f32 v190, v190, v117
    v_mul_f32 v191, v191, v117
    v_exp_f32 v112, v88
    s_nop 0
    v_exp_f32 v113, v89
    s_nop 0
    v_add_f32 v19, v112, v113
    v_cvt_pk_bf16_f32 v64, v112, v113
    v_exp_f32 v114, v90
    s_nop 0
    v_add_f32 v19, v19, v114
    v_exp_f32 v115, v91
    s_nop 0
    v_add_f32 v19, v19, v115
    v_cvt_pk_bf16_f32 v65, v114, v115
    v_exp_f32 v116, v96
    s_nop 0
    v_add_f32 v19, v19, v116
    v_exp_f32 v117, v97
    s_nop 0
    v_add_f32 v19, v19, v117
    v_cvt_pk_bf16_f32 v66, v116, v117
    v_exp_f32 v118, v98
    s_nop 0
    v_add_f32 v19, v19, v118
    v_exp_f32 v119, v99
    s_nop 0
    v_add_f32 v19, v19, v119
    v_cvt_pk_bf16_f32 v67, v118, v119
    v_exp_f32 v112, v92
    s_nop 0
    v_exp_f32 v113, v93
    s_nop 0
    v_add_f32 v20, v112, v113
    v_cvt_pk_bf16_f32 v68, v112, v113
    v_exp_f32 v114, v94
    s_nop 0
    v_add_f32 v20, v20, v114
    v_exp_f32 v115, v95
    s_nop 0
    v_add_f32 v20, v20, v115
    v_cvt_pk_bf16_f32 v69, v114, v115
    v_exp_f32 v116, v100
    s_nop 0
    v_add_f32 v20, v20, v116
    v_exp_f32 v117, v101
    s_nop 0
    v_add_f32 v20, v20, v117
    v_cvt_pk_bf16_f32 v70, v116, v117
    v_exp_f32 v118, v102
    s_nop 0
    v_add_f32 v20, v20, v118
    v_exp_f32 v119, v103
    s_nop 0
    v_add_f32 v20, v20, v119
    v_cvt_pk_bf16_f32 v71, v118, v119
    s_nop 1
    s_branch RBSa_R
RBSb:
    s_nop 12
    v_max3_f32 v112, v72, v73, v74
    v_max3_f32 v112, v112, v75, v80
    v_max3_f32 v112, v112, v81, v82
    v_max3_f32 v112, v112, v83, 0
    v_max3_f32 v113, v76, v77, v78
    v_max3_f32 v113, v113, v79, v84
    v_max3_f32 v113, v113, v85, v86
    v_max3_f32 v113, v113, v87, 0
    s_nop 1
    v_permlane16_swap_b32 v112, v113
    v_max_f32 v112, v112, v113
    v_mov_b32 v114, v112
    s_nop 1
    v_permlane32_swap_b32 v112, v114
    v_max_f32 v112, v112, v114
    v_mov_b32 v113, v112
    s_nop 1
    v_permlane16_swap_b32 v112, v113
    v_exp_f32 v116, -v112
    v_sub_f32 v72, v72, v112
    v_sub_f32 v88, v88, v112
    v_sub_f32 v73, v73, v112
    v_sub_f32 v89, v89, v112
    v_sub_f32 v74, v74, v112
    v_sub_f32 v90, v90, v112
    v_sub_f32 v75, v75, v112
    v_sub_f32 v91, v91, v112
    v_sub_f32 v80, v80, v112
    v_sub_f32 v96, v96, v112
    v_sub_f32 v81, v81, v112
    v_sub_f32 v97, v97, v112
    v_sub_f32 v82, v82, v112
    v_sub_f32 v98, v98, v112
    v_sub_f32 v83, v83, v112
    v_sub_f32 v99, v99, v112
    v_sub_f32 v104, v104, v112
    v_sub_f32 v105, v105, v112
    v_sub_f32 v106, v106, v112
    v_sub_f32 v107, v107, v112
    v_mul_f32 v17, v17, v116
    v_mul_f32 v128, v128, v116
    v_mul_f32 v129, v129, v116
    v_mul_f32 v130, v130, v116
    v_mul_f32 v131, v131, v116
    v_mul_f32 v136, v136, v116
    v_mul_f32 v137, v137, v116
    v_mul_f32 v138, v138, v116
    v_mul_f32 v139, v139, v116
    v_mul_f32 v144, v144, v116
    v_mul_f32 v145, v145, v116
    v_mul_f32 v146, v146, v116
    v_mul_f32 v147, v147, v116
    v_mul_f32 v152, v152, v116
    v_mul_f32 v153, v153, v116
    v_mul_f32 v154, v154, v116
    v_mul_f32 v155, v155, v116
    v_mul_f32 v160, v160, v116
    v_mul_f32 v161, v161, v116
    v_mul_f32 v162, v162, v116
    v_mul_f32 v163, v163, v116
    v_mul_f32 v168, v168, v116
    v_mul_f32 v169, v169, v116
    v_mul_f32 v170, v170, v116
    v_mul_f32 v171, v171, v116
    v_mul_f32 v176, v176, v116
    v_mul_f32 v177, v177, v116
    v_mul_f32 v178, v178, v116
    v_mul_f32 v179, v179, v116
    v_mul_f32 v184, v184, v116
    v_mul_f32 v185, v185, v116
    v_mul_f32 v186, v186, v116
    v_mul_f32 v187, v187, v116
    v_exp_f32 v117, -v113
    v_sub_f32 v76, v76, v113
    v_sub_f32 v92, v92, v113
    v_sub_f32 v77, v77, v113
    v_sub_f32 v93, v93, v113
    v_sub_f32 v78, v78, v113
    v_sub_f32 v94, v94, v113
    v_sub_f32 v79, v79, v113
    v_sub_f32 v95, v95, v113
    v_sub_f32 v84, v84, v113
    v_sub_f32 v100, v100, v113
    v_sub_f32 v85, v85, v113
    v_sub_f32 v101, v101, v113
    v_sub_f32 v86, v86, v113
    v_sub_f32 v102, v102, v113
    v_sub_f32 v87, v87, v113
    v_sub_f32 v103, v103, v113
    v_sub_f32 v108, v108, v113
    v_sub_f32 v109, v109, v113
    v_sub_f32 v110, v110, v113
    v_sub_f32 v111, v111, v113
    v_mul_f32 v18, v18, v117
    v_mul_f32 v132, v132, v117
    v_mul_f32 v133, v133, v117
    v_mul_f32 v134, v134, v117
    v_mul_f32 v135, v135, v117
    v_mul_f32 v140, v140, v117
    v_mul_f32 v141, v141, v117
    v_mul_f32 v142, v142, v117
    v_mul_f32 v143, v143, v117
    v_mul_f32 v148, v148, v117
    v_mul_f32 v149, v149, v117
    v_mul_f32 v150, v150, v117
    v_mul_f32 v151, v151, v117
    v_mul_f32 v156, v156, v117
    v_mul_f32 v157, v157, v117
    v_mul_f32 v158, v158, v117
    v_mul_f32 v159, v159, v117
    v_mul_f32 v164, v164, v117
    v_mul_f32 v165, v165, v117
    v_mul_f32 v166, v166, v117
    v_mul_f32 v167, v167, v117
    v_mul_f32 v172, v172, v117
    v_mul_f32 v173, v173, v117
    v_mul_f32 v174, v174, v117
    v_mul_f32 v175, v175, v117
    v_mul_f32 v180, v180, v117
    v_mul_f32 v181, v181, v117
    v_mul_f32 v182, v182, v117
    v_mul_f32 v183, v183, v117
    v_mul_f32 v188, v188, v117
    v_mul_f32 v189, v189, v117
    v_mul_f32 v190, v190, v117
    v_mul_f32 v191, v191, v117
    v_exp_f32 v112, v72
    s_nop 0
    v_exp_f32 v113, v73
    s_nop 0
    v_add_f32 v19, v112, v113
    v_cvt_pk_bf16_f32 v56, v112, v113
    v_exp_f32 v114, v74
    s_nop 0
    v_add_f32 v19, v19, v114
    v_exp_f32 v115, v75
    s_nop 0
    v_add_f32 v19, v19, v115
    v_cvt_pk_bf16_f32 v57, v114, v115
    v_exp_f32 v116, v80
    s_nop 0
    v_add_f32 v19, v19, v116
    v_exp_f32 v117, v81
    s_nop 0
    v_add_f32 v19, v19, v117
    v_cvt_pk_bf16_f32 v58, v116, v117
    v_exp_f32 v118, v82
    s_nop 0
    v_add_f32 v19, v19, v118
    v_exp_f32 v119, v83
    s_nop 0
    v_add_f32 v19, v19, v119
    v_cvt_pk_bf16_f32 v59, v118, v119
    v_exp_f32 v112, v76
    s_nop 0
    v_exp_f32 v113, v77
    s_nop 0
    v_add_f32 v20, v112, v113
    v_cvt_pk_bf16_f32 v60, v112, v113
    v_exp_f32 v114, v78
    s_nop 0
    v_add_f32 v20, v20, v114
    v_exp_f32 v115, v79
    s_nop 0
    v_add_f32 v20, v20, v115
    v_cvt_pk_bf16_f32 v61, v114, v115
    v_exp_f32 v116, v84
    s_nop 0
    v_add_f32 v20, v20, v116
    v_exp_f32 v117, v85
    s_nop 0
    v_add_f32 v20, v20, v117
    v_cvt_pk_bf16_f32 v62, v116, v117
    v_exp_f32 v118, v86
    s_nop 0
    v_add_f32 v20, v20, v118
    v_exp_f32 v119, v87
    s_nop 0
    v_add_f32 v20, v20, v119
    v_cvt_pk_bf16_f32 v63, v118, v119
    s_nop 1
    s_branch RBSb_R
RBE1a:
    s_nop 12
    v_max3_f32 v112, v88, v89, v90
    v_max3_f32 v112, v112, v91, v96
    v_max3_f32 v112, v112, v97, v98
    v_max3_f32 v112, v112, v99, 0
    v_max3_f32 v113, v92, v93, v94
    v_max3_f32 v113, v113, v95, v100
    v_max3_f32 v113, v113, v101, v102
    v_max3_f32 v113, v113, v103, 0
    s_nop 1
    v_permlane16_swap_b32 v112, v113
    v_max_f32 v112, v112, v113
    v_mov_b32 v114, v112
    s_nop 1
    v_permlane32_swap_b32 v112, v114
    v_max_f32 v112, v112, v114
    v_mov_b32 v113, v112
    s_nop 1
    v_permlane16_swap_b32 v112, v113
    v_exp_f32 v116, -v112
    v_sub_f32 v88, v88, v112
    v_sub_f32 v72, v72, v112
    v_sub_f32 v89, v89, v112
    v_sub_f32 v73, v73, v112
    v_sub_f32 v90, v90, v112
    v_sub_f32 v74, v74, v112
    v_sub_f32 v91, v91, v112
    v_sub_f32 v75, v75, v112
    v_sub_f32 v96, v96, v112
    v_sub_f32 v80, v80, v112
    v_sub_f32 v97, v97, v112
    v_sub_f32 v81, v81, v112
    v_sub_f32 v98, v98, v112
    v_sub_f32 v82, v82, v112
    v_sub_f32 v99, v99, v112
    v_sub_f32 v83, v83, v112
    v_sub_f32 v104, v104, v112
    v_sub_f32 v105, v105, v112
    v_sub_f32 v106, v106, v112
    v_sub_f32 v107, v107, v112
    v_mul_f32 v17, v17, v116
    v_mul_f32 v128, v128, v116
    v_mul_f32 v129, v129, v116
    v_mul_f32 v130, v130, v116
    v_mul_f32 v131, v131, v116
    v_mul_f32 v136, v136, v116
    v_mul_f32 v137, v137, v116
    v_mul_f32 v138, v138, v116
    v_mul_f32 v139, v139, v116
    v_mul_f32 v144, v144, v116
    v_mul_f32 v145, v145, v116
    v_mul_f32 v146, v146, v116
    v_mul_f32 v147, v147, v116
    v_mul_f32 v152, v152, v116
    v_mul_f32 v153, v153, v116
    v_mul_f32 v154, v154, v116
    v_mul_f32 v155, v155, v116
    v_mul_f32 v160, v160, v116
    v_mul_f32 v161, v161, v116
    v_mul_f32 v162, v162, v116
    v_mul_f32 v163, v163, v116
    v_mul_f32 v168, v168, v116
    v_mul_f32 v169, v169, v116
    v_mul_f32 v170, v170, v116
    v_mul_f32 v171, v171, v116
    v_mul_f32 v176, v176, v116
    v_mul_f32 v177, v177, v116
    v_mul_f32 v178, v178, v116
    v_mul_f32 v179, v179, v116
    v_mul_f32 v184, v184, v116
    v_mul_f32 v185, v185, v116
    v_mul_f32 v186, v186, v116
    v_mul_f32 v187, v187, v116
    v_exp_f32 v117, -v113
    v_sub_f32 v92, v92, v113
    v_sub_f32 v76, v76, v113
    v_sub_f32 v93, v93, v113
    v_sub_f32 v77, v77, v113
    v_sub_f32 v94, v94, v113
    v_sub_f32 v78, v78, v113
    v_sub_f32 v95, v95, v113
    v_sub_f32 v79, v79, v113
    v_sub_f32 v100, v100, v113
    v_sub_f32 v84, v84, v113
    v_sub_f32 v101, v101, v113
    v_sub_f32 v85, v85, v113
    v_sub_f32 v102, v102, v113
    v_sub_f32 v86, v86, v113
    v_sub_f32 v103, v103, v113
    v_sub_f32 v87, v87, v113
    v_sub_f32 v108, v108, v113
    v_sub_f32 v109, v109, v113
    v_sub_f32 v110, v110, v113
    v_sub_f32 v111, v111, v113
    v_mul_f32 v18, v18, v117
    v_mul_f32 v132, v132, v117
    v_mul_f32 v133, v133, v117
    v_mul_f32 v134, v134, v117
    v_mul_f32 v135, v135, v117
    v_mul_f32 v140, v140, v117
    v_mul_f32 v141, v141, v117
    v_mul_f32 v142, v142, v117
    v_mul_f32 v143, v143, v117
    v_mul_f32 v148, v148, v117
    v_mul_f32 v149, v149, v117
    v_mul_f32 v150, v150, v117
    v_mul_f32 v151, v151, v117
    v_mul_f32 v156, v156, v117
    v_mul_f32 v157, v157, v117
    v_mul_f32 v158, v158, v117
    v_mul_f32 v159, v159, v117
    v_mul_f32 v164, v164, v117
    v_mul_f32 v165, v165, v117
    v_mul_f32 v166, v166, v117
    v_mul_f32 v167, v167, v117
    v_mul_f32 v172, v172, v117
    v_mul_f32 v173, v173, v117
    v_mul_f32 v174, v174, v117
    v_mul_f32 v175, v175, v117
    v_mul_f32 v180, v180, v117
    v_mul_f32 v181, v181, v117
    v_mul_f32 v182, v182, v117
    v_mul_f32 v183, v183, v117
    v_mul_f32 v188, v188, v117
    v_mul_f32 v189, v189, v117
    v_mul_f32 v190, v190, v117
    v_mul_f32 v191, v191, v117
    v_exp_f32 v112, v88
    s_nop 0
    v_exp_f32 v113, v89
    s_nop 0
    v_add_f32 v19, v112, v113
    v_cvt_pk_bf16_f32 v64, v112, v113
    v_exp_f32 v114, v90
    s_nop 0
    v_add_f32 v19, v19, v114
    v_exp_f32 v115, v91
    s_nop 0
    v_add_f32 v19, v19, v115
    v_cvt_pk_bf16_f32 v65, v114, v115
    v_exp_f32 v116, v96
    s_nop 0
    v_add_f32 v19, v19, v116
    v_exp_f32 v117, v97
    s_nop 0
    v_add_f32 v19, v19, v117
    v_cvt_pk_bf16_f32 v66, v116, v117
    v_exp_f32 v118, v98
    s_nop 0
    v_add_f32 v19, v19, v118
    v_exp_f32 v119, v99
    s_nop 0
    v_add_f32 v19, v19, v119
    v_cvt_pk_bf16_f32 v67, v118, v119
    v_exp_f32 v112, v92
    s_nop 0
    v_exp_f32 v113, v93
    s_nop 0
    v_add_f32 v20, v112, v113
    v_cvt_pk_bf16_f32 v68, v112, v113
    v_exp_f32 v114, v94
    s_nop 0
    v_add_f32 v20, v20, v114
    v_exp_f32 v115, v95
    s_nop 0
    v_add_f32 v20, v20, v115
    v_cvt_pk_bf16_f32 v69, v114, v115
    v_exp_f32 v116, v100
    s_nop 0
    v_add_f32 v20, v20, v116
    v_exp_f32 v117, v101
    s_nop 0
    v_add_f32 v20, v20, v117
    v_cvt_pk_bf16_f32 v70, v116, v117
    v_exp_f32 v118, v102
    s_nop 0
    v_add_f32 v20, v20, v118
    v_exp_f32 v119, v103
    s_nop 0
    v_add_f32 v20, v20, v119
    v_cvt_pk_bf16_f32 v71, v118, v119
    s_nop 1
    s_branch RBE1a_R
RBE1b:
    s_nop 12
    v_max3_f32 v112, v72, v73, v74
    v_max3_f32 v112, v112, v75, v80
    v_max3_f32 v112, v112, v81, v82
    v_max3_f32 v112, v112, v83, 0
    v_max3_f32 v113, v76, v77, v78
    v_max3_f32 v113, v113, v79, v84
    v_max3_f32 v113, v113, v85, v86
    v_max3_f32 v113, v113, v87, 0
    s_nop 1
    v_permlane16_swap_b32 v112, v113
    v_max_f32 v112, v112, v113
    v_mov_b32 v114, v112
    s_nop 1
    v_permlane32_swap_b32 v112, v114
    v_max_f32 v112, v112, v114
    v_mov_b32 v113, v112
    s_nop 1
    v_permlane16_swap_b32 v112, v113
    v_exp_f32 v116, -v112
    v_sub_f32 v72, v72, v112
    v_sub_f32 v88, v88, v112
    v_sub_f32 v73, v73, v112
    v_sub_f32 v89, v89, v112
    v_sub_f32 v74, v74, v112
    v_sub_f32 v90, v90, v112
    v_sub_f32 v75, v75, v112
    v_sub_f32 v91, v91, v112
    v_sub_f32 v80, v80, v112
    v_sub_f32 v96, v96, v112
    v_sub_f32 v81, v81, v112
    v_sub_f32 v97, v97, v112
    v_sub_f32 v82, v82, v112
    v_sub_f32 v98, v98, v112
    v_sub_f32 v83, v83, v112
    v_sub_f32 v99, v99, v112
    v_sub_f32 v104, v104, v112
    v_sub_f32 v105, v105, v112
    v_sub_f32 v106, v106, v112
    v_sub_f32 v107, v107, v112
    v_mul_f32 v17, v17, v116
    v_mul_f32 v128, v128, v116
    v_mul_f32 v129, v129, v116
    v_mul_f32 v130, v130, v116
    v_mul_f32 v131, v131, v116
    v_mul_f32 v136, v136, v116
    v_mul_f32 v137, v137, v116
    v_mul_f32 v138, v138, v116
    v_mul_f32 v139, v139, v116
    v_mul_f32 v144, v144, v116
    v_mul_f32 v145, v145, v116
    v_mul_f32 v146, v146, v116
    v_mul_f32 v147, v147, v116
    v_mul_f32 v152, v152, v116
    v_mul_f32 v153, v153, v116
    v_mul_f32 v154, v154, v116
    v_mul_f32 v155, v155, v116
    v_mul_f32 v160, v160, v116
    v_mul_f32 v161, v161, v116
    v_mul_f32 v162, v162, v116
    v_mul_f32 v163, v163, v116
    v_mul_f32 v168, v168, v116
    v_mul_f32 v169, v169, v116
    v_mul_f32 v170, v170, v116
    v_mul_f32 v171, v171, v116
    v_mul_f32 v176, v176, v116
    v_mul_f32 v177, v177, v116
    v_mul_f32 v178, v178, v116
    v_mul_f32 v179, v179, v116
    v_mul_f32 v184, v184, v116
    v_mul_f32 v185, v185, v116
    v_mul_f32 v186, v186, v116
    v_mul_f32 v187, v187, v116
    v_exp_f32 v117, -v113
    v_sub_f32 v76, v76, v113
    v_sub_f32 v92, v92, v113
    v_sub_f32 v77, v77, v113
    v_sub_f32 v93, v93, v113
    v_sub_f32 v78, v78, v113
    v_sub_f32 v94, v94, v113
    v_sub_f32 v79, v79, v113
    v_sub_f32 v95, v95, v113
    v_sub_f32 v84, v84, v113
    v_sub_f32 v100, v100, v113
    v_sub_f32 v85, v85, v113
    v_sub_f32 v101, v101, v113
    v_sub_f32 v86, v86, v113
    v_sub_f32 v102, v102, v113
    v_sub_f32 v87, v87, v113
    v_sub_f32 v103, v103, v113
    v_sub_f32 v108, v108, v113
    v_sub_f32 v109, v109, v113
    v_sub_f32 v110, v110, v113
    v_sub_f32 v111, v111, v113
    v_mul_f32 v18, v18, v117
    v_mul_f32 v132, v132, v117
    v_mul_f32 v133, v133, v117
    v_mul_f32 v134, v134, v117
    v_mul_f32 v135, v135, v117
    v_mul_f32 v140, v140, v117
    v_mul_f32 v141, v141, v117
    v_mul_f32 v142, v142, v117
    v_mul_f32 v143, v143, v117
    v_mul_f32 v148, v148, v117
    v_mul_f32 v149, v149, v117
    v_mul_f32 v150, v150, v117
    v_mul_f32 v151, v151, v117
    v_mul_f32 v156, v156, v117
    v_mul_f32 v157, v157, v117
    v_mul_f32 v158, v158, v117
    v_mul_f32 v159, v159, v117
    v_mul_f32 v164, v164, v117
    v_mul_f32 v165, v165, v117
    v_mul_f32 v166, v166, v117
    v_mul_f32 v167, v167, v117
    v_mul_f32 v172, v172, v117
    v_mul_f32 v173, v173, v117
    v_mul_f32 v174, v174, v117
    v_mul_f32 v175, v175, v117
    v_mul_f32 v180, v180, v117
    v_mul_f32 v181, v181, v117
    v_mul_f32 v182, v182, v117
    v_mul_f32 v183, v183, v117
    v_mul_f32 v188, v188, v117
    v_mul_f32 v189, v189, v117
    v_mul_f32 v190, v190, v117
    v_mul_f32 v191, v191, v117
    v_exp_f32 v112, v72
    s_nop 0
    v_exp_f32 v113, v73
    s_nop 0
    v_add_f32 v19, v112, v113
    v_cvt_pk_bf16_f32 v56, v112, v113
    v_exp_f32 v114, v74
    s_nop 0
    v_add_f32 v19, v19, v114
    v_exp_f32 v115, v75
    s_nop 0
    v_add_f32 v19, v19, v115
    v_cvt_pk_bf16_f32 v57, v114, v115
    v_exp_f32 v116, v80
    s_nop 0
    v_add_f32 v19, v19, v116
    v_exp_f32 v117, v81
    s_nop 0
    v_add_f32 v19, v19, v117
    v_cvt_pk_bf16_f32 v58, v116, v117
    v_exp_f32 v118, v82
    s_nop 0
    v_add_f32 v19, v19, v118
    v_exp_f32 v119, v83
    s_nop 0
    v_add_f32 v19, v19, v119
    v_cvt_pk_bf16_f32 v59, v118, v119
    v_exp_f32 v112, v76
    s_nop 0
    v_exp_f32 v113, v77
    s_nop 0
    v_add_f32 v20, v112, v113
    v_cvt_pk_bf16_f32 v60, v112, v113
    v_exp_f32 v114, v78
    s_nop 0
    v_add_f32 v20, v20, v114
    v_exp_f32 v115, v79
    s_nop 0
    v_add_f32 v20, v20, v115
    v_cvt_pk_bf16_f32 v61, v114, v115
    v_exp_f32 v116, v84
    s_nop 0
    v_add_f32 v20, v20, v116
    v_exp_f32 v117, v85
    s_nop 0
    v_add_f32 v20, v20, v117
    v_cvt_pk_bf16_f32 v62, v116, v117
    v_exp_f32 v118, v86
    s_nop 0
    v_add_f32 v20, v20, v118
    v_exp_f32 v119, v87
    s_nop 0
    v_add_f32 v20, v20, v119
    v_cvt_pk_bf16_f32 v63, v118, v119
    s_nop 1
    s_branch RBE1b_R
RBS1a:
    s_nop 12
    v_max3_f32 v112, v88, v89, v90
    v_max3_f32 v112, v112, v91, v96
    v_max3_f32 v112, v112, v97, v98
    v_max3_f32 v112, v112, v99, 0
    v_max3_f32 v113, v92, v93, v94
    v_max3_f32 v113, v113, v95, v100
    v_max3_f32 v113, v113, v101, v102
    v_max3_f32 v113, v113, v103, 0
    s_nop 1
    v_permlane16_swap_b32 v112, v113
    v_max_f32 v112, v112, v113
    v_mov_b32 v114, v112
    s_nop 1
    v_permlane32_swap_b32 v112, v114
    v_max_f32 v112, v112, v114
    v_mov_b32 v113, v112
    s_nop 1
    v_permlane16_swap_b32 v112, v113
    v_exp_f32 v116, -v112
    v_sub_f32 v88, v88, v112
    v_sub_f32 v72, v72, v112
    v_sub_f32 v89, v89, v112
    v_sub_f32 v73, v73, v112
    v_sub_f32 v90, v90, v112
    v_sub_f32 v74, v74, v112
    v_sub_f32 v91, v91, v112
    v_sub_f32 v75, v75, v112
    v_sub_f32 v96, v96, v112
    v_sub_f32 v80, v80, v112
    v_sub_f32 v97, v97, v112
    v_sub_f32 v81, v81, v112
    v_sub_f32 v98, v98, v112
    v_sub_f32 v82, v82, v112
    v_sub_f32 v99, v99, v112
    v_sub_f32 v83, v83, v112
    v_sub_f32 v104, v104, v112
    v_sub_f32 v105, v105, v112
    v_sub_f32 v106, v106, v112
    v_sub_f32 v107, v107, v112
    v_mul_f32 v17, v17, v116
    v_mul_f32 v128, v128, v116
    v_mul_f32 v129, v129, v116
    v_mul_f32 v130, v130, v116
    v_mul_f32 v131, v131, v116
    v_mul_f32 v136, v136, v116
    v_mul_f32 v137, v137, v116
    v_mul_f32 v138, v138, v116
    v_mul_f32 v139, v139, v116
    v_mul_f32 v144, v144, v116
    v_mul_f32 v145, v145, v116
    v_mul_f32 v146, v146, v116
    v_mul_f32 v147, v147, v116
    v_mul_f32 v152, v152, v116
    v_mul_f32 v153, v153, v116
    v_mul_f32 v154, v154, v116
    v_mul_f32 v155, v155, v116
    v_mul_f32 v160, v160, v116
    v_mul_f32 v161, v161, v116
    v_mul_f32 v162, v162, v116
    v_mul_f32 v163, v163, v116
    v_mul_f32 v168, v168, v116
    v_mul_f32 v169, v169, v116
    v_mul_f32 v170, v170, v116
    v_mul_f32 v171, v171, v116
    v_mul_f32 v176, v176, v116
    v_mul_f32 v177, v177, v116
    v_mul_f32 v178, v178, v116
    v_mul_f32 v179, v179, v116
    v_mul_f32 v184, v184, v116
    v_mul_f32 v185, v185, v116
    v_mul_f32 v186, v186, v116
    v_mul_f32 v187, v187, v116
    v_exp_f32 v117, -v113
    v_sub_f32 v92, v92, v113
    v_sub_f32 v76, v76, v113
    v_sub_f32 v93, v93, v113
    v_sub_f32 v77, v77, v113
    v_sub_f32 v94, v94, v113
    v_sub_f32 v78, v78, v113
    v_sub_f32 v95, v95, v113
    v_sub_f32 v79, v79, v113
    v_sub_f32 v100, v100, v113
    v_sub_f32 v84, v84, v113
    v_sub_f32 v101, v101, v113
    v_sub_f32 v85, v85, v113
    v_sub_f32 v102, v102, v113
    v_sub_f32 v86, v86, v113
    v_sub_f32 v103, v103, v113
    v_sub_f32 v87, v87, v113
    v_sub_f32 v108, v108, v113
    v_sub_f32 v109, v109, v113
    v_sub_f32 v110, v110, v113
    v_sub_f32 v111, v111, v113
    v_mul_f32 v18, v18, v117
    v_mul_f32 v132, v132, v117
    v_mul_f32 v133, v133, v117
    v_mul_f32 v134, v134, v117
    v_mul_f32 v135, v135, v117
    v_mul_f32 v140, v140, v117
    v_mul_f32 v141, v141, v117
    v_mul_f32 v142, v142, v117
    v_mul_f32 v143, v143, v117
    v_mul_f32 v148, v148, v117
    v_mul_f32 v149, v149, v117
    v_mul_f32 v150, v150, v117
    v_mul_f32 v151, v151, v117
    v_mul_f32 v156, v156, v117
    v_mul_f32 v157, v157, v117
    v_mul_f32 v158, v158, v117
    v_mul_f32 v159, v159, v117
    v_mul_f32 v164, v164, v117
    v_mul_f32 v165, v165, v117
    v_mul_f32 v166, v166, v117
    v_mul_f32 v167, v167, v117
    v_mul_f32 v172, v172, v117
    v_mul_f32 v173, v173, v117
    v_mul_f32 v174, v174, v117
    v_mul_f32 v175, v175, v117
    v_mul_f32 v180, v180, v117
    v_mul_f32 v181, v181, v117
    v_mul_f32 v182, v182, v117
    v_mul_f32 v183, v183, v117
    v_mul_f32 v188, v188, v117
    v_mul_f32 v189, v189, v117
    v_mul_f32 v190, v190, v117
    v_mul_f32 v191, v191, v117
    v_exp_f32 v112, v88
    s_nop 0
    v_exp_f32 v113, v89
    s_nop 0
    v_add_f32 v19, v112, v113
    v_cvt_pk_bf16_f32 v64, v112, v113
    v_exp_f32 v114, v90
    s_nop 0
    v_add_f32 v19, v19, v114
    v_exp_f32 v115, v91
    s_nop 0
    v_add_f32 v19, v19, v115
    v_cvt_pk_bf16_f32 v65, v114, v115
    v_exp_f32 v116, v96
    s_nop 0
    v_add_f32 v19, v19, v116
    v_exp_f32 v117, v97
    s_nop 0
    v_add_f32 v19, v19, v117
    v_cvt_pk_bf16_f32 v66, v116, v117
    v_exp_f32 v118, v98
    s_nop 0
    v_add_f32 v19, v19, v118
    v_exp_f32 v119, v99
    s_nop 0
    v_add_f32 v19, v19, v119
    v_cvt_pk_bf16_f32 v67, v118, v119
    v_exp_f32 v112, v92
    s_nop 0
    v_exp_f32 v113, v93
    s_nop 0
    v_add_f32 v20, v112, v113
    v_cvt_pk_bf16_f32 v68, v112, v113
    v_exp_f32 v114, v94
    s_nop 0
    v_add_f32 v20, v20, v114
    v_exp_f32 v115, v95
    s_nop 0
    v_add_f32 v20, v20, v115
    v_cvt_pk_bf16_f32 v69, v114, v115
    v_exp_f32 v116, v100
    s_nop 0
    v_add_f32 v20, v20, v116
    v_exp_f32 v117, v101
    s_nop 0
    v_add_f32 v20, v20, v117
    v_cvt_pk_bf16_f32 v70, v116, v117
    v_exp_f32 v118, v102
    s_nop 0
    v_add_f32 v20, v20, v118
    v_exp_f32 v119, v103
    s_nop 0
    v_add_f32 v20, v20, v119
    v_cvt_pk_bf16_f32 v71, v118, v119
    s_nop 1
    s_branch RBS1a_R
RBS1b:
    s_nop 12
    v_max3_f32 v112, v72, v73, v74
    v_max3_f32 v112, v112, v75, v80
    v_max3_f32 v112, v112, v81, v82
    v_max3_f32 v112, v112, v83, 0
    v_max3_f32 v113, v76, v77, v78
    v_max3_f32 v113, v113, v79, v84
    v_max3_f32 v113, v113, v85, v86
    v_max3_f32 v113, v113, v87, 0
    s_nop 1
    v_permlane16_swap_b32 v112, v113
    v_max_f32 v112, v112, v113
    v_mov_b32 v114, v112
    s_nop 1
    v_permlane32_swap_b32 v112, v114
    v_max_f32 v112, v112, v114
    v_mov_b32 v113, v112
    s_nop 1
    v_permlane16_swap_b32 v112, v113
    v_exp_f32 v116, -v112
    v_sub_f32 v72, v72, v112
    v_sub_f32 v88, v88, v112
    v_sub_f32 v73, v73, v112
    v_sub_f32 v89, v89, v112
    v_sub_f32 v74, v74, v112
    v_sub_f32 v90, v90, v112
    v_sub_f32 v75, v75, v112
    v_sub_f32 v91, v91, v112
    v_sub_f32 v80, v80, v112
    v_sub_f32 v96, v96, v112
    v_sub_f32 v81, v81, v112
    v_sub_f32 v97, v97, v112
    v_sub_f32 v82, v82, v112
    v_sub_f32 v98, v98, v112
    v_sub_f32 v83, v83, v112
    v_sub_f32 v99, v99, v112
    v_sub_f32 v104, v104, v112
    v_sub_f32 v105, v105, v112
    v_sub_f32 v106, v106, v112
    v_sub_f32 v107, v107, v112
    v_mul_f32 v17, v17, v116
    v_mul_f32 v128, v128, v116
    v_mul_f32 v129, v129, v116
    v_mul_f32 v130, v130, v116
    v_mul_f32 v131, v131, v116
    v_mul_f32 v136, v136, v116
    v_mul_f32 v137, v137, v116
    v_mul_f32 v138, v138, v116
    v_mul_f32 v139, v139, v116
    v_mul_f32 v144, v144, v116
    v_mul_f32 v145, v145, v116
    v_mul_f32 v146, v146, v116
    v_mul_f32 v147, v147, v116
    v_mul_f32 v152, v152, v116
    v_mul_f32 v153, v153, v116
    v_mul_f32 v154, v154, v116
    v_mul_f32 v155, v155, v116
    v_mul_f32 v160, v160, v116
    v_mul_f32 v161, v161, v116
    v_mul_f32 v162, v162, v116
    v_mul_f32 v163, v163, v116
    v_mul_f32 v168, v168, v116
    v_mul_f32 v169, v169, v116
    v_mul_f32 v170, v170, v116
    v_mul_f32 v171, v171, v116
    v_mul_f32 v176, v176, v116
    v_mul_f32 v177, v177, v116
    v_mul_f32 v178, v178, v116
    v_mul_f32 v179, v179, v116
    v_mul_f32 v184, v184, v116
    v_mul_f32 v185, v185, v116
    v_mul_f32 v186, v186, v116
    v_mul_f32 v187, v187, v116
    v_exp_f32 v117, -v113
    v_sub_f32 v76, v76, v113
    v_sub_f32 v92, v92, v113
    v_sub_f32 v77, v77, v113
    v_sub_f32 v93, v93, v113
    v_sub_f32 v78, v78, v113
    v_sub_f32 v94, v94, v113
    v_sub_f32 v79, v79, v113
    v_sub_f32 v95, v95, v113
    v_sub_f32 v84, v84, v113
    v_sub_f32 v100, v100, v113
    v_sub_f32 v85, v85, v113
    v_sub_f32 v101, v101, v113
    v_sub_f32 v86, v86, v113
    v_sub_f32 v102, v102, v113
    v_sub_f32 v87, v87, v113
    v_sub_f32 v103, v103, v113
    v_sub_f32 v108, v108, v113
    v_sub_f32 v109, v109, v113
    v_sub_f32 v110, v110, v113
    v_sub_f32 v111, v111, v113
    v_mul_f32 v18, v18, v117
    v_mul_f32 v132, v132, v117
    v_mul_f32 v133, v133, v117
    v_mul_f32 v134, v134, v117
    v_mul_f32 v135, v135, v117
    v_mul_f32 v140, v140, v117
    v_mul_f32 v141, v141, v117
    v_mul_f32 v142, v142, v117
    v_mul_f32 v143, v143, v117
    v_mul_f32 v148, v148, v117
    v_mul_f32 v149, v149, v117
    v_mul_f32 v150, v150, v117
    v_mul_f32 v151, v151, v117
    v_mul_f32 v156, v156, v117
    v_mul_f32 v157, v157, v117
    v_mul_f32 v158, v158, v117
    v_mul_f32 v159, v159, v117
    v_mul_f32 v164, v164, v117
    v_mul_f32 v165, v165, v117
    v_mul_f32 v166, v166, v117
    v_mul_f32 v167, v167, v117
    v_mul_f32 v172, v172, v117
    v_mul_f32 v173, v173, v117
    v_mul_f32 v174, v174, v117
    v_mul_f32 v175, v175, v117
    v_mul_f32 v180, v180, v117
    v_mul_f32 v181, v181, v117
    v_mul_f32 v182, v182, v117
    v_mul_f32 v183, v183, v117
    v_mul_f32 v188, v188, v117
    v_mul_f32 v189, v189, v117
    v_mul_f32 v190, v190, v117
    v_mul_f32 v191, v191, v117
    v_exp_f32 v112, v72
    s_nop 0
    v_exp_f32 v113, v73
    s_nop 0
    v_add_f32 v19, v112, v113
    v_cvt_pk_bf16_f32 v56, v112, v113
    v_exp_f32 v114, v74
    s_nop 0
    v_add_f32 v19, v19, v114
    v_exp_f32 v115, v75
    s_nop 0
    v_add_f32 v19, v19, v115
    v_cvt_pk_bf16_f32 v57, v114, v115
    v_exp_f32 v116, v80
    s_nop 0
    v_add_f32 v19, v19, v116
    v_exp_f32 v117, v81
    s_nop 0
    v_add_f32 v19, v19, v117
    v_cvt_pk_bf16_f32 v58, v116, v117
    v_exp_f32 v118, v82
    s_nop 0
    v_add_f32 v19, v19, v118
    v_exp_f32 v119, v83
    s_nop 0
    v_add_f32 v19, v19, v119
    v_cvt_pk_bf16_f32 v59, v118, v119
    v_exp_f32 v112, v76
    s_nop 0
    v_exp_f32 v113, v77
    s_nop 0
    v_add_f32 v20, v112, v113
    v_cvt_pk_bf16_f32 v60, v112, v113
    v_exp_f32 v114, v78
    s_nop 0
    v_add_f32 v20, v20, v114
    v_exp_f32 v115, v79
    s_nop 0
    v_add_f32 v20, v20, v115
    v_cvt_pk_bf16_f32 v61, v114, v115
    v_exp_f32 v116, v84
    s_nop 0
    v_add_f32 v20, v20, v116
    v_exp_f32 v117, v85
    s_nop 0
    v_add_f32 v20, v20, v117
    v_cvt_pk_bf16_f32 v62, v116, v117
    v_exp_f32 v118, v86
    s_nop 0
    v_add_f32 v20, v20, v118
    v_exp_f32 v119, v87
    s_nop 0
    v_add_f32 v20, v20, v119
    v_cvt_pk_bf16_f32 v63, v118, v119
    s_nop 1
    s_branch RBS1b_R
RBS2a:
    s_nop 12
    v_max3_f32 v112, v88, v89, v90
    v_max3_f32 v112, v112, v91, v96
    v_max3_f32 v112, v112, v97, v98
    v_max3_f32 v112, v112, v99, 0
    v_max3_f32 v113, v92, v93, v94
    v_max3_f32 v113, v113, v95, v100
    v_max3_f32 v113, v113, v101, v102
    v_max3_f32 v113, v113, v103, 0
    s_nop 1
    v_permlane16_swap_b32 v112, v113
    v_max_f32 v112, v112, v113
    v_mov_b32 v114, v112
    s_nop 1
    v_permlane32_swap_b32 v112, v114
    v_max_f32 v112, v112, v114
    v_mov_b32 v113, v112
    s_nop 1
    v_permlane16_swap_b32 v112, v113
    v_exp_f32 v116, -v112
    v_sub_f32 v88, v88, v112
    v_sub_f32 v72, v72, v112
    v_sub_f32 v89, v89, v112
    v_sub_f32 v73, v73, v112
    v_sub_f32 v90, v90, v112
    v_sub_f32 v74, v74, v112
    v_sub_f32 v91, v91, v112
    v_sub_f32 v75, v75, v112
    v_sub_f32 v96, v96, v112
    v_sub_f32 v80, v80, v112
    v_sub_f32 v97, v97, v112
    v_sub_f32 v81, v81, v112
    v_sub_f32 v98, v98, v112
    v_sub_f32 v82, v82, v112
    v_sub_f32 v99, v99, v112
    v_sub_f32 v83, v83, v112
    v_sub_f32 v104, v104, v112
    v_sub_f32 v105, v105, v112
    v_sub_f32 v106, v106, v112
    v_sub_f32 v107, v107, v112
    v_mul_f32 v17, v17, v116
    v_mul_f32 v128, v128, v116
    v_mul_f32 v129, v129, v116
    v_mul_f32 v130, v130, v116
    v_mul_f32 v131, v131, v116
    v_mul_f32 v136, v136, v116
    v_mul_f32 v137, v137, v116
    v_mul_f32 v138, v138, v116
    v_mul_f32 v139, v139, v116
    v_mul_f32 v144, v144, v116
    v_mul_f32 v145, v145, v116
    v_mul_f32 v146, v146, v116
    v_mul_f32 v147, v147, v116
    v_mul_f32 v152, v152, v116
    v_mul_f32 v153, v153, v116
    v_mul_f32 v154, v154, v116
    v_mul_f32 v155, v155, v116
    v_mul_f32 v160, v160, v116
    v_mul_f32 v161, v161, v116
    v_mul_f32 v162, v162, v116
    v_mul_f32 v163, v163, v116
    v_mul_f32 v168, v168, v116
    v_mul_f32 v169, v169, v116
    v_mul_f32 v170, v170, v116
    v_mul_f32 v171, v171, v116
    v_mul_f32 v176, v176, v116
    v_mul_f32 v177, v177, v116
    v_mul_f32 v178, v178, v116
    v_mul_f32 v179, v179, v116
    v_mul_f32 v184, v184, v116
    v_mul_f32 v185, v185, v116
    v_mul_f32 v186, v186, v116
    v_mul_f32 v187, v187, v116
    v_exp_f32 v117, -v113
    v_sub_f32 v92, v92, v113
    v_sub_f32 v76, v76, v113
    v_sub_f32 v93, v93, v113
    v_sub_f32 v77, v77, v113
    v_sub_f32 v94, v94, v113
    v_sub_f32 v78, v78, v113
    v_sub_f32 v95, v95, v113
    v_sub_f32 v79, v79, v113
    v_sub_f32 v100, v100, v113
    v_sub_f32 v84, v84, v113
    v_sub_f32 v101, v101, v113
    v_sub_f32 v85, v85, v113
    v_sub_f32 v102, v102, v113
    v_sub_f32 v86, v86, v113
    v_sub_f32 v103, v103, v113
    v_sub_f32 v87, v87, v113
    v_sub_f32 v108, v108, v113
    v_sub_f32 v109, v109, v113
    v_sub_f32 v110, v110, v113
    v_sub_f32 v111, v111, v113
    v_mul_f32 v18, v18, v117
    v_mul_f32 v132, v132, v117
    v_mul_f32 v133, v133, v117
    v_mul_f32 v134, v134, v117
    v_mul_f32 v135, v135, v117
    v_mul_f32 v140, v140, v117
    v_mul_f32 v141, v141, v117
    v_mul_f32 v142, v142, v117
    v_mul_f32 v143, v143, v117
    v_mul_f32 v148, v148, v117
    v_mul_f32 v149, v149, v117
    v_mul_f32 v150, v150, v117
    v_mul_f32 v151, v151, v117
    v_mul_f32 v156, v156, v117
    v_mul_f32 v157, v157, v117
    v_mul_f32 v158, v158, v117
    v_mul_f32 v159, v159, v117
    v_mul_f32 v164, v164, v117
    v_mul_f32 v165, v165, v117
    v_mul_f32 v166, v166, v117
    v_mul_f32 v167, v167, v117
    v_mul_f32 v172, v172, v117
    v_mul_f32 v173, v173, v117
    v_mul_f32 v174, v174, v117
    v_mul_f32 v175, v175, v117
    v_mul_f32 v180, v180, v117
    v_mul_f32 v181, v181, v117
    v_mul_f32 v182, v182, v117
    v_mul_f32 v183, v183, v117
    v_mul_f32 v188, v188, v117
    v_mul_f32 v189, v189, v117
    v_mul_f32 v190, v190, v117
    v_mul_f32 v191, v191, v117
    v_exp_f32 v112, v88
    s_nop 0
    v_exp_f32 v113, v89
    s_nop 0
    v_add_f32 v19, v112, v113
    v_cvt_pk_bf16_f32 v64, v112, v113
    v_exp_f32 v114, v90
    s_nop 0
    v_add_f32 v19, v19, v114
    v_exp_f32 v115, v91
    s_nop 0
    v_add_f32 v19, v19, v115
    v_cvt_pk_bf16_f32 v65, v114, v115
    v_exp_f32 v116, v96
    s_nop 0
    v_add_f32 v19, v19, v116
    v_exp_f32 v117, v97
    s_nop 0
    v_add_f32 v19, v19, v117
    v_cvt_pk_bf16_f32 v66, v116, v117
    v_exp_f32 v118, v98
    s_nop 0
    v_add_f32 v19, v19, v118
    v_exp_f32 v119, v99
    s_nop 0
    v_add_f32 v19, v19, v119
    v_cvt_pk_bf16_f32 v67, v118, v119
    v_exp_f32 v112, v92
    s_nop 0
    v_exp_f32 v113, v93
    s_nop 0
    v_add_f32 v20, v112, v113
    v_cvt_pk_bf16_f32 v68, v112, v113
    v_exp_f32 v114, v94
    s_nop 0
    v_add_f32 v20, v20, v114
    v_exp_f32 v115, v95
    s_nop 0
    v_add_f32 v20, v20, v115
    v_cvt_pk_bf16_f32 v69, v114, v115
    v_exp_f32 v116, v100
    s_nop 0
    v_add_f32 v20, v20, v116
    v_exp_f32 v117, v101
    s_nop 0
    v_add_f32 v20, v20, v117
    v_cvt_pk_bf16_f32 v70, v116, v117
    v_exp_f32 v118, v102
    s_nop 0
    v_add_f32 v20, v20, v118
    v_exp_f32 v119, v103
    s_nop 0
    v_add_f32 v20, v20, v119
    v_cvt_pk_bf16_f32 v71, v118, v119
    s_nop 1
    s_branch RBS2a_R
.section .rodata,"a"
.p2align 6
.amdhsa_kernel gated_mix__compressed_kv_cla__linear_kernel_hedgehog__prompt_kernel
  .amdhsa_next_free_vgpr 256
  .amdhsa_next_free_sgpr 102
  .amdhsa_accum_offset 256
  .amdhsa_group_segment_fixed_size 0
  .amdhsa_kernarg_size 112
  .amdhsa_user_sgpr_count 2
  .amdhsa_user_sgpr_kernarg_segment_ptr 1
  .amdhsa_system_sgpr_workgroup_id_x 1
.end_amdhsa_kernel
```
